```python
import torch

def _softmax(x, axis=-1):
    return torch.softmax(x, dim=axis)
def _gelu(x):
    return torch.nn.functional.gelu(x, approximate="tanh")
def _silu(x):
    return torch.nn.functional.silu(x)
def _sigmoid(x):
    return torch.sigmoid(x)
def _layernorm(x, axis=-1, eps=1e-5):
    m = x.mean(dim=axis, keepdim=True)
    v = x.var(dim=axis, keepdim=True, unbiased=False)
    return (x - m) / torch.sqrt(v + eps)
def _scatter_add(tgt, idx, src, axis=0):
    return tgt.clone().index_add_(axis, idx, src)
def _segment_sum(src, seg, n):
    out = torch.zeros((n,) + src.shape[1:], dtype=src.dtype)
    return out.index_add_(0, seg, src)
def _pad(x, pw):
    flat = tuple(v for pair in reversed(pw) for v in pair)
    return torch.nn.functional.pad(x, flat)

kernel_name = 'concat_heads__mha_block__compressed_kv_cla__prompt'

def setup_inputs():

    _w = (lambda a: (lambda t: t.to(torch.bfloat16) if t.is_floating_point() else t)(torch.as_tensor(a)))
    def _A_setup():
        B, S, D, H = 1, 2048, 512, 32
        return {
            "x": _w((lambda *s: torch.randn(*s, dtype=torch.bfloat16) * 0.4)(B, S, D)),
            "wqkv": _w((lambda *s: torch.randn(*s, dtype=torch.bfloat16) * 0.4)(D, 3 * D)),
            "wo": _w((lambda *s: torch.randn(*s, dtype=torch.bfloat16) * 0.05)(D, D)),
        }
    _A_in = _A_setup()

    def _B_setup():
        B, H, Sq, Sk, D, M = 1, 32, 2048, 2048, 128, 512
        Dc = 4 * D
        return {
            "x": _w((lambda *s: torch.randn(*s, dtype=torch.bfloat16) * 0.2)(B, Sq, M)),
            "c_kv": _w((lambda *s: torch.randn(*s, dtype=torch.bfloat16) * 1.6)(B, Sk, Dc)),
            "w_q": _w((lambda *s: torch.randn(*s, dtype=torch.bfloat16) * 3.2)(M, H, D) * (M ** -0.5)),
            "w_uk": _w((lambda *s: torch.randn(*s, dtype=torch.bfloat16) * 3.2)(Dc, H, D) * (Dc ** -0.5)),
            "w_uv": _w((lambda *s: torch.randn(*s, dtype=torch.bfloat16) * 1.6)(Dc, H, D) * (Dc ** -0.5)),
            "w_o": _w((lambda *s: torch.randn(*s, dtype=torch.bfloat16) * 1.6)(H, D, M) * ((H * D) ** -0.5)),
        }
    _B_in = _B_setup()

    return {
        "A_x": _A_in["x"],
        "A_wqkv": _A_in["wqkv"],
        "A_wo": _A_in["wo"],
        "B_x": _B_in["x"],
        "B_c_kv": _B_in["c_kv"],
        "B_w_q": _B_in["w_q"],
        "B_w_uk": _B_in["w_uk"],
        "B_w_uv": _B_in["w_uv"],
        "B_w_o": _B_in["w_o"],
    }

def reference(A_x, A_wqkv, A_wo, B_x, B_c_kv, B_w_q, B_w_uk, B_w_uv, B_w_o):
    def _A_ref(x, wqkv, wo):
        B, S, D = x.shape
        H = 32
        Dh = D // H
        qkv = (lambda x, *d: x.permute(*d))((x @ wqkv).reshape(B, S, 3, H, Dh), 2, 0, 3, 1, 4)
        q, k, v = qkv[0], qkv[1], qkv[2]
        scores = torch.einsum("bhqd,bhkd->bhqk", q, k) * (Dh ** -0.5)
        p = _softmax(scores, axis=-1)
        o = torch.einsum("bhqk,bhkd->bhqd", p, v)
        return (lambda x, *d: x.permute(*d))(o, 0, 2, 1, 3).reshape(B, S, D) @ wo

    def _B_ref(x, c_kv, w_q, w_uk, w_uv, w_o):
        B, Sq, M = x.shape[0], x.shape[1], x.shape[2]
        Sk = c_kv.shape[1]
        H, D = w_q.shape[1], w_q.shape[2]
        q = torch.einsum("bqm,mhd->bhqd", x, w_q)
        k = torch.einsum("bkc,chd->bhkd", c_kv, w_uk)
        v = torch.einsum("bkc,chd->bhkd", c_kv, w_uv)
        scores = torch.einsum("bhqd,bhkd->bhqk", q, k) * (D ** -0.5)
        off = Sk - Sq
        qi = torch.arange(Sq)[:, None]
        kj = torch.arange(Sk)[None, :]
        cmask = kj <= (qi + off)
        scores = torch.where(cmask[None, None], scores, -1e9)
        p = _softmax(scores, axis=-1)
        ctx = torch.einsum("bhqk,bhkd->bhqd", p, v)
        return torch.einsum("bhqd,hdm->bqm", ctx, w_o)

    a = _A_ref(A_x, A_wqkv, A_wo)
    b = _B_ref(B_x, B_c_kv, B_w_q, B_w_uk, B_w_uv, B_w_o)
    return torch.concatenate([a, b], axis=-1)
```

```asm
; @launch grid=(256,1,1) block=(256,1,1) lds=163840
.amdgcn_target "amdgcn-amd-amdhsa--gfx950"
.text
.globl concat_heads__mha_block__compressed_kv_cla__prompt_kernel
.p2align 8
.type concat_heads__mha_block__compressed_kv_cla__prompt_kernel,@function
concat_heads__mha_block__compressed_kv_cla__prompt_kernel:
  s_cmp_lt_u32 s2, 256
  s_cbranch_scc1 L_go
  s_endpgm
L_go:
  s_load_dwordx16 s[20:35], s[0:1], 0
  s_load_dwordx2 s[36:37], s[0:1], 64
  s_load_dwordx2 s[38:39], s[0:1], 88
  s_load_dwordx2 s[100:101], s[0:1], 80
  s_and_b32 s41, s2, 7
  s_lshr_b32 s52, s2, 3
  s_and_b32 s52, s52, 3
  s_lshl_b32 s52, s52, 3
  s_add_u32 s41, s41, s52
  s_lshr_b32 s40, s2, 5
  v_lshrrev_b32 v22, 6, v0
  v_and_b32 v27, 63, v0
  s_nop 0
  v_readfirstlane_b32 s42, v22
  v_lshrrev_b32 v22, 3, v27
  v_lshlrev_b32 v22, 10, v22
  v_and_b32 v23, 7, v27
  v_lshrrev_b32 v24, 4, v27
  v_add_u32 v25, 0, v24
  v_xor_b32 v25, v25, v23
  v_lshl_add_u32 v25, v25, 4, v22
  v_add_u32 v9, 0, v25
  v_add_u32 v25, 4, v24
  v_xor_b32 v25, v25, v23
  v_lshl_add_u32 v25, v25, 4, v22
  v_add_u32 v10, 0x1c00, v25
  v_add_u32 v25, 0, v24
  v_xor_b32 v25, v25, v23
  v_lshl_add_u32 v25, v25, 4, v22
  v_add_u32 v11, 0x3800, v25
  v_add_u32 v25, 4, v24
  v_xor_b32 v25, v25, v23
  v_lshl_add_u32 v25, v25, 4, v22
  v_add_u32 v12, 0x5400, v25
  v_add_u32 v25, 0, v24
  v_xor_b32 v25, v25, v23
  v_lshl_add_u32 v25, v25, 4, v22
  v_add_u32 v13, 0x8000, v25
  v_add_u32 v25, 4, v24
  v_xor_b32 v25, v25, v23
  v_lshl_add_u32 v25, v25, 4, v22
  v_add_u32 v14, 0x9c00, v25
  v_add_u32 v25, 0, v24
  v_xor_b32 v25, v25, v23
  v_lshl_add_u32 v25, v25, 4, v22
  v_add_u32 v15, 0xb800, v25
  v_add_u32 v25, 4, v24
  v_xor_b32 v25, v25, v23
  v_lshl_add_u32 v25, v25, 4, v22
  v_add_u32 v16, 0xd400, v25
  v_lshrrev_b32 v22, 4, v27
  v_lshlrev_b32 v23, 2, v22
  v_and_b32 v24, 15, v27
  v_xor_b32 v23, v23, v24
  v_mul_u32_u24 v22, 0x2000, v22
  v_lshl_add_u32 v22, v23, 4, v22
  v_add_u32 v17, 0, v22
  v_add_u32 v18, 0x7c00, v22
  v_add_u32 v19, 0xf800, v22
  v_add_u32 v20, 0x17400, v22
  s_lshl_b32 s45, s42, 13
  s_lshl_b32 s46, s42, 12
  s_lshl_b32 s43, s40, 18
  s_lshl_b32 s52, s42, 16
  s_add_u32 s43, s43, s52
  s_lshl_b32 s44, s41, 8
  s_lshl_b32 s52, s42, 17
  s_add_u32 s44, s44, s52
  s_waitcnt lgkmcnt(0)
  s_mov_b32 s8, s28
  s_and_b32 s9, s29, 0xffff
  s_mov_b32 s10, 0x200000
  s_mov_b32 s11, 0x20000
  s_mov_b32 s12, s32
  s_and_b32 s13, s33, 0xffff
  s_mov_b32 s14, 0x400000
  s_mov_b32 s15, 0x20000
  s_add_u32 m0, s46, 0x18000
  s_nop 0
  buffer_load_dwordx4 v17, s[12:15], s44 offen lds
  buffer_load_dwordx4 v18, s[12:15], s44 offen offset:1024 lds
  buffer_load_dwordx4 v19, s[12:15], s44 offen offset:2048 lds
  buffer_load_dwordx4 v20, s[12:15], s44 offen offset:3072 lds
  s_add_u32 s44, s44, 0x80000
  s_add_u32 m0, s45, 0
  s_nop 0
  buffer_load_dwordx4 v9, s[8:11], s43 offen lds
  buffer_load_dwordx4 v10, s[8:11], s43 offen offset:1024 lds
  buffer_load_dwordx4 v11, s[8:11], s43 offen offset:2048 lds
  buffer_load_dwordx4 v12, s[8:11], s43 offen offset:3072 lds
  s_add_u32 m0, s45, 0x1000
  s_nop 0
  buffer_load_dwordx4 v13, s[8:11], s43 offen lds
  buffer_load_dwordx4 v14, s[8:11], s43 offen offset:1024 lds
  buffer_load_dwordx4 v15, s[8:11], s43 offen offset:2048 lds
  buffer_load_dwordx4 v16, s[8:11], s43 offen offset:3072 lds
  s_add_u32 s43, s43, 128
  s_add_u32 m0, s45, 0x8000
  s_nop 0
  buffer_load_dwordx4 v9, s[8:11], s43 offen lds
  buffer_load_dwordx4 v10, s[8:11], s43 offen offset:1024 lds
  buffer_load_dwordx4 v11, s[8:11], s43 offen offset:2048 lds
  buffer_load_dwordx4 v12, s[8:11], s43 offen offset:3072 lds
  s_add_u32 m0, s45, 0x9000
  s_nop 0
  buffer_load_dwordx4 v13, s[8:11], s43 offen lds
  buffer_load_dwordx4 v14, s[8:11], s43 offen offset:1024 lds
  buffer_load_dwordx4 v15, s[8:11], s43 offen offset:2048 lds
  buffer_load_dwordx4 v16, s[8:11], s43 offen offset:3072 lds
  s_add_u32 s43, s43, 128
  s_add_u32 m0, s46, 0x1c000
  s_nop 0
  buffer_load_dwordx4 v17, s[12:15], s44 offen lds
  buffer_load_dwordx4 v18, s[12:15], s44 offen offset:1024 lds
  buffer_load_dwordx4 v19, s[12:15], s44 offen offset:2048 lds
  buffer_load_dwordx4 v20, s[12:15], s44 offen offset:3072 lds
  s_add_u32 s44, s44, 0x80000
  s_add_u32 m0, s45, 0x10000
  s_nop 0
  buffer_load_dwordx4 v9, s[8:11], s43 offen lds
  buffer_load_dwordx4 v10, s[8:11], s43 offen offset:1024 lds
  buffer_load_dwordx4 v11, s[8:11], s43 offen offset:2048 lds
  buffer_load_dwordx4 v12, s[8:11], s43 offen offset:3072 lds
  s_add_u32 m0, s45, 0x11000
  s_nop 0
  buffer_load_dwordx4 v13, s[8:11], s43 offen lds
  buffer_load_dwordx4 v14, s[8:11], s43 offen offset:1024 lds
  buffer_load_dwordx4 v15, s[8:11], s43 offen offset:2048 lds
  buffer_load_dwordx4 v16, s[8:11], s43 offen offset:3072 lds
  s_add_u32 s43, s43, 128
  s_add_u32 m0, s46, 0x20000
  s_nop 0
  buffer_load_dwordx4 v17, s[12:15], s44 offen lds
  buffer_load_dwordx4 v18, s[12:15], s44 offen offset:1024 lds
  buffer_load_dwordx4 v19, s[12:15], s44 offen offset:2048 lds
  buffer_load_dwordx4 v20, s[12:15], s44 offen offset:3072 lds
  s_add_u32 s44, s44, 0x80000
  v_and_b32 v22, 31, v27
  v_lshrrev_b32 v23, 5, v27
  v_bfe_u32 v24, v22, 1, 3
  v_lshlrev_b32 v25, 7, v22
  v_add_u32 v25, s45, v25
  v_add_u32 v26, 0, v23
  v_xor_b32 v26, v26, v24
  v_lshl_add_u32 v1, v26, 4, v25
  v_add_u32 v28, 0x10000, v1
  v_add_u32 v26, 2, v23
  v_xor_b32 v26, v26, v24
  v_lshl_add_u32 v2, v26, 4, v25
  v_add_u32 v29, 0x10000, v2
  v_add_u32 v26, 4, v23
  v_xor_b32 v26, v26, v24
  v_lshl_add_u32 v3, v26, 4, v25
  v_add_u32 v30, 0x10000, v3
  v_add_u32 v26, 6, v23
  v_xor_b32 v26, v26, v24
  v_lshl_add_u32 v4, v26, 4, v25
  v_add_u32 v31, 0x10000, v4
  v_and_b32 v22, 15, v27
  v_lshrrev_b32 v23, 2, v22
  v_lshrrev_b32 v24, 5, v27
  v_lshl_add_u32 v24, v24, 3, v23
  v_lshlrev_b32 v24, 8, v24
  v_bfe_u32 v25, v27, 4, 1
  v_lshl_add_u32 v24, v25, 5, v24
  v_and_b32 v25, 3, v22
  v_lshl_add_u32 v24, v25, 3, v24
  v_add_u32 v24, 0x18000, v24
  v_xor_b32 v25, 0, v23
  v_lshl_add_u32 v5, v25, 6, v24
  v_xor_b32 v25, 1, v23
  v_lshl_add_u32 v6, v25, 6, v24
  v_xor_b32 v25, 2, v23
  v_lshl_add_u32 v7, v25, 6, v24
  v_xor_b32 v25, 3, v23
  v_lshl_add_u32 v8, v25, 6, v24
  v_lshlrev_b32 v21, 4, v27
  s_mov_b32 s16, s38
  s_and_b32 s17, s39, 0xffff
  s_mov_b32 s18, 0x4e00000
  s_mov_b32 s19, 0x20000
  s_waitcnt vmcnt(24)
  s_barrier
  ds_read_b128 a[0:3], v1
  ds_read_b128 a[4:7], v2
  ds_read_b128 a[8:11], v3
  ds_read_b128 a[12:15], v4
  ds_read_b128 a[16:19], v1 offset:4096
  ds_read_b128 a[20:23], v2 offset:4096
  ds_read_b128 a[24:27], v3 offset:4096
  ds_read_b128 a[28:31], v4 offset:4096
  ds_read_b64_tr_b16 v[96:97], v5
  ds_read_b64_tr_b16 v[98:99], v5 offset:1024
  ds_read_b64_tr_b16 v[100:101], v5 offset:4096
  ds_read_b64_tr_b16 v[102:103], v5 offset:5120
  ds_read_b64_tr_b16 v[104:105], v5 offset:8192
  ds_read_b64_tr_b16 v[106:107], v5 offset:9216
  ds_read_b64_tr_b16 v[108:109], v5 offset:12288
  ds_read_b64_tr_b16 v[110:111], v5 offset:13312
  s_waitcnt lgkmcnt(6)
  v_mfma_f32_32x32x16_bf16 v[128:143], v[96:99], a[0:3], 0
  ds_read_b64_tr_b16 v[112:113], v6
  s_waitcnt lgkmcnt(5)
  v_mfma_f32_32x32x16_bf16 v[128:143], v[100:103], a[4:7], v[128:143]
  ds_read_b64_tr_b16 v[114:115], v6 offset:1024
  s_waitcnt lgkmcnt(4)
  v_mfma_f32_32x32x16_bf16 v[128:143], v[104:107], a[8:11], v[128:143]
  ds_read_b64_tr_b16 v[116:117], v6 offset:4096
  s_waitcnt lgkmcnt(3)
  v_mfma_f32_32x32x16_bf16 v[128:143], v[108:111], a[12:15], v[128:143]
  ds_read_b64_tr_b16 v[118:119], v6 offset:5120
  v_mfma_f32_32x32x16_bf16 v[144:159], v[96:99], a[16:19], 0
  ds_read_b64_tr_b16 v[120:121], v6 offset:8192
  v_mfma_f32_32x32x16_bf16 v[144:159], v[100:103], a[20:23], v[144:159]
  ds_read_b64_tr_b16 v[122:123], v6 offset:9216
  v_mfma_f32_32x32x16_bf16 v[144:159], v[104:107], a[24:27], v[144:159]
  ds_read_b64_tr_b16 v[124:125], v6 offset:12288
  v_mfma_f32_32x32x16_bf16 v[144:159], v[108:111], a[28:31], v[144:159]
  ds_read_b64_tr_b16 v[126:127], v6 offset:13312
  s_waitcnt lgkmcnt(6)
  v_mfma_f32_32x32x16_bf16 v[160:175], v[112:115], a[0:3], 0
  s_add_u32 m0, s45, 0
  ds_read_b64_tr_b16 v[96:97], v7
  buffer_load_dwordx4 v9, s[8:11], s43 offen lds
  s_waitcnt lgkmcnt(5)
  v_mfma_f32_32x32x16_bf16 v[160:175], v[116:119], a[4:7], v[160:175]
  ds_read_b64_tr_b16 v[98:99], v7 offset:1024
  s_sub_u32 s96, s40, 0
  s_cmp_ge_u32 s96, 2
  s_cbranch_scc1 L_tch_0
  s_lshl_b32 s97, s42, 6
  v_add_u32 v94, s97, v27
  v_lshlrev_b32 v94, 7, v94
  s_mul_i32 s96, s2, 0x2000
  s_add_u32 s92, s26, s96
  s_addc_u32 s93, s27, 0
  s_and_b32 s93, s93, 0xffff
  s_mov_b32 s94, 0x2000
  s_mov_b32 s95, 0x20000
  buffer_load_dword v95, v94, s[92:95], 0 offen
  s_mul_i32 s96, s2, 0x4000
  s_add_u32 s92, s30, s96
  s_addc_u32 s93, s31, 0
  s_and_b32 s93, s93, 0xffff
  s_mov_b32 s94, 0x4000
  s_mov_b32 s95, 0x20000
  buffer_load_dword v95, v94, s[92:95], 0 offen
  s_mul_i32 s96, s2, 0x2000
  s_add_u32 s92, s20, s96
  s_addc_u32 s93, s21, 0
  s_and_b32 s93, s93, 0xffff
  s_mov_b32 s94, 0x2000
  s_mov_b32 s95, 0x20000
  buffer_load_dword v95, v94, s[92:95], 0 offen
  s_mul_i32 s96, s2, 0x1800
  s_add_u32 s92, s22, s96
  s_addc_u32 s93, s23, 0
  s_and_b32 s93, s93, 0xffff
  s_mov_b32 s94, 0x1800
  s_mov_b32 s95, 0x20000
  buffer_load_dword v95, v94, s[92:95], 0 offen
L_tch_0:
  s_waitcnt lgkmcnt(4)
  v_mfma_f32_32x32x16_bf16 v[160:175], v[120:123], a[8:11], v[160:175]
  ds_read_b64_tr_b16 v[100:101], v7 offset:4096
  buffer_load_dwordx4 v10, s[8:11], s43 offen offset:1024 lds
  s_waitcnt lgkmcnt(3)
  v_mfma_f32_32x32x16_bf16 v[160:175], v[124:127], a[12:15], v[160:175]
  ds_read_b64_tr_b16 v[102:103], v7 offset:5120
  v_mfma_f32_32x32x16_bf16 v[176:191], v[112:115], a[16:19], 0
  ds_read_b64_tr_b16 v[104:105], v7 offset:8192
  buffer_load_dwordx4 v11, s[8:11], s43 offen offset:2048 lds
  v_mfma_f32_32x32x16_bf16 v[176:191], v[116:119], a[20:23], v[176:191]
  ds_read_b64_tr_b16 v[106:107], v7 offset:9216
  v_mfma_f32_32x32x16_bf16 v[176:191], v[120:123], a[24:27], v[176:191]
  ds_read_b64_tr_b16 v[108:109], v7 offset:12288
  buffer_load_dwordx4 v12, s[8:11], s43 offen offset:3072 lds
  v_mfma_f32_32x32x16_bf16 v[176:191], v[124:127], a[28:31], v[176:191]
  ds_read_b64_tr_b16 v[110:111], v7 offset:13312
  s_waitcnt lgkmcnt(6)
  v_mfma_f32_32x32x16_bf16 v[192:207], v[96:99], a[0:3], 0
  s_add_u32 m0, s45, 0x1000
  ds_read_b64_tr_b16 v[112:113], v8
  buffer_load_dwordx4 v13, s[8:11], s43 offen lds
  s_waitcnt lgkmcnt(5)
  v_mfma_f32_32x32x16_bf16 v[192:207], v[100:103], a[4:7], v[192:207]
  ds_read_b64_tr_b16 v[114:115], v8 offset:1024
  s_waitcnt vmcnt(21)
  ds_read_b128 a[32:35], v1 offset:32768
  s_waitcnt lgkmcnt(5)
  v_mfma_f32_32x32x16_bf16 v[192:207], v[104:107], a[8:11], v[192:207]
  ds_read_b64_tr_b16 v[116:117], v8 offset:4096
  buffer_load_dwordx4 v14, s[8:11], s43 offen offset:1024 lds
  s_waitcnt lgkmcnt(4)
  v_mfma_f32_32x32x16_bf16 v[192:207], v[108:111], a[12:15], v[192:207]
  ds_read_b64_tr_b16 v[118:119], v8 offset:5120
  ds_read_b128 a[36:39], v2 offset:32768
  v_mfma_f32_32x32x16_bf16 v[208:223], v[96:99], a[16:19], 0
  ds_read_b64_tr_b16 v[120:121], v8 offset:8192
  buffer_load_dwordx4 v15, s[8:11], s43 offen offset:2048 lds
  v_mfma_f32_32x32x16_bf16 v[208:223], v[100:103], a[20:23], v[208:223]
  ds_read_b64_tr_b16 v[122:123], v8 offset:9216
  ds_read_b128 a[40:43], v3 offset:32768
  v_mfma_f32_32x32x16_bf16 v[208:223], v[104:107], a[24:27], v[208:223]
  ds_read_b64_tr_b16 v[124:125], v8 offset:12288
  buffer_load_dwordx4 v16, s[8:11], s43 offen offset:3072 lds
  s_add_u32 s43, s43, 128
  v_mfma_f32_32x32x16_bf16 v[208:223], v[108:111], a[28:31], v[208:223]
  ds_read_b64_tr_b16 v[126:127], v8 offset:13312
  s_waitcnt vmcnt(20)
  s_barrier
  ds_read_b128 a[44:47], v4 offset:32768
  s_waitcnt lgkmcnt(10)
  v_mfma_f32_32x32x16_bf16 v[224:239], v[112:115], a[0:3], 0
  s_add_u32 m0, s46, 0x24000
  ds_read_b64_tr_b16 v[96:97], v5 offset:16384
  buffer_load_dwordx4 v17, s[12:15], s44 offen lds
  s_waitcnt lgkmcnt(8)
  v_mfma_f32_32x32x16_bf16 v[224:239], v[116:119], a[4:7], v[224:239]
  ds_read_b64_tr_b16 v[98:99], v5 offset:17408
  ds_read_b128 a[48:51], v1 offset:36864
  s_waitcnt lgkmcnt(7)
  v_mfma_f32_32x32x16_bf16 v[224:239], v[120:123], a[8:11], v[224:239]
  ds_read_b64_tr_b16 v[100:101], v5 offset:20480
  buffer_load_dwordx4 v18, s[12:15], s44 offen offset:1024 lds
  s_waitcnt lgkmcnt(5)
  v_mfma_f32_32x32x16_bf16 v[224:239], v[124:127], a[12:15], v[224:239]
  ds_read_b64_tr_b16 v[102:103], v5 offset:21504
  ds_read_b128 a[52:55], v2 offset:36864
  v_mfma_f32_32x32x16_bf16 v[240:255], v[112:115], a[16:19], 0
  ds_read_b64_tr_b16 v[104:105], v5 offset:24576
  buffer_load_dwordx4 v19, s[12:15], s44 offen offset:2048 lds
  v_mfma_f32_32x32x16_bf16 v[240:255], v[116:119], a[20:23], v[240:255]
  ds_read_b64_tr_b16 v[106:107], v5 offset:25600
  ds_read_b128 a[56:59], v3 offset:36864
  v_mfma_f32_32x32x16_bf16 v[240:255], v[120:123], a[24:27], v[240:255]
  ds_read_b64_tr_b16 v[108:109], v5 offset:28672
  buffer_load_dwordx4 v20, s[12:15], s44 offen offset:3072 lds
  v_mfma_f32_32x32x16_bf16 v[240:255], v[124:127], a[28:31], v[240:255]
  ds_read_b64_tr_b16 v[110:111], v5 offset:29696
  ds_read_b128 a[60:63], v4 offset:36864
  s_add_u32 s44, s44, 0x80000
  s_waitcnt lgkmcnt(10)
  v_mfma_f32_32x32x16_bf16 v[128:143], v[96:99], a[32:35], v[128:143]
  ds_read_b64_tr_b16 v[112:113], v6 offset:16384
  s_mov_b32 s4, s100
  s_and_b32 s5, s101, 0xffff
  s_mov_b32 s6, 256
  s_mov_b32 s7, 0x20000
  s_or_b32 s52, s2, s42
  s_cmp_lg_u32 s52, 0
  s_cbranch_scc1 L_npub
  s_add_u32 s56, s38, 0x4d00000
  s_addc_u32 s57, s39, 0
  s_load_dword s53, s[56:57], 0
  s_waitcnt lgkmcnt(0)
  s_mul_i32 s54, s53, 0x9e3779b1
  s_add_u32 s54, s54, 0x6a09e667
  s_cmp_eq_u32 s54, s53
  s_cselect_b32 s55, 1, 0
  s_add_u32 s54, s54, s55
  s_cmp_eq_u32 s54, 0
  s_cselect_b32 s53, 1, s54
  s_mov_b32 s54, 0
  v_mov_b32 v22, 0
  v_mov_b32 v23, s53
  s_mov_b64 exec, 1
  s_nop 1
  buffer_store_dword v23, v22, s[4:7], s54 offen sc1
  s_mov_b64 exec, -1
  s_nop 3
L_npub:
  s_waitcnt lgkmcnt(8)
  v_mfma_f32_32x32x16_bf16 v[128:143], v[100:103], a[36:39], v[128:143]
  ds_read_b64_tr_b16 v[114:115], v6 offset:17408
  s_waitcnt lgkmcnt(6)
  v_mfma_f32_32x32x16_bf16 v[128:143], v[104:107], a[40:43], v[128:143]
  ds_read_b64_tr_b16 v[116:117], v6 offset:20480
  s_waitcnt lgkmcnt(4)
  v_mfma_f32_32x32x16_bf16 v[128:143], v[108:111], a[44:47], v[128:143]
  ds_read_b64_tr_b16 v[118:119], v6 offset:21504
  v_mfma_f32_32x32x16_bf16 v[144:159], v[96:99], a[48:51], v[144:159]
  ds_read_b64_tr_b16 v[120:121], v6 offset:24576
  v_mfma_f32_32x32x16_bf16 v[144:159], v[100:103], a[52:55], v[144:159]
  ds_read_b64_tr_b16 v[122:123], v6 offset:25600
  v_mfma_f32_32x32x16_bf16 v[144:159], v[104:107], a[56:59], v[144:159]
  ds_read_b64_tr_b16 v[124:125], v6 offset:28672
  s_waitcnt lgkmcnt(7)
  v_mfma_f32_32x32x16_bf16 v[144:159], v[108:111], a[60:63], v[144:159]
  ds_read_b64_tr_b16 v[126:127], v6 offset:29696
  s_waitcnt lgkmcnt(6)
  v_mfma_f32_32x32x16_bf16 v[160:175], v[112:115], a[32:35], v[160:175]
  s_add_u32 m0, s45, 0x8000
  ds_read_b64_tr_b16 v[96:97], v7 offset:16384
  buffer_load_dwordx4 v9, s[8:11], s43 offen lds
  s_waitcnt lgkmcnt(5)
  v_mfma_f32_32x32x16_bf16 v[160:175], v[116:119], a[36:39], v[160:175]
  ds_read_b64_tr_b16 v[98:99], v7 offset:17408
  s_waitcnt lgkmcnt(4)
  v_mfma_f32_32x32x16_bf16 v[160:175], v[120:123], a[40:43], v[160:175]
  ds_read_b64_tr_b16 v[100:101], v7 offset:20480
  buffer_load_dwordx4 v10, s[8:11], s43 offen offset:1024 lds
  s_sub_u32 s96, s40, 2
  s_cmp_ge_u32 s96, 2
  s_cbranch_scc1 L_tch_1
  s_lshl_b32 s97, s42, 6
  v_add_u32 v94, s97, v27
  v_lshlrev_b32 v94, 7, v94
  s_mul_i32 s96, s2, 0x2000
  s_add_u32 s92, s26, s96
  s_addc_u32 s93, s27, 0
  s_and_b32 s93, s93, 0xffff
  s_mov_b32 s94, 0x2000
  s_mov_b32 s95, 0x20000
  buffer_load_dword v95, v94, s[92:95], 0 offen
  s_mul_i32 s96, s2, 0x4000
  s_add_u32 s92, s30, s96
  s_addc_u32 s93, s31, 0
  s_and_b32 s93, s93, 0xffff
  s_mov_b32 s94, 0x4000
  s_mov_b32 s95, 0x20000
  buffer_load_dword v95, v94, s[92:95], 0 offen
  s_mul_i32 s96, s2, 0x2000
  s_add_u32 s92, s20, s96
  s_addc_u32 s93, s21, 0
  s_and_b32 s93, s93, 0xffff
  s_mov_b32 s94, 0x2000
  s_mov_b32 s95, 0x20000
  buffer_load_dword v95, v94, s[92:95], 0 offen
  s_mul_i32 s96, s2, 0x1800
  s_add_u32 s92, s22, s96
  s_addc_u32 s93, s23, 0
  s_and_b32 s93, s93, 0xffff
  s_mov_b32 s94, 0x1800
  s_mov_b32 s95, 0x20000
  buffer_load_dword v95, v94, s[92:95], 0 offen
L_tch_1:
  s_waitcnt lgkmcnt(3)
  v_mfma_f32_32x32x16_bf16 v[160:175], v[124:127], a[44:47], v[160:175]
  ds_read_b64_tr_b16 v[102:103], v7 offset:21504
  v_mfma_f32_32x32x16_bf16 v[176:191], v[112:115], a[48:51], v[176:191]
  ds_read_b64_tr_b16 v[104:105], v7 offset:24576
  buffer_load_dwordx4 v11, s[8:11], s43 offen offset:2048 lds
  v_mfma_f32_32x32x16_bf16 v[176:191], v[116:119], a[52:55], v[176:191]
  ds_read_b64_tr_b16 v[106:107], v7 offset:25600
  v_mfma_f32_32x32x16_bf16 v[176:191], v[120:123], a[56:59], v[176:191]
  ds_read_b64_tr_b16 v[108:109], v7 offset:28672
  buffer_load_dwordx4 v12, s[8:11], s43 offen offset:3072 lds
  v_mfma_f32_32x32x16_bf16 v[176:191], v[124:127], a[60:63], v[176:191]
  ds_read_b64_tr_b16 v[110:111], v7 offset:29696
  s_waitcnt lgkmcnt(6)
  v_mfma_f32_32x32x16_bf16 v[192:207], v[96:99], a[32:35], v[192:207]
  s_add_u32 m0, s45, 0x9000
  ds_read_b64_tr_b16 v[112:113], v8 offset:16384
  buffer_load_dwordx4 v13, s[8:11], s43 offen lds
  s_waitcnt lgkmcnt(5)
  v_mfma_f32_32x32x16_bf16 v[192:207], v[100:103], a[36:39], v[192:207]
  ds_read_b64_tr_b16 v[114:115], v8 offset:17408
  s_waitcnt vmcnt(21)
  ds_read_b128 a[64:67], v28
  s_waitcnt lgkmcnt(5)
  v_mfma_f32_32x32x16_bf16 v[192:207], v[104:107], a[40:43], v[192:207]
  ds_read_b64_tr_b16 v[116:117], v8 offset:20480
  buffer_load_dwordx4 v14, s[8:11], s43 offen offset:1024 lds
  s_waitcnt lgkmcnt(4)
  v_mfma_f32_32x32x16_bf16 v[192:207], v[108:111], a[44:47], v[192:207]
  ds_read_b64_tr_b16 v[118:119], v8 offset:21504
  ds_read_b128 a[68:71], v29
  v_mfma_f32_32x32x16_bf16 v[208:223], v[96:99], a[48:51], v[208:223]
  ds_read_b64_tr_b16 v[120:121], v8 offset:24576
  buffer_load_dwordx4 v15, s[8:11], s43 offen offset:2048 lds
  v_mfma_f32_32x32x16_bf16 v[208:223], v[100:103], a[52:55], v[208:223]
  ds_read_b64_tr_b16 v[122:123], v8 offset:25600
  ds_read_b128 a[72:75], v30
  v_mfma_f32_32x32x16_bf16 v[208:223], v[104:107], a[56:59], v[208:223]
  ds_read_b64_tr_b16 v[124:125], v8 offset:28672
  buffer_load_dwordx4 v16, s[8:11], s43 offen offset:3072 lds
  s_add_u32 s43, s43, 128
  v_mfma_f32_32x32x16_bf16 v[208:223], v[108:111], a[60:63], v[208:223]
  ds_read_b64_tr_b16 v[126:127], v8 offset:29696
  s_waitcnt vmcnt(20)
  s_barrier
  ds_read_b128 a[76:79], v31
  s_waitcnt lgkmcnt(10)
  v_mfma_f32_32x32x16_bf16 v[224:239], v[112:115], a[32:35], v[224:239]
  s_add_u32 m0, s46, 0x18000
  ds_read_b64_tr_b16 v[96:97], v5 offset:32768
  buffer_load_dwordx4 v17, s[12:15], s44 offen lds
  s_waitcnt lgkmcnt(8)
  v_mfma_f32_32x32x16_bf16 v[224:239], v[116:119], a[36:39], v[224:239]
  ds_read_b64_tr_b16 v[98:99], v5 offset:33792
  ds_read_b128 a[80:83], v28 offset:4096
  s_waitcnt lgkmcnt(7)
  v_mfma_f32_32x32x16_bf16 v[224:239], v[120:123], a[40:43], v[224:239]
  ds_read_b64_tr_b16 v[100:101], v5 offset:36864
  buffer_load_dwordx4 v18, s[12:15], s44 offen offset:1024 lds
  s_waitcnt lgkmcnt(5)
  v_mfma_f32_32x32x16_bf16 v[224:239], v[124:127], a[44:47], v[224:239]
  ds_read_b64_tr_b16 v[102:103], v5 offset:37888
  ds_read_b128 a[84:87], v29 offset:4096
  v_mfma_f32_32x32x16_bf16 v[240:255], v[112:115], a[48:51], v[240:255]
  ds_read_b64_tr_b16 v[104:105], v5 offset:40960
  buffer_load_dwordx4 v19, s[12:15], s44 offen offset:2048 lds
  v_mfma_f32_32x32x16_bf16 v[240:255], v[116:119], a[52:55], v[240:255]
  ds_read_b64_tr_b16 v[106:107], v5 offset:41984
  ds_read_b128 a[88:91], v30 offset:4096
  v_mfma_f32_32x32x16_bf16 v[240:255], v[120:123], a[56:59], v[240:255]
  ds_read_b64_tr_b16 v[108:109], v5 offset:45056
  buffer_load_dwordx4 v20, s[12:15], s44 offen offset:3072 lds
  v_mfma_f32_32x32x16_bf16 v[240:255], v[124:127], a[60:63], v[240:255]
  ds_read_b64_tr_b16 v[110:111], v5 offset:46080
  ds_read_b128 a[92:95], v31 offset:4096
  s_add_u32 s44, s44, 0x80000
  s_waitcnt lgkmcnt(10)
  v_mfma_f32_32x32x16_bf16 v[128:143], v[96:99], a[64:67], v[128:143]
  ds_read_b64_tr_b16 v[112:113], v6 offset:32768
  s_waitcnt lgkmcnt(8)
  v_mfma_f32_32x32x16_bf16 v[128:143], v[100:103], a[68:71], v[128:143]
  ds_read_b64_tr_b16 v[114:115], v6 offset:33792
  s_waitcnt lgkmcnt(6)
  v_mfma_f32_32x32x16_bf16 v[128:143], v[104:107], a[72:75], v[128:143]
  ds_read_b64_tr_b16 v[116:117], v6 offset:36864
  s_waitcnt lgkmcnt(4)
  v_mfma_f32_32x32x16_bf16 v[128:143], v[108:111], a[76:79], v[128:143]
  ds_read_b64_tr_b16 v[118:119], v6 offset:37888
  v_mfma_f32_32x32x16_bf16 v[144:159], v[96:99], a[80:83], v[144:159]
  ds_read_b64_tr_b16 v[120:121], v6 offset:40960
  v_mfma_f32_32x32x16_bf16 v[144:159], v[100:103], a[84:87], v[144:159]
  ds_read_b64_tr_b16 v[122:123], v6 offset:41984
  v_mfma_f32_32x32x16_bf16 v[144:159], v[104:107], a[88:91], v[144:159]
  ds_read_b64_tr_b16 v[124:125], v6 offset:45056
  s_waitcnt lgkmcnt(7)
  v_mfma_f32_32x32x16_bf16 v[144:159], v[108:111], a[92:95], v[144:159]
  ds_read_b64_tr_b16 v[126:127], v6 offset:46080
  s_waitcnt lgkmcnt(6)
  v_mfma_f32_32x32x16_bf16 v[160:175], v[112:115], a[64:67], v[160:175]
  s_add_u32 m0, s45, 0x10000
  ds_read_b64_tr_b16 v[96:97], v7 offset:32768
  buffer_load_dwordx4 v9, s[8:11], s43 offen lds
  s_waitcnt lgkmcnt(5)
  v_mfma_f32_32x32x16_bf16 v[160:175], v[116:119], a[68:71], v[160:175]
  ds_read_b64_tr_b16 v[98:99], v7 offset:33792
  s_sub_u32 s96, s40, 4
  s_cmp_ge_u32 s96, 1
  s_cbranch_scc1 L_tch_2
  s_lshl_b32 s97, s42, 6
  v_add_u32 v94, s97, v27
  v_lshlrev_b32 v94, 7, v94
  s_mul_i32 s96, s2, 0x2000
  s_add_u32 s92, s26, s96
  s_addc_u32 s93, s27, 0
  s_and_b32 s93, s93, 0xffff
  s_mov_b32 s94, 0x2000
  s_mov_b32 s95, 0x20000
  buffer_load_dword v95, v94, s[92:95], 0 offen
  s_mul_i32 s96, s2, 0x4000
  s_add_u32 s92, s30, s96
  s_addc_u32 s93, s31, 0
  s_and_b32 s93, s93, 0xffff
  s_mov_b32 s94, 0x4000
  s_mov_b32 s95, 0x20000
  buffer_load_dword v95, v94, s[92:95], 0 offen
  s_mul_i32 s96, s2, 0x2000
  s_add_u32 s92, s20, s96
  s_addc_u32 s93, s21, 0
  s_and_b32 s93, s93, 0xffff
  s_mov_b32 s94, 0x2000
  s_mov_b32 s95, 0x20000
  buffer_load_dword v95, v94, s[92:95], 0 offen
  s_mul_i32 s96, s2, 0x1800
  s_add_u32 s92, s22, s96
  s_addc_u32 s93, s23, 0
  s_and_b32 s93, s93, 0xffff
  s_mov_b32 s94, 0x1800
  s_mov_b32 s95, 0x20000
  buffer_load_dword v95, v94, s[92:95], 0 offen
L_tch_2:
  s_waitcnt lgkmcnt(4)
  v_mfma_f32_32x32x16_bf16 v[160:175], v[120:123], a[72:75], v[160:175]
  ds_read_b64_tr_b16 v[100:101], v7 offset:36864
  buffer_load_dwordx4 v10, s[8:11], s43 offen offset:1024 lds
  s_waitcnt lgkmcnt(3)
  v_mfma_f32_32x32x16_bf16 v[160:175], v[124:127], a[76:79], v[160:175]
  ds_read_b64_tr_b16 v[102:103], v7 offset:37888
  v_mfma_f32_32x32x16_bf16 v[176:191], v[112:115], a[80:83], v[176:191]
  ds_read_b64_tr_b16 v[104:105], v7 offset:40960
  buffer_load_dwordx4 v11, s[8:11], s43 offen offset:2048 lds
  v_mfma_f32_32x32x16_bf16 v[176:191], v[116:119], a[84:87], v[176:191]
  ds_read_b64_tr_b16 v[106:107], v7 offset:41984
  v_mfma_f32_32x32x16_bf16 v[176:191], v[120:123], a[88:91], v[176:191]
  ds_read_b64_tr_b16 v[108:109], v7 offset:45056
  buffer_load_dwordx4 v12, s[8:11], s43 offen offset:3072 lds
  v_mfma_f32_32x32x16_bf16 v[176:191], v[124:127], a[92:95], v[176:191]
  ds_read_b64_tr_b16 v[110:111], v7 offset:46080
  s_waitcnt lgkmcnt(6)
  v_mfma_f32_32x32x16_bf16 v[192:207], v[96:99], a[64:67], v[192:207]
  s_add_u32 m0, s45, 0x11000
  ds_read_b64_tr_b16 v[112:113], v8 offset:32768
  buffer_load_dwordx4 v13, s[8:11], s43 offen lds
  s_waitcnt lgkmcnt(5)
  v_mfma_f32_32x32x16_bf16 v[192:207], v[100:103], a[68:71], v[192:207]
  ds_read_b64_tr_b16 v[114:115], v8 offset:33792
  s_waitcnt vmcnt(21)
  ds_read_b128 a[96:99], v1
  s_waitcnt lgkmcnt(5)
  v_mfma_f32_32x32x16_bf16 v[192:207], v[104:107], a[72:75], v[192:207]
  ds_read_b64_tr_b16 v[116:117], v8 offset:36864
  buffer_load_dwordx4 v14, s[8:11], s43 offen offset:1024 lds
  s_waitcnt lgkmcnt(4)
  v_mfma_f32_32x32x16_bf16 v[192:207], v[108:111], a[76:79], v[192:207]
  ds_read_b64_tr_b16 v[118:119], v8 offset:37888
  ds_read_b128 a[100:103], v2
  v_mfma_f32_32x32x16_bf16 v[208:223], v[96:99], a[80:83], v[208:223]
  ds_read_b64_tr_b16 v[120:121], v8 offset:40960
  buffer_load_dwordx4 v15, s[8:11], s43 offen offset:2048 lds
  v_mfma_f32_32x32x16_bf16 v[208:223], v[100:103], a[84:87], v[208:223]
  ds_read_b64_tr_b16 v[122:123], v8 offset:41984
  ds_read_b128 a[104:107], v3
  v_mfma_f32_32x32x16_bf16 v[208:223], v[104:107], a[88:91], v[208:223]
  ds_read_b64_tr_b16 v[124:125], v8 offset:45056
  buffer_load_dwordx4 v16, s[8:11], s43 offen offset:3072 lds
  s_add_u32 s43, s43, 128
  v_mfma_f32_32x32x16_bf16 v[208:223], v[108:111], a[92:95], v[208:223]
  ds_read_b64_tr_b16 v[126:127], v8 offset:46080
  s_waitcnt vmcnt(20)
  s_barrier
  ds_read_b128 a[108:111], v4
  s_waitcnt lgkmcnt(10)
  v_mfma_f32_32x32x16_bf16 v[224:239], v[112:115], a[64:67], v[224:239]
  s_add_u32 m0, s46, 0x1c000
  ds_read_b64_tr_b16 v[96:97], v5 offset:49152
  buffer_load_dwordx4 v17, s[12:15], s44 offen lds
  s_waitcnt lgkmcnt(8)
  v_mfma_f32_32x32x16_bf16 v[224:239], v[116:119], a[68:71], v[224:239]
  ds_read_b64_tr_b16 v[98:99], v5 offset:50176
  ds_read_b128 a[112:115], v1 offset:4096
  s_waitcnt lgkmcnt(7)
  v_mfma_f32_32x32x16_bf16 v[224:239], v[120:123], a[72:75], v[224:239]
  ds_read_b64_tr_b16 v[100:101], v5 offset:53248
  buffer_load_dwordx4 v18, s[12:15], s44 offen offset:1024 lds
  s_waitcnt lgkmcnt(5)
  v_mfma_f32_32x32x16_bf16 v[224:239], v[124:127], a[76:79], v[224:239]
  ds_read_b64_tr_b16 v[102:103], v5 offset:54272
  ds_read_b128 a[116:119], v2 offset:4096
  v_mfma_f32_32x32x16_bf16 v[240:255], v[112:115], a[80:83], v[240:255]
  ds_read_b64_tr_b16 v[104:105], v5 offset:57344
  buffer_load_dwordx4 v19, s[12:15], s44 offen offset:2048 lds
  v_mfma_f32_32x32x16_bf16 v[240:255], v[116:119], a[84:87], v[240:255]
  ds_read_b64_tr_b16 v[106:107], v5 offset:58368
  ds_read_b128 a[120:123], v3 offset:4096
  v_mfma_f32_32x32x16_bf16 v[240:255], v[120:123], a[88:91], v[240:255]
  ds_read_b64_tr_b16 v[108:109], v5 offset:61440
  buffer_load_dwordx4 v20, s[12:15], s44 offen offset:3072 lds
  v_mfma_f32_32x32x16_bf16 v[240:255], v[124:127], a[92:95], v[240:255]
  ds_read_b64_tr_b16 v[110:111], v5 offset:62464
  ds_read_b128 a[124:127], v4 offset:4096
  s_add_u32 s44, s44, 0x80000
  s_waitcnt lgkmcnt(10)
  v_mfma_f32_32x32x16_bf16 v[128:143], v[96:99], a[96:99], v[128:143]
  ds_read_b64_tr_b16 v[112:113], v6 offset:49152
  s_waitcnt lgkmcnt(8)
  v_mfma_f32_32x32x16_bf16 v[128:143], v[100:103], a[100:103], v[128:143]
  ds_read_b64_tr_b16 v[114:115], v6 offset:50176
  s_waitcnt lgkmcnt(6)
  v_mfma_f32_32x32x16_bf16 v[128:143], v[104:107], a[104:107], v[128:143]
  ds_read_b64_tr_b16 v[116:117], v6 offset:53248
  s_waitcnt lgkmcnt(4)
  v_mfma_f32_32x32x16_bf16 v[128:143], v[108:111], a[108:111], v[128:143]
  ds_read_b64_tr_b16 v[118:119], v6 offset:54272
  v_mfma_f32_32x32x16_bf16 v[144:159], v[96:99], a[112:115], v[144:159]
  ds_read_b64_tr_b16 v[120:121], v6 offset:57344
  v_mfma_f32_32x32x16_bf16 v[144:159], v[100:103], a[116:119], v[144:159]
  ds_read_b64_tr_b16 v[122:123], v6 offset:58368
  v_mfma_f32_32x32x16_bf16 v[144:159], v[104:107], a[120:123], v[144:159]
  ds_read_b64_tr_b16 v[124:125], v6 offset:61440
  s_waitcnt lgkmcnt(7)
  v_mfma_f32_32x32x16_bf16 v[144:159], v[108:111], a[124:127], v[144:159]
  ds_read_b64_tr_b16 v[126:127], v6 offset:62464
  s_waitcnt lgkmcnt(6)
  v_mfma_f32_32x32x16_bf16 v[160:175], v[112:115], a[96:99], v[160:175]
  s_add_u32 m0, s45, 0
  ds_read_b64_tr_b16 v[96:97], v7 offset:49152
  buffer_load_dwordx4 v9, s[8:11], s43 offen lds
  s_waitcnt lgkmcnt(5)
  v_mfma_f32_32x32x16_bf16 v[160:175], v[116:119], a[100:103], v[160:175]
  ds_read_b64_tr_b16 v[98:99], v7 offset:50176
  s_sub_u32 s96, s40, 5
  s_cmp_ge_u32 s96, 2
  s_cbranch_scc1 L_tch_3
  s_lshl_b32 s97, s42, 6
  v_add_u32 v94, s97, v27
  v_lshlrev_b32 v94, 7, v94
  s_mul_i32 s96, s2, 0x2000
  s_add_u32 s92, s26, s96
  s_addc_u32 s93, s27, 0
  s_and_b32 s93, s93, 0xffff
  s_mov_b32 s94, 0x2000
  s_mov_b32 s95, 0x20000
  buffer_load_dword v95, v94, s[92:95], 0 offen
  s_mul_i32 s96, s2, 0x4000
  s_add_u32 s92, s30, s96
  s_addc_u32 s93, s31, 0
  s_and_b32 s93, s93, 0xffff
  s_mov_b32 s94, 0x4000
  s_mov_b32 s95, 0x20000
  buffer_load_dword v95, v94, s[92:95], 0 offen
  s_mul_i32 s96, s2, 0x2000
  s_add_u32 s92, s20, s96
  s_addc_u32 s93, s21, 0
  s_and_b32 s93, s93, 0xffff
  s_mov_b32 s94, 0x2000
  s_mov_b32 s95, 0x20000
  buffer_load_dword v95, v94, s[92:95], 0 offen
  s_mul_i32 s96, s2, 0x1800
  s_add_u32 s92, s22, s96
  s_addc_u32 s93, s23, 0
  s_and_b32 s93, s93, 0xffff
  s_mov_b32 s94, 0x1800
  s_mov_b32 s95, 0x20000
  buffer_load_dword v95, v94, s[92:95], 0 offen
L_tch_3:
  s_waitcnt lgkmcnt(4)
  v_mfma_f32_32x32x16_bf16 v[160:175], v[120:123], a[104:107], v[160:175]
  ds_read_b64_tr_b16 v[100:101], v7 offset:53248
  buffer_load_dwordx4 v10, s[8:11], s43 offen offset:1024 lds
  s_waitcnt lgkmcnt(3)
  v_mfma_f32_32x32x16_bf16 v[160:175], v[124:127], a[108:111], v[160:175]
  ds_read_b64_tr_b16 v[102:103], v7 offset:54272
  v_mfma_f32_32x32x16_bf16 v[176:191], v[112:115], a[112:115], v[176:191]
  ds_read_b64_tr_b16 v[104:105], v7 offset:57344
  buffer_load_dwordx4 v11, s[8:11], s43 offen offset:2048 lds
  v_mfma_f32_32x32x16_bf16 v[176:191], v[116:119], a[116:119], v[176:191]
  ds_read_b64_tr_b16 v[106:107], v7 offset:58368
  v_mfma_f32_32x32x16_bf16 v[176:191], v[120:123], a[120:123], v[176:191]
  ds_read_b64_tr_b16 v[108:109], v7 offset:61440
  buffer_load_dwordx4 v12, s[8:11], s43 offen offset:3072 lds
  v_mfma_f32_32x32x16_bf16 v[176:191], v[124:127], a[124:127], v[176:191]
  ds_read_b64_tr_b16 v[110:111], v7 offset:62464
  s_waitcnt lgkmcnt(6)
  v_mfma_f32_32x32x16_bf16 v[192:207], v[96:99], a[96:99], v[192:207]
  s_add_u32 m0, s45, 0x1000
  ds_read_b64_tr_b16 v[112:113], v8 offset:49152
  buffer_load_dwordx4 v13, s[8:11], s43 offen lds
  s_waitcnt lgkmcnt(5)
  v_mfma_f32_32x32x16_bf16 v[192:207], v[100:103], a[100:103], v[192:207]
  ds_read_b64_tr_b16 v[114:115], v8 offset:50176
  s_waitcnt vmcnt(21)
  ds_read_b128 a[128:131], v1 offset:32768
  s_waitcnt lgkmcnt(5)
  v_mfma_f32_32x32x16_bf16 v[192:207], v[104:107], a[104:107], v[192:207]
  ds_read_b64_tr_b16 v[116:117], v8 offset:53248
  buffer_load_dwordx4 v14, s[8:11], s43 offen offset:1024 lds
  s_waitcnt lgkmcnt(4)
  v_mfma_f32_32x32x16_bf16 v[192:207], v[108:111], a[108:111], v[192:207]
  ds_read_b64_tr_b16 v[118:119], v8 offset:54272
  ds_read_b128 a[132:135], v2 offset:32768
  v_mfma_f32_32x32x16_bf16 v[208:223], v[96:99], a[112:115], v[208:223]
  ds_read_b64_tr_b16 v[120:121], v8 offset:57344
  buffer_load_dwordx4 v15, s[8:11], s43 offen offset:2048 lds
  v_mfma_f32_32x32x16_bf16 v[208:223], v[100:103], a[116:119], v[208:223]
  ds_read_b64_tr_b16 v[122:123], v8 offset:58368
  ds_read_b128 a[136:139], v3 offset:32768
  v_mfma_f32_32x32x16_bf16 v[208:223], v[104:107], a[120:123], v[208:223]
  ds_read_b64_tr_b16 v[124:125], v8 offset:61440
  buffer_load_dwordx4 v16, s[8:11], s43 offen offset:3072 lds
  s_add_u32 s43, s43, 128
  v_mfma_f32_32x32x16_bf16 v[208:223], v[108:111], a[124:127], v[208:223]
  ds_read_b64_tr_b16 v[126:127], v8 offset:62464
  s_waitcnt vmcnt(20)
  s_barrier
  ds_read_b128 a[140:143], v4 offset:32768
  s_waitcnt lgkmcnt(10)
  v_mfma_f32_32x32x16_bf16 v[224:239], v[112:115], a[96:99], v[224:239]
  s_add_u32 m0, s46, 0x20000
  ds_read_b64_tr_b16 v[96:97], v5
  buffer_load_dwordx4 v17, s[12:15], s44 offen lds
  s_waitcnt lgkmcnt(8)
  v_mfma_f32_32x32x16_bf16 v[224:239], v[116:119], a[100:103], v[224:239]
  ds_read_b64_tr_b16 v[98:99], v5 offset:1024
  ds_read_b128 a[144:147], v1 offset:36864
  s_waitcnt lgkmcnt(7)
  v_mfma_f32_32x32x16_bf16 v[224:239], v[120:123], a[104:107], v[224:239]
  ds_read_b64_tr_b16 v[100:101], v5 offset:4096
  buffer_load_dwordx4 v18, s[12:15], s44 offen offset:1024 lds
  s_waitcnt lgkmcnt(5)
  v_mfma_f32_32x32x16_bf16 v[224:239], v[124:127], a[108:111], v[224:239]
  ds_read_b64_tr_b16 v[102:103], v5 offset:5120
  ds_read_b128 a[148:151], v2 offset:36864
  v_mfma_f32_32x32x16_bf16 v[240:255], v[112:115], a[112:115], v[240:255]
  ds_read_b64_tr_b16 v[104:105], v5 offset:8192
  buffer_load_dwordx4 v19, s[12:15], s44 offen offset:2048 lds
  v_mfma_f32_32x32x16_bf16 v[240:255], v[116:119], a[116:119], v[240:255]
  ds_read_b64_tr_b16 v[106:107], v5 offset:9216
  ds_read_b128 a[152:155], v3 offset:36864
  v_mfma_f32_32x32x16_bf16 v[240:255], v[120:123], a[120:123], v[240:255]
  ds_read_b64_tr_b16 v[108:109], v5 offset:12288
  buffer_load_dwordx4 v20, s[12:15], s44 offen offset:3072 lds
  v_mfma_f32_32x32x16_bf16 v[240:255], v[124:127], a[124:127], v[240:255]
  ds_read_b64_tr_b16 v[110:111], v5 offset:13312
  ds_read_b128 a[156:159], v4 offset:36864
  s_add_u32 s44, s44, 0x80000
  s_waitcnt lgkmcnt(10)
  v_mfma_f32_32x32x16_bf16 v[128:143], v[96:99], a[128:131], v[128:143]
  ds_read_b64_tr_b16 v[112:113], v6
  s_waitcnt lgkmcnt(8)
  v_mfma_f32_32x32x16_bf16 v[128:143], v[100:103], a[132:135], v[128:143]
  ds_read_b64_tr_b16 v[114:115], v6 offset:1024
  s_waitcnt lgkmcnt(6)
  v_mfma_f32_32x32x16_bf16 v[128:143], v[104:107], a[136:139], v[128:143]
  ds_read_b64_tr_b16 v[116:117], v6 offset:4096
  s_waitcnt lgkmcnt(4)
  v_mfma_f32_32x32x16_bf16 v[128:143], v[108:111], a[140:143], v[128:143]
  ds_read_b64_tr_b16 v[118:119], v6 offset:5120
  v_mfma_f32_32x32x16_bf16 v[144:159], v[96:99], a[144:147], v[144:159]
  ds_read_b64_tr_b16 v[120:121], v6 offset:8192
  v_mfma_f32_32x32x16_bf16 v[144:159], v[100:103], a[148:151], v[144:159]
  ds_read_b64_tr_b16 v[122:123], v6 offset:9216
  v_mfma_f32_32x32x16_bf16 v[144:159], v[104:107], a[152:155], v[144:159]
  ds_read_b64_tr_b16 v[124:125], v6 offset:12288
  s_waitcnt lgkmcnt(7)
  v_mfma_f32_32x32x16_bf16 v[144:159], v[108:111], a[156:159], v[144:159]
  ds_read_b64_tr_b16 v[126:127], v6 offset:13312
  s_waitcnt lgkmcnt(6)
  v_mfma_f32_32x32x16_bf16 v[160:175], v[112:115], a[128:131], v[160:175]
  s_add_u32 m0, s45, 0x8000
  ds_read_b64_tr_b16 v[96:97], v7
  buffer_load_dwordx4 v9, s[8:11], s43 offen lds
  s_waitcnt lgkmcnt(5)
  v_mfma_f32_32x32x16_bf16 v[160:175], v[116:119], a[132:135], v[160:175]
  ds_read_b64_tr_b16 v[98:99], v7 offset:1024
  s_sub_u32 s96, s40, 7
  s_cmp_ge_u32 s96, 1
  s_cbranch_scc1 L_tch_4
  s_lshl_b32 s97, s42, 6
  v_add_u32 v94, s97, v27
  v_lshlrev_b32 v94, 7, v94
  s_mul_i32 s96, s2, 0x2000
  s_add_u32 s92, s26, s96
  s_addc_u32 s93, s27, 0
  s_and_b32 s93, s93, 0xffff
  s_mov_b32 s94, 0x2000
  s_mov_b32 s95, 0x20000
  buffer_load_dword v95, v94, s[92:95], 0 offen
  s_mul_i32 s96, s2, 0x4000
  s_add_u32 s92, s30, s96
  s_addc_u32 s93, s31, 0
  s_and_b32 s93, s93, 0xffff
  s_mov_b32 s94, 0x4000
  s_mov_b32 s95, 0x20000
  buffer_load_dword v95, v94, s[92:95], 0 offen
  s_mul_i32 s96, s2, 0x2000
  s_add_u32 s92, s20, s96
  s_addc_u32 s93, s21, 0
  s_and_b32 s93, s93, 0xffff
  s_mov_b32 s94, 0x2000
  s_mov_b32 s95, 0x20000
  buffer_load_dword v95, v94, s[92:95], 0 offen
  s_mul_i32 s96, s2, 0x1800
  s_add_u32 s92, s22, s96
  s_addc_u32 s93, s23, 0
  s_and_b32 s93, s93, 0xffff
  s_mov_b32 s94, 0x1800
  s_mov_b32 s95, 0x20000
  buffer_load_dword v95, v94, s[92:95], 0 offen
L_tch_4:
  s_waitcnt lgkmcnt(4)
  v_mfma_f32_32x32x16_bf16 v[160:175], v[120:123], a[136:139], v[160:175]
  ds_read_b64_tr_b16 v[100:101], v7 offset:4096
  buffer_load_dwordx4 v10, s[8:11], s43 offen offset:1024 lds
  s_waitcnt lgkmcnt(3)
  v_mfma_f32_32x32x16_bf16 v[160:175], v[124:127], a[140:143], v[160:175]
  ds_read_b64_tr_b16 v[102:103], v7 offset:5120
  v_mfma_f32_32x32x16_bf16 v[176:191], v[112:115], a[144:147], v[176:191]
  ds_read_b64_tr_b16 v[104:105], v7 offset:8192
  buffer_load_dwordx4 v11, s[8:11], s43 offen offset:2048 lds
  v_mfma_f32_32x32x16_bf16 v[176:191], v[116:119], a[148:151], v[176:191]
  ds_read_b64_tr_b16 v[106:107], v7 offset:9216
  v_mfma_f32_32x32x16_bf16 v[176:191], v[120:123], a[152:155], v[176:191]
  ds_read_b64_tr_b16 v[108:109], v7 offset:12288
  buffer_load_dwordx4 v12, s[8:11], s43 offen offset:3072 lds
  v_mfma_f32_32x32x16_bf16 v[176:191], v[124:127], a[156:159], v[176:191]
  ds_read_b64_tr_b16 v[110:111], v7 offset:13312
  s_waitcnt lgkmcnt(6)
  v_mfma_f32_32x32x16_bf16 v[192:207], v[96:99], a[128:131], v[192:207]
  s_add_u32 m0, s45, 0x9000
  ds_read_b64_tr_b16 v[112:113], v8
  buffer_load_dwordx4 v13, s[8:11], s43 offen lds
  s_waitcnt lgkmcnt(5)
  v_mfma_f32_32x32x16_bf16 v[192:207], v[100:103], a[132:135], v[192:207]
  ds_read_b64_tr_b16 v[114:115], v8 offset:1024
  s_waitcnt vmcnt(21)
  ds_read_b128 a[160:163], v28
  s_waitcnt lgkmcnt(5)
  v_mfma_f32_32x32x16_bf16 v[192:207], v[104:107], a[136:139], v[192:207]
  ds_read_b64_tr_b16 v[116:117], v8 offset:4096
  buffer_load_dwordx4 v14, s[8:11], s43 offen offset:1024 lds
  s_waitcnt lgkmcnt(4)
  v_mfma_f32_32x32x16_bf16 v[192:207], v[108:111], a[140:143], v[192:207]
  ds_read_b64_tr_b16 v[118:119], v8 offset:5120
  ds_read_b128 a[164:167], v29
  v_mfma_f32_32x32x16_bf16 v[208:223], v[96:99], a[144:147], v[208:223]
  ds_read_b64_tr_b16 v[120:121], v8 offset:8192
  buffer_load_dwordx4 v15, s[8:11], s43 offen offset:2048 lds
  v_mfma_f32_32x32x16_bf16 v[208:223], v[100:103], a[148:151], v[208:223]
  ds_read_b64_tr_b16 v[122:123], v8 offset:9216
  ds_read_b128 a[168:171], v30
  v_mfma_f32_32x32x16_bf16 v[208:223], v[104:107], a[152:155], v[208:223]
  ds_read_b64_tr_b16 v[124:125], v8 offset:12288
  buffer_load_dwordx4 v16, s[8:11], s43 offen offset:3072 lds
  s_add_u32 s43, s43, 128
  v_mfma_f32_32x32x16_bf16 v[208:223], v[108:111], a[156:159], v[208:223]
  ds_read_b64_tr_b16 v[126:127], v8 offset:13312
  s_waitcnt vmcnt(20)
  s_barrier
  ds_read_b128 a[172:175], v31
  s_waitcnt lgkmcnt(10)
  v_mfma_f32_32x32x16_bf16 v[224:239], v[112:115], a[128:131], v[224:239]
  s_add_u32 m0, s46, 0x24000
  ds_read_b64_tr_b16 v[96:97], v5 offset:16384
  buffer_load_dwordx4 v17, s[12:15], s44 offen lds
  s_waitcnt lgkmcnt(8)
  v_mfma_f32_32x32x16_bf16 v[224:239], v[116:119], a[132:135], v[224:239]
  ds_read_b64_tr_b16 v[98:99], v5 offset:17408
  ds_read_b128 a[176:179], v28 offset:4096
  s_waitcnt lgkmcnt(7)
  v_mfma_f32_32x32x16_bf16 v[224:239], v[120:123], a[136:139], v[224:239]
  ds_read_b64_tr_b16 v[100:101], v5 offset:20480
  buffer_load_dwordx4 v18, s[12:15], s44 offen offset:1024 lds
  s_waitcnt lgkmcnt(5)
  v_mfma_f32_32x32x16_bf16 v[224:239], v[124:127], a[140:143], v[224:239]
  ds_read_b64_tr_b16 v[102:103], v5 offset:21504
  ds_read_b128 a[180:183], v29 offset:4096
  v_mfma_f32_32x32x16_bf16 v[240:255], v[112:115], a[144:147], v[240:255]
  ds_read_b64_tr_b16 v[104:105], v5 offset:24576
  buffer_load_dwordx4 v19, s[12:15], s44 offen offset:2048 lds
  v_mfma_f32_32x32x16_bf16 v[240:255], v[116:119], a[148:151], v[240:255]
  ds_read_b64_tr_b16 v[106:107], v5 offset:25600
  ds_read_b128 a[184:187], v30 offset:4096
  v_mfma_f32_32x32x16_bf16 v[240:255], v[120:123], a[152:155], v[240:255]
  ds_read_b64_tr_b16 v[108:109], v5 offset:28672
  buffer_load_dwordx4 v20, s[12:15], s44 offen offset:3072 lds
  v_mfma_f32_32x32x16_bf16 v[240:255], v[124:127], a[156:159], v[240:255]
  ds_read_b64_tr_b16 v[110:111], v5 offset:29696
  ds_read_b128 a[188:191], v31 offset:4096
  s_add_u32 s44, s44, 0x80000
  s_waitcnt lgkmcnt(10)
  v_mfma_f32_32x32x16_bf16 v[128:143], v[96:99], a[160:163], v[128:143]
  ds_read_b64_tr_b16 v[112:113], v6 offset:16384
  s_waitcnt lgkmcnt(8)
  v_mfma_f32_32x32x16_bf16 v[128:143], v[100:103], a[164:167], v[128:143]
  ds_read_b64_tr_b16 v[114:115], v6 offset:17408
  s_waitcnt lgkmcnt(6)
  v_mfma_f32_32x32x16_bf16 v[128:143], v[104:107], a[168:171], v[128:143]
  ds_read_b64_tr_b16 v[116:117], v6 offset:20480
  s_waitcnt lgkmcnt(4)
  v_mfma_f32_32x32x16_bf16 v[128:143], v[108:111], a[172:175], v[128:143]
  ds_read_b64_tr_b16 v[118:119], v6 offset:21504
  v_mfma_f32_32x32x16_bf16 v[144:159], v[96:99], a[176:179], v[144:159]
  ds_read_b64_tr_b16 v[120:121], v6 offset:24576
  v_mfma_f32_32x32x16_bf16 v[144:159], v[100:103], a[180:183], v[144:159]
  ds_read_b64_tr_b16 v[122:123], v6 offset:25600
  v_mfma_f32_32x32x16_bf16 v[144:159], v[104:107], a[184:187], v[144:159]
  ds_read_b64_tr_b16 v[124:125], v6 offset:28672
  s_waitcnt lgkmcnt(7)
  v_mfma_f32_32x32x16_bf16 v[144:159], v[108:111], a[188:191], v[144:159]
  ds_read_b64_tr_b16 v[126:127], v6 offset:29696
  s_waitcnt lgkmcnt(6)
  v_mfma_f32_32x32x16_bf16 v[160:175], v[112:115], a[160:163], v[160:175]
  ds_read_b64_tr_b16 v[96:97], v7 offset:16384
  s_mov_b32 s8, s26
  s_and_b32 s9, s27, 0xffff
  s_mov_b32 s10, 0x200000
  s_mov_b32 s11, 0x20000
  s_lshl_b32 s52, s40, 17
  s_lshl_b32 s53, s42, 15
  s_add_u32 s52, s52, s53
  s_sub_u32 s54, 15, s40
  s_lshl_b32 s54, s54, 17
  s_add_u32 s54, s54, s53
  v_lshrrev_b32 v22, 3, v27
  s_waitcnt lgkmcnt(5)
  v_mfma_f32_32x32x16_bf16 v[160:175], v[116:119], a[164:167], v[160:175]
  ds_read_b64_tr_b16 v[98:99], v7 offset:17408
  v_lshlrev_b32 v22, 10, v22
  v_and_b32 v23, 7, v27
  v_lshrrev_b32 v24, 4, v27
  v_add_u32 v25, 0, v24
  v_xor_b32 v25, v25, v23
  v_lshl_add_u32 v25, v25, 4, v22
  v_add_u32 v25, 0, v25
  v_add_u32 v9, s52, v25
  v_add_u32 v25, 4, v24
  v_xor_b32 v25, v25, v23
  v_lshl_add_u32 v25, v25, 4, v22
  s_waitcnt lgkmcnt(4)
  v_mfma_f32_32x32x16_bf16 v[160:175], v[120:123], a[168:171], v[160:175]
  ds_read_b64_tr_b16 v[100:101], v7 offset:20480
  v_add_u32 v25, 0x1c00, v25
  v_add_u32 v10, s52, v25
  v_add_u32 v25, 0, v24
  v_xor_b32 v25, v25, v23
  v_lshl_add_u32 v25, v25, 4, v22
  v_add_u32 v25, 0x3800, v25
  v_add_u32 v11, s52, v25
  v_add_u32 v25, 4, v24
  v_xor_b32 v25, v25, v23
  v_lshl_add_u32 v25, v25, 4, v22
  v_add_u32 v25, 0x5400, v25
  s_waitcnt lgkmcnt(3)
  v_mfma_f32_32x32x16_bf16 v[160:175], v[124:127], a[172:175], v[160:175]
  ds_read_b64_tr_b16 v[102:103], v7 offset:21504
  v_add_u32 v12, s52, v25
  v_add_u32 v25, 0, v24
  v_xor_b32 v25, v25, v23
  v_lshl_add_u32 v25, v25, 4, v22
  v_add_u32 v25, 0, v25
  v_add_u32 v13, s54, v25
  v_add_u32 v25, 4, v24
  v_xor_b32 v25, v25, v23
  v_lshl_add_u32 v25, v25, 4, v22
  v_add_u32 v25, 0x1c00, v25
  v_add_u32 v14, s54, v25
  v_mfma_f32_32x32x16_bf16 v[176:191], v[112:115], a[176:179], v[176:191]
  ds_read_b64_tr_b16 v[104:105], v7 offset:24576
  v_add_u32 v25, 0, v24
  v_xor_b32 v25, v25, v23
  v_lshl_add_u32 v25, v25, 4, v22
  v_add_u32 v25, 0x3800, v25
  v_add_u32 v15, s54, v25
  v_add_u32 v25, 4, v24
  v_xor_b32 v25, v25, v23
  v_lshl_add_u32 v25, v25, 4, v22
  v_add_u32 v25, 0x5400, v25
  v_add_u32 v16, s54, v25
  s_mov_b32 s43, 0
  v_mfma_f32_32x32x16_bf16 v[176:191], v[116:119], a[180:183], v[176:191]
  s_add_u32 m0, s45, 0x10000
  ds_read_b64_tr_b16 v[106:107], v7 offset:25600
  buffer_load_dwordx4 v9, s[8:11], s43 offen lds
  v_mfma_f32_32x32x16_bf16 v[176:191], v[120:123], a[184:187], v[176:191]
  ds_read_b64_tr_b16 v[108:109], v7 offset:28672
  buffer_load_dwordx4 v10, s[8:11], s43 offen offset:1024 lds
  v_mfma_f32_32x32x16_bf16 v[176:191], v[124:127], a[188:191], v[176:191]
  ds_read_b64_tr_b16 v[110:111], v7 offset:29696
  buffer_load_dwordx4 v11, s[8:11], s43 offen offset:2048 lds
  s_waitcnt lgkmcnt(6)
  v_mfma_f32_32x32x16_bf16 v[192:207], v[96:99], a[160:163], v[192:207]
  ds_read_b64_tr_b16 v[112:113], v8 offset:16384
  buffer_load_dwordx4 v12, s[8:11], s43 offen offset:3072 lds
  s_waitcnt lgkmcnt(5)
  v_mfma_f32_32x32x16_bf16 v[192:207], v[100:103], a[164:167], v[192:207]
  ds_read_b64_tr_b16 v[114:115], v8 offset:17408
  s_waitcnt vmcnt(20)
  s_add_u32 m0, s45, 0x11000
  ds_read_b128 a[192:195], v1
  buffer_load_dwordx4 v13, s[8:11], s43 offen lds
  s_waitcnt lgkmcnt(5)
  v_mfma_f32_32x32x16_bf16 v[192:207], v[104:107], a[168:171], v[192:207]
  ds_read_b64_tr_b16 v[116:117], v8 offset:20480
  buffer_load_dwordx4 v14, s[8:11], s43 offen offset:1024 lds
  s_waitcnt lgkmcnt(4)
  v_mfma_f32_32x32x16_bf16 v[192:207], v[108:111], a[172:175], v[192:207]
  ds_read_b64_tr_b16 v[118:119], v8 offset:21504
  ds_read_b128 a[196:199], v2
  buffer_load_dwordx4 v15, s[8:11], s43 offen offset:2048 lds
  v_mfma_f32_32x32x16_bf16 v[208:223], v[96:99], a[176:179], v[208:223]
  ds_read_b64_tr_b16 v[120:121], v8 offset:24576
  buffer_load_dwordx4 v16, s[8:11], s43 offen offset:3072 lds
  v_mfma_f32_32x32x16_bf16 v[208:223], v[100:103], a[180:183], v[208:223]
  ds_read_b64_tr_b16 v[122:123], v8 offset:25600
  ds_read_b128 a[200:203], v3
  s_add_u32 s43, s43, 128
  v_mfma_f32_32x32x16_bf16 v[208:223], v[104:107], a[184:187], v[208:223]
  ds_read_b64_tr_b16 v[124:125], v8 offset:28672
  v_mfma_f32_32x32x16_bf16 v[208:223], v[108:111], a[188:191], v[208:223]
  ds_read_b64_tr_b16 v[126:127], v8 offset:29696
  s_waitcnt vmcnt(20)
  s_barrier
  ds_read_b128 a[204:207], v4
  s_waitcnt lgkmcnt(10)
  v_mfma_f32_32x32x16_bf16 v[224:239], v[112:115], a[160:163], v[224:239]
  ds_read_b64_tr_b16 v[96:97], v5 offset:32768
  s_mov_b32 s12, s34
  s_and_b32 s13, s35, 0xffff
  s_mov_b32 s14, 0x400000
  s_waitcnt lgkmcnt(8)
  v_mfma_f32_32x32x16_bf16 v[224:239], v[116:119], a[164:167], v[224:239]
  ds_read_b64_tr_b16 v[98:99], v5 offset:33792
  ds_read_b128 a[208:211], v1 offset:4096
  s_mov_b32 s15, 0x20000
  s_sub_u32 s44, s44, 0x400000
  s_waitcnt lgkmcnt(7)
  v_mfma_f32_32x32x16_bf16 v[224:239], v[120:123], a[168:171], v[224:239]
  s_add_u32 m0, s46, 0x18000
  ds_read_b64_tr_b16 v[100:101], v5 offset:36864
  buffer_load_dwordx4 v17, s[12:15], s44 offen lds
  s_waitcnt lgkmcnt(5)
  v_mfma_f32_32x32x16_bf16 v[224:239], v[124:127], a[172:175], v[224:239]
  ds_read_b64_tr_b16 v[102:103], v5 offset:37888
  ds_read_b128 a[212:215], v2 offset:4096
  buffer_load_dwordx4 v18, s[12:15], s44 offen offset:1024 lds
  v_mfma_f32_32x32x16_bf16 v[240:255], v[112:115], a[176:179], v[240:255]
  ds_read_b64_tr_b16 v[104:105], v5 offset:40960
  buffer_load_dwordx4 v19, s[12:15], s44 offen offset:2048 lds
  v_mfma_f32_32x32x16_bf16 v[240:255], v[116:119], a[180:183], v[240:255]
  ds_read_b64_tr_b16 v[106:107], v5 offset:41984
  ds_read_b128 a[216:219], v3 offset:4096
  buffer_load_dwordx4 v20, s[12:15], s44 offen offset:3072 lds
  v_mfma_f32_32x32x16_bf16 v[240:255], v[120:123], a[184:187], v[240:255]
  ds_read_b64_tr_b16 v[108:109], v5 offset:45056
  s_add_u32 s44, s44, 0x80000
  v_mfma_f32_32x32x16_bf16 v[240:255], v[124:127], a[188:191], v[240:255]
  ds_read_b64_tr_b16 v[110:111], v5 offset:46080
  ds_read_b128 a[220:223], v4 offset:4096
  s_waitcnt lgkmcnt(10)
  v_mfma_f32_32x32x16_bf16 v[128:143], v[96:99], a[192:195], v[128:143]
  ds_read_b64_tr_b16 v[112:113], v6 offset:32768
  s_waitcnt lgkmcnt(8)
  v_mfma_f32_32x32x16_bf16 v[128:143], v[100:103], a[196:199], v[128:143]
  ds_read_b64_tr_b16 v[114:115], v6 offset:33792
  s_waitcnt lgkmcnt(6)
  v_mfma_f32_32x32x16_bf16 v[128:143], v[104:107], a[200:203], v[128:143]
  ds_read_b64_tr_b16 v[116:117], v6 offset:36864
  s_waitcnt lgkmcnt(4)
  v_mfma_f32_32x32x16_bf16 v[128:143], v[108:111], a[204:207], v[128:143]
  ds_read_b64_tr_b16 v[118:119], v6 offset:37888
  v_mfma_f32_32x32x16_bf16 v[144:159], v[96:99], a[208:211], v[144:159]
  ds_read_b64_tr_b16 v[120:121], v6 offset:40960
  v_mfma_f32_32x32x16_bf16 v[144:159], v[100:103], a[212:215], v[144:159]
  ds_read_b64_tr_b16 v[122:123], v6 offset:41984
  v_mfma_f32_32x32x16_bf16 v[144:159], v[104:107], a[216:219], v[144:159]
  ds_read_b64_tr_b16 v[124:125], v6 offset:45056
  s_waitcnt lgkmcnt(7)
  v_mfma_f32_32x32x16_bf16 v[144:159], v[108:111], a[220:223], v[144:159]
  ds_read_b64_tr_b16 v[126:127], v6 offset:46080
  s_waitcnt lgkmcnt(6)
  v_mfma_f32_32x32x16_bf16 v[160:175], v[112:115], a[192:195], v[160:175]
  s_add_u32 m0, s45, 0
  ds_read_b64_tr_b16 v[96:97], v7 offset:32768
  buffer_load_dwordx4 v9, s[8:11], s43 offen lds
  s_waitcnt lgkmcnt(5)
  v_mfma_f32_32x32x16_bf16 v[160:175], v[116:119], a[196:199], v[160:175]
  ds_read_b64_tr_b16 v[98:99], v7 offset:33792
  s_waitcnt lgkmcnt(4)
  v_mfma_f32_32x32x16_bf16 v[160:175], v[120:123], a[200:203], v[160:175]
  ds_read_b64_tr_b16 v[100:101], v7 offset:36864
  buffer_load_dwordx4 v10, s[8:11], s43 offen offset:1024 lds
  s_waitcnt lgkmcnt(3)
  v_mfma_f32_32x32x16_bf16 v[160:175], v[124:127], a[204:207], v[160:175]
  ds_read_b64_tr_b16 v[102:103], v7 offset:37888
  v_mfma_f32_32x32x16_bf16 v[176:191], v[112:115], a[208:211], v[176:191]
  ds_read_b64_tr_b16 v[104:105], v7 offset:40960
  buffer_load_dwordx4 v11, s[8:11], s43 offen offset:2048 lds
  v_mfma_f32_32x32x16_bf16 v[176:191], v[116:119], a[212:215], v[176:191]
  ds_read_b64_tr_b16 v[106:107], v7 offset:41984
  v_mfma_f32_32x32x16_bf16 v[176:191], v[120:123], a[216:219], v[176:191]
  ds_read_b64_tr_b16 v[108:109], v7 offset:45056
  buffer_load_dwordx4 v12, s[8:11], s43 offen offset:3072 lds
  v_mfma_f32_32x32x16_bf16 v[176:191], v[124:127], a[220:223], v[176:191]
  ds_read_b64_tr_b16 v[110:111], v7 offset:46080
  s_waitcnt lgkmcnt(6)
  v_mfma_f32_32x32x16_bf16 v[192:207], v[96:99], a[192:195], v[192:207]
  s_add_u32 m0, s45, 0x1000
  ds_read_b64_tr_b16 v[112:113], v8 offset:32768
  buffer_load_dwordx4 v13, s[8:11], s43 offen lds
  s_waitcnt lgkmcnt(5)
  v_mfma_f32_32x32x16_bf16 v[192:207], v[100:103], a[196:199], v[192:207]
  ds_read_b64_tr_b16 v[114:115], v8 offset:33792
  s_waitcnt vmcnt(21)
  ds_read_b128 a[224:227], v1 offset:32768
  s_waitcnt lgkmcnt(5)
  v_mfma_f32_32x32x16_bf16 v[192:207], v[104:107], a[200:203], v[192:207]
  ds_read_b64_tr_b16 v[116:117], v8 offset:36864
  buffer_load_dwordx4 v14, s[8:11], s43 offen offset:1024 lds
  s_waitcnt lgkmcnt(4)
  v_mfma_f32_32x32x16_bf16 v[192:207], v[108:111], a[204:207], v[192:207]
  ds_read_b64_tr_b16 v[118:119], v8 offset:37888
  ds_read_b128 a[228:231], v2 offset:32768
  v_mfma_f32_32x32x16_bf16 v[208:223], v[96:99], a[208:211], v[208:223]
  ds_read_b64_tr_b16 v[120:121], v8 offset:40960
  buffer_load_dwordx4 v15, s[8:11], s43 offen offset:2048 lds
  v_mfma_f32_32x32x16_bf16 v[208:223], v[100:103], a[212:215], v[208:223]
  ds_read_b64_tr_b16 v[122:123], v8 offset:41984
  ds_read_b128 a[232:235], v3 offset:32768
  v_mfma_f32_32x32x16_bf16 v[208:223], v[104:107], a[216:219], v[208:223]
  ds_read_b64_tr_b16 v[124:125], v8 offset:45056
  buffer_load_dwordx4 v16, s[8:11], s43 offen offset:3072 lds
  s_add_u32 s43, s43, 128
  v_mfma_f32_32x32x16_bf16 v[208:223], v[108:111], a[220:223], v[208:223]
  ds_read_b64_tr_b16 v[126:127], v8 offset:46080
  s_waitcnt vmcnt(20)
  s_barrier
  ds_read_b128 a[236:239], v4 offset:32768
  s_waitcnt lgkmcnt(10)
  v_mfma_f32_32x32x16_bf16 v[224:239], v[112:115], a[192:195], v[224:239]
  s_add_u32 m0, s46, 0x1c000
  ds_read_b64_tr_b16 v[96:97], v5 offset:49152
  buffer_load_dwordx4 v17, s[12:15], s44 offen lds
  s_waitcnt lgkmcnt(8)
  v_mfma_f32_32x32x16_bf16 v[224:239], v[116:119], a[196:199], v[224:239]
  ds_read_b64_tr_b16 v[98:99], v5 offset:50176
  ds_read_b128 a[240:243], v1 offset:36864
  s_waitcnt lgkmcnt(7)
  v_mfma_f32_32x32x16_bf16 v[224:239], v[120:123], a[200:203], v[224:239]
  ds_read_b64_tr_b16 v[100:101], v5 offset:53248
  buffer_load_dwordx4 v18, s[12:15], s44 offen offset:1024 lds
  s_waitcnt lgkmcnt(5)
  v_mfma_f32_32x32x16_bf16 v[224:239], v[124:127], a[204:207], v[224:239]
  ds_read_b64_tr_b16 v[102:103], v5 offset:54272
  ds_read_b128 a[244:247], v2 offset:36864
  v_mfma_f32_32x32x16_bf16 v[240:255], v[112:115], a[208:211], v[240:255]
  ds_read_b64_tr_b16 v[104:105], v5 offset:57344
  buffer_load_dwordx4 v19, s[12:15], s44 offen offset:2048 lds
  v_mfma_f32_32x32x16_bf16 v[240:255], v[116:119], a[212:215], v[240:255]
  ds_read_b64_tr_b16 v[106:107], v5 offset:58368
  ds_read_b128 a[248:251], v3 offset:36864
  v_mfma_f32_32x32x16_bf16 v[240:255], v[120:123], a[216:219], v[240:255]
  ds_read_b64_tr_b16 v[108:109], v5 offset:61440
  buffer_load_dwordx4 v20, s[12:15], s44 offen offset:3072 lds
  v_mfma_f32_32x32x16_bf16 v[240:255], v[124:127], a[220:223], v[240:255]
  ds_read_b64_tr_b16 v[110:111], v5 offset:62464
  ds_read_b128 a[252:255], v4 offset:36864
  s_add_u32 s44, s44, 0x80000
  s_waitcnt lgkmcnt(10)
  v_mfma_f32_32x32x16_bf16 v[128:143], v[96:99], a[224:227], v[128:143]
  ds_read_b64_tr_b16 v[112:113], v6 offset:49152
  s_waitcnt lgkmcnt(8)
  v_mfma_f32_32x32x16_bf16 v[128:143], v[100:103], a[228:231], v[128:143]
  ds_read_b64_tr_b16 v[114:115], v6 offset:50176
  s_lshl_b32 s52, s40, 3
  s_lshl_b32 s53, s42, 1
  s_add_u32 s52, s52, s53
  s_waitcnt lgkmcnt(6)
  v_mfma_f32_32x32x16_bf16 v[128:143], v[104:107], a[232:235], v[128:143]
  ds_read_b64_tr_b16 v[116:117], v6 offset:53248
  s_lshl_b32 s52, s52, 13
  s_mul_i32 s53, s41, 0x80000
  s_add_u32 s52, s52, s53
  s_waitcnt lgkmcnt(4)
  v_mfma_f32_32x32x16_bf16 v[128:143], v[108:111], a[236:239], v[128:143]
  ds_read_b64_tr_b16 v[118:119], v6 offset:54272
  s_add_u32 s47, s52, 0x1000000
  s_add_u32 s48, s47, 4096
  s_add_u32 s49, s47, 8192
  v_mfma_f32_32x32x16_bf16 v[144:159], v[96:99], a[240:243], v[144:159]
  ds_read_b64_tr_b16 v[120:121], v6 offset:57344
  s_add_u32 s50, s47, 12288
  s_mov_b32 s56, 0x3e0293ee
  s_mov_b32 s57, 0x3e0293ee
  v_mfma_f32_32x32x16_bf16 v[144:159], v[100:103], a[244:247], v[144:159]
  ds_read_b64_tr_b16 v[122:123], v6 offset:58368
  v_mfma_f32_32x32x16_bf16 v[144:159], v[104:107], a[248:251], v[144:159]
  ds_read_b64_tr_b16 v[124:125], v6 offset:61440
  s_waitcnt lgkmcnt(7)
  v_mfma_f32_32x32x16_bf16 v[144:159], v[108:111], a[252:255], v[144:159]
  ds_read_b64_tr_b16 v[126:127], v6 offset:62464
  v_mul_f32 v128, s56, v128
  v_mul_f32 v129, s56, v129
  v_mul_f32 v130, s56, v130
  v_mul_f32 v131, s56, v131
  v_mul_f32 v132, s56, v132
  s_waitcnt lgkmcnt(6)
  v_mfma_f32_32x32x16_bf16 v[160:175], v[112:115], a[224:227], v[160:175]
  s_add_u32 m0, s45, 0x8000
  ds_read_b64_tr_b16 v[96:97], v7 offset:49152
  buffer_load_dwordx4 v9, s[8:11], s43 offen lds
  v_mul_f32 v133, s56, v133
  v_mul_f32 v134, s56, v134
  v_mul_f32 v135, s56, v135
  v_mul_f32 v136, s56, v136
  v_mul_f32 v137, s56, v137
  s_waitcnt lgkmcnt(5)
  v_mfma_f32_32x32x16_bf16 v[160:175], v[116:119], a[228:231], v[160:175]
  ds_read_b64_tr_b16 v[98:99], v7 offset:50176
  v_mul_f32 v138, s56, v138
  v_mul_f32 v139, s56, v139
  v_mul_f32 v140, s56, v140
  v_mul_f32 v141, s56, v141
  v_mul_f32 v142, s56, v142
  s_waitcnt lgkmcnt(4)
  v_mfma_f32_32x32x16_bf16 v[160:175], v[120:123], a[232:235], v[160:175]
  ds_read_b64_tr_b16 v[100:101], v7 offset:53248
  buffer_load_dwordx4 v10, s[8:11], s43 offen offset:1024 lds
  v_mul_f32 v143, s56, v143
  v_cvt_pk_bf16_f32 v32, v128, v129
  v_cvt_pk_bf16_f32 v33, v130, v131
  v_cvt_pk_bf16_f32 v34, v132, v133
  v_cvt_pk_bf16_f32 v35, v134, v135
  s_waitcnt lgkmcnt(3)
  v_mfma_f32_32x32x16_bf16 v[160:175], v[124:127], a[236:239], v[160:175]
  ds_read_b64_tr_b16 v[102:103], v7 offset:54272
  v_cvt_pk_bf16_f32 v36, v136, v137
  v_cvt_pk_bf16_f32 v37, v138, v139
  v_cvt_pk_bf16_f32 v38, v140, v141
  v_cvt_pk_bf16_f32 v39, v142, v143
  v_mul_f32 v144, s56, v144
  v_mul_f32 v145, s56, v145
  v_mul_f32 v146, s56, v146
  v_mul_f32 v147, s56, v147
  v_mul_f32 v148, s56, v148
  v_mfma_f32_32x32x16_bf16 v[176:191], v[112:115], a[240:243], v[176:191]
  ds_read_b64_tr_b16 v[104:105], v7 offset:57344
  buffer_load_dwordx4 v11, s[8:11], s43 offen offset:2048 lds
  v_mul_f32 v149, s56, v149
  v_mul_f32 v150, s56, v150
  v_mul_f32 v151, s56, v151
  v_mul_f32 v152, s56, v152
  v_mul_f32 v153, s56, v153
  v_mfma_f32_32x32x16_bf16 v[176:191], v[116:119], a[244:247], v[176:191]
  ds_read_b64_tr_b16 v[106:107], v7 offset:58368
  v_mul_f32 v154, s56, v154
  v_mul_f32 v155, s56, v155
  v_mul_f32 v156, s56, v156
  v_mul_f32 v157, s56, v157
  v_mul_f32 v158, s56, v158
  v_mfma_f32_32x32x16_bf16 v[176:191], v[120:123], a[248:251], v[176:191]
  ds_read_b64_tr_b16 v[108:109], v7 offset:61440
  buffer_load_dwordx4 v12, s[8:11], s43 offen offset:3072 lds
  v_mul_f32 v159, s56, v159
  v_cvt_pk_bf16_f32 v40, v144, v145
  v_cvt_pk_bf16_f32 v41, v146, v147
  v_cvt_pk_bf16_f32 v42, v148, v149
  v_cvt_pk_bf16_f32 v43, v150, v151
  v_mfma_f32_32x32x16_bf16 v[176:191], v[124:127], a[252:255], v[176:191]
  ds_read_b64_tr_b16 v[110:111], v7 offset:62464
  v_cvt_pk_bf16_f32 v44, v152, v153
  v_cvt_pk_bf16_f32 v45, v154, v155
  v_cvt_pk_bf16_f32 v46, v156, v157
  v_cvt_pk_bf16_f32 v47, v158, v159
  v_mul_f32 v160, s56, v160
  v_mul_f32 v161, s56, v161
  v_mul_f32 v162, s56, v162
  v_mul_f32 v163, s56, v163
  v_mul_f32 v164, s56, v164
  s_waitcnt lgkmcnt(6)
  v_mfma_f32_32x32x16_bf16 v[192:207], v[96:99], a[224:227], v[192:207]
  s_add_u32 m0, s45, 0x9000
  ds_read_b64_tr_b16 v[112:113], v8 offset:49152
  buffer_load_dwordx4 v13, s[8:11], s43 offen lds
  v_mul_f32 v165, s56, v165
  v_mul_f32 v166, s56, v166
  v_mul_f32 v167, s56, v167
  v_mul_f32 v168, s56, v168
  v_mul_f32 v169, s56, v169
  s_waitcnt lgkmcnt(5)
  v_mfma_f32_32x32x16_bf16 v[192:207], v[100:103], a[228:231], v[192:207]
  ds_read_b64_tr_b16 v[114:115], v8 offset:50176
  v_mul_f32 v170, s56, v170
  v_mul_f32 v171, s56, v171
  v_mul_f32 v172, s56, v172
  v_mul_f32 v173, s56, v173
  v_mul_f32 v174, s56, v174
  s_waitcnt lgkmcnt(4)
  v_mfma_f32_32x32x16_bf16 v[192:207], v[104:107], a[232:235], v[192:207]
  ds_read_b64_tr_b16 v[116:117], v8 offset:53248
  buffer_load_dwordx4 v14, s[8:11], s43 offen offset:1024 lds
  v_mul_f32 v175, s56, v175
  v_cvt_pk_bf16_f32 v48, v160, v161
  v_cvt_pk_bf16_f32 v49, v162, v163
  v_cvt_pk_bf16_f32 v50, v164, v165
  v_cvt_pk_bf16_f32 v51, v166, v167
  s_waitcnt lgkmcnt(3)
  v_mfma_f32_32x32x16_bf16 v[192:207], v[108:111], a[236:239], v[192:207]
  ds_read_b64_tr_b16 v[118:119], v8 offset:54272
  v_cvt_pk_bf16_f32 v52, v168, v169
  v_cvt_pk_bf16_f32 v53, v170, v171
  v_cvt_pk_bf16_f32 v54, v172, v173
  v_cvt_pk_bf16_f32 v55, v174, v175
  v_mul_f32 v176, s56, v176
  v_mul_f32 v177, s56, v177
  v_mul_f32 v178, s56, v178
  v_mul_f32 v179, s56, v179
  v_mul_f32 v180, s56, v180
  v_mfma_f32_32x32x16_bf16 v[208:223], v[96:99], a[240:243], v[208:223]
  ds_read_b64_tr_b16 v[120:121], v8 offset:57344
  buffer_load_dwordx4 v15, s[8:11], s43 offen offset:2048 lds
  v_mul_f32 v181, s56, v181
  v_mul_f32 v182, s56, v182
  v_mul_f32 v183, s56, v183
  v_mul_f32 v184, s56, v184
  v_mul_f32 v185, s56, v185
  v_mfma_f32_32x32x16_bf16 v[208:223], v[100:103], a[244:247], v[208:223]
  ds_read_b64_tr_b16 v[122:123], v8 offset:58368
  v_mul_f32 v186, s56, v186
  v_mul_f32 v187, s56, v187
  v_mul_f32 v188, s56, v188
  v_mul_f32 v189, s56, v189
  v_mul_f32 v190, s56, v190
  v_mfma_f32_32x32x16_bf16 v[208:223], v[104:107], a[248:251], v[208:223]
  ds_read_b64_tr_b16 v[124:125], v8 offset:61440
  buffer_load_dwordx4 v16, s[8:11], s43 offen offset:3072 lds
  s_add_u32 s43, s43, 128
  v_mul_f32 v191, s56, v191
  v_cvt_pk_bf16_f32 v56, v176, v177
  v_cvt_pk_bf16_f32 v57, v178, v179
  v_cvt_pk_bf16_f32 v58, v180, v181
  v_cvt_pk_bf16_f32 v59, v182, v183
  v_mfma_f32_32x32x16_bf16 v[208:223], v[108:111], a[252:255], v[208:223]
  ds_read_b64_tr_b16 v[126:127], v8 offset:62464
  s_waitcnt vmcnt(20)
  s_barrier
  v_cvt_pk_bf16_f32 v60, v184, v185
  v_cvt_pk_bf16_f32 v61, v186, v187
  v_cvt_pk_bf16_f32 v62, v188, v189
  v_cvt_pk_bf16_f32 v63, v190, v191
  v_mul_f32 v192, s56, v192
  v_mul_f32 v193, s56, v193
  v_mul_f32 v194, s56, v194
  v_mul_f32 v195, s56, v195
  v_mul_f32 v196, s56, v196
  s_waitcnt lgkmcnt(6)
  v_mfma_f32_32x32x16_bf16 v[224:239], v[112:115], a[224:227], v[224:239]
  s_add_u32 m0, s46, 0x20000
  ds_read_b64_tr_b16 v[96:97], v5
  buffer_load_dwordx4 v17, s[12:15], s44 offen lds
  v_mul_f32 v197, s56, v197
  v_mul_f32 v198, s56, v198
  v_mul_f32 v199, s56, v199
  v_mul_f32 v200, s56, v200
  v_mul_f32 v201, s56, v201
  s_waitcnt lgkmcnt(5)
  v_mfma_f32_32x32x16_bf16 v[224:239], v[116:119], a[228:231], v[224:239]
  ds_read_b64_tr_b16 v[98:99], v5 offset:1024
  v_mul_f32 v202, s56, v202
  v_mul_f32 v203, s56, v203
  v_mul_f32 v204, s56, v204
  v_mul_f32 v205, s56, v205
  v_mul_f32 v206, s56, v206
  s_waitcnt lgkmcnt(4)
  v_mfma_f32_32x32x16_bf16 v[224:239], v[120:123], a[232:235], v[224:239]
  ds_read_b64_tr_b16 v[100:101], v5 offset:4096
  buffer_load_dwordx4 v18, s[12:15], s44 offen offset:1024 lds
  v_mul_f32 v207, s56, v207
  v_cvt_pk_bf16_f32 v64, v192, v193
  v_cvt_pk_bf16_f32 v65, v194, v195
  v_cvt_pk_bf16_f32 v66, v196, v197
  v_cvt_pk_bf16_f32 v67, v198, v199
  s_waitcnt lgkmcnt(3)
  v_mfma_f32_32x32x16_bf16 v[224:239], v[124:127], a[236:239], v[224:239]
  ds_read_b64_tr_b16 v[102:103], v5 offset:5120
  v_cvt_pk_bf16_f32 v68, v200, v201
  v_cvt_pk_bf16_f32 v69, v202, v203
  v_cvt_pk_bf16_f32 v70, v204, v205
  v_cvt_pk_bf16_f32 v71, v206, v207
  v_mul_f32 v208, s56, v208
  v_mul_f32 v209, s56, v209
  v_mul_f32 v210, s56, v210
  v_mul_f32 v211, s56, v211
  v_mul_f32 v212, s56, v212
  v_mfma_f32_32x32x16_bf16 v[240:255], v[112:115], a[240:243], v[240:255]
  ds_read_b64_tr_b16 v[104:105], v5 offset:8192
  buffer_load_dwordx4 v19, s[12:15], s44 offen offset:2048 lds
  v_mul_f32 v213, s56, v213
  v_mul_f32 v214, s56, v214
  v_mul_f32 v215, s56, v215
  v_mul_f32 v216, s56, v216
  v_mul_f32 v217, s56, v217
  v_mfma_f32_32x32x16_bf16 v[240:255], v[116:119], a[244:247], v[240:255]
  ds_read_b64_tr_b16 v[106:107], v5 offset:9216
  v_mul_f32 v218, s56, v218
  v_mul_f32 v219, s56, v219
  v_mul_f32 v220, s56, v220
  v_mul_f32 v221, s56, v221
  v_mul_f32 v222, s56, v222
  v_mfma_f32_32x32x16_bf16 v[240:255], v[120:123], a[248:251], v[240:255]
  ds_read_b64_tr_b16 v[108:109], v5 offset:12288
  buffer_load_dwordx4 v20, s[12:15], s44 offen offset:3072 lds
  v_mul_f32 v223, s56, v223
  v_cvt_pk_bf16_f32 v72, v208, v209
  v_cvt_pk_bf16_f32 v73, v210, v211
  v_cvt_pk_bf16_f32 v74, v212, v213
  v_cvt_pk_bf16_f32 v75, v214, v215
  v_mfma_f32_32x32x16_bf16 v[240:255], v[124:127], a[252:255], v[240:255]
  ds_read_b64_tr_b16 v[110:111], v5 offset:13312
  s_add_u32 s44, s44, 0x80000
  v_cvt_pk_bf16_f32 v76, v216, v217
  v_cvt_pk_bf16_f32 v77, v218, v219
  v_cvt_pk_bf16_f32 v78, v220, v221
  v_cvt_pk_bf16_f32 v79, v222, v223
  v_mul_f32 v224, s56, v224
  v_mul_f32 v225, s56, v225
  v_mul_f32 v226, s56, v226
  v_mul_f32 v227, s56, v227
  v_mul_f32 v228, s56, v228
  s_waitcnt lgkmcnt(6)
  v_mfma_f32_32x32x16_bf16 v[128:143], a[0:3], v[96:99], 0
  ds_read_b64_tr_b16 v[112:113], v6
  v_mul_f32 v229, s56, v229
  v_mul_f32 v230, s56, v230
  v_mul_f32 v231, s56, v231
  v_mul_f32 v232, s56, v232
  v_mul_f32 v233, s56, v233
  s_waitcnt lgkmcnt(5)
  v_mfma_f32_32x32x16_bf16 v[128:143], a[4:7], v[100:103], v[128:143]
  ds_read_b64_tr_b16 v[114:115], v6 offset:1024
  v_mul_f32 v234, s56, v234
  v_mul_f32 v235, s56, v235
  v_mul_f32 v236, s56, v236
  v_mul_f32 v237, s56, v237
  v_mul_f32 v238, s56, v238
  s_waitcnt lgkmcnt(4)
  v_mfma_f32_32x32x16_bf16 v[128:143], a[8:11], v[104:107], v[128:143]
  ds_read_b64_tr_b16 v[116:117], v6 offset:4096
  v_mul_f32 v239, s56, v239
  v_cvt_pk_bf16_f32 v80, v224, v225
  v_cvt_pk_bf16_f32 v81, v226, v227
  v_cvt_pk_bf16_f32 v82, v228, v229
  v_cvt_pk_bf16_f32 v83, v230, v231
  s_waitcnt lgkmcnt(3)
  v_mfma_f32_32x32x16_bf16 v[128:143], a[12:15], v[108:111], v[128:143]
  ds_read_b64_tr_b16 v[118:119], v6 offset:5120
  v_cvt_pk_bf16_f32 v84, v232, v233
  v_cvt_pk_bf16_f32 v85, v234, v235
  v_cvt_pk_bf16_f32 v86, v236, v237
  v_cvt_pk_bf16_f32 v87, v238, v239
  v_mul_f32 v240, s56, v240
  v_mul_f32 v241, s56, v241
  v_mul_f32 v242, s56, v242
  v_mul_f32 v243, s56, v243
  v_mul_f32 v244, s56, v244
  v_mfma_f32_32x32x16_bf16 v[144:159], a[16:19], v[96:99], 0
  ds_read_b64_tr_b16 v[120:121], v6 offset:8192
  v_mul_f32 v245, s56, v245
  v_mul_f32 v246, s56, v246
  v_mul_f32 v247, s56, v247
  v_mul_f32 v248, s56, v248
  v_mul_f32 v249, s56, v249
  v_mfma_f32_32x32x16_bf16 v[144:159], a[20:23], v[100:103], v[144:159]
  ds_read_b64_tr_b16 v[122:123], v6 offset:9216
  v_mul_f32 v250, s56, v250
  v_mul_f32 v251, s56, v251
  v_mul_f32 v252, s56, v252
  v_mul_f32 v253, s56, v253
  v_mul_f32 v254, s56, v254
  v_mfma_f32_32x32x16_bf16 v[144:159], a[24:27], v[104:107], v[144:159]
  ds_read_b64_tr_b16 v[124:125], v6 offset:12288
  v_mul_f32 v255, s56, v255
  v_cvt_pk_bf16_f32 v88, v240, v241
  v_cvt_pk_bf16_f32 v89, v242, v243
  v_cvt_pk_bf16_f32 v90, v244, v245
  v_cvt_pk_bf16_f32 v91, v246, v247
  v_mfma_f32_32x32x16_bf16 v[144:159], a[28:31], v[108:111], v[144:159]
  ds_read_b64_tr_b16 v[126:127], v6 offset:13312
  v_cvt_pk_bf16_f32 v92, v248, v249
  v_cvt_pk_bf16_f32 v93, v250, v251
  v_cvt_pk_bf16_f32 v94, v252, v253
  v_cvt_pk_bf16_f32 v95, v254, v255
  s_waitcnt lgkmcnt(6)
  v_mfma_f32_32x32x16_bf16 v[160:175], a[0:3], v[112:115], 0
  ds_read_b64_tr_b16 v[96:97], v7
  s_waitcnt lgkmcnt(5)
  v_mfma_f32_32x32x16_bf16 v[160:175], a[4:7], v[116:119], v[160:175]
  ds_read_b64_tr_b16 v[98:99], v7 offset:1024
  buffer_store_dwordx4 v[32:35], v21, s[16:19], s47 offen sc1
  s_waitcnt lgkmcnt(4)
  v_mfma_f32_32x32x16_bf16 v[160:175], a[8:11], v[120:123], v[160:175]
  ds_read_b64_tr_b16 v[100:101], v7 offset:4096
  s_waitcnt lgkmcnt(3)
  v_mfma_f32_32x32x16_bf16 v[160:175], a[12:15], v[124:127], v[160:175]
  ds_read_b64_tr_b16 v[102:103], v7 offset:5120
  v_mfma_f32_32x32x16_bf16 v[176:191], a[16:19], v[112:115], 0
  ds_read_b64_tr_b16 v[104:105], v7 offset:8192
  v_mfma_f32_32x32x16_bf16 v[176:191], a[20:23], v[116:119], v[176:191]
  ds_read_b64_tr_b16 v[106:107], v7 offset:9216
  v_mfma_f32_32x32x16_bf16 v[176:191], a[24:27], v[120:123], v[176:191]
  ds_read_b64_tr_b16 v[108:109], v7 offset:12288
  v_mfma_f32_32x32x16_bf16 v[176:191], a[28:31], v[124:127], v[176:191]
  ds_read_b64_tr_b16 v[110:111], v7 offset:13312
  buffer_store_dwordx4 v[36:39], v21, s[16:19], s47 offen offset:1024 sc1
  s_waitcnt lgkmcnt(6)
  v_mfma_f32_32x32x16_bf16 v[192:207], a[0:3], v[96:99], 0
  ds_read_b64_tr_b16 v[112:113], v8
  s_waitcnt lgkmcnt(5)
  v_mfma_f32_32x32x16_bf16 v[192:207], a[4:7], v[100:103], v[192:207]
  ds_read_b64_tr_b16 v[114:115], v8 offset:1024
  s_waitcnt lgkmcnt(4)
  v_mfma_f32_32x32x16_bf16 v[192:207], a[8:11], v[104:107], v[192:207]
  ds_read_b64_tr_b16 v[116:117], v8 offset:4096
  s_waitcnt lgkmcnt(3)
  v_mfma_f32_32x32x16_bf16 v[192:207], a[12:15], v[108:111], v[192:207]
  ds_read_b64_tr_b16 v[118:119], v8 offset:5120
  v_mfma_f32_32x32x16_bf16 v[208:223], a[16:19], v[96:99], 0
  ds_read_b64_tr_b16 v[120:121], v8 offset:8192
  v_mfma_f32_32x32x16_bf16 v[208:223], a[20:23], v[100:103], v[208:223]
  ds_read_b64_tr_b16 v[122:123], v8 offset:9216
  v_mfma_f32_32x32x16_bf16 v[208:223], a[24:27], v[104:107], v[208:223]
  ds_read_b64_tr_b16 v[124:125], v8 offset:12288
  v_mfma_f32_32x32x16_bf16 v[208:223], a[28:31], v[108:111], v[208:223]
  ds_read_b64_tr_b16 v[126:127], v8 offset:13312
  s_waitcnt vmcnt(14)
  s_barrier
  s_waitcnt lgkmcnt(6)
  v_mfma_f32_32x32x16_bf16 v[224:239], a[0:3], v[112:115], 0
  s_add_u32 m0, s46, 0x24000
  ds_read_b64_tr_b16 v[96:97], v5 offset:16384
  buffer_load_dwordx4 v17, s[12:15], s44 offen lds
  s_waitcnt lgkmcnt(5)
  v_mfma_f32_32x32x16_bf16 v[224:239], a[4:7], v[116:119], v[224:239]
  ds_read_b64_tr_b16 v[98:99], v5 offset:17408
  s_waitcnt lgkmcnt(4)
  v_mfma_f32_32x32x16_bf16 v[224:239], a[8:11], v[120:123], v[224:239]
  ds_read_b64_tr_b16 v[100:101], v5 offset:20480
  buffer_load_dwordx4 v18, s[12:15], s44 offen offset:1024 lds
  s_waitcnt lgkmcnt(3)
  v_mfma_f32_32x32x16_bf16 v[224:239], a[12:15], v[124:127], v[224:239]
  ds_read_b64_tr_b16 v[102:103], v5 offset:21504
  v_mfma_f32_32x32x16_bf16 v[240:255], a[16:19], v[112:115], 0
  ds_read_b64_tr_b16 v[104:105], v5 offset:24576
  buffer_load_dwordx4 v19, s[12:15], s44 offen offset:2048 lds
  v_mfma_f32_32x32x16_bf16 v[240:255], a[20:23], v[116:119], v[240:255]
  ds_read_b64_tr_b16 v[106:107], v5 offset:25600
  v_mfma_f32_32x32x16_bf16 v[240:255], a[24:27], v[120:123], v[240:255]
  ds_read_b64_tr_b16 v[108:109], v5 offset:28672
  buffer_load_dwordx4 v20, s[12:15], s44 offen offset:3072 lds
  v_mfma_f32_32x32x16_bf16 v[240:255], a[28:31], v[124:127], v[240:255]
  ds_read_b64_tr_b16 v[110:111], v5 offset:29696
  s_add_u32 s44, s44, 0x80000
  s_waitcnt lgkmcnt(6)
  v_mfma_f32_32x32x16_bf16 v[128:143], a[32:35], v[96:99], v[128:143]
  ds_read_b64_tr_b16 v[112:113], v6 offset:16384
  s_waitcnt lgkmcnt(5)
  v_mfma_f32_32x32x16_bf16 v[128:143], a[36:39], v[100:103], v[128:143]
  ds_read_b64_tr_b16 v[114:115], v6 offset:17408
  s_waitcnt lgkmcnt(4)
  v_mfma_f32_32x32x16_bf16 v[128:143], a[40:43], v[104:107], v[128:143]
  ds_read_b64_tr_b16 v[116:117], v6 offset:20480
  s_waitcnt lgkmcnt(3)
  v_mfma_f32_32x32x16_bf16 v[128:143], a[44:47], v[108:111], v[128:143]
  ds_read_b64_tr_b16 v[118:119], v6 offset:21504
  buffer_store_dwordx4 v[40:43], v21, s[16:19], s49 offen sc1
  v_mfma_f32_32x32x16_bf16 v[144:159], a[48:51], v[96:99], v[144:159]
  ds_read_b64_tr_b16 v[120:121], v6 offset:24576
  v_mfma_f32_32x32x16_bf16 v[144:159], a[52:55], v[100:103], v[144:159]
  ds_read_b64_tr_b16 v[122:123], v6 offset:25600
  v_mfma_f32_32x32x16_bf16 v[144:159], a[56:59], v[104:107], v[144:159]
  ds_read_b64_tr_b16 v[124:125], v6 offset:28672
  v_mfma_f32_32x32x16_bf16 v[144:159], a[60:63], v[108:111], v[144:159]
  ds_read_b64_tr_b16 v[126:127], v6 offset:29696
  s_waitcnt lgkmcnt(6)
  v_mfma_f32_32x32x16_bf16 v[160:175], a[32:35], v[112:115], v[160:175]
  ds_read_b64_tr_b16 v[96:97], v7 offset:16384
  s_waitcnt lgkmcnt(5)
  v_mfma_f32_32x32x16_bf16 v[160:175], a[36:39], v[116:119], v[160:175]
  ds_read_b64_tr_b16 v[98:99], v7 offset:17408
  buffer_store_dwordx4 v[44:47], v21, s[16:19], s49 offen offset:1024 sc1
  s_waitcnt lgkmcnt(4)
  v_mfma_f32_32x32x16_bf16 v[160:175], a[40:43], v[120:123], v[160:175]
  ds_read_b64_tr_b16 v[100:101], v7 offset:20480
  s_waitcnt lgkmcnt(3)
  v_mfma_f32_32x32x16_bf16 v[160:175], a[44:47], v[124:127], v[160:175]
  ds_read_b64_tr_b16 v[102:103], v7 offset:21504
  v_mfma_f32_32x32x16_bf16 v[176:191], a[48:51], v[112:115], v[176:191]
  ds_read_b64_tr_b16 v[104:105], v7 offset:24576
  v_mfma_f32_32x32x16_bf16 v[176:191], a[52:55], v[116:119], v[176:191]
  ds_read_b64_tr_b16 v[106:107], v7 offset:25600
  v_mfma_f32_32x32x16_bf16 v[176:191], a[56:59], v[120:123], v[176:191]
  ds_read_b64_tr_b16 v[108:109], v7 offset:28672
  v_mfma_f32_32x32x16_bf16 v[176:191], a[60:63], v[124:127], v[176:191]
  ds_read_b64_tr_b16 v[110:111], v7 offset:29696
  s_waitcnt lgkmcnt(6)
  v_mfma_f32_32x32x16_bf16 v[192:207], a[32:35], v[96:99], v[192:207]
  ds_read_b64_tr_b16 v[112:113], v8 offset:16384
  s_waitcnt lgkmcnt(5)
  v_mfma_f32_32x32x16_bf16 v[192:207], a[36:39], v[100:103], v[192:207]
  ds_read_b64_tr_b16 v[114:115], v8 offset:17408
  s_waitcnt lgkmcnt(4)
  v_mfma_f32_32x32x16_bf16 v[192:207], a[40:43], v[104:107], v[192:207]
  ds_read_b64_tr_b16 v[116:117], v8 offset:20480
  s_waitcnt lgkmcnt(3)
  v_mfma_f32_32x32x16_bf16 v[192:207], a[44:47], v[108:111], v[192:207]
  ds_read_b64_tr_b16 v[118:119], v8 offset:21504
  v_mfma_f32_32x32x16_bf16 v[208:223], a[48:51], v[96:99], v[208:223]
  ds_read_b64_tr_b16 v[120:121], v8 offset:24576
  v_mfma_f32_32x32x16_bf16 v[208:223], a[52:55], v[100:103], v[208:223]
  ds_read_b64_tr_b16 v[122:123], v8 offset:25600
  v_mfma_f32_32x32x16_bf16 v[208:223], a[56:59], v[104:107], v[208:223]
  ds_read_b64_tr_b16 v[124:125], v8 offset:28672
  v_mfma_f32_32x32x16_bf16 v[208:223], a[60:63], v[108:111], v[208:223]
  ds_read_b64_tr_b16 v[126:127], v8 offset:29696
  s_waitcnt vmcnt(8)
  s_barrier
  s_waitcnt lgkmcnt(6)
  v_mfma_f32_32x32x16_bf16 v[224:239], a[32:35], v[112:115], v[224:239]
  s_add_u32 m0, s46, 0x18000
  ds_read_b64_tr_b16 v[96:97], v5 offset:32768
  buffer_load_dwordx4 v17, s[12:15], s44 offen lds
  s_waitcnt lgkmcnt(5)
  v_mfma_f32_32x32x16_bf16 v[224:239], a[36:39], v[116:119], v[224:239]
  ds_read_b64_tr_b16 v[98:99], v5 offset:33792
  s_waitcnt lgkmcnt(4)
  v_mfma_f32_32x32x16_bf16 v[224:239], a[40:43], v[120:123], v[224:239]
  ds_read_b64_tr_b16 v[100:101], v5 offset:36864
  buffer_load_dwordx4 v18, s[12:15], s44 offen offset:1024 lds
  s_waitcnt lgkmcnt(3)
  v_mfma_f32_32x32x16_bf16 v[224:239], a[44:47], v[124:127], v[224:239]
  ds_read_b64_tr_b16 v[102:103], v5 offset:37888
  v_mfma_f32_32x32x16_bf16 v[240:255], a[48:51], v[112:115], v[240:255]
  ds_read_b64_tr_b16 v[104:105], v5 offset:40960
  buffer_load_dwordx4 v19, s[12:15], s44 offen offset:2048 lds
  v_mfma_f32_32x32x16_bf16 v[240:255], a[52:55], v[116:119], v[240:255]
  ds_read_b64_tr_b16 v[106:107], v5 offset:41984
  v_mfma_f32_32x32x16_bf16 v[240:255], a[56:59], v[120:123], v[240:255]
  ds_read_b64_tr_b16 v[108:109], v5 offset:45056
  buffer_load_dwordx4 v20, s[12:15], s44 offen offset:3072 lds
  v_mfma_f32_32x32x16_bf16 v[240:255], a[60:63], v[124:127], v[240:255]
  ds_read_b64_tr_b16 v[110:111], v5 offset:46080
  s_add_u32 s44, s44, 0x80000
  s_waitcnt lgkmcnt(6)
  v_mfma_f32_32x32x16_bf16 v[128:143], a[64:67], v[96:99], v[128:143]
  ds_read_b64_tr_b16 v[112:113], v6 offset:32768
  s_waitcnt lgkmcnt(5)
  v_mfma_f32_32x32x16_bf16 v[128:143], a[68:71], v[100:103], v[128:143]
  ds_read_b64_tr_b16 v[114:115], v6 offset:33792
  s_waitcnt lgkmcnt(4)
  v_mfma_f32_32x32x16_bf16 v[128:143], a[72:75], v[104:107], v[128:143]
  ds_read_b64_tr_b16 v[116:117], v6 offset:36864
  v_mov_b32 v25, 0
  buffer_load_dword v24, v25, s[4:7], 0 offen sc1
  s_waitcnt lgkmcnt(3)
  v_mfma_f32_32x32x16_bf16 v[128:143], a[76:79], v[108:111], v[128:143]
  ds_read_b64_tr_b16 v[118:119], v6 offset:37888
  buffer_store_dwordx4 v[48:51], v21, s[16:19], s47 offen offset:2048 sc1
  v_mfma_f32_32x32x16_bf16 v[144:159], a[80:83], v[96:99], v[144:159]
  ds_read_b64_tr_b16 v[120:121], v6 offset:40960
  v_mfma_f32_32x32x16_bf16 v[144:159], a[84:87], v[100:103], v[144:159]
  ds_read_b64_tr_b16 v[122:123], v6 offset:41984
  v_mfma_f32_32x32x16_bf16 v[144:159], a[88:91], v[104:107], v[144:159]
  ds_read_b64_tr_b16 v[124:125], v6 offset:45056
  v_mfma_f32_32x32x16_bf16 v[144:159], a[92:95], v[108:111], v[144:159]
  ds_read_b64_tr_b16 v[126:127], v6 offset:46080
  s_waitcnt lgkmcnt(6)
  v_mfma_f32_32x32x16_bf16 v[160:175], a[64:67], v[112:115], v[160:175]
  ds_read_b64_tr_b16 v[96:97], v7 offset:32768
  s_waitcnt lgkmcnt(5)
  v_mfma_f32_32x32x16_bf16 v[160:175], a[68:71], v[116:119], v[160:175]
  ds_read_b64_tr_b16 v[98:99], v7 offset:33792
  buffer_store_dwordx4 v[52:55], v21, s[16:19], s47 offen offset:3072 sc1
  s_waitcnt lgkmcnt(4)
  v_mfma_f32_32x32x16_bf16 v[160:175], a[72:75], v[120:123], v[160:175]
  ds_read_b64_tr_b16 v[100:101], v7 offset:36864
  s_waitcnt lgkmcnt(3)
  v_mfma_f32_32x32x16_bf16 v[160:175], a[76:79], v[124:127], v[160:175]
  ds_read_b64_tr_b16 v[102:103], v7 offset:37888
  v_mfma_f32_32x32x16_bf16 v[176:191], a[80:83], v[112:115], v[176:191]
  ds_read_b64_tr_b16 v[104:105], v7 offset:40960
  v_mfma_f32_32x32x16_bf16 v[176:191], a[84:87], v[116:119], v[176:191]
  ds_read_b64_tr_b16 v[106:107], v7 offset:41984
  v_mfma_f32_32x32x16_bf16 v[176:191], a[88:91], v[120:123], v[176:191]
  ds_read_b64_tr_b16 v[108:109], v7 offset:45056
  v_mfma_f32_32x32x16_bf16 v[176:191], a[92:95], v[124:127], v[176:191]
  ds_read_b64_tr_b16 v[110:111], v7 offset:46080
  s_waitcnt lgkmcnt(6)
  v_mfma_f32_32x32x16_bf16 v[192:207], a[64:67], v[96:99], v[192:207]
  ds_read_b64_tr_b16 v[112:113], v8 offset:32768
  s_waitcnt lgkmcnt(5)
  v_mfma_f32_32x32x16_bf16 v[192:207], a[68:71], v[100:103], v[192:207]
  ds_read_b64_tr_b16 v[114:115], v8 offset:33792
  s_waitcnt lgkmcnt(4)
  v_mfma_f32_32x32x16_bf16 v[192:207], a[72:75], v[104:107], v[192:207]
  ds_read_b64_tr_b16 v[116:117], v8 offset:36864
  s_waitcnt lgkmcnt(3)
  v_mfma_f32_32x32x16_bf16 v[192:207], a[76:79], v[108:111], v[192:207]
  ds_read_b64_tr_b16 v[118:119], v8 offset:37888
  v_mfma_f32_32x32x16_bf16 v[208:223], a[80:83], v[96:99], v[208:223]
  ds_read_b64_tr_b16 v[120:121], v8 offset:40960
  v_mfma_f32_32x32x16_bf16 v[208:223], a[84:87], v[100:103], v[208:223]
  ds_read_b64_tr_b16 v[122:123], v8 offset:41984
  v_mfma_f32_32x32x16_bf16 v[208:223], a[88:91], v[104:107], v[208:223]
  ds_read_b64_tr_b16 v[124:125], v8 offset:45056
  v_mfma_f32_32x32x16_bf16 v[208:223], a[92:95], v[108:111], v[208:223]
  ds_read_b64_tr_b16 v[126:127], v8 offset:46080
  s_waitcnt vmcnt(9)
  s_barrier
  s_waitcnt lgkmcnt(6)
  v_mfma_f32_32x32x16_bf16 v[224:239], a[64:67], v[112:115], v[224:239]
  s_add_u32 m0, s46, 0x1c000
  ds_read_b64_tr_b16 v[96:97], v5 offset:49152
  buffer_load_dwordx4 v17, s[12:15], s44 offen lds
  s_waitcnt lgkmcnt(5)
  v_mfma_f32_32x32x16_bf16 v[224:239], a[68:71], v[116:119], v[224:239]
  ds_read_b64_tr_b16 v[98:99], v5 offset:50176
  s_waitcnt lgkmcnt(4)
  v_mfma_f32_32x32x16_bf16 v[224:239], a[72:75], v[120:123], v[224:239]
  ds_read_b64_tr_b16 v[100:101], v5 offset:53248
  buffer_load_dwordx4 v18, s[12:15], s44 offen offset:1024 lds
  s_waitcnt lgkmcnt(3)
  v_mfma_f32_32x32x16_bf16 v[224:239], a[76:79], v[124:127], v[224:239]
  ds_read_b64_tr_b16 v[102:103], v5 offset:54272
  v_mfma_f32_32x32x16_bf16 v[240:255], a[80:83], v[112:115], v[240:255]
  ds_read_b64_tr_b16 v[104:105], v5 offset:57344
  buffer_load_dwordx4 v19, s[12:15], s44 offen offset:2048 lds
  v_mfma_f32_32x32x16_bf16 v[240:255], a[84:87], v[116:119], v[240:255]
  ds_read_b64_tr_b16 v[106:107], v5 offset:58368
  v_mfma_f32_32x32x16_bf16 v[240:255], a[88:91], v[120:123], v[240:255]
  ds_read_b64_tr_b16 v[108:109], v5 offset:61440
  buffer_load_dwordx4 v20, s[12:15], s44 offen offset:3072 lds
  v_mfma_f32_32x32x16_bf16 v[240:255], a[92:95], v[124:127], v[240:255]
  ds_read_b64_tr_b16 v[110:111], v5 offset:62464
  s_add_u32 s44, s44, 0x80000
  s_waitcnt lgkmcnt(6)
  v_mfma_f32_32x32x16_bf16 v[128:143], a[96:99], v[96:99], v[128:143]
  ds_read_b64_tr_b16 v[112:113], v6 offset:49152
  s_waitcnt lgkmcnt(5)
  v_mfma_f32_32x32x16_bf16 v[128:143], a[100:103], v[100:103], v[128:143]
  ds_read_b64_tr_b16 v[114:115], v6 offset:50176
  s_waitcnt lgkmcnt(4)
  v_mfma_f32_32x32x16_bf16 v[128:143], a[104:107], v[104:107], v[128:143]
  ds_read_b64_tr_b16 v[116:117], v6 offset:53248
  s_waitcnt lgkmcnt(3)
  v_mfma_f32_32x32x16_bf16 v[128:143], a[108:111], v[108:111], v[128:143]
  ds_read_b64_tr_b16 v[118:119], v6 offset:54272
  buffer_store_dwordx4 v[56:59], v21, s[16:19], s49 offen offset:2048 sc1
  v_mfma_f32_32x32x16_bf16 v[144:159], a[112:115], v[96:99], v[144:159]
  ds_read_b64_tr_b16 v[120:121], v6 offset:57344
  v_mfma_f32_32x32x16_bf16 v[144:159], a[116:119], v[100:103], v[144:159]
  ds_read_b64_tr_b16 v[122:123], v6 offset:58368
  v_mfma_f32_32x32x16_bf16 v[144:159], a[120:123], v[104:107], v[144:159]
  ds_read_b64_tr_b16 v[124:125], v6 offset:61440
  v_mfma_f32_32x32x16_bf16 v[144:159], a[124:127], v[108:111], v[144:159]
  ds_read_b64_tr_b16 v[126:127], v6 offset:62464
  s_waitcnt lgkmcnt(6)
  v_mfma_f32_32x32x16_bf16 v[160:175], a[96:99], v[112:115], v[160:175]
  ds_read_b64_tr_b16 v[96:97], v7 offset:49152
  s_waitcnt lgkmcnt(5)
  v_mfma_f32_32x32x16_bf16 v[160:175], a[100:103], v[116:119], v[160:175]
  ds_read_b64_tr_b16 v[98:99], v7 offset:50176
  buffer_store_dwordx4 v[60:63], v21, s[16:19], s49 offen offset:3072 sc1
  s_waitcnt lgkmcnt(4)
  v_mfma_f32_32x32x16_bf16 v[160:175], a[104:107], v[120:123], v[160:175]
  ds_read_b64_tr_b16 v[100:101], v7 offset:53248
  s_waitcnt lgkmcnt(3)
  v_mfma_f32_32x32x16_bf16 v[160:175], a[108:111], v[124:127], v[160:175]
  ds_read_b64_tr_b16 v[102:103], v7 offset:54272
  v_mfma_f32_32x32x16_bf16 v[176:191], a[112:115], v[112:115], v[176:191]
  ds_read_b64_tr_b16 v[104:105], v7 offset:57344
  v_mfma_f32_32x32x16_bf16 v[176:191], a[116:119], v[116:119], v[176:191]
  ds_read_b64_tr_b16 v[106:107], v7 offset:58368
  v_mfma_f32_32x32x16_bf16 v[176:191], a[120:123], v[120:123], v[176:191]
  ds_read_b64_tr_b16 v[108:109], v7 offset:61440
  v_mfma_f32_32x32x16_bf16 v[176:191], a[124:127], v[124:127], v[176:191]
  ds_read_b64_tr_b16 v[110:111], v7 offset:62464
  s_waitcnt lgkmcnt(6)
  v_mfma_f32_32x32x16_bf16 v[192:207], a[96:99], v[96:99], v[192:207]
  ds_read_b64_tr_b16 v[112:113], v8 offset:49152
  s_waitcnt lgkmcnt(5)
  v_mfma_f32_32x32x16_bf16 v[192:207], a[100:103], v[100:103], v[192:207]
  ds_read_b64_tr_b16 v[114:115], v8 offset:50176
  s_waitcnt lgkmcnt(4)
  v_mfma_f32_32x32x16_bf16 v[192:207], a[104:107], v[104:107], v[192:207]
  ds_read_b64_tr_b16 v[116:117], v8 offset:53248
  s_waitcnt lgkmcnt(3)
  v_mfma_f32_32x32x16_bf16 v[192:207], a[108:111], v[108:111], v[192:207]
  ds_read_b64_tr_b16 v[118:119], v8 offset:54272
  v_mfma_f32_32x32x16_bf16 v[208:223], a[112:115], v[96:99], v[208:223]
  ds_read_b64_tr_b16 v[120:121], v8 offset:57344
  v_mfma_f32_32x32x16_bf16 v[208:223], a[116:119], v[100:103], v[208:223]
  ds_read_b64_tr_b16 v[122:123], v8 offset:58368
  v_mfma_f32_32x32x16_bf16 v[208:223], a[120:123], v[104:107], v[208:223]
  ds_read_b64_tr_b16 v[124:125], v8 offset:61440
  v_mfma_f32_32x32x16_bf16 v[208:223], a[124:127], v[108:111], v[208:223]
  ds_read_b64_tr_b16 v[126:127], v8 offset:62464
  s_waitcnt vmcnt(9)
  s_barrier
  s_waitcnt lgkmcnt(6)
  v_mfma_f32_32x32x16_bf16 v[224:239], a[96:99], v[112:115], v[224:239]
  s_add_u32 m0, s46, 0x20000
  ds_read_b64_tr_b16 v[96:97], v5
  buffer_load_dwordx4 v17, s[12:15], s44 offen lds
  s_waitcnt lgkmcnt(5)
  v_mfma_f32_32x32x16_bf16 v[224:239], a[100:103], v[116:119], v[224:239]
  ds_read_b64_tr_b16 v[98:99], v5 offset:1024
  s_waitcnt lgkmcnt(4)
  v_mfma_f32_32x32x16_bf16 v[224:239], a[104:107], v[120:123], v[224:239]
  ds_read_b64_tr_b16 v[100:101], v5 offset:4096
  buffer_load_dwordx4 v18, s[12:15], s44 offen offset:1024 lds
  s_waitcnt lgkmcnt(3)
  v_mfma_f32_32x32x16_bf16 v[224:239], a[108:111], v[124:127], v[224:239]
  ds_read_b64_tr_b16 v[102:103], v5 offset:5120
  v_mfma_f32_32x32x16_bf16 v[240:255], a[112:115], v[112:115], v[240:255]
  ds_read_b64_tr_b16 v[104:105], v5 offset:8192
  buffer_load_dwordx4 v19, s[12:15], s44 offen offset:2048 lds
  v_mfma_f32_32x32x16_bf16 v[240:255], a[116:119], v[116:119], v[240:255]
  ds_read_b64_tr_b16 v[106:107], v5 offset:9216
  v_mfma_f32_32x32x16_bf16 v[240:255], a[120:123], v[120:123], v[240:255]
  ds_read_b64_tr_b16 v[108:109], v5 offset:12288
  buffer_load_dwordx4 v20, s[12:15], s44 offen offset:3072 lds
  v_mfma_f32_32x32x16_bf16 v[240:255], a[124:127], v[124:127], v[240:255]
  ds_read_b64_tr_b16 v[110:111], v5 offset:13312
  s_add_u32 s44, s44, 0x80000
  s_waitcnt lgkmcnt(6)
  v_mfma_f32_32x32x16_bf16 v[128:143], a[128:131], v[96:99], v[128:143]
  ds_read_b64_tr_b16 v[112:113], v6
  s_waitcnt lgkmcnt(5)
  v_mfma_f32_32x32x16_bf16 v[128:143], a[132:135], v[100:103], v[128:143]
  ds_read_b64_tr_b16 v[114:115], v6 offset:1024
  s_waitcnt lgkmcnt(4)
  v_mfma_f32_32x32x16_bf16 v[128:143], a[136:139], v[104:107], v[128:143]
  ds_read_b64_tr_b16 v[116:117], v6 offset:4096
  s_waitcnt vmcnt(12)
  v_readfirstlane_b32 s59, v24
  s_nop 3
  s_cmp_eq_u32 s59, 0
  s_cbranch_scc1 L_nspin
L_nspin_ret:
  s_waitcnt lgkmcnt(3)
  v_mfma_f32_32x32x16_bf16 v[128:143], a[140:143], v[108:111], v[128:143]
  ds_read_b64_tr_b16 v[118:119], v6 offset:5120
  buffer_store_dwordx4 v[64:67], v21, s[16:19], s48 offen sc1
  v_mfma_f32_32x32x16_bf16 v[144:159], a[144:147], v[96:99], v[144:159]
  ds_read_b64_tr_b16 v[120:121], v6 offset:8192
  v_mfma_f32_32x32x16_bf16 v[144:159], a[148:151], v[100:103], v[144:159]
  ds_read_b64_tr_b16 v[122:123], v6 offset:9216
  v_mfma_f32_32x32x16_bf16 v[144:159], a[152:155], v[104:107], v[144:159]
  ds_read_b64_tr_b16 v[124:125], v6 offset:12288
  v_mfma_f32_32x32x16_bf16 v[144:159], a[156:159], v[108:111], v[144:159]
  ds_read_b64_tr_b16 v[126:127], v6 offset:13312
  s_waitcnt lgkmcnt(6)
  v_mfma_f32_32x32x16_bf16 v[160:175], a[128:131], v[112:115], v[160:175]
  ds_read_b64_tr_b16 v[96:97], v7
  s_waitcnt lgkmcnt(5)
  v_mfma_f32_32x32x16_bf16 v[160:175], a[132:135], v[116:119], v[160:175]
  ds_read_b64_tr_b16 v[98:99], v7 offset:1024
  buffer_store_dwordx4 v[68:71], v21, s[16:19], s48 offen offset:1024 sc1
  s_waitcnt lgkmcnt(4)
  v_mfma_f32_32x32x16_bf16 v[160:175], a[136:139], v[120:123], v[160:175]
  ds_read_b64_tr_b16 v[100:101], v7 offset:4096
  s_waitcnt lgkmcnt(3)
  v_mfma_f32_32x32x16_bf16 v[160:175], a[140:143], v[124:127], v[160:175]
  ds_read_b64_tr_b16 v[102:103], v7 offset:5120
  v_mfma_f32_32x32x16_bf16 v[176:191], a[144:147], v[112:115], v[176:191]
  ds_read_b64_tr_b16 v[104:105], v7 offset:8192
  v_mfma_f32_32x32x16_bf16 v[176:191], a[148:151], v[116:119], v[176:191]
  ds_read_b64_tr_b16 v[106:107], v7 offset:9216
  v_mfma_f32_32x32x16_bf16 v[176:191], a[152:155], v[120:123], v[176:191]
  ds_read_b64_tr_b16 v[108:109], v7 offset:12288
  v_mfma_f32_32x32x16_bf16 v[176:191], a[156:159], v[124:127], v[176:191]
  ds_read_b64_tr_b16 v[110:111], v7 offset:13312
  s_waitcnt lgkmcnt(6)
  v_mfma_f32_32x32x16_bf16 v[192:207], a[128:131], v[96:99], v[192:207]
  ds_read_b64_tr_b16 v[112:113], v8
  s_waitcnt lgkmcnt(5)
  v_mfma_f32_32x32x16_bf16 v[192:207], a[132:135], v[100:103], v[192:207]
  ds_read_b64_tr_b16 v[114:115], v8 offset:1024
  s_waitcnt lgkmcnt(4)
  v_mfma_f32_32x32x16_bf16 v[192:207], a[136:139], v[104:107], v[192:207]
  ds_read_b64_tr_b16 v[116:117], v8 offset:4096
  s_waitcnt lgkmcnt(3)
  v_mfma_f32_32x32x16_bf16 v[192:207], a[140:143], v[108:111], v[192:207]
  ds_read_b64_tr_b16 v[118:119], v8 offset:5120
  v_mfma_f32_32x32x16_bf16 v[208:223], a[144:147], v[96:99], v[208:223]
  ds_read_b64_tr_b16 v[120:121], v8 offset:8192
  v_mfma_f32_32x32x16_bf16 v[208:223], a[148:151], v[100:103], v[208:223]
  ds_read_b64_tr_b16 v[122:123], v8 offset:9216
  v_mfma_f32_32x32x16_bf16 v[208:223], a[152:155], v[104:107], v[208:223]
  ds_read_b64_tr_b16 v[124:125], v8 offset:12288
  v_mfma_f32_32x32x16_bf16 v[208:223], a[156:159], v[108:111], v[208:223]
  ds_read_b64_tr_b16 v[126:127], v8 offset:13312
  s_waitcnt vmcnt(8)
  s_barrier
  s_waitcnt lgkmcnt(6)
  v_mfma_f32_32x32x16_bf16 v[224:239], a[128:131], v[112:115], v[224:239]
  s_add_u32 m0, s46, 0x24000
  ds_read_b64_tr_b16 v[96:97], v5 offset:16384
  buffer_load_dwordx4 v17, s[12:15], s44 offen lds
  s_waitcnt lgkmcnt(5)
  v_mfma_f32_32x32x16_bf16 v[224:239], a[132:135], v[116:119], v[224:239]
  ds_read_b64_tr_b16 v[98:99], v5 offset:17408
  s_waitcnt lgkmcnt(4)
  v_mfma_f32_32x32x16_bf16 v[224:239], a[136:139], v[120:123], v[224:239]
  ds_read_b64_tr_b16 v[100:101], v5 offset:20480
  buffer_load_dwordx4 v18, s[12:15], s44 offen offset:1024 lds
  s_waitcnt lgkmcnt(3)
  v_mfma_f32_32x32x16_bf16 v[224:239], a[140:143], v[124:127], v[224:239]
  ds_read_b64_tr_b16 v[102:103], v5 offset:21504
  v_mfma_f32_32x32x16_bf16 v[240:255], a[144:147], v[112:115], v[240:255]
  ds_read_b64_tr_b16 v[104:105], v5 offset:24576
  buffer_load_dwordx4 v19, s[12:15], s44 offen offset:2048 lds
  v_mfma_f32_32x32x16_bf16 v[240:255], a[148:151], v[116:119], v[240:255]
  ds_read_b64_tr_b16 v[106:107], v5 offset:25600
  v_mfma_f32_32x32x16_bf16 v[240:255], a[152:155], v[120:123], v[240:255]
  ds_read_b64_tr_b16 v[108:109], v5 offset:28672
  buffer_load_dwordx4 v20, s[12:15], s44 offen offset:3072 lds
  v_mfma_f32_32x32x16_bf16 v[240:255], a[156:159], v[124:127], v[240:255]
  ds_read_b64_tr_b16 v[110:111], v5 offset:29696
  s_add_u32 s44, s44, 0x80000
  s_waitcnt lgkmcnt(6)
  v_mfma_f32_32x32x16_bf16 v[128:143], a[160:163], v[96:99], v[128:143]
  ds_read_b64_tr_b16 v[112:113], v6 offset:16384
  s_waitcnt lgkmcnt(5)
  v_mfma_f32_32x32x16_bf16 v[128:143], a[164:167], v[100:103], v[128:143]
  ds_read_b64_tr_b16 v[114:115], v6 offset:17408
  s_waitcnt lgkmcnt(4)
  v_mfma_f32_32x32x16_bf16 v[128:143], a[168:171], v[104:107], v[128:143]
  ds_read_b64_tr_b16 v[116:117], v6 offset:20480
  s_waitcnt lgkmcnt(3)
  v_mfma_f32_32x32x16_bf16 v[128:143], a[172:175], v[108:111], v[128:143]
  ds_read_b64_tr_b16 v[118:119], v6 offset:21504
  buffer_store_dwordx4 v[72:75], v21, s[16:19], s50 offen sc1
  v_mfma_f32_32x32x16_bf16 v[144:159], a[176:179], v[96:99], v[144:159]
  ds_read_b64_tr_b16 v[120:121], v6 offset:24576
  v_mfma_f32_32x32x16_bf16 v[144:159], a[180:183], v[100:103], v[144:159]
  ds_read_b64_tr_b16 v[122:123], v6 offset:25600
  v_mfma_f32_32x32x16_bf16 v[144:159], a[184:187], v[104:107], v[144:159]
  ds_read_b64_tr_b16 v[124:125], v6 offset:28672
  v_mfma_f32_32x32x16_bf16 v[144:159], a[188:191], v[108:111], v[144:159]
  ds_read_b64_tr_b16 v[126:127], v6 offset:29696
  s_waitcnt lgkmcnt(6)
  v_mfma_f32_32x32x16_bf16 v[160:175], a[160:163], v[112:115], v[160:175]
  ds_read_b64_tr_b16 v[96:97], v7 offset:16384
  s_waitcnt lgkmcnt(5)
  v_mfma_f32_32x32x16_bf16 v[160:175], a[164:167], v[116:119], v[160:175]
  ds_read_b64_tr_b16 v[98:99], v7 offset:17408
  buffer_store_dwordx4 v[76:79], v21, s[16:19], s50 offen offset:1024 sc1
  s_waitcnt lgkmcnt(4)
  v_mfma_f32_32x32x16_bf16 v[160:175], a[168:171], v[120:123], v[160:175]
  ds_read_b64_tr_b16 v[100:101], v7 offset:20480
  s_waitcnt lgkmcnt(3)
  v_mfma_f32_32x32x16_bf16 v[160:175], a[172:175], v[124:127], v[160:175]
  ds_read_b64_tr_b16 v[102:103], v7 offset:21504
  v_mfma_f32_32x32x16_bf16 v[176:191], a[176:179], v[112:115], v[176:191]
  ds_read_b64_tr_b16 v[104:105], v7 offset:24576
  v_mfma_f32_32x32x16_bf16 v[176:191], a[180:183], v[116:119], v[176:191]
  ds_read_b64_tr_b16 v[106:107], v7 offset:25600
  v_mfma_f32_32x32x16_bf16 v[176:191], a[184:187], v[120:123], v[176:191]
  ds_read_b64_tr_b16 v[108:109], v7 offset:28672
  v_mfma_f32_32x32x16_bf16 v[176:191], a[188:191], v[124:127], v[176:191]
  ds_read_b64_tr_b16 v[110:111], v7 offset:29696
  s_waitcnt lgkmcnt(6)
  v_mfma_f32_32x32x16_bf16 v[192:207], a[160:163], v[96:99], v[192:207]
  ds_read_b64_tr_b16 v[112:113], v8 offset:16384
  s_waitcnt lgkmcnt(5)
  v_mfma_f32_32x32x16_bf16 v[192:207], a[164:167], v[100:103], v[192:207]
  ds_read_b64_tr_b16 v[114:115], v8 offset:17408
  s_waitcnt lgkmcnt(4)
  v_mfma_f32_32x32x16_bf16 v[192:207], a[168:171], v[104:107], v[192:207]
  ds_read_b64_tr_b16 v[116:117], v8 offset:20480
  s_waitcnt lgkmcnt(3)
  v_mfma_f32_32x32x16_bf16 v[192:207], a[172:175], v[108:111], v[192:207]
  ds_read_b64_tr_b16 v[118:119], v8 offset:21504
  v_mfma_f32_32x32x16_bf16 v[208:223], a[176:179], v[96:99], v[208:223]
  ds_read_b64_tr_b16 v[120:121], v8 offset:24576
  v_mfma_f32_32x32x16_bf16 v[208:223], a[180:183], v[100:103], v[208:223]
  ds_read_b64_tr_b16 v[122:123], v8 offset:25600
  v_mfma_f32_32x32x16_bf16 v[208:223], a[184:187], v[104:107], v[208:223]
  ds_read_b64_tr_b16 v[124:125], v8 offset:28672
  v_mfma_f32_32x32x16_bf16 v[208:223], a[188:191], v[108:111], v[208:223]
  ds_read_b64_tr_b16 v[126:127], v8 offset:29696
  s_waitcnt vmcnt(8)
  s_barrier
  s_waitcnt lgkmcnt(6)
  v_mfma_f32_32x32x16_bf16 v[224:239], a[160:163], v[112:115], v[224:239]
  ds_read_b64_tr_b16 v[96:97], v5 offset:32768
  s_mov_b32 s12, s30
  s_and_b32 s13, s31, 0xffff
  s_mov_b32 s14, 0x400000
  s_waitcnt lgkmcnt(5)
  v_mfma_f32_32x32x16_bf16 v[224:239], a[164:167], v[116:119], v[224:239]
  ds_read_b64_tr_b16 v[98:99], v5 offset:33792
  s_mov_b32 s15, 0x20000
  s_sub_u32 s44, s44, 0x400000
  s_waitcnt lgkmcnt(4)
  v_mfma_f32_32x32x16_bf16 v[224:239], a[168:171], v[120:123], v[224:239]
  s_add_u32 m0, s46, 0x18000
  ds_read_b64_tr_b16 v[100:101], v5 offset:36864
  buffer_load_dwordx4 v17, s[12:15], s44 offen lds
  s_waitcnt lgkmcnt(3)
  v_mfma_f32_32x32x16_bf16 v[224:239], a[172:175], v[124:127], v[224:239]
  ds_read_b64_tr_b16 v[102:103], v5 offset:37888
  buffer_load_dwordx4 v18, s[12:15], s44 offen offset:1024 lds
  v_mfma_f32_32x32x16_bf16 v[240:255], a[176:179], v[112:115], v[240:255]
  ds_read_b64_tr_b16 v[104:105], v5 offset:40960
  buffer_load_dwordx4 v19, s[12:15], s44 offen offset:2048 lds
  v_mfma_f32_32x32x16_bf16 v[240:255], a[180:183], v[116:119], v[240:255]
  ds_read_b64_tr_b16 v[106:107], v5 offset:41984
  buffer_load_dwordx4 v20, s[12:15], s44 offen offset:3072 lds
  v_mfma_f32_32x32x16_bf16 v[240:255], a[184:187], v[120:123], v[240:255]
  ds_read_b64_tr_b16 v[108:109], v5 offset:45056
  s_add_u32 s44, s44, 0x80000
  v_mfma_f32_32x32x16_bf16 v[240:255], a[188:191], v[124:127], v[240:255]
  ds_read_b64_tr_b16 v[110:111], v5 offset:46080
  s_waitcnt lgkmcnt(6)
  v_mfma_f32_32x32x16_bf16 v[128:143], a[192:195], v[96:99], v[128:143]
  ds_read_b64_tr_b16 v[112:113], v6 offset:32768
  s_waitcnt lgkmcnt(5)
  v_mfma_f32_32x32x16_bf16 v[128:143], a[196:199], v[100:103], v[128:143]
  ds_read_b64_tr_b16 v[114:115], v6 offset:33792
  s_waitcnt lgkmcnt(4)
  v_mfma_f32_32x32x16_bf16 v[128:143], a[200:203], v[104:107], v[128:143]
  ds_read_b64_tr_b16 v[116:117], v6 offset:36864
  s_waitcnt lgkmcnt(3)
  v_mfma_f32_32x32x16_bf16 v[128:143], a[204:207], v[108:111], v[128:143]
  ds_read_b64_tr_b16 v[118:119], v6 offset:37888
  buffer_store_dwordx4 v[80:83], v21, s[16:19], s48 offen offset:2048 sc1
  v_mfma_f32_32x32x16_bf16 v[144:159], a[208:211], v[96:99], v[144:159]
  ds_read_b64_tr_b16 v[120:121], v6 offset:40960
  v_mfma_f32_32x32x16_bf16 v[144:159], a[212:215], v[100:103], v[144:159]
  ds_read_b64_tr_b16 v[122:123], v6 offset:41984
  v_mfma_f32_32x32x16_bf16 v[144:159], a[216:219], v[104:107], v[144:159]
  ds_read_b64_tr_b16 v[124:125], v6 offset:45056
  v_mfma_f32_32x32x16_bf16 v[144:159], a[220:223], v[108:111], v[144:159]
  ds_read_b64_tr_b16 v[126:127], v6 offset:46080
  s_waitcnt lgkmcnt(6)
  v_mfma_f32_32x32x16_bf16 v[160:175], a[192:195], v[112:115], v[160:175]
  ds_read_b64_tr_b16 v[96:97], v7 offset:32768
  s_waitcnt lgkmcnt(5)
  v_mfma_f32_32x32x16_bf16 v[160:175], a[196:199], v[116:119], v[160:175]
  ds_read_b64_tr_b16 v[98:99], v7 offset:33792
  buffer_store_dwordx4 v[84:87], v21, s[16:19], s48 offen offset:3072 sc1
  s_waitcnt lgkmcnt(4)
  v_mfma_f32_32x32x16_bf16 v[160:175], a[200:203], v[120:123], v[160:175]
  ds_read_b64_tr_b16 v[100:101], v7 offset:36864
  s_waitcnt lgkmcnt(3)
  v_mfma_f32_32x32x16_bf16 v[160:175], a[204:207], v[124:127], v[160:175]
  ds_read_b64_tr_b16 v[102:103], v7 offset:37888
  v_mfma_f32_32x32x16_bf16 v[176:191], a[208:211], v[112:115], v[176:191]
  ds_read_b64_tr_b16 v[104:105], v7 offset:40960
  v_mfma_f32_32x32x16_bf16 v[176:191], a[212:215], v[116:119], v[176:191]
  ds_read_b64_tr_b16 v[106:107], v7 offset:41984
  v_mfma_f32_32x32x16_bf16 v[176:191], a[216:219], v[120:123], v[176:191]
  ds_read_b64_tr_b16 v[108:109], v7 offset:45056
  v_mfma_f32_32x32x16_bf16 v[176:191], a[220:223], v[124:127], v[176:191]
  ds_read_b64_tr_b16 v[110:111], v7 offset:46080
  s_waitcnt lgkmcnt(6)
  v_mfma_f32_32x32x16_bf16 v[192:207], a[192:195], v[96:99], v[192:207]
  ds_read_b64_tr_b16 v[112:113], v8 offset:32768
  s_waitcnt lgkmcnt(5)
  v_mfma_f32_32x32x16_bf16 v[192:207], a[196:199], v[100:103], v[192:207]
  ds_read_b64_tr_b16 v[114:115], v8 offset:33792
  s_waitcnt lgkmcnt(4)
  v_mfma_f32_32x32x16_bf16 v[192:207], a[200:203], v[104:107], v[192:207]
  ds_read_b64_tr_b16 v[116:117], v8 offset:36864
  s_waitcnt lgkmcnt(3)
  v_mfma_f32_32x32x16_bf16 v[192:207], a[204:207], v[108:111], v[192:207]
  ds_read_b64_tr_b16 v[118:119], v8 offset:37888
  v_mfma_f32_32x32x16_bf16 v[208:223], a[208:211], v[96:99], v[208:223]
  ds_read_b64_tr_b16 v[120:121], v8 offset:40960
  v_mfma_f32_32x32x16_bf16 v[208:223], a[212:215], v[100:103], v[208:223]
  ds_read_b64_tr_b16 v[122:123], v8 offset:41984
  v_mfma_f32_32x32x16_bf16 v[208:223], a[216:219], v[104:107], v[208:223]
  ds_read_b64_tr_b16 v[124:125], v8 offset:45056
  v_mfma_f32_32x32x16_bf16 v[208:223], a[220:223], v[108:111], v[208:223]
  ds_read_b64_tr_b16 v[126:127], v8 offset:46080
  s_waitcnt vmcnt(8)
  s_barrier
  s_waitcnt lgkmcnt(6)
  v_mfma_f32_32x32x16_bf16 v[224:239], a[192:195], v[112:115], v[224:239]
  s_add_u32 m0, s46, 0x1c000
  ds_read_b64_tr_b16 v[96:97], v5 offset:49152
  buffer_load_dwordx4 v17, s[12:15], s44 offen lds
  s_waitcnt lgkmcnt(5)
  v_mfma_f32_32x32x16_bf16 v[224:239], a[196:199], v[116:119], v[224:239]
  ds_read_b64_tr_b16 v[98:99], v5 offset:50176
  s_waitcnt lgkmcnt(4)
  v_mfma_f32_32x32x16_bf16 v[224:239], a[200:203], v[120:123], v[224:239]
  ds_read_b64_tr_b16 v[100:101], v5 offset:53248
  buffer_load_dwordx4 v18, s[12:15], s44 offen offset:1024 lds
  s_waitcnt lgkmcnt(3)
  v_mfma_f32_32x32x16_bf16 v[224:239], a[204:207], v[124:127], v[224:239]
  ds_read_b64_tr_b16 v[102:103], v5 offset:54272
  v_mfma_f32_32x32x16_bf16 v[240:255], a[208:211], v[112:115], v[240:255]
  ds_read_b64_tr_b16 v[104:105], v5 offset:57344
  buffer_load_dwordx4 v19, s[12:15], s44 offen offset:2048 lds
  v_mfma_f32_32x32x16_bf16 v[240:255], a[212:215], v[116:119], v[240:255]
  ds_read_b64_tr_b16 v[106:107], v5 offset:58368
  v_mfma_f32_32x32x16_bf16 v[240:255], a[216:219], v[120:123], v[240:255]
  ds_read_b64_tr_b16 v[108:109], v5 offset:61440
  buffer_load_dwordx4 v20, s[12:15], s44 offen offset:3072 lds
  v_mfma_f32_32x32x16_bf16 v[240:255], a[220:223], v[124:127], v[240:255]
  ds_read_b64_tr_b16 v[110:111], v5 offset:62464
  s_add_u32 s44, s44, 0x80000
  s_waitcnt lgkmcnt(6)
  v_mfma_f32_32x32x16_bf16 v[128:143], a[224:227], v[96:99], v[128:143]
  ds_read_b64_tr_b16 v[112:113], v6 offset:49152
  s_waitcnt lgkmcnt(5)
  v_mfma_f32_32x32x16_bf16 v[128:143], a[228:231], v[100:103], v[128:143]
  ds_read_b64_tr_b16 v[114:115], v6 offset:50176
  s_waitcnt lgkmcnt(4)
  v_mfma_f32_32x32x16_bf16 v[128:143], a[232:235], v[104:107], v[128:143]
  ds_read_b64_tr_b16 v[116:117], v6 offset:53248
  s_waitcnt lgkmcnt(3)
  v_mfma_f32_32x32x16_bf16 v[128:143], a[236:239], v[108:111], v[128:143]
  ds_read_b64_tr_b16 v[118:119], v6 offset:54272
  buffer_store_dwordx4 v[88:91], v21, s[16:19], s50 offen offset:2048 sc1
  v_mfma_f32_32x32x16_bf16 v[144:159], a[240:243], v[96:99], v[144:159]
  ds_read_b64_tr_b16 v[120:121], v6 offset:57344
  v_mfma_f32_32x32x16_bf16 v[144:159], a[244:247], v[100:103], v[144:159]
  ds_read_b64_tr_b16 v[122:123], v6 offset:58368
  v_mfma_f32_32x32x16_bf16 v[144:159], a[248:251], v[104:107], v[144:159]
  ds_read_b64_tr_b16 v[124:125], v6 offset:61440
  v_mfma_f32_32x32x16_bf16 v[144:159], a[252:255], v[108:111], v[144:159]
  ds_read_b64_tr_b16 v[126:127], v6 offset:62464
  s_nop 1
  v_cvt_pk_bf16_f32 v32, v128, v129
  v_cvt_pk_bf16_f32 v33, v130, v131
  s_waitcnt lgkmcnt(6)
  v_mfma_f32_32x32x16_bf16 v[160:175], a[224:227], v[112:115], v[160:175]
  ds_read_b64_tr_b16 v[96:97], v7 offset:49152
  v_cvt_pk_bf16_f32 v34, v132, v133
  v_cvt_pk_bf16_f32 v35, v134, v135
  s_waitcnt lgkmcnt(5)
  v_mfma_f32_32x32x16_bf16 v[160:175], a[228:231], v[116:119], v[160:175]
  ds_read_b64_tr_b16 v[98:99], v7 offset:50176
  buffer_store_dwordx4 v[92:95], v21, s[16:19], s50 offen offset:3072 sc1
  v_cvt_pk_bf16_f32 v36, v136, v137
  v_cvt_pk_bf16_f32 v37, v138, v139
  s_waitcnt lgkmcnt(4)
  v_mfma_f32_32x32x16_bf16 v[160:175], a[232:235], v[120:123], v[160:175]
  ds_read_b64_tr_b16 v[100:101], v7 offset:53248
  v_cvt_pk_bf16_f32 v38, v140, v141
  v_cvt_pk_bf16_f32 v39, v142, v143
  s_waitcnt lgkmcnt(3)
  v_mfma_f32_32x32x16_bf16 v[160:175], a[236:239], v[124:127], v[160:175]
  ds_read_b64_tr_b16 v[102:103], v7 offset:54272
  s_lshl_b32 s52, s40, 3
  s_lshl_b32 s53, s42, 1
  s_add_u32 s52, s52, s53
  v_cvt_pk_bf16_f32 v40, v144, v145
  v_cvt_pk_bf16_f32 v41, v146, v147
  v_mfma_f32_32x32x16_bf16 v[176:191], a[240:243], v[112:115], v[176:191]
  ds_read_b64_tr_b16 v[104:105], v7 offset:57344
  s_lshl_b32 s52, s52, 13
  s_mul_i32 s53, s41, 0x80000
  s_add_u32 s52, s52, s53
  v_cvt_pk_bf16_f32 v42, v148, v149
  v_cvt_pk_bf16_f32 v43, v150, v151
  v_mfma_f32_32x32x16_bf16 v[176:191], a[244:247], v[116:119], v[176:191]
  ds_read_b64_tr_b16 v[106:107], v7 offset:58368
  s_add_u32 s47, s52, 0x2000000
  s_add_u32 s48, s47, 4096
  s_add_u32 s49, s47, 8192
  v_cvt_pk_bf16_f32 v44, v152, v153
  v_cvt_pk_bf16_f32 v45, v154, v155
  v_mfma_f32_32x32x16_bf16 v[176:191], a[248:251], v[120:123], v[176:191]
  ds_read_b64_tr_b16 v[108:109], v7 offset:61440
  s_add_u32 s50, s47, 12288
  v_cvt_pk_bf16_f32 v46, v156, v157
  v_cvt_pk_bf16_f32 v47, v158, v159
  v_mfma_f32_32x32x16_bf16 v[176:191], a[252:255], v[124:127], v[176:191]
  ds_read_b64_tr_b16 v[110:111], v7 offset:62464
  v_cvt_pk_bf16_f32 v48, v160, v161
  v_cvt_pk_bf16_f32 v49, v162, v163
  s_waitcnt lgkmcnt(6)
  v_mfma_f32_32x32x16_bf16 v[192:207], a[224:227], v[96:99], v[192:207]
  ds_read_b64_tr_b16 v[112:113], v8 offset:49152
  v_cvt_pk_bf16_f32 v50, v164, v165
  v_cvt_pk_bf16_f32 v51, v166, v167
  s_waitcnt lgkmcnt(5)
  v_mfma_f32_32x32x16_bf16 v[192:207], a[228:231], v[100:103], v[192:207]
  ds_read_b64_tr_b16 v[114:115], v8 offset:50176
  s_waitcnt vmcnt(63)
  ds_read_b128 a[0:3], v28
  v_cvt_pk_bf16_f32 v52, v168, v169
  v_cvt_pk_bf16_f32 v53, v170, v171
  s_waitcnt lgkmcnt(5)
  v_mfma_f32_32x32x16_bf16 v[192:207], a[232:235], v[104:107], v[192:207]
  ds_read_b64_tr_b16 v[116:117], v8 offset:53248
  v_cvt_pk_bf16_f32 v54, v172, v173
  v_cvt_pk_bf16_f32 v55, v174, v175
  s_waitcnt lgkmcnt(4)
  v_mfma_f32_32x32x16_bf16 v[192:207], a[236:239], v[108:111], v[192:207]
  ds_read_b64_tr_b16 v[118:119], v8 offset:54272
  ds_read_b128 a[4:7], v29
  v_cvt_pk_bf16_f32 v56, v176, v177
  v_cvt_pk_bf16_f32 v57, v178, v179
  v_mfma_f32_32x32x16_bf16 v[208:223], a[240:243], v[96:99], v[208:223]
  ds_read_b64_tr_b16 v[120:121], v8 offset:57344
  v_cvt_pk_bf16_f32 v58, v180, v181
  v_cvt_pk_bf16_f32 v59, v182, v183
  v_mfma_f32_32x32x16_bf16 v[208:223], a[244:247], v[100:103], v[208:223]
  ds_read_b64_tr_b16 v[122:123], v8 offset:58368
  ds_read_b128 a[8:11], v30
  v_cvt_pk_bf16_f32 v60, v184, v185
  v_cvt_pk_bf16_f32 v61, v186, v187
  v_mfma_f32_32x32x16_bf16 v[208:223], a[248:251], v[104:107], v[208:223]
  ds_read_b64_tr_b16 v[124:125], v8 offset:61440
  v_cvt_pk_bf16_f32 v62, v188, v189
  v_cvt_pk_bf16_f32 v63, v190, v191
  v_mfma_f32_32x32x16_bf16 v[208:223], a[252:255], v[108:111], v[208:223]
  ds_read_b64_tr_b16 v[126:127], v8 offset:62464
  s_waitcnt vmcnt(8)
  s_barrier
  ds_read_b128 a[12:15], v31
  v_cvt_pk_bf16_f32 v64, v192, v193
  v_cvt_pk_bf16_f32 v65, v194, v195
  s_waitcnt lgkmcnt(10)
  v_mfma_f32_32x32x16_bf16 v[224:239], a[224:227], v[112:115], v[224:239]
  s_add_u32 m0, s46, 0x20000
  ds_read_b64_tr_b16 v[96:97], v5
  buffer_load_dwordx4 v17, s[12:15], s44 offen lds
  v_cvt_pk_bf16_f32 v66, v196, v197
  v_cvt_pk_bf16_f32 v67, v198, v199
  s_waitcnt lgkmcnt(8)
  v_mfma_f32_32x32x16_bf16 v[224:239], a[228:231], v[116:119], v[224:239]
  ds_read_b64_tr_b16 v[98:99], v5 offset:1024
  ds_read_b128 a[16:19], v28 offset:4096
  v_cvt_pk_bf16_f32 v68, v200, v201
  v_cvt_pk_bf16_f32 v69, v202, v203
  s_waitcnt lgkmcnt(7)
  v_mfma_f32_32x32x16_bf16 v[224:239], a[232:235], v[120:123], v[224:239]
  ds_read_b64_tr_b16 v[100:101], v5 offset:4096
  buffer_load_dwordx4 v18, s[12:15], s44 offen offset:1024 lds
  v_cvt_pk_bf16_f32 v70, v204, v205
  v_cvt_pk_bf16_f32 v71, v206, v207
  s_waitcnt lgkmcnt(5)
  v_mfma_f32_32x32x16_bf16 v[224:239], a[236:239], v[124:127], v[224:239]
  ds_read_b64_tr_b16 v[102:103], v5 offset:5120
  ds_read_b128 a[20:23], v29 offset:4096
  v_cvt_pk_bf16_f32 v72, v208, v209
  v_cvt_pk_bf16_f32 v73, v210, v211
  v_mfma_f32_32x32x16_bf16 v[240:255], a[240:243], v[112:115], v[240:255]
  ds_read_b64_tr_b16 v[104:105], v5 offset:8192
  buffer_load_dwordx4 v19, s[12:15], s44 offen offset:2048 lds
  v_cvt_pk_bf16_f32 v74, v212, v213
  v_cvt_pk_bf16_f32 v75, v214, v215
  v_mfma_f32_32x32x16_bf16 v[240:255], a[244:247], v[116:119], v[240:255]
  ds_read_b64_tr_b16 v[106:107], v5 offset:9216
  ds_read_b128 a[24:27], v30 offset:4096
  v_cvt_pk_bf16_f32 v76, v216, v217
  v_cvt_pk_bf16_f32 v77, v218, v219
  v_mfma_f32_32x32x16_bf16 v[240:255], a[248:251], v[120:123], v[240:255]
  ds_read_b64_tr_b16 v[108:109], v5 offset:12288
  buffer_load_dwordx4 v20, s[12:15], s44 offen offset:3072 lds
  v_cvt_pk_bf16_f32 v78, v220, v221
  v_cvt_pk_bf16_f32 v79, v222, v223
  v_mfma_f32_32x32x16_bf16 v[240:255], a[252:255], v[124:127], v[240:255]
  ds_read_b64_tr_b16 v[110:111], v5 offset:13312
  ds_read_b128 a[28:31], v31 offset:4096
  s_add_u32 s44, s44, 0x80000
  v_cvt_pk_bf16_f32 v80, v224, v225
  v_cvt_pk_bf16_f32 v81, v226, v227
  s_waitcnt lgkmcnt(10)
  v_mfma_f32_32x32x16_bf16 v[128:143], v[96:99], a[0:3], 0
  ds_read_b64_tr_b16 v[112:113], v6
  v_cvt_pk_bf16_f32 v82, v228, v229
  v_cvt_pk_bf16_f32 v83, v230, v231
  s_waitcnt lgkmcnt(8)
  v_mfma_f32_32x32x16_bf16 v[128:143], v[100:103], a[4:7], v[128:143]
  ds_read_b64_tr_b16 v[114:115], v6 offset:1024
  v_cvt_pk_bf16_f32 v84, v232, v233
  v_cvt_pk_bf16_f32 v85, v234, v235
  s_waitcnt lgkmcnt(6)
  v_mfma_f32_32x32x16_bf16 v[128:143], v[104:107], a[8:11], v[128:143]
  ds_read_b64_tr_b16 v[116:117], v6 offset:4096
  v_cvt_pk_bf16_f32 v86, v236, v237
  v_cvt_pk_bf16_f32 v87, v238, v239
  s_waitcnt lgkmcnt(4)
  v_mfma_f32_32x32x16_bf16 v[128:143], v[108:111], a[12:15], v[128:143]
  ds_read_b64_tr_b16 v[118:119], v6 offset:5120
  v_cvt_pk_bf16_f32 v88, v240, v241
  v_cvt_pk_bf16_f32 v89, v242, v243
  v_mfma_f32_32x32x16_bf16 v[144:159], v[96:99], a[16:19], 0
  ds_read_b64_tr_b16 v[120:121], v6 offset:8192
  v_cvt_pk_bf16_f32 v90, v244, v245
  v_cvt_pk_bf16_f32 v91, v246, v247
  v_mfma_f32_32x32x16_bf16 v[144:159], v[100:103], a[20:23], v[144:159]
  ds_read_b64_tr_b16 v[122:123], v6 offset:9216
  v_cvt_pk_bf16_f32 v92, v248, v249
  v_cvt_pk_bf16_f32 v93, v250, v251
  v_mfma_f32_32x32x16_bf16 v[144:159], v[104:107], a[24:27], v[144:159]
  ds_read_b64_tr_b16 v[124:125], v6 offset:12288
  v_cvt_pk_bf16_f32 v94, v252, v253
  v_cvt_pk_bf16_f32 v95, v254, v255
  s_waitcnt lgkmcnt(7)
  v_mfma_f32_32x32x16_bf16 v[144:159], v[108:111], a[28:31], v[144:159]
  ds_read_b64_tr_b16 v[126:127], v6 offset:13312
  s_waitcnt lgkmcnt(6)
  v_mfma_f32_32x32x16_bf16 v[160:175], v[112:115], a[0:3], 0
  s_add_u32 m0, s45, 0x10000
  ds_read_b64_tr_b16 v[96:97], v7
  buffer_load_dwordx4 v9, s[8:11], s43 offen lds
  buffer_store_dwordx4 v[32:35], v21, s[16:19], s47 offen sc1
  s_waitcnt lgkmcnt(5)
  v_mfma_f32_32x32x16_bf16 v[160:175], v[116:119], a[4:7], v[160:175]
  ds_read_b64_tr_b16 v[98:99], v7 offset:1024
  s_waitcnt lgkmcnt(4)
  v_mfma_f32_32x32x16_bf16 v[160:175], v[120:123], a[8:11], v[160:175]
  ds_read_b64_tr_b16 v[100:101], v7 offset:4096
  buffer_load_dwordx4 v10, s[8:11], s43 offen offset:1024 lds
  s_waitcnt lgkmcnt(3)
  v_mfma_f32_32x32x16_bf16 v[160:175], v[124:127], a[12:15], v[160:175]
  ds_read_b64_tr_b16 v[102:103], v7 offset:5120
  v_mfma_f32_32x32x16_bf16 v[176:191], v[112:115], a[16:19], 0
  ds_read_b64_tr_b16 v[104:105], v7 offset:8192
  buffer_load_dwordx4 v11, s[8:11], s43 offen offset:2048 lds
  v_mfma_f32_32x32x16_bf16 v[176:191], v[116:119], a[20:23], v[176:191]
  ds_read_b64_tr_b16 v[106:107], v7 offset:9216
  buffer_store_dwordx4 v[36:39], v21, s[16:19], s48 offen sc1
  v_mfma_f32_32x32x16_bf16 v[176:191], v[120:123], a[24:27], v[176:191]
  ds_read_b64_tr_b16 v[108:109], v7 offset:12288
  buffer_load_dwordx4 v12, s[8:11], s43 offen offset:3072 lds
  v_mfma_f32_32x32x16_bf16 v[176:191], v[124:127], a[28:31], v[176:191]
  ds_read_b64_tr_b16 v[110:111], v7 offset:13312
  s_waitcnt lgkmcnt(6)
  v_mfma_f32_32x32x16_bf16 v[192:207], v[96:99], a[0:3], 0
  s_add_u32 m0, s45, 0x11000
  ds_read_b64_tr_b16 v[112:113], v8
  buffer_load_dwordx4 v13, s[8:11], s43 offen lds
  s_waitcnt lgkmcnt(5)
  v_mfma_f32_32x32x16_bf16 v[192:207], v[100:103], a[4:7], v[192:207]
  ds_read_b64_tr_b16 v[114:115], v8 offset:1024
  s_waitcnt vmcnt(63)
  ds_read_b128 a[32:35], v1
  s_waitcnt lgkmcnt(5)
  v_mfma_f32_32x32x16_bf16 v[192:207], v[104:107], a[8:11], v[192:207]
  ds_read_b64_tr_b16 v[116:117], v8 offset:4096
  buffer_load_dwordx4 v14, s[8:11], s43 offen offset:1024 lds
  buffer_store_dwordx4 v[40:43], v21, s[16:19], s49 offen sc1
  s_waitcnt lgkmcnt(4)
  v_mfma_f32_32x32x16_bf16 v[192:207], v[108:111], a[12:15], v[192:207]
  ds_read_b64_tr_b16 v[118:119], v8 offset:5120
  ds_read_b128 a[36:39], v2
  v_mfma_f32_32x32x16_bf16 v[208:223], v[96:99], a[16:19], 0
  ds_read_b64_tr_b16 v[120:121], v8 offset:8192
  buffer_load_dwordx4 v15, s[8:11], s43 offen offset:2048 lds
  v_mfma_f32_32x32x16_bf16 v[208:223], v[100:103], a[20:23], v[208:223]
  ds_read_b64_tr_b16 v[122:123], v8 offset:9216
  ds_read_b128 a[40:43], v3
  v_mfma_f32_32x32x16_bf16 v[208:223], v[104:107], a[24:27], v[208:223]
  ds_read_b64_tr_b16 v[124:125], v8 offset:12288
  buffer_load_dwordx4 v16, s[8:11], s43 offen offset:3072 lds
  s_add_u32 s43, s43, 128
  v_mfma_f32_32x32x16_bf16 v[208:223], v[108:111], a[28:31], v[208:223]
  ds_read_b64_tr_b16 v[126:127], v8 offset:13312
  s_waitcnt vmcnt(17)
  s_barrier
  ds_read_b128 a[44:47], v4
  s_waitcnt lgkmcnt(10)
  v_mfma_f32_32x32x16_bf16 v[224:239], v[112:115], a[0:3], 0
  s_add_u32 m0, s46, 0x24000
  ds_read_b64_tr_b16 v[96:97], v5 offset:16384
  buffer_load_dwordx4 v17, s[12:15], s44 offen lds
  s_waitcnt lgkmcnt(8)
  v_mfma_f32_32x32x16_bf16 v[224:239], v[116:119], a[4:7], v[224:239]
  ds_read_b64_tr_b16 v[98:99], v5 offset:17408
  ds_read_b128 a[48:51], v1 offset:4096
  s_waitcnt lgkmcnt(7)
  v_mfma_f32_32x32x16_bf16 v[224:239], v[120:123], a[8:11], v[224:239]
  ds_read_b64_tr_b16 v[100:101], v5 offset:20480
  buffer_load_dwordx4 v18, s[12:15], s44 offen offset:1024 lds
  s_waitcnt lgkmcnt(5)
  v_mfma_f32_32x32x16_bf16 v[224:239], v[124:127], a[12:15], v[224:239]
  ds_read_b64_tr_b16 v[102:103], v5 offset:21504
  ds_read_b128 a[52:55], v2 offset:4096
  v_mfma_f32_32x32x16_bf16 v[240:255], v[112:115], a[16:19], 0
  ds_read_b64_tr_b16 v[104:105], v5 offset:24576
  buffer_load_dwordx4 v19, s[12:15], s44 offen offset:2048 lds
  v_mfma_f32_32x32x16_bf16 v[240:255], v[116:119], a[20:23], v[240:255]
  ds_read_b64_tr_b16 v[106:107], v5 offset:25600
  ds_read_b128 a[56:59], v3 offset:4096
  v_mfma_f32_32x32x16_bf16 v[240:255], v[120:123], a[24:27], v[240:255]
  ds_read_b64_tr_b16 v[108:109], v5 offset:28672
  buffer_load_dwordx4 v20, s[12:15], s44 offen offset:3072 lds
  v_mfma_f32_32x32x16_bf16 v[240:255], v[124:127], a[28:31], v[240:255]
  ds_read_b64_tr_b16 v[110:111], v5 offset:29696
  ds_read_b128 a[60:63], v4 offset:4096
  s_add_u32 s44, s44, 0x80000
  s_waitcnt lgkmcnt(10)
  v_mfma_f32_32x32x16_bf16 v[128:143], v[96:99], a[32:35], v[128:143]
  ds_read_b64_tr_b16 v[112:113], v6 offset:16384
  s_waitcnt lgkmcnt(8)
  v_mfma_f32_32x32x16_bf16 v[128:143], v[100:103], a[36:39], v[128:143]
  ds_read_b64_tr_b16 v[114:115], v6 offset:17408
  buffer_store_dwordx4 v[44:47], v21, s[16:19], s50 offen sc1
  s_waitcnt lgkmcnt(6)
  v_mfma_f32_32x32x16_bf16 v[128:143], v[104:107], a[40:43], v[128:143]
  ds_read_b64_tr_b16 v[116:117], v6 offset:20480
  s_waitcnt lgkmcnt(4)
  v_mfma_f32_32x32x16_bf16 v[128:143], v[108:111], a[44:47], v[128:143]
  ds_read_b64_tr_b16 v[118:119], v6 offset:21504
  v_mfma_f32_32x32x16_bf16 v[144:159], v[96:99], a[48:51], v[144:159]
  ds_read_b64_tr_b16 v[120:121], v6 offset:24576
  v_mfma_f32_32x32x16_bf16 v[144:159], v[100:103], a[52:55], v[144:159]
  ds_read_b64_tr_b16 v[122:123], v6 offset:25600
  v_mfma_f32_32x32x16_bf16 v[144:159], v[104:107], a[56:59], v[144:159]
  ds_read_b64_tr_b16 v[124:125], v6 offset:28672
  buffer_store_dwordx4 v[48:51], v21, s[16:19], s47 offen offset:1024 sc1
  s_waitcnt lgkmcnt(7)
  v_mfma_f32_32x32x16_bf16 v[144:159], v[108:111], a[60:63], v[144:159]
  ds_read_b64_tr_b16 v[126:127], v6 offset:29696
  s_waitcnt lgkmcnt(6)
  v_mfma_f32_32x32x16_bf16 v[160:175], v[112:115], a[32:35], v[160:175]
  s_add_u32 m0, s45, 0
  ds_read_b64_tr_b16 v[96:97], v7 offset:16384
  buffer_load_dwordx4 v9, s[8:11], s43 offen lds
  s_waitcnt lgkmcnt(5)
  v_mfma_f32_32x32x16_bf16 v[160:175], v[116:119], a[36:39], v[160:175]
  ds_read_b64_tr_b16 v[98:99], v7 offset:17408
  v_and_b32 v22, 31, v27
  v_lshrrev_b32 v23, 5, v27
  v_lshlrev_b32 v23, 2, v23
  s_waitcnt lgkmcnt(4)
  v_mfma_f32_32x32x16_bf16 v[160:175], v[120:123], a[40:43], v[160:175]
  ds_read_b64_tr_b16 v[100:101], v7 offset:20480
  buffer_load_dwordx4 v10, s[8:11], s43 offen offset:1024 lds
  v_sub_u32 v22, v22, v23
  v_mov_b32 v24, 0xff800000
  v_mov_b32 v25, 0
  s_waitcnt lgkmcnt(3)
  v_mfma_f32_32x32x16_bf16 v[160:175], v[124:127], a[44:47], v[160:175]
  ds_read_b64_tr_b16 v[102:103], v7 offset:21504
  buffer_store_dwordx4 v[52:55], v21, s[16:19], s48 offen offset:1024 sc1
  v_cmp_le_i32 vcc, 0, v22
  s_nop 1
  v_cndmask_b32 v26, v24, v25, vcc
  v_mfma_f32_32x32x16_bf16 v[176:191], v[112:115], a[48:51], v[176:191]
  ds_read_b64_tr_b16 v[104:105], v7 offset:24576
  buffer_load_dwordx4 v11, s[8:11], s43 offen offset:2048 lds
  v_accvgpr_write_b32 a128, v26
  v_cmp_le_i32 vcc, 1, v22
  s_nop 1
  v_mfma_f32_32x32x16_bf16 v[176:191], v[116:119], a[52:55], v[176:191]
  ds_read_b64_tr_b16 v[106:107], v7 offset:25600
  v_cndmask_b32 v26, v24, v25, vcc
  v_accvgpr_write_b32 a129, v26
  v_cmp_le_i32 vcc, 2, v22
  v_mfma_f32_32x32x16_bf16 v[176:191], v[120:123], a[56:59], v[176:191]
  ds_read_b64_tr_b16 v[108:109], v7 offset:28672
  buffer_load_dwordx4 v12, s[8:11], s43 offen offset:3072 lds
  s_nop 1
  v_cndmask_b32 v26, v24, v25, vcc
  v_accvgpr_write_b32 a130, v26
  v_mfma_f32_32x32x16_bf16 v[176:191], v[124:127], a[60:63], v[176:191]
  ds_read_b64_tr_b16 v[110:111], v7 offset:29696
  v_cmp_le_i32 vcc, 3, v22
  s_nop 1
  v_cndmask_b32 v26, v24, v25, vcc
  s_waitcnt lgkmcnt(6)
  v_mfma_f32_32x32x16_bf16 v[192:207], v[96:99], a[32:35], v[192:207]
  s_add_u32 m0, s45, 0x1000
  ds_read_b64_tr_b16 v[112:113], v8 offset:16384
  buffer_load_dwordx4 v13, s[8:11], s43 offen lds
  v_accvgpr_write_b32 a131, v26
  v_cmp_le_i32 vcc, 8, v22
  s_nop 1
  s_waitcnt lgkmcnt(5)
  v_mfma_f32_32x32x16_bf16 v[192:207], v[100:103], a[36:39], v[192:207]
  ds_read_b64_tr_b16 v[114:115], v8 offset:17408
  s_waitcnt vmcnt(63)
  ds_read_b128 a[0:3], v1 offset:32768
  v_cndmask_b32 v26, v24, v25, vcc
  v_accvgpr_write_b32 a132, v26
  v_cmp_le_i32 vcc, 9, v22
  s_waitcnt lgkmcnt(5)
  v_mfma_f32_32x32x16_bf16 v[192:207], v[104:107], a[40:43], v[192:207]
  ds_read_b64_tr_b16 v[116:117], v8 offset:20480
  buffer_load_dwordx4 v14, s[8:11], s43 offen offset:1024 lds
  s_nop 1
  v_cndmask_b32 v26, v24, v25, vcc
  v_accvgpr_write_b32 a133, v26
  s_waitcnt lgkmcnt(4)
  v_mfma_f32_32x32x16_bf16 v[192:207], v[108:111], a[44:47], v[192:207]
  ds_read_b64_tr_b16 v[118:119], v8 offset:21504
  ds_read_b128 a[4:7], v2 offset:32768
  v_cmp_le_i32 vcc, 10, v22
  s_nop 1
  v_cndmask_b32 v26, v24, v25, vcc
  v_mfma_f32_32x32x16_bf16 v[208:223], v[96:99], a[48:51], v[208:223]
  ds_read_b64_tr_b16 v[120:121], v8 offset:24576
  buffer_load_dwordx4 v15, s[8:11], s43 offen offset:2048 lds
  v_accvgpr_write_b32 a134, v26
  v_cmp_le_i32 vcc, 11, v22
  s_nop 1
  v_mfma_f32_32x32x16_bf16 v[208:223], v[100:103], a[52:55], v[208:223]
  ds_read_b64_tr_b16 v[122:123], v8 offset:25600
  ds_read_b128 a[8:11], v3 offset:32768
  v_mfma_f32_32x32x16_bf16 v[208:223], v[104:107], a[56:59], v[208:223]
  ds_read_b64_tr_b16 v[124:125], v8 offset:28672
  buffer_load_dwordx4 v16, s[8:11], s43 offen offset:3072 lds
  s_add_u32 s43, s43, 128
  v_mfma_f32_32x32x16_bf16 v[208:223], v[108:111], a[60:63], v[208:223]
  ds_read_b64_tr_b16 v[126:127], v8 offset:29696
  s_waitcnt vmcnt(26)
  s_barrier
  ds_read_b128 a[12:15], v4 offset:32768
  s_waitcnt lgkmcnt(10)
  v_mfma_f32_32x32x16_bf16 v[224:239], v[112:115], a[32:35], v[224:239]
  s_add_u32 m0, s46, 0x18000
  ds_read_b64_tr_b16 v[96:97], v5 offset:32768
  buffer_load_dwordx4 v17, s[12:15], s44 offen lds
  s_waitcnt lgkmcnt(8)
  v_mfma_f32_32x32x16_bf16 v[224:239], v[116:119], a[36:39], v[224:239]
  ds_read_b64_tr_b16 v[98:99], v5 offset:33792
  ds_read_b128 a[16:19], v1 offset:36864
  s_waitcnt lgkmcnt(7)
  v_mfma_f32_32x32x16_bf16 v[224:239], v[120:123], a[40:43], v[224:239]
  ds_read_b64_tr_b16 v[100:101], v5 offset:36864
  buffer_load_dwordx4 v18, s[12:15], s44 offen offset:1024 lds
  s_waitcnt lgkmcnt(5)
  v_mfma_f32_32x32x16_bf16 v[224:239], v[124:127], a[44:47], v[224:239]
  ds_read_b64_tr_b16 v[102:103], v5 offset:37888
  ds_read_b128 a[20:23], v2 offset:36864
  v_mfma_f32_32x32x16_bf16 v[240:255], v[112:115], a[48:51], v[240:255]
  ds_read_b64_tr_b16 v[104:105], v5 offset:40960
  buffer_load_dwordx4 v19, s[12:15], s44 offen offset:2048 lds
  v_mfma_f32_32x32x16_bf16 v[240:255], v[116:119], a[52:55], v[240:255]
  ds_read_b64_tr_b16 v[106:107], v5 offset:41984
  ds_read_b128 a[24:27], v3 offset:36864
  v_mfma_f32_32x32x16_bf16 v[240:255], v[120:123], a[56:59], v[240:255]
  ds_read_b64_tr_b16 v[108:109], v5 offset:45056
  buffer_load_dwordx4 v20, s[12:15], s44 offen offset:3072 lds
  v_mfma_f32_32x32x16_bf16 v[240:255], v[124:127], a[60:63], v[240:255]
  ds_read_b64_tr_b16 v[110:111], v5 offset:46080
  ds_read_b128 a[28:31], v4 offset:36864
  s_add_u32 s44, s44, 0x80000
  s_waitcnt lgkmcnt(10)
  v_mfma_f32_32x32x16_bf16 v[128:143], v[96:99], a[0:3], v[128:143]
  ds_read_b64_tr_b16 v[112:113], v6 offset:32768
  s_waitcnt lgkmcnt(8)
  v_mfma_f32_32x32x16_bf16 v[128:143], v[100:103], a[4:7], v[128:143]
  ds_read_b64_tr_b16 v[114:115], v6 offset:33792
  buffer_store_dwordx4 v[56:59], v21, s[16:19], s49 offen offset:1024 sc1
  s_waitcnt lgkmcnt(6)
  v_mfma_f32_32x32x16_bf16 v[128:143], v[104:107], a[8:11], v[128:143]
  ds_read_b64_tr_b16 v[116:117], v6 offset:36864
  s_waitcnt lgkmcnt(4)
  v_mfma_f32_32x32x16_bf16 v[128:143], v[108:111], a[12:15], v[128:143]
  ds_read_b64_tr_b16 v[118:119], v6 offset:37888
  v_mfma_f32_32x32x16_bf16 v[144:159], v[96:99], a[16:19], v[144:159]
  ds_read_b64_tr_b16 v[120:121], v6 offset:40960
  v_mfma_f32_32x32x16_bf16 v[144:159], v[100:103], a[20:23], v[144:159]
  ds_read_b64_tr_b16 v[122:123], v6 offset:41984
  v_mfma_f32_32x32x16_bf16 v[144:159], v[104:107], a[24:27], v[144:159]
  ds_read_b64_tr_b16 v[124:125], v6 offset:45056
  buffer_store_dwordx4 v[60:63], v21, s[16:19], s50 offen offset:1024 sc1
  s_waitcnt lgkmcnt(7)
  v_mfma_f32_32x32x16_bf16 v[144:159], v[108:111], a[28:31], v[144:159]
  ds_read_b64_tr_b16 v[126:127], v6 offset:46080
  s_waitcnt lgkmcnt(6)
  v_mfma_f32_32x32x16_bf16 v[160:175], v[112:115], a[0:3], v[160:175]
  s_add_u32 m0, s45, 0x8000
  ds_read_b64_tr_b16 v[96:97], v7 offset:32768
  buffer_load_dwordx4 v9, s[8:11], s43 offen lds
  s_waitcnt lgkmcnt(5)
  v_mfma_f32_32x32x16_bf16 v[160:175], v[116:119], a[4:7], v[160:175]
  ds_read_b64_tr_b16 v[98:99], v7 offset:33792
  v_cndmask_b32 v26, v24, v25, vcc
  v_accvgpr_write_b32 a135, v26
  v_cmp_le_i32 vcc, 16, v22
  s_waitcnt lgkmcnt(4)
  v_mfma_f32_32x32x16_bf16 v[160:175], v[120:123], a[8:11], v[160:175]
  ds_read_b64_tr_b16 v[100:101], v7 offset:36864
  buffer_load_dwordx4 v10, s[8:11], s43 offen offset:1024 lds
  s_nop 1
  v_cndmask_b32 v26, v24, v25, vcc
  v_accvgpr_write_b32 a136, v26
  s_waitcnt lgkmcnt(3)
  v_mfma_f32_32x32x16_bf16 v[160:175], v[124:127], a[12:15], v[160:175]
  ds_read_b64_tr_b16 v[102:103], v7 offset:37888
  v_cmp_le_i32 vcc, 17, v22
  s_nop 1
  v_cndmask_b32 v26, v24, v25, vcc
  v_mfma_f32_32x32x16_bf16 v[176:191], v[112:115], a[16:19], v[176:191]
  ds_read_b64_tr_b16 v[104:105], v7 offset:40960
  buffer_load_dwordx4 v11, s[8:11], s43 offen offset:2048 lds
  v_accvgpr_write_b32 a137, v26
  v_cmp_le_i32 vcc, 18, v22
  s_nop 1
  v_mfma_f32_32x32x16_bf16 v[176:191], v[116:119], a[20:23], v[176:191]
  ds_read_b64_tr_b16 v[106:107], v7 offset:41984
  v_cndmask_b32 v26, v24, v25, vcc
  v_accvgpr_write_b32 a138, v26
  v_cmp_le_i32 vcc, 19, v22
  v_mfma_f32_32x32x16_bf16 v[176:191], v[120:123], a[24:27], v[176:191]
  ds_read_b64_tr_b16 v[108:109], v7 offset:45056
  buffer_load_dwordx4 v12, s[8:11], s43 offen offset:3072 lds
  s_nop 1
  v_cndmask_b32 v26, v24, v25, vcc
  v_accvgpr_write_b32 a139, v26
  v_mfma_f32_32x32x16_bf16 v[176:191], v[124:127], a[28:31], v[176:191]
  ds_read_b64_tr_b16 v[110:111], v7 offset:46080
  v_cmp_le_i32 vcc, 24, v22
  s_nop 1
  v_cndmask_b32 v26, v24, v25, vcc
  s_waitcnt lgkmcnt(6)
  v_mfma_f32_32x32x16_bf16 v[192:207], v[96:99], a[0:3], v[192:207]
  s_add_u32 m0, s45, 0x9000
  ds_read_b64_tr_b16 v[112:113], v8 offset:32768
  buffer_load_dwordx4 v13, s[8:11], s43 offen lds
  v_accvgpr_write_b32 a140, v26
  v_cmp_le_i32 vcc, 25, v22
  s_nop 1
  s_waitcnt lgkmcnt(5)
  v_mfma_f32_32x32x16_bf16 v[192:207], v[100:103], a[4:7], v[192:207]
  ds_read_b64_tr_b16 v[114:115], v8 offset:33792
  s_waitcnt vmcnt(26)
  ds_read_b128 a[32:35], v28
  v_cndmask_b32 v26, v24, v25, vcc
  v_accvgpr_write_b32 a141, v26
  v_cmp_le_i32 vcc, 26, v22
  s_waitcnt lgkmcnt(5)
  v_mfma_f32_32x32x16_bf16 v[192:207], v[104:107], a[8:11], v[192:207]
  ds_read_b64_tr_b16 v[116:117], v8 offset:36864
  buffer_load_dwordx4 v14, s[8:11], s43 offen offset:1024 lds
  s_nop 1
  v_cndmask_b32 v26, v24, v25, vcc
  v_accvgpr_write_b32 a142, v26
  s_waitcnt lgkmcnt(4)
  v_mfma_f32_32x32x16_bf16 v[192:207], v[108:111], a[12:15], v[192:207]
  ds_read_b64_tr_b16 v[118:119], v8 offset:37888
  ds_read_b128 a[36:39], v29
  v_cmp_le_i32 vcc, 27, v22
  s_nop 1
  v_cndmask_b32 v26, v24, v25, vcc
  v_mfma_f32_32x32x16_bf16 v[208:223], v[96:99], a[16:19], v[208:223]
  ds_read_b64_tr_b16 v[120:121], v8 offset:40960
  buffer_load_dwordx4 v15, s[8:11], s43 offen offset:2048 lds
  v_accvgpr_write_b32 a143, v26
  v_mfma_f32_32x32x16_bf16 v[208:223], v[100:103], a[20:23], v[208:223]
  ds_read_b64_tr_b16 v[122:123], v8 offset:41984
  ds_read_b128 a[40:43], v30
  v_mfma_f32_32x32x16_bf16 v[208:223], v[104:107], a[24:27], v[208:223]
  ds_read_b64_tr_b16 v[124:125], v8 offset:45056
  buffer_load_dwordx4 v16, s[8:11], s43 offen offset:3072 lds
  s_add_u32 s43, s43, 128
  v_mfma_f32_32x32x16_bf16 v[208:223], v[108:111], a[28:31], v[208:223]
  ds_read_b64_tr_b16 v[126:127], v8 offset:46080
  s_waitcnt vmcnt(25)
  s_barrier
  ds_read_b128 a[44:47], v31
  s_waitcnt lgkmcnt(10)
  v_mfma_f32_32x32x16_bf16 v[224:239], v[112:115], a[0:3], v[224:239]
  s_add_u32 m0, s46, 0x1c000
  ds_read_b64_tr_b16 v[96:97], v5 offset:49152
  buffer_load_dwordx4 v17, s[12:15], s44 offen lds
  s_waitcnt lgkmcnt(8)
  v_mfma_f32_32x32x16_bf16 v[224:239], v[116:119], a[4:7], v[224:239]
  ds_read_b64_tr_b16 v[98:99], v5 offset:50176
  ds_read_b128 a[48:51], v28 offset:4096
  s_waitcnt lgkmcnt(7)
  v_mfma_f32_32x32x16_bf16 v[224:239], v[120:123], a[8:11], v[224:239]
  ds_read_b64_tr_b16 v[100:101], v5 offset:53248
  buffer_load_dwordx4 v18, s[12:15], s44 offen offset:1024 lds
  s_waitcnt lgkmcnt(5)
  v_mfma_f32_32x32x16_bf16 v[224:239], v[124:127], a[12:15], v[224:239]
  ds_read_b64_tr_b16 v[102:103], v5 offset:54272
  ds_read_b128 a[52:55], v29 offset:4096
  v_mfma_f32_32x32x16_bf16 v[240:255], v[112:115], a[16:19], v[240:255]
  ds_read_b64_tr_b16 v[104:105], v5 offset:57344
  buffer_load_dwordx4 v19, s[12:15], s44 offen offset:2048 lds
  v_mfma_f32_32x32x16_bf16 v[240:255], v[116:119], a[20:23], v[240:255]
  ds_read_b64_tr_b16 v[106:107], v5 offset:58368
  ds_read_b128 a[56:59], v30 offset:4096
  v_mfma_f32_32x32x16_bf16 v[240:255], v[120:123], a[24:27], v[240:255]
  ds_read_b64_tr_b16 v[108:109], v5 offset:61440
  buffer_load_dwordx4 v20, s[12:15], s44 offen offset:3072 lds
  v_mfma_f32_32x32x16_bf16 v[240:255], v[124:127], a[28:31], v[240:255]
  ds_read_b64_tr_b16 v[110:111], v5 offset:62464
  ds_read_b128 a[60:63], v31 offset:4096
  s_add_u32 s44, s44, 0x80000
  s_waitcnt lgkmcnt(10)
  v_mfma_f32_32x32x16_bf16 v[128:143], v[96:99], a[32:35], v[128:143]
  ds_read_b64_tr_b16 v[112:113], v6 offset:49152
  s_waitcnt lgkmcnt(8)
  v_mfma_f32_32x32x16_bf16 v[128:143], v[100:103], a[36:39], v[128:143]
  ds_read_b64_tr_b16 v[114:115], v6 offset:50176
  buffer_store_dwordx4 v[64:67], v21, s[16:19], s47 offen offset:2048 sc1
  s_waitcnt lgkmcnt(6)
  v_mfma_f32_32x32x16_bf16 v[128:143], v[104:107], a[40:43], v[128:143]
  ds_read_b64_tr_b16 v[116:117], v6 offset:53248
  s_waitcnt lgkmcnt(4)
  v_mfma_f32_32x32x16_bf16 v[128:143], v[108:111], a[44:47], v[128:143]
  ds_read_b64_tr_b16 v[118:119], v6 offset:54272
  v_mfma_f32_32x32x16_bf16 v[144:159], v[96:99], a[48:51], v[144:159]
  ds_read_b64_tr_b16 v[120:121], v6 offset:57344
  v_mfma_f32_32x32x16_bf16 v[144:159], v[100:103], a[52:55], v[144:159]
  ds_read_b64_tr_b16 v[122:123], v6 offset:58368
  v_mfma_f32_32x32x16_bf16 v[144:159], v[104:107], a[56:59], v[144:159]
  ds_read_b64_tr_b16 v[124:125], v6 offset:61440
  buffer_store_dwordx4 v[68:71], v21, s[16:19], s48 offen offset:2048 sc1
  s_waitcnt lgkmcnt(7)
  v_mfma_f32_32x32x16_bf16 v[144:159], v[108:111], a[60:63], v[144:159]
  ds_read_b64_tr_b16 v[126:127], v6 offset:62464
  s_waitcnt lgkmcnt(6)
  v_mfma_f32_32x32x16_bf16 v[160:175], v[112:115], a[32:35], v[160:175]
  s_add_u32 m0, s45, 0x10000
  ds_read_b64_tr_b16 v[96:97], v7 offset:49152
  buffer_load_dwordx4 v9, s[8:11], s43 offen lds
  s_waitcnt lgkmcnt(5)
  v_mfma_f32_32x32x16_bf16 v[160:175], v[116:119], a[36:39], v[160:175]
  ds_read_b64_tr_b16 v[98:99], v7 offset:50176
  s_waitcnt lgkmcnt(4)
  v_mfma_f32_32x32x16_bf16 v[160:175], v[120:123], a[40:43], v[160:175]
  ds_read_b64_tr_b16 v[100:101], v7 offset:53248
  buffer_load_dwordx4 v10, s[8:11], s43 offen offset:1024 lds
  s_waitcnt lgkmcnt(3)
  v_mfma_f32_32x32x16_bf16 v[160:175], v[124:127], a[44:47], v[160:175]
  ds_read_b64_tr_b16 v[102:103], v7 offset:54272
  buffer_store_dwordx4 v[72:75], v21, s[16:19], s49 offen offset:2048 sc1
  v_mfma_f32_32x32x16_bf16 v[176:191], v[112:115], a[48:51], v[176:191]
  ds_read_b64_tr_b16 v[104:105], v7 offset:57344
  buffer_load_dwordx4 v11, s[8:11], s43 offen offset:2048 lds
  v_mfma_f32_32x32x16_bf16 v[176:191], v[116:119], a[52:55], v[176:191]
  ds_read_b64_tr_b16 v[106:107], v7 offset:58368
  v_mfma_f32_32x32x16_bf16 v[176:191], v[120:123], a[56:59], v[176:191]
  ds_read_b64_tr_b16 v[108:109], v7 offset:61440
  buffer_load_dwordx4 v12, s[8:11], s43 offen offset:3072 lds
  v_mfma_f32_32x32x16_bf16 v[176:191], v[124:127], a[60:63], v[176:191]
  ds_read_b64_tr_b16 v[110:111], v7 offset:62464
  s_waitcnt lgkmcnt(6)
  v_mfma_f32_32x32x16_bf16 v[192:207], v[96:99], a[32:35], v[192:207]
  s_add_u32 m0, s45, 0x11000
  ds_read_b64_tr_b16 v[112:113], v8 offset:49152
  buffer_load_dwordx4 v13, s[8:11], s43 offen lds
  s_waitcnt lgkmcnt(5)
  v_mfma_f32_32x32x16_bf16 v[192:207], v[100:103], a[36:39], v[192:207]
  ds_read_b64_tr_b16 v[114:115], v8 offset:50176
  s_waitcnt vmcnt(26)
  ds_read_b128 a[0:3], v1
  s_waitcnt lgkmcnt(5)
  v_mfma_f32_32x32x16_bf16 v[192:207], v[104:107], a[40:43], v[192:207]
  ds_read_b64_tr_b16 v[116:117], v8 offset:53248
  buffer_load_dwordx4 v14, s[8:11], s43 offen offset:1024 lds
  s_waitcnt lgkmcnt(4)
  v_mfma_f32_32x32x16_bf16 v[192:207], v[108:111], a[44:47], v[192:207]
  ds_read_b64_tr_b16 v[118:119], v8 offset:54272
  ds_read_b128 a[4:7], v2
  v_mfma_f32_32x32x16_bf16 v[208:223], v[96:99], a[48:51], v[208:223]
  ds_read_b64_tr_b16 v[120:121], v8 offset:57344
  buffer_load_dwordx4 v15, s[8:11], s43 offen offset:2048 lds
  v_mfma_f32_32x32x16_bf16 v[208:223], v[100:103], a[52:55], v[208:223]
  ds_read_b64_tr_b16 v[122:123], v8 offset:58368
  ds_read_b128 a[8:11], v3
  v_mfma_f32_32x32x16_bf16 v[208:223], v[104:107], a[56:59], v[208:223]
  ds_read_b64_tr_b16 v[124:125], v8 offset:61440
  buffer_load_dwordx4 v16, s[8:11], s43 offen offset:3072 lds
  s_add_u32 s43, s43, 128
  v_mfma_f32_32x32x16_bf16 v[208:223], v[108:111], a[60:63], v[208:223]
  ds_read_b64_tr_b16 v[126:127], v8 offset:62464
  s_waitcnt vmcnt(25)
  s_barrier
  ds_read_b128 a[12:15], v4
  s_waitcnt lgkmcnt(10)
  v_mfma_f32_32x32x16_bf16 v[224:239], v[112:115], a[32:35], v[224:239]
  s_add_u32 m0, s46, 0x20000
  ds_read_b64_tr_b16 v[96:97], v5
  buffer_load_dwordx4 v17, s[12:15], s44 offen lds
  s_waitcnt lgkmcnt(8)
  v_mfma_f32_32x32x16_bf16 v[224:239], v[116:119], a[36:39], v[224:239]
  ds_read_b64_tr_b16 v[98:99], v5 offset:1024
  ds_read_b128 a[16:19], v1 offset:4096
  s_waitcnt lgkmcnt(7)
  v_mfma_f32_32x32x16_bf16 v[224:239], v[120:123], a[40:43], v[224:239]
  ds_read_b64_tr_b16 v[100:101], v5 offset:4096
  buffer_load_dwordx4 v18, s[12:15], s44 offen offset:1024 lds
  s_waitcnt lgkmcnt(5)
  v_mfma_f32_32x32x16_bf16 v[224:239], v[124:127], a[44:47], v[224:239]
  ds_read_b64_tr_b16 v[102:103], v5 offset:5120
  ds_read_b128 a[20:23], v2 offset:4096
  v_mfma_f32_32x32x16_bf16 v[240:255], v[112:115], a[48:51], v[240:255]
  ds_read_b64_tr_b16 v[104:105], v5 offset:8192
  buffer_load_dwordx4 v19, s[12:15], s44 offen offset:2048 lds
  v_mfma_f32_32x32x16_bf16 v[240:255], v[116:119], a[52:55], v[240:255]
  ds_read_b64_tr_b16 v[106:107], v5 offset:9216
  ds_read_b128 a[24:27], v3 offset:4096
  v_mfma_f32_32x32x16_bf16 v[240:255], v[120:123], a[56:59], v[240:255]
  ds_read_b64_tr_b16 v[108:109], v5 offset:12288
  buffer_load_dwordx4 v20, s[12:15], s44 offen offset:3072 lds
  v_mfma_f32_32x32x16_bf16 v[240:255], v[124:127], a[60:63], v[240:255]
  ds_read_b64_tr_b16 v[110:111], v5 offset:13312
  ds_read_b128 a[28:31], v4 offset:4096
  s_add_u32 s44, s44, 0x80000
  s_waitcnt lgkmcnt(10)
  v_mfma_f32_32x32x16_bf16 v[128:143], v[96:99], a[0:3], v[128:143]
  ds_read_b64_tr_b16 v[112:113], v6
  s_waitcnt lgkmcnt(8)
  v_mfma_f32_32x32x16_bf16 v[128:143], v[100:103], a[4:7], v[128:143]
  ds_read_b64_tr_b16 v[114:115], v6 offset:1024
  buffer_store_dwordx4 v[76:79], v21, s[16:19], s50 offen offset:2048 sc1
  s_waitcnt lgkmcnt(6)
  v_mfma_f32_32x32x16_bf16 v[128:143], v[104:107], a[8:11], v[128:143]
  ds_read_b64_tr_b16 v[116:117], v6 offset:4096
  s_waitcnt lgkmcnt(4)
  v_mfma_f32_32x32x16_bf16 v[128:143], v[108:111], a[12:15], v[128:143]
  ds_read_b64_tr_b16 v[118:119], v6 offset:5120
  v_mfma_f32_32x32x16_bf16 v[144:159], v[96:99], a[16:19], v[144:159]
  ds_read_b64_tr_b16 v[120:121], v6 offset:8192
  v_mfma_f32_32x32x16_bf16 v[144:159], v[100:103], a[20:23], v[144:159]
  ds_read_b64_tr_b16 v[122:123], v6 offset:9216
  v_mfma_f32_32x32x16_bf16 v[144:159], v[104:107], a[24:27], v[144:159]
  ds_read_b64_tr_b16 v[124:125], v6 offset:12288
  buffer_store_dwordx4 v[80:83], v21, s[16:19], s47 offen offset:3072 sc1
  s_waitcnt lgkmcnt(7)
  v_mfma_f32_32x32x16_bf16 v[144:159], v[108:111], a[28:31], v[144:159]
  ds_read_b64_tr_b16 v[126:127], v6 offset:13312
  s_waitcnt lgkmcnt(6)
  v_mfma_f32_32x32x16_bf16 v[160:175], v[112:115], a[0:3], v[160:175]
  s_add_u32 m0, s45, 0
  ds_read_b64_tr_b16 v[96:97], v7
  buffer_load_dwordx4 v9, s[8:11], s43 offen lds
  s_waitcnt lgkmcnt(5)
  v_mfma_f32_32x32x16_bf16 v[160:175], v[116:119], a[4:7], v[160:175]
  ds_read_b64_tr_b16 v[98:99], v7 offset:1024
  s_waitcnt lgkmcnt(4)
  v_mfma_f32_32x32x16_bf16 v[160:175], v[120:123], a[8:11], v[160:175]
  ds_read_b64_tr_b16 v[100:101], v7 offset:4096
  buffer_load_dwordx4 v10, s[8:11], s43 offen offset:1024 lds
  s_waitcnt lgkmcnt(3)
  v_mfma_f32_32x32x16_bf16 v[160:175], v[124:127], a[12:15], v[160:175]
  ds_read_b64_tr_b16 v[102:103], v7 offset:5120
  buffer_store_dwordx4 v[84:87], v21, s[16:19], s48 offen offset:3072 sc1
  v_mfma_f32_32x32x16_bf16 v[176:191], v[112:115], a[16:19], v[176:191]
  ds_read_b64_tr_b16 v[104:105], v7 offset:8192
  buffer_load_dwordx4 v11, s[8:11], s43 offen offset:2048 lds
  v_mfma_f32_32x32x16_bf16 v[176:191], v[116:119], a[20:23], v[176:191]
  ds_read_b64_tr_b16 v[106:107], v7 offset:9216
  v_mfma_f32_32x32x16_bf16 v[176:191], v[120:123], a[24:27], v[176:191]
  ds_read_b64_tr_b16 v[108:109], v7 offset:12288
  buffer_load_dwordx4 v12, s[8:11], s43 offen offset:3072 lds
  v_mfma_f32_32x32x16_bf16 v[176:191], v[124:127], a[28:31], v[176:191]
  ds_read_b64_tr_b16 v[110:111], v7 offset:13312
  s_waitcnt lgkmcnt(6)
  v_mfma_f32_32x32x16_bf16 v[192:207], v[96:99], a[0:3], v[192:207]
  s_add_u32 m0, s45, 0x1000
  ds_read_b64_tr_b16 v[112:113], v8
  buffer_load_dwordx4 v13, s[8:11], s43 offen lds
  s_waitcnt lgkmcnt(5)
  v_mfma_f32_32x32x16_bf16 v[192:207], v[100:103], a[4:7], v[192:207]
  ds_read_b64_tr_b16 v[114:115], v8 offset:1024
  s_waitcnt vmcnt(27)
  ds_read_b128 a[32:35], v1 offset:32768
  s_waitcnt lgkmcnt(5)
  v_mfma_f32_32x32x16_bf16 v[192:207], v[104:107], a[8:11], v[192:207]
  ds_read_b64_tr_b16 v[116:117], v8 offset:4096
  buffer_load_dwordx4 v14, s[8:11], s43 offen offset:1024 lds
  s_waitcnt lgkmcnt(4)
  v_mfma_f32_32x32x16_bf16 v[192:207], v[108:111], a[12:15], v[192:207]
  ds_read_b64_tr_b16 v[118:119], v8 offset:5120
  ds_read_b128 a[36:39], v2 offset:32768
  v_mfma_f32_32x32x16_bf16 v[208:223], v[96:99], a[16:19], v[208:223]
  ds_read_b64_tr_b16 v[120:121], v8 offset:8192
  buffer_load_dwordx4 v15, s[8:11], s43 offen offset:2048 lds
  v_mfma_f32_32x32x16_bf16 v[208:223], v[100:103], a[20:23], v[208:223]
  ds_read_b64_tr_b16 v[122:123], v8 offset:9216
  ds_read_b128 a[40:43], v3 offset:32768
  v_mfma_f32_32x32x16_bf16 v[208:223], v[104:107], a[24:27], v[208:223]
  ds_read_b64_tr_b16 v[124:125], v8 offset:12288
  buffer_load_dwordx4 v16, s[8:11], s43 offen offset:3072 lds
  s_add_u32 s43, s43, 128
  v_mfma_f32_32x32x16_bf16 v[208:223], v[108:111], a[28:31], v[208:223]
  ds_read_b64_tr_b16 v[126:127], v8 offset:13312
  s_waitcnt vmcnt(26)
  s_barrier
  ds_read_b128 a[44:47], v4 offset:32768
  s_waitcnt lgkmcnt(10)
  v_mfma_f32_32x32x16_bf16 v[224:239], v[112:115], a[0:3], v[224:239]
  s_add_u32 m0, s46, 0x24000
  ds_read_b64_tr_b16 v[96:97], v5 offset:16384
  buffer_load_dwordx4 v17, s[12:15], s44 offen lds
  s_waitcnt lgkmcnt(8)
  v_mfma_f32_32x32x16_bf16 v[224:239], v[116:119], a[4:7], v[224:239]
  ds_read_b64_tr_b16 v[98:99], v5 offset:17408
  ds_read_b128 a[48:51], v1 offset:36864
  s_waitcnt lgkmcnt(7)
  v_mfma_f32_32x32x16_bf16 v[224:239], v[120:123], a[8:11], v[224:239]
  ds_read_b64_tr_b16 v[100:101], v5 offset:20480
  buffer_load_dwordx4 v18, s[12:15], s44 offen offset:1024 lds
  s_waitcnt lgkmcnt(5)
  v_mfma_f32_32x32x16_bf16 v[224:239], v[124:127], a[12:15], v[224:239]
  ds_read_b64_tr_b16 v[102:103], v5 offset:21504
  ds_read_b128 a[52:55], v2 offset:36864
  v_mfma_f32_32x32x16_bf16 v[240:255], v[112:115], a[16:19], v[240:255]
  ds_read_b64_tr_b16 v[104:105], v5 offset:24576
  buffer_load_dwordx4 v19, s[12:15], s44 offen offset:2048 lds
  v_mfma_f32_32x32x16_bf16 v[240:255], v[116:119], a[20:23], v[240:255]
  ds_read_b64_tr_b16 v[106:107], v5 offset:25600
  ds_read_b128 a[56:59], v3 offset:36864
  v_mfma_f32_32x32x16_bf16 v[240:255], v[120:123], a[24:27], v[240:255]
  ds_read_b64_tr_b16 v[108:109], v5 offset:28672
  buffer_load_dwordx4 v20, s[12:15], s44 offen offset:3072 lds
  v_mfma_f32_32x32x16_bf16 v[240:255], v[124:127], a[28:31], v[240:255]
  ds_read_b64_tr_b16 v[110:111], v5 offset:29696
  ds_read_b128 a[60:63], v4 offset:36864
  s_add_u32 s44, s44, 0x80000
  s_waitcnt lgkmcnt(10)
  v_mfma_f32_32x32x16_bf16 v[128:143], v[96:99], a[32:35], v[128:143]
  ds_read_b64_tr_b16 v[112:113], v6 offset:16384
  s_waitcnt lgkmcnt(8)
  v_mfma_f32_32x32x16_bf16 v[128:143], v[100:103], a[36:39], v[128:143]
  ds_read_b64_tr_b16 v[114:115], v6 offset:17408
  buffer_store_dwordx4 v[88:91], v21, s[16:19], s49 offen offset:3072 sc1
  s_waitcnt lgkmcnt(6)
  v_mfma_f32_32x32x16_bf16 v[128:143], v[104:107], a[40:43], v[128:143]
  ds_read_b64_tr_b16 v[116:117], v6 offset:20480
  s_waitcnt lgkmcnt(4)
  v_mfma_f32_32x32x16_bf16 v[128:143], v[108:111], a[44:47], v[128:143]
  ds_read_b64_tr_b16 v[118:119], v6 offset:21504
  v_mfma_f32_32x32x16_bf16 v[144:159], v[96:99], a[48:51], v[144:159]
  ds_read_b64_tr_b16 v[120:121], v6 offset:24576
  v_mfma_f32_32x32x16_bf16 v[144:159], v[100:103], a[52:55], v[144:159]
  ds_read_b64_tr_b16 v[122:123], v6 offset:25600
  v_mfma_f32_32x32x16_bf16 v[144:159], v[104:107], a[56:59], v[144:159]
  ds_read_b64_tr_b16 v[124:125], v6 offset:28672
  buffer_store_dwordx4 v[92:95], v21, s[16:19], s50 offen offset:3072 sc1
  s_waitcnt lgkmcnt(7)
  v_mfma_f32_32x32x16_bf16 v[144:159], v[108:111], a[60:63], v[144:159]
  ds_read_b64_tr_b16 v[126:127], v6 offset:29696
  s_waitcnt lgkmcnt(6)
  v_mfma_f32_32x32x16_bf16 v[160:175], v[112:115], a[32:35], v[160:175]
  ds_read_b64_tr_b16 v[96:97], v7 offset:16384
  s_mov_b32 s8, s20
  s_and_b32 s9, s21, 0xffff
  s_mov_b32 s10, 0x200000
  s_mov_b32 s11, 0x20000
  v_lshrrev_b32 v22, 3, v27
  v_lshlrev_b32 v22, 10, v22
  v_and_b32 v23, 7, v27
  v_lshrrev_b32 v24, 4, v27
  v_add_u32 v25, 0, v24
  s_waitcnt lgkmcnt(5)
  v_mfma_f32_32x32x16_bf16 v[160:175], v[116:119], a[36:39], v[160:175]
  ds_read_b64_tr_b16 v[98:99], v7 offset:17408
  v_xor_b32 v25, v25, v23
  v_lshl_add_u32 v25, v25, 4, v22
  v_add_u32 v9, 0, v25
  v_add_u32 v25, 4, v24
  v_xor_b32 v25, v25, v23
  v_lshl_add_u32 v25, v25, 4, v22
  v_add_u32 v10, 0x1c00, v25
  v_add_u32 v25, 0, v24
  v_xor_b32 v25, v25, v23
  s_waitcnt lgkmcnt(4)
  v_mfma_f32_32x32x16_bf16 v[160:175], v[120:123], a[40:43], v[160:175]
  ds_read_b64_tr_b16 v[100:101], v7 offset:20480
  v_lshl_add_u32 v25, v25, 4, v22
  v_add_u32 v11, 0x3800, v25
  v_add_u32 v25, 4, v24
  v_xor_b32 v25, v25, v23
  v_lshl_add_u32 v25, v25, 4, v22
  v_add_u32 v12, 0x5400, v25
  v_add_u32 v25, 0, v24
  v_xor_b32 v25, v25, v23
  v_lshl_add_u32 v25, v25, 4, v22
  s_waitcnt lgkmcnt(3)
  v_mfma_f32_32x32x16_bf16 v[160:175], v[124:127], a[44:47], v[160:175]
  ds_read_b64_tr_b16 v[102:103], v7 offset:21504
  v_add_u32 v13, 0x8000, v25
  v_add_u32 v25, 4, v24
  v_xor_b32 v25, v25, v23
  v_lshl_add_u32 v25, v25, 4, v22
  v_add_u32 v14, 0x9c00, v25
  v_add_u32 v25, 0, v24
  v_xor_b32 v25, v25, v23
  v_lshl_add_u32 v25, v25, 4, v22
  v_add_u32 v15, 0xb800, v25
  v_mfma_f32_32x32x16_bf16 v[176:191], v[112:115], a[48:51], v[176:191]
  ds_read_b64_tr_b16 v[104:105], v7 offset:24576
  v_add_u32 v25, 4, v24
  v_xor_b32 v25, v25, v23
  v_lshl_add_u32 v25, v25, 4, v22
  v_add_u32 v16, 0xd400, v25
  s_lshl_b32 s43, s40, 18
  s_lshl_b32 s52, s42, 16
  s_add_u32 s43, s43, s52
  v_mfma_f32_32x32x16_bf16 v[176:191], v[116:119], a[52:55], v[176:191]
  s_add_u32 m0, s45, 0x8000
  ds_read_b64_tr_b16 v[106:107], v7 offset:25600
  buffer_load_dwordx4 v9, s[8:11], s43 offen lds
  v_mfma_f32_32x32x16_bf16 v[176:191], v[120:123], a[56:59], v[176:191]
  ds_read_b64_tr_b16 v[108:109], v7 offset:28672
  buffer_load_dwordx4 v10, s[8:11], s43 offen offset:1024 lds
  v_mfma_f32_32x32x16_bf16 v[176:191], v[124:127], a[60:63], v[176:191]
  ds_read_b64_tr_b16 v[110:111], v7 offset:29696
  buffer_load_dwordx4 v11, s[8:11], s43 offen offset:2048 lds
  s_waitcnt lgkmcnt(6)
  v_mfma_f32_32x32x16_bf16 v[192:207], v[96:99], a[32:35], v[192:207]
  ds_read_b64_tr_b16 v[112:113], v8 offset:16384
  buffer_load_dwordx4 v12, s[8:11], s43 offen offset:3072 lds
  s_waitcnt lgkmcnt(5)
  v_mfma_f32_32x32x16_bf16 v[192:207], v[100:103], a[36:39], v[192:207]
  ds_read_b64_tr_b16 v[114:115], v8 offset:17408
  s_waitcnt vmcnt(25)
  s_add_u32 m0, s45, 0x9000
  ds_read_b128 a[0:3], v28
  buffer_load_dwordx4 v13, s[8:11], s43 offen lds
  s_waitcnt lgkmcnt(5)
  v_mfma_f32_32x32x16_bf16 v[192:207], v[104:107], a[40:43], v[192:207]
  ds_read_b64_tr_b16 v[116:117], v8 offset:20480
  buffer_load_dwordx4 v14, s[8:11], s43 offen offset:1024 lds
  s_waitcnt lgkmcnt(4)
  v_mfma_f32_32x32x16_bf16 v[192:207], v[108:111], a[44:47], v[192:207]
  ds_read_b64_tr_b16 v[118:119], v8 offset:21504
  ds_read_b128 a[4:7], v29
  buffer_load_dwordx4 v15, s[8:11], s43 offen offset:2048 lds
  v_mfma_f32_32x32x16_bf16 v[208:223], v[96:99], a[48:51], v[208:223]
  ds_read_b64_tr_b16 v[120:121], v8 offset:24576
  buffer_load_dwordx4 v16, s[8:11], s43 offen offset:3072 lds
  v_mfma_f32_32x32x16_bf16 v[208:223], v[100:103], a[52:55], v[208:223]
  ds_read_b64_tr_b16 v[122:123], v8 offset:25600
  ds_read_b128 a[8:11], v30
  s_add_u32 s43, s43, 128
  v_mfma_f32_32x32x16_bf16 v[208:223], v[104:107], a[56:59], v[208:223]
  ds_read_b64_tr_b16 v[124:125], v8 offset:28672
  v_mfma_f32_32x32x16_bf16 v[208:223], v[108:111], a[60:63], v[208:223]
  ds_read_b64_tr_b16 v[126:127], v8 offset:29696
  s_waitcnt vmcnt(25)
  s_barrier
  ds_read_b128 a[12:15], v31
  s_waitcnt lgkmcnt(10)
  v_mfma_f32_32x32x16_bf16 v[224:239], v[112:115], a[32:35], v[224:239]
  ds_read_b64_tr_b16 v[96:97], v5 offset:32768
  s_mov_b32 s12, s22
  s_and_b32 s13, s23, 0xffff
  s_mov_b32 s14, 0x180000
  s_mov_b32 s15, 0x20000
  s_lshl_b32 s44, s41, 7
  s_mul_i32 s54, s42, 49152
  s_add_u32 s44, s44, s54
  v_lshrrev_b32 v22, 3, v27
  v_bfe_u32 v23, v27, 4, 1
  s_waitcnt lgkmcnt(8)
  v_mfma_f32_32x32x16_bf16 v[224:239], v[116:119], a[36:39], v[224:239]
  ds_read_b64_tr_b16 v[98:99], v5 offset:33792
  ds_read_b128 a[16:19], v28 offset:4096
  v_lshlrev_b32 v23, 2, v23
  v_and_b32 v24, 7, v27
  v_xor_b32 v23, v23, v24
  v_mul_u32_u24 v22, 0xc00, v22
  v_lshl_add_u32 v22, v23, 4, v22
  v_add_u32 v17, 0, v22
  v_add_u32 v18, 0x5c00, v22
  s_lshr_b32 s55, s46, 1
  s_waitcnt lgkmcnt(7)
  v_mfma_f32_32x32x16_bf16 v[224:239], v[120:123], a[40:43], v[224:239]
  s_add_u32 m0, s55, 0x18000
  ds_read_b64_tr_b16 v[100:101], v5 offset:36864
  buffer_load_dwordx4 v17, s[12:15], s44 offen lds
  s_waitcnt lgkmcnt(5)
  v_mfma_f32_32x32x16_bf16 v[224:239], v[124:127], a[44:47], v[224:239]
  ds_read_b64_tr_b16 v[102:103], v5 offset:37888
  ds_read_b128 a[20:23], v29 offset:4096
  buffer_load_dwordx4 v18, s[12:15], s44 offen offset:1024 lds
  v_mfma_f32_32x32x16_bf16 v[240:255], v[112:115], a[48:51], v[240:255]
  ds_read_b64_tr_b16 v[104:105], v5 offset:40960
  s_add_u32 s44, s44, 0x30000
  v_mfma_f32_32x32x16_bf16 v[240:255], v[116:119], a[52:55], v[240:255]
  ds_read_b64_tr_b16 v[106:107], v5 offset:41984
  ds_read_b128 a[24:27], v30 offset:4096
  v_mfma_f32_32x32x16_bf16 v[240:255], v[120:123], a[56:59], v[240:255]
  ds_read_b64_tr_b16 v[108:109], v5 offset:45056
  v_mfma_f32_32x32x16_bf16 v[240:255], v[124:127], a[60:63], v[240:255]
  ds_read_b64_tr_b16 v[110:111], v5 offset:46080
  ds_read_b128 a[28:31], v31 offset:4096
  s_waitcnt lgkmcnt(10)
  v_mfma_f32_32x32x16_bf16 v[128:143], v[96:99], a[0:3], v[128:143]
  ds_read_b64_tr_b16 v[112:113], v6 offset:32768
  s_waitcnt lgkmcnt(8)
  v_mfma_f32_32x32x16_bf16 v[128:143], v[100:103], a[4:7], v[128:143]
  ds_read_b64_tr_b16 v[114:115], v6 offset:33792
  s_waitcnt lgkmcnt(6)
  v_mfma_f32_32x32x16_bf16 v[128:143], v[104:107], a[8:11], v[128:143]
  ds_read_b64_tr_b16 v[116:117], v6 offset:36864
  s_waitcnt lgkmcnt(4)
  v_mfma_f32_32x32x16_bf16 v[128:143], v[108:111], a[12:15], v[128:143]
  ds_read_b64_tr_b16 v[118:119], v6 offset:37888
  v_mfma_f32_32x32x16_bf16 v[144:159], v[96:99], a[16:19], v[144:159]
  ds_read_b64_tr_b16 v[120:121], v6 offset:40960
  v_mfma_f32_32x32x16_bf16 v[144:159], v[100:103], a[20:23], v[144:159]
  ds_read_b64_tr_b16 v[122:123], v6 offset:41984
  v_mfma_f32_32x32x16_bf16 v[144:159], v[104:107], a[24:27], v[144:159]
  ds_read_b64_tr_b16 v[124:125], v6 offset:45056
  s_waitcnt lgkmcnt(7)
  v_mfma_f32_32x32x16_bf16 v[144:159], v[108:111], a[28:31], v[144:159]
  ds_read_b64_tr_b16 v[126:127], v6 offset:46080
  s_waitcnt lgkmcnt(6)
  v_mfma_f32_32x32x16_bf16 v[160:175], v[112:115], a[0:3], v[160:175]
  s_add_u32 m0, s45, 0x10000
  ds_read_b64_tr_b16 v[96:97], v7 offset:32768
  buffer_load_dwordx4 v9, s[8:11], s43 offen lds
  s_waitcnt lgkmcnt(5)
  v_mfma_f32_32x32x16_bf16 v[160:175], v[116:119], a[4:7], v[160:175]
  ds_read_b64_tr_b16 v[98:99], v7 offset:33792
  s_waitcnt lgkmcnt(4)
  v_mfma_f32_32x32x16_bf16 v[160:175], v[120:123], a[8:11], v[160:175]
  ds_read_b64_tr_b16 v[100:101], v7 offset:36864
  buffer_load_dwordx4 v10, s[8:11], s43 offen offset:1024 lds
  s_waitcnt lgkmcnt(3)
  v_mfma_f32_32x32x16_bf16 v[160:175], v[124:127], a[12:15], v[160:175]
  ds_read_b64_tr_b16 v[102:103], v7 offset:37888
  v_mfma_f32_32x32x16_bf16 v[176:191], v[112:115], a[16:19], v[176:191]
  ds_read_b64_tr_b16 v[104:105], v7 offset:40960
  buffer_load_dwordx4 v11, s[8:11], s43 offen offset:2048 lds
  v_mfma_f32_32x32x16_bf16 v[176:191], v[116:119], a[20:23], v[176:191]
  ds_read_b64_tr_b16 v[106:107], v7 offset:41984
  v_mfma_f32_32x32x16_bf16 v[176:191], v[120:123], a[24:27], v[176:191]
  ds_read_b64_tr_b16 v[108:109], v7 offset:45056
  buffer_load_dwordx4 v12, s[8:11], s43 offen offset:3072 lds
  v_mfma_f32_32x32x16_bf16 v[176:191], v[124:127], a[28:31], v[176:191]
  ds_read_b64_tr_b16 v[110:111], v7 offset:46080
  s_waitcnt lgkmcnt(6)
  v_mfma_f32_32x32x16_bf16 v[192:207], v[96:99], a[0:3], v[192:207]
  s_add_u32 m0, s45, 0x11000
  ds_read_b64_tr_b16 v[112:113], v8 offset:32768
  buffer_load_dwordx4 v13, s[8:11], s43 offen lds
  s_waitcnt lgkmcnt(5)
  v_mfma_f32_32x32x16_bf16 v[192:207], v[100:103], a[4:7], v[192:207]
  ds_read_b64_tr_b16 v[114:115], v8 offset:33792
  s_waitcnt vmcnt(21)
  ds_read_b128 a[32:35], v1
  s_waitcnt lgkmcnt(5)
  v_mfma_f32_32x32x16_bf16 v[192:207], v[104:107], a[8:11], v[192:207]
  ds_read_b64_tr_b16 v[116:117], v8 offset:36864
  buffer_load_dwordx4 v14, s[8:11], s43 offen offset:1024 lds
  s_waitcnt lgkmcnt(4)
  v_mfma_f32_32x32x16_bf16 v[192:207], v[108:111], a[12:15], v[192:207]
  ds_read_b64_tr_b16 v[118:119], v8 offset:37888
  ds_read_b128 a[36:39], v2
  v_mfma_f32_32x32x16_bf16 v[208:223], v[96:99], a[16:19], v[208:223]
  ds_read_b64_tr_b16 v[120:121], v8 offset:40960
  buffer_load_dwordx4 v15, s[8:11], s43 offen offset:2048 lds
  v_mfma_f32_32x32x16_bf16 v[208:223], v[100:103], a[20:23], v[208:223]
  ds_read_b64_tr_b16 v[122:123], v8 offset:41984
  ds_read_b128 a[40:43], v3
  v_mfma_f32_32x32x16_bf16 v[208:223], v[104:107], a[24:27], v[208:223]
  ds_read_b64_tr_b16 v[124:125], v8 offset:45056
  buffer_load_dwordx4 v16, s[8:11], s43 offen offset:3072 lds
  s_add_u32 s43, s43, 128
  v_mfma_f32_32x32x16_bf16 v[208:223], v[108:111], a[28:31], v[208:223]
  ds_read_b64_tr_b16 v[126:127], v8 offset:46080
  s_waitcnt vmcnt(20)
  s_barrier
  ds_read_b128 a[44:47], v4
  s_waitcnt lgkmcnt(10)
  v_mfma_f32_32x32x16_bf16 v[224:239], v[112:115], a[0:3], v[224:239]
  ds_read_b64_tr_b16 v[96:97], v5 offset:49152
  s_lshr_b32 s55, s46, 1
  s_add_u32 m0, s55, 0x1c000
  s_nop 0
  buffer_load_dwordx4 v17, s[12:15], s44 offen lds
  s_waitcnt lgkmcnt(8)
  v_mfma_f32_32x32x16_bf16 v[224:239], v[116:119], a[4:7], v[224:239]
  ds_read_b64_tr_b16 v[98:99], v5 offset:50176
  ds_read_b128 a[48:51], v1 offset:4096
  s_waitcnt lgkmcnt(7)
  v_mfma_f32_32x32x16_bf16 v[224:239], v[120:123], a[8:11], v[224:239]
  ds_read_b64_tr_b16 v[100:101], v5 offset:53248
  buffer_load_dwordx4 v18, s[12:15], s44 offen offset:1024 lds
  s_waitcnt lgkmcnt(5)
  v_mfma_f32_32x32x16_bf16 v[224:239], v[124:127], a[12:15], v[224:239]
  ds_read_b64_tr_b16 v[102:103], v5 offset:54272
  ds_read_b128 a[52:55], v2 offset:4096
  v_mfma_f32_32x32x16_bf16 v[240:255], v[112:115], a[16:19], v[240:255]
  ds_read_b64_tr_b16 v[104:105], v5 offset:57344
  s_add_u32 s44, s44, 0x30000
  v_mfma_f32_32x32x16_bf16 v[240:255], v[116:119], a[20:23], v[240:255]
  ds_read_b64_tr_b16 v[106:107], v5 offset:58368
  ds_read_b128 a[56:59], v3 offset:4096
  v_mfma_f32_32x32x16_bf16 v[240:255], v[120:123], a[24:27], v[240:255]
  ds_read_b64_tr_b16 v[108:109], v5 offset:61440
  v_mfma_f32_32x32x16_bf16 v[240:255], v[124:127], a[28:31], v[240:255]
  ds_read_b64_tr_b16 v[110:111], v5 offset:62464
  ds_read_b128 a[60:63], v4 offset:4096
  s_waitcnt lgkmcnt(10)
  v_mfma_f32_32x32x16_bf16 v[128:143], v[96:99], a[32:35], v[128:143]
  ds_read_b64_tr_b16 v[112:113], v6 offset:49152
  s_waitcnt lgkmcnt(8)
  v_mfma_f32_32x32x16_bf16 v[128:143], v[100:103], a[36:39], v[128:143]
  ds_read_b64_tr_b16 v[114:115], v6 offset:50176
  s_waitcnt lgkmcnt(6)
  v_mfma_f32_32x32x16_bf16 v[128:143], v[104:107], a[40:43], v[128:143]
  ds_read_b64_tr_b16 v[116:117], v6 offset:53248
  s_waitcnt lgkmcnt(4)
  v_mfma_f32_32x32x16_bf16 v[128:143], v[108:111], a[44:47], v[128:143]
  ds_read_b64_tr_b16 v[118:119], v6 offset:54272
  v_mfma_f32_32x32x16_bf16 v[144:159], v[96:99], a[48:51], v[144:159]
  ds_read_b64_tr_b16 v[120:121], v6 offset:57344
  v_mfma_f32_32x32x16_bf16 v[144:159], v[100:103], a[52:55], v[144:159]
  ds_read_b64_tr_b16 v[122:123], v6 offset:58368
  v_mfma_f32_32x32x16_bf16 v[144:159], v[104:107], a[56:59], v[144:159]
  ds_read_b64_tr_b16 v[124:125], v6 offset:61440
  s_waitcnt lgkmcnt(7)
  v_mfma_f32_32x32x16_bf16 v[144:159], v[108:111], a[60:63], v[144:159]
  ds_read_b64_tr_b16 v[126:127], v6 offset:62464
  s_nop 2
  v_cvt_pk_bf16_f32 v32, v128, v129
  v_cvt_pk_bf16_f32 v33, v130, v131
  s_waitcnt lgkmcnt(6)
  v_mfma_f32_32x32x16_bf16 v[160:175], v[112:115], a[32:35], v[160:175]
  s_add_u32 m0, s45, 0
  ds_read_b64_tr_b16 v[96:97], v7 offset:49152
  buffer_load_dwordx4 v9, s[8:11], s43 offen lds
  v_cvt_pk_bf16_f32 v34, v132, v133
  v_cvt_pk_bf16_f32 v35, v134, v135
  s_waitcnt lgkmcnt(5)
  v_mfma_f32_32x32x16_bf16 v[160:175], v[116:119], a[36:39], v[160:175]
  ds_read_b64_tr_b16 v[98:99], v7 offset:50176
  v_and_b32 v22, 15, v27
  v_lshrrev_b32 v23, 2, v22
  v_lshrrev_b32 v24, 5, v27
  v_cvt_pk_bf16_f32 v36, v136, v137
  v_cvt_pk_bf16_f32 v37, v138, v139
  s_waitcnt lgkmcnt(4)
  v_mfma_f32_32x32x16_bf16 v[160:175], v[120:123], a[40:43], v[160:175]
  ds_read_b64_tr_b16 v[100:101], v7 offset:53248
  buffer_load_dwordx4 v10, s[8:11], s43 offen offset:1024 lds
  v_lshl_add_u32 v24, v24, 3, v23
  v_lshlrev_b32 v24, 7, v24
  v_bfe_u32 v25, v27, 4, 1
  v_cvt_pk_bf16_f32 v38, v140, v141
  v_cvt_pk_bf16_f32 v39, v142, v143
  s_waitcnt lgkmcnt(3)
  v_mfma_f32_32x32x16_bf16 v[160:175], v[124:127], a[44:47], v[160:175]
  ds_read_b64_tr_b16 v[102:103], v7 offset:54272
  v_lshl_add_u32 v24, v25, 5, v24
  v_and_b32 v25, 3, v22
  v_lshl_add_u32 v24, v25, 3, v24
  v_cvt_pk_bf16_f32 v64, v144, v145
  v_cvt_pk_bf16_f32 v65, v146, v147
  v_mfma_f32_32x32x16_bf16 v[176:191], v[112:115], a[48:51], v[176:191]
  ds_read_b64_tr_b16 v[104:105], v7 offset:57344
  buffer_load_dwordx4 v11, s[8:11], s43 offen offset:2048 lds
  v_add_u32 v24, 0x18000, v24
  v_lshrrev_b32 v23, 1, v23
  v_xor_b32 v25, 0, v23
  v_cvt_pk_bf16_f32 v66, v148, v149
  v_cvt_pk_bf16_f32 v67, v150, v151
  v_mfma_f32_32x32x16_bf16 v[176:191], v[116:119], a[52:55], v[176:191]
  ds_read_b64_tr_b16 v[106:107], v7 offset:58368
  v_lshl_add_u32 v5, v25, 6, v24
  v_xor_b32 v25, 1, v23
  v_lshl_add_u32 v26, v25, 6, v24
  v_cvt_pk_bf16_f32 v68, v152, v153
  v_cvt_pk_bf16_f32 v69, v154, v155
  v_mfma_f32_32x32x16_bf16 v[176:191], v[120:123], a[56:59], v[176:191]
  ds_read_b64_tr_b16 v[108:109], v7 offset:61440
  buffer_load_dwordx4 v12, s[8:11], s43 offen offset:3072 lds
  v_cvt_pk_bf16_f32 v70, v156, v157
  v_cvt_pk_bf16_f32 v71, v158, v159
  v_mfma_f32_32x32x16_bf16 v[176:191], v[124:127], a[60:63], v[176:191]
  ds_read_b64_tr_b16 v[110:111], v7 offset:62464
  v_cvt_pk_bf16_f32 v40, v160, v161
  v_cvt_pk_bf16_f32 v41, v162, v163
  s_waitcnt lgkmcnt(6)
  v_mfma_f32_32x32x16_bf16 v[192:207], v[96:99], a[32:35], v[192:207]
  s_add_u32 m0, s45, 0x1000
  ds_read_b64_tr_b16 v[112:113], v8 offset:49152
  buffer_load_dwordx4 v13, s[8:11], s43 offen lds
  v_cvt_pk_bf16_f32 v42, v164, v165
  v_cvt_pk_bf16_f32 v43, v166, v167
  s_waitcnt lgkmcnt(5)
  v_mfma_f32_32x32x16_bf16 v[192:207], v[100:103], a[36:39], v[192:207]
  ds_read_b64_tr_b16 v[114:115], v8 offset:50176
  s_waitcnt vmcnt(17)
  ds_read_b128 a[0:3], v1 offset:32768
  v_cvt_pk_bf16_f32 v44, v168, v169
  v_cvt_pk_bf16_f32 v45, v170, v171
  s_waitcnt lgkmcnt(5)
  v_mfma_f32_32x32x16_bf16 v[192:207], v[104:107], a[40:43], v[192:207]
  ds_read_b64_tr_b16 v[116:117], v8 offset:53248
  buffer_load_dwordx4 v14, s[8:11], s43 offen offset:1024 lds
  v_cvt_pk_bf16_f32 v46, v172, v173
  v_cvt_pk_bf16_f32 v47, v174, v175
  s_waitcnt lgkmcnt(4)
  v_mfma_f32_32x32x16_bf16 v[192:207], v[108:111], a[44:47], v[192:207]
  ds_read_b64_tr_b16 v[118:119], v8 offset:54272
  ds_read_b128 a[4:7], v2 offset:32768
  v_cvt_pk_bf16_f32 v72, v176, v177
  v_cvt_pk_bf16_f32 v73, v178, v179
  v_mfma_f32_32x32x16_bf16 v[208:223], v[96:99], a[48:51], v[208:223]
  ds_read_b64_tr_b16 v[120:121], v8 offset:57344
  buffer_load_dwordx4 v15, s[8:11], s43 offen offset:2048 lds
  v_cvt_pk_bf16_f32 v74, v180, v181
  v_cvt_pk_bf16_f32 v75, v182, v183
  v_mfma_f32_32x32x16_bf16 v[208:223], v[100:103], a[52:55], v[208:223]
  ds_read_b64_tr_b16 v[122:123], v8 offset:58368
  ds_read_b128 a[8:11], v3 offset:32768
  v_cvt_pk_bf16_f32 v76, v184, v185
  v_cvt_pk_bf16_f32 v77, v186, v187
  v_mfma_f32_32x32x16_bf16 v[208:223], v[104:107], a[56:59], v[208:223]
  ds_read_b64_tr_b16 v[124:125], v8 offset:61440
  buffer_load_dwordx4 v16, s[8:11], s43 offen offset:3072 lds
  s_add_u32 s43, s43, 128
  v_mov_b32 v6, v26
  v_cvt_pk_bf16_f32 v78, v188, v189
  v_cvt_pk_bf16_f32 v79, v190, v191
  v_mfma_f32_32x32x16_bf16 v[208:223], v[108:111], a[60:63], v[208:223]
  ds_read_b64_tr_b16 v[126:127], v8 offset:62464
  s_waitcnt vmcnt(18)
  s_barrier
  ds_read_b128 a[12:15], v4 offset:32768
  s_cmp_lg_u32 s42, 0
  s_cbranch_scc1 L_sig
  s_lshl_b32 s52, s41, 7
  s_lshl_b32 s53, s40, 2
  s_add_u32 s52, s52, s53
  s_add_u32 s52, s52, 0x4d00000
  v_mov_b32 v22, 0
  v_mov_b32 v23, s59
  s_mov_b64 exec, 1
  s_nop 1
  buffer_store_dword v23, v22, s[16:19], s52 offen sc1
  s_mov_b64 exec, -1
  s_nop 3
L_sig:
  v_cvt_pk_bf16_f32 v48, v192, v193
  v_cvt_pk_bf16_f32 v49, v194, v195
  s_waitcnt lgkmcnt(10)
  v_mfma_f32_32x32x16_bf16 v[224:239], v[112:115], a[32:35], v[224:239]
  ds_read_b64_tr_b16 v[96:97], v5
  s_lshr_b32 s55, s46, 1
  s_add_u32 m0, s55, 0x20000
  s_nop 0
  buffer_load_dwordx4 v17, s[12:15], s44 offen lds
  v_cvt_pk_bf16_f32 v50, v196, v197
  v_cvt_pk_bf16_f32 v51, v198, v199
  s_waitcnt lgkmcnt(8)
  v_mfma_f32_32x32x16_bf16 v[224:239], v[116:119], a[36:39], v[224:239]
  ds_read_b64_tr_b16 v[98:99], v5 offset:512
  ds_read_b128 a[16:19], v1 offset:36864
  v_cvt_pk_bf16_f32 v52, v200, v201
  v_cvt_pk_bf16_f32 v53, v202, v203
  s_waitcnt lgkmcnt(7)
  v_mfma_f32_32x32x16_bf16 v[224:239], v[120:123], a[40:43], v[224:239]
  ds_read_b64_tr_b16 v[100:101], v5 offset:2048
  buffer_load_dwordx4 v18, s[12:15], s44 offen offset:1024 lds
  v_cvt_pk_bf16_f32 v54, v204, v205
  v_cvt_pk_bf16_f32 v55, v206, v207
  s_waitcnt lgkmcnt(5)
  v_mfma_f32_32x32x16_bf16 v[224:239], v[124:127], a[44:47], v[224:239]
  ds_read_b64_tr_b16 v[102:103], v5 offset:2560
  ds_read_b128 a[20:23], v2 offset:36864
  v_cvt_pk_bf16_f32 v80, v208, v209
  v_cvt_pk_bf16_f32 v81, v210, v211
  v_mfma_f32_32x32x16_bf16 v[240:255], v[112:115], a[48:51], v[240:255]
  ds_read_b64_tr_b16 v[104:105], v5 offset:4096
  s_add_u32 s44, s44, 0x30000
  v_cvt_pk_bf16_f32 v82, v212, v213
  v_cvt_pk_bf16_f32 v83, v214, v215
  v_mfma_f32_32x32x16_bf16 v[240:255], v[116:119], a[52:55], v[240:255]
  ds_read_b64_tr_b16 v[106:107], v5 offset:4608
  ds_read_b128 a[24:27], v3 offset:36864
  v_cvt_pk_bf16_f32 v84, v216, v217
  v_cvt_pk_bf16_f32 v85, v218, v219
  v_mfma_f32_32x32x16_bf16 v[240:255], v[120:123], a[56:59], v[240:255]
  ds_read_b64_tr_b16 v[108:109], v5 offset:6144
  v_cvt_pk_bf16_f32 v86, v220, v221
  v_cvt_pk_bf16_f32 v87, v222, v223
  v_mfma_f32_32x32x16_bf16 v[240:255], v[124:127], a[60:63], v[240:255]
  ds_read_b64_tr_b16 v[110:111], v5 offset:6656
  ds_read_b128 a[28:31], v4 offset:36864
  v_cvt_pk_bf16_f32 v56, v224, v225
  v_cvt_pk_bf16_f32 v57, v226, v227
  s_cmp_ge_u32 s41, 24
  s_cbranch_scc1 L_proj_TR
  s_cmp_ge_u32 s41, 16
  s_cbranch_scc1 L_proj_AV
  s_cmp_ge_u32 s41, 8
  s_cbranch_scc1 L_proj_AK
L_proj_AQ:
  s_waitcnt lgkmcnt(10)
  v_mfma_f32_32x32x16_bf16 v[128:143], v[96:99], a[0:3], 0
  ds_read_b64_tr_b16 v[112:113], v6
  s_lshl_b32 s99, s42, 14
  v_cvt_pk_bf16_f32 v58, v228, v229
  v_cvt_pk_bf16_f32 v59, v230, v231
  s_waitcnt lgkmcnt(8)
  v_mfma_f32_32x32x16_bf16 v[128:143], v[100:103], a[4:7], v[128:143]
  ds_read_b64_tr_b16 v[114:115], v6 offset:512
  s_add_u32 s99, s99, 0x1a000
  v_cvt_pk_bf16_f32 v60, v232, v233
  v_cvt_pk_bf16_f32 v61, v234, v235
  s_waitcnt lgkmcnt(6)
  v_mfma_f32_32x32x16_bf16 v[128:143], v[104:107], a[8:11], v[128:143]
  ds_read_b64_tr_b16 v[116:117], v6 offset:2048
  s_lshl_b32 s98, s42, 13
  v_cvt_pk_bf16_f32 v62, v236, v237
  v_cvt_pk_bf16_f32 v63, v238, v239
  s_waitcnt lgkmcnt(4)
  v_mfma_f32_32x32x16_bf16 v[128:143], v[108:111], a[12:15], v[128:143]
  ds_read_b64_tr_b16 v[118:119], v6 offset:2560
  s_add_u32 s98, s98, 40960
  v_cvt_pk_bf16_f32 v88, v240, v241
  v_cvt_pk_bf16_f32 v89, v242, v243
  v_mfma_f32_32x32x16_bf16 v[144:159], v[96:99], a[16:19], 0
  ds_read_b64_tr_b16 v[120:121], v6 offset:4096
  v_cvt_pk_bf16_f32 v90, v244, v245
  v_cvt_pk_bf16_f32 v91, v246, v247
  v_mfma_f32_32x32x16_bf16 v[144:159], v[100:103], a[20:23], v[144:159]
  ds_read_b64_tr_b16 v[122:123], v6 offset:4608
  v_cvt_pk_bf16_f32 v92, v248, v249
  v_cvt_pk_bf16_f32 v93, v250, v251
  v_mfma_f32_32x32x16_bf16 v[144:159], v[104:107], a[24:27], v[144:159]
  ds_read_b64_tr_b16 v[124:125], v6 offset:6144
  s_waitcnt vmcnt(12)
  ds_read_b128 a[32:35], v28
  v_cvt_pk_bf16_f32 v94, v252, v253
  v_cvt_pk_bf16_f32 v95, v254, v255
  s_waitcnt lgkmcnt(8)
  v_mfma_f32_32x32x16_bf16 v[144:159], v[108:111], a[28:31], v[144:159]
  ds_read_b64_tr_b16 v[126:127], v6 offset:6656
  s_waitcnt vmcnt(10)
  s_barrier
  ds_read_b128 a[36:39], v29
  s_waitcnt lgkmcnt(8)
  v_mfma_f32_32x32x16_bf16 v[160:175], v[112:115], a[0:3], 0
  ds_read_b64_tr_b16 v[96:97], v5 offset:16384
  ds_read_b128 a[40:43], v30
  s_lshr_b32 s55, s46, 1
  s_add_u32 m0, s55, 0x24000
  s_waitcnt lgkmcnt(8)
  v_mfma_f32_32x32x16_bf16 v[160:175], v[116:119], a[4:7], v[160:175]
  ds_read_b64_tr_b16 v[98:99], v5 offset:16896
  ds_read_b128 a[44:47], v31
  buffer_load_dwordx4 v17, s[12:15], s44 offen lds
  buffer_load_dwordx4 v18, s[12:15], s44 offen offset:1024 lds
  s_waitcnt lgkmcnt(8)
  v_mfma_f32_32x32x16_bf16 v[160:175], v[120:123], a[8:11], v[160:175]
  ds_read_b64_tr_b16 v[100:101], v5 offset:18432
  ds_read_b128 a[48:51], v28 offset:4096
  s_add_u32 s44, s44, 0x30000
  s_add_u32 m0, s99, 0
  s_waitcnt lgkmcnt(7)
  v_mfma_f32_32x32x16_bf16 v[160:175], v[124:127], a[12:15], v[160:175]
  ds_read_b64_tr_b16 v[102:103], v5 offset:18944
  ds_read_b128 a[52:55], v29 offset:4096
  buffer_load_dwordx4 v9, s[8:11], s43 offen lds
  buffer_load_dwordx4 v10, s[8:11], s43 offen offset:1024 lds
  v_mfma_f32_32x32x16_bf16 v[176:191], v[112:115], a[16:19], 0
  ds_read_b64_tr_b16 v[104:105], v5 offset:20480
  ds_read_b128 a[56:59], v30 offset:4096
  buffer_load_dwordx4 v11, s[8:11], s43 offen offset:2048 lds
  buffer_load_dwordx4 v12, s[8:11], s43 offen offset:3072 lds
  v_mfma_f32_32x32x16_bf16 v[176:191], v[116:119], a[20:23], v[176:191]
  ds_read_b64_tr_b16 v[106:107], v5 offset:20992
  s_add_u32 m0, s99, 4096
  ds_read_b128 a[60:63], v31 offset:4096
  buffer_load_dwordx4 v13, s[8:11], s43 offen lds
  v_mfma_f32_32x32x16_bf16 v[176:191], v[120:123], a[24:27], v[176:191]
  ds_read_b64_tr_b16 v[108:109], v5 offset:22528
  buffer_load_dwordx4 v14, s[8:11], s43 offen offset:1024 lds
  buffer_load_dwordx4 v15, s[8:11], s43 offen offset:2048 lds
  v_mfma_f32_32x32x16_bf16 v[176:191], v[124:127], a[28:31], v[176:191]
  ds_read_b64_tr_b16 v[110:111], v5 offset:23040
  buffer_load_dwordx4 v16, s[8:11], s43 offen offset:3072 lds
  s_add_u32 s43, s43, 128
  s_waitcnt lgkmcnt(11)
  v_mfma_f32_32x32x16_bf16 v[128:143], v[96:99], a[32:35], v[128:143]
  s_add_u32 m0, s45, 0x8000
  ds_read_b64_tr_b16 v[112:113], v6 offset:16384
  buffer_load_dwordx4 v9, s[8:11], s43 offen lds
  v_add_u32 v28, s98, v28
  s_lshl_b32 s76, s40, 2
  s_sub_u32 s85, 64, s76
  s_mul_i32 s76, s41, 0x80000
  s_waitcnt lgkmcnt(8)
  v_mfma_f32_32x32x16_bf16 v[128:143], v[100:103], a[36:39], v[128:143]
  ds_read_b64_tr_b16 v[114:115], v6 offset:16896
  v_add_u32 v29, s98, v29
  s_add_u32 s76, s76, 0x1000000
  s_add_u32 s60, s38, s76
  s_addc_u32 s61, s39, 0
  s_waitcnt lgkmcnt(5)
  v_mfma_f32_32x32x16_bf16 v[128:143], v[104:107], a[40:43], v[128:143]
  ds_read_b64_tr_b16 v[116:117], v6 offset:18432
  buffer_load_dwordx4 v10, s[8:11], s43 offen offset:1024 lds
  v_add_u32 v30, s98, v30
  s_and_b32 s61, s61, 0xffff
  s_lshl_b32 s62, s85, 13
  s_mov_b32 s63, 0x20000
  s_waitcnt lgkmcnt(3)
  v_mfma_f32_32x32x16_bf16 v[128:143], v[108:111], a[44:47], v[128:143]
  ds_read_b64_tr_b16 v[118:119], v6 offset:18944
  v_add_u32 v31, s98, v31
  s_mul_i32 s76, s41, 0x80000
  s_add_u32 s76, s76, 0x2000000
  s_add_u32 s64, s38, s76
  v_mfma_f32_32x32x16_bf16 v[144:159], v[96:99], a[48:51], v[144:159]
  ds_read_b64_tr_b16 v[120:121], v6 offset:20480
  buffer_load_dwordx4 v11, s[8:11], s43 offen offset:2048 lds
  s_addc_u32 s65, s39, 0
  s_and_b32 s65, s65, 0xffff
  s_lshl_b32 s66, s85, 13
  v_mfma_f32_32x32x16_bf16 v[144:159], v[100:103], a[52:55], v[144:159]
  ds_read_b64_tr_b16 v[122:123], v6 offset:20992
  s_mov_b32 s67, 0x20000
  s_mov_b32 s82, 0
  s_lshl_b32 s76, s42, 12
  v_mfma_f32_32x32x16_bf16 v[144:159], v[104:107], a[56:59], v[144:159]
  ds_read_b64_tr_b16 v[124:125], v6 offset:22528
  s_waitcnt vmcnt(15)
  ds_read_b128 a[0:3], v1
  buffer_load_dwordx4 v12, s[8:11], s43 offen offset:3072 lds
  s_add_u32 s68, s76, 0x8000
  s_add_u32 s69, s76, 0
  s_add_u32 s70, s76, 0x10000
  v_mfma_f32_32x32x16_bf16 v[144:159], v[108:111], a[60:63], v[144:159]
  ds_read_b64_tr_b16 v[126:127], v6 offset:23040
  s_waitcnt vmcnt(14)
  s_barrier
  ds_read_b128 a[4:7], v2
  s_add_u32 s71, s70, 0x8000
  s_mov_b32 s72, 0
  s_mov_b32 s73, 0
  s_waitcnt lgkmcnt(8)
  v_mfma_f32_32x32x16_bf16 v[160:175], v[112:115], a[32:35], v[160:175]
  ds_read_b64_tr_b16 v[96:97], v5 offset:32768
  ds_read_b128 a[8:11], v3
  s_lshr_b32 s55, s46, 1
  s_add_u32 m0, s55, 0x18000
  s_waitcnt lgkmcnt(8)
  v_mfma_f32_32x32x16_bf16 v[160:175], v[116:119], a[36:39], v[160:175]
  ds_read_b64_tr_b16 v[98:99], v5 offset:33280
  ds_read_b128 a[12:15], v4
  buffer_load_dwordx4 v17, s[12:15], s44 offen lds
  buffer_load_dwordx4 v18, s[12:15], s44 offen offset:1024 lds
  s_waitcnt lgkmcnt(8)
  v_mfma_f32_32x32x16_bf16 v[160:175], v[120:123], a[40:43], v[160:175]
  ds_read_b64_tr_b16 v[100:101], v5 offset:34816
  ds_read_b128 a[16:19], v1 offset:4096
  s_add_u32 s44, s44, 0x30000
  s_add_u32 m0, s45, 0x9000
  s_waitcnt lgkmcnt(7)
  v_mfma_f32_32x32x16_bf16 v[160:175], v[124:127], a[44:47], v[160:175]
  ds_read_b64_tr_b16 v[102:103], v5 offset:35328
  ds_read_b128 a[20:23], v2 offset:4096
  buffer_load_dwordx4 v13, s[8:11], s43 offen lds
  buffer_load_dwordx4 v14, s[8:11], s43 offen offset:1024 lds
  v_mfma_f32_32x32x16_bf16 v[176:191], v[112:115], a[48:51], v[176:191]
  ds_read_b64_tr_b16 v[104:105], v5 offset:36864
  ds_read_b128 a[24:27], v3 offset:4096
  buffer_load_dwordx4 v15, s[8:11], s43 offen offset:2048 lds
  buffer_load_dwordx4 v16, s[8:11], s43 offen offset:3072 lds
  v_mfma_f32_32x32x16_bf16 v[176:191], v[116:119], a[52:55], v[176:191]
  ds_read_b64_tr_b16 v[106:107], v5 offset:37376
  ds_read_b128 a[28:31], v4 offset:4096
  s_add_u32 s43, s43, 128
  v_mfma_f32_32x32x16_bf16 v[176:191], v[120:123], a[56:59], v[176:191]
  ds_read_b64_tr_b16 v[108:109], v5 offset:38912
  v_mfma_f32_32x32x16_bf16 v[176:191], v[124:127], a[60:63], v[176:191]
  ds_read_b64_tr_b16 v[110:111], v5 offset:39424
  s_waitcnt lgkmcnt(11)
  v_mfma_f32_32x32x16_bf16 v[128:143], v[96:99], a[0:3], v[128:143]
  s_add_u32 m0, s45, 0x10000
  ds_read_b64_tr_b16 v[112:113], v6 offset:32768
  buffer_load_dwordx4 v9, s[8:11], s43 offen lds
  s_waitcnt lgkmcnt(8)
  v_mfma_f32_32x32x16_bf16 v[128:143], v[100:103], a[4:7], v[128:143]
  ds_read_b64_tr_b16 v[114:115], v6 offset:33280
  s_waitcnt lgkmcnt(5)
  v_mfma_f32_32x32x16_bf16 v[128:143], v[104:107], a[8:11], v[128:143]
  ds_read_b64_tr_b16 v[116:117], v6 offset:34816
  buffer_load_dwordx4 v10, s[8:11], s43 offen offset:1024 lds
  s_waitcnt lgkmcnt(3)
  v_mfma_f32_32x32x16_bf16 v[128:143], v[108:111], a[12:15], v[128:143]
  ds_read_b64_tr_b16 v[118:119], v6 offset:35328
  v_mfma_f32_32x32x16_bf16 v[144:159], v[96:99], a[16:19], v[144:159]
  ds_read_b64_tr_b16 v[120:121], v6 offset:36864
  buffer_load_dwordx4 v11, s[8:11], s43 offen offset:2048 lds
  v_mfma_f32_32x32x16_bf16 v[144:159], v[100:103], a[20:23], v[144:159]
  ds_read_b64_tr_b16 v[122:123], v6 offset:37376
  v_mfma_f32_32x32x16_bf16 v[144:159], v[104:107], a[24:27], v[144:159]
  ds_read_b64_tr_b16 v[124:125], v6 offset:38912
  s_waitcnt vmcnt(13)
  ds_read_b128 a[32:35], v28
  buffer_load_dwordx4 v12, s[8:11], s43 offen offset:3072 lds
  v_mfma_f32_32x32x16_bf16 v[144:159], v[108:111], a[28:31], v[144:159]
  ds_read_b64_tr_b16 v[126:127], v6 offset:39424
  s_waitcnt vmcnt(22)
  s_barrier
  ds_read_b128 a[36:39], v29
  s_waitcnt lgkmcnt(8)
  v_mfma_f32_32x32x16_bf16 v[160:175], v[112:115], a[0:3], v[160:175]
  ds_read_b64_tr_b16 v[96:97], v5 offset:49152
  ds_read_b128 a[40:43], v30
  s_lshr_b32 s55, s46, 1
  s_add_u32 m0, s55, 0x1c000
  s_lshl_b32 s75, s41, 7
  s_add_u32 s75, s75, 0x4d00000
  s_waitcnt lgkmcnt(8)
  v_mfma_f32_32x32x16_bf16 v[160:175], v[116:119], a[4:7], v[160:175]
  ds_read_b64_tr_b16 v[98:99], v5 offset:49664
  ds_read_b128 a[44:47], v31
  buffer_load_dwordx4 v17, s[12:15], s44 offen lds
  buffer_load_dwordx4 v18, s[12:15], s44 offen offset:1024 lds
  v_lshlrev_b32 v25, 2, v27
  buffer_load_dword v24, v25, s[16:19], s75 offen sc1
  s_waitcnt lgkmcnt(8)
  v_mfma_f32_32x32x16_bf16 v[160:175], v[120:123], a[8:11], v[160:175]
  ds_read_b64_tr_b16 v[100:101], v5 offset:51200
  ds_read_b128 a[48:51], v28 offset:4096
  s_add_u32 s44, s44, 0x30000
  s_add_u32 m0, s45, 0x11000
  s_waitcnt lgkmcnt(7)
  v_mfma_f32_32x32x16_bf16 v[160:175], v[124:127], a[12:15], v[160:175]
  ds_read_b64_tr_b16 v[102:103], v5 offset:51712
  ds_read_b128 a[52:55], v29 offset:4096
  buffer_load_dwordx4 v13, s[8:11], s43 offen lds
  buffer_load_dwordx4 v14, s[8:11], s43 offen offset:1024 lds
  v_mfma_f32_32x32x16_bf16 v[176:191], v[112:115], a[16:19], v[176:191]
  ds_read_b64_tr_b16 v[104:105], v5 offset:53248
  ds_read_b128 a[56:59], v30 offset:4096
  buffer_load_dwordx4 v15, s[8:11], s43 offen offset:2048 lds
  buffer_load_dwordx4 v16, s[8:11], s43 offen offset:3072 lds
  v_mfma_f32_32x32x16_bf16 v[176:191], v[116:119], a[20:23], v[176:191]
  ds_read_b64_tr_b16 v[106:107], v5 offset:53760
  ds_read_b128 a[60:63], v31 offset:4096
  s_add_u32 s43, s43, 128
  v_mfma_f32_32x32x16_bf16 v[176:191], v[120:123], a[24:27], v[176:191]
  ds_read_b64_tr_b16 v[108:109], v5 offset:55296
  v_mfma_f32_32x32x16_bf16 v[176:191], v[124:127], a[28:31], v[176:191]
  ds_read_b64_tr_b16 v[110:111], v5 offset:55808
  s_waitcnt lgkmcnt(11)
  v_mfma_f32_32x32x16_bf16 v[128:143], v[96:99], a[32:35], v[128:143]
  s_add_u32 m0, s45, 0
  ds_read_b64_tr_b16 v[112:113], v6 offset:49152
  buffer_load_dwordx4 v9, s[8:11], s43 offen lds
  v_subrev_u32 v28, s98, v28
  s_waitcnt lgkmcnt(8)
  v_mfma_f32_32x32x16_bf16 v[128:143], v[100:103], a[36:39], v[128:143]
  ds_read_b64_tr_b16 v[114:115], v6 offset:49664
  v_subrev_u32 v29, s98, v29
  s_waitcnt lgkmcnt(5)
  v_mfma_f32_32x32x16_bf16 v[128:143], v[104:107], a[40:43], v[128:143]
  ds_read_b64_tr_b16 v[116:117], v6 offset:51200
  buffer_load_dwordx4 v10, s[8:11], s43 offen offset:1024 lds
  v_subrev_u32 v30, s98, v30
  s_waitcnt lgkmcnt(3)
  v_mfma_f32_32x32x16_bf16 v[128:143], v[108:111], a[44:47], v[128:143]
  ds_read_b64_tr_b16 v[118:119], v6 offset:51712
  v_subrev_u32 v31, s98, v31
  v_mfma_f32_32x32x16_bf16 v[144:159], v[96:99], a[48:51], v[144:159]
  ds_read_b64_tr_b16 v[120:121], v6 offset:53248
  buffer_load_dwordx4 v11, s[8:11], s43 offen offset:2048 lds
  v_mfma_f32_32x32x16_bf16 v[144:159], v[100:103], a[52:55], v[144:159]
  ds_read_b64_tr_b16 v[122:123], v6 offset:53760
  v_mfma_f32_32x32x16_bf16 v[144:159], v[104:107], a[56:59], v[144:159]
  ds_read_b64_tr_b16 v[124:125], v6 offset:55296
  s_waitcnt vmcnt(14)
  ds_read_b128 a[0:3], v1 offset:32768
  buffer_load_dwordx4 v12, s[8:11], s43 offen offset:3072 lds
  v_mfma_f32_32x32x16_bf16 v[144:159], v[108:111], a[60:63], v[144:159]
  ds_read_b64_tr_b16 v[126:127], v6 offset:55808
  s_waitcnt vmcnt(19)
  s_barrier
  ds_read_b128 a[4:7], v2 offset:32768
  s_waitcnt lgkmcnt(8)
  v_mfma_f32_32x32x16_bf16 v[160:175], v[112:115], a[32:35], v[160:175]
  ds_read_b64_tr_b16 v[96:97], v5
  ds_read_b128 a[8:11], v3 offset:32768
  s_lshr_b32 s55, s46, 1
  s_add_u32 m0, s55, 0x20000
  s_waitcnt lgkmcnt(8)
  v_mfma_f32_32x32x16_bf16 v[160:175], v[116:119], a[36:39], v[160:175]
  ds_read_b64_tr_b16 v[98:99], v5 offset:512
  ds_read_b128 a[12:15], v4 offset:32768
  buffer_load_dwordx4 v17, s[12:15], s44 offen lds
  buffer_load_dwordx4 v18, s[12:15], s44 offen offset:1024 lds
  s_waitcnt lgkmcnt(8)
  v_mfma_f32_32x32x16_bf16 v[160:175], v[120:123], a[40:43], v[160:175]
  ds_read_b64_tr_b16 v[100:101], v5 offset:2048
  ds_read_b128 a[16:19], v1 offset:36864
  s_add_u32 s44, s44, 0x30000
  s_add_u32 m0, s45, 0x1000
  s_waitcnt lgkmcnt(7)
  v_mfma_f32_32x32x16_bf16 v[160:175], v[124:127], a[44:47], v[160:175]
  ds_read_b64_tr_b16 v[102:103], v5 offset:2560
  ds_read_b128 a[20:23], v2 offset:36864
  buffer_load_dwordx4 v13, s[8:11], s43 offen lds
  buffer_load_dwordx4 v14, s[8:11], s43 offen offset:1024 lds
  v_mfma_f32_32x32x16_bf16 v[176:191], v[112:115], a[48:51], v[176:191]
  ds_read_b64_tr_b16 v[104:105], v5 offset:4096
  ds_read_b128 a[24:27], v3 offset:36864
  buffer_load_dwordx4 v15, s[8:11], s43 offen offset:2048 lds
  buffer_load_dwordx4 v16, s[8:11], s43 offen offset:3072 lds
  v_mfma_f32_32x32x16_bf16 v[176:191], v[116:119], a[52:55], v[176:191]
  ds_read_b64_tr_b16 v[106:107], v5 offset:4608
  ds_read_b128 a[28:31], v4 offset:36864
  s_add_u32 s43, s43, 128
  v_mfma_f32_32x32x16_bf16 v[176:191], v[120:123], a[56:59], v[176:191]
  ds_read_b64_tr_b16 v[108:109], v5 offset:6144
  v_mfma_f32_32x32x16_bf16 v[176:191], v[124:127], a[60:63], v[176:191]
  ds_read_b64_tr_b16 v[110:111], v5 offset:6656
  s_waitcnt lgkmcnt(11)
  v_mfma_f32_32x32x16_bf16 v[128:143], v[96:99], a[0:3], v[128:143]
  s_add_u32 m0, s99, 0
  ds_read_b64_tr_b16 v[112:113], v6
  buffer_load_dwordx4 v9, s[8:11], s43 offen lds
  s_waitcnt lgkmcnt(8)
  v_mfma_f32_32x32x16_bf16 v[128:143], v[100:103], a[4:7], v[128:143]
  ds_read_b64_tr_b16 v[114:115], v6 offset:512
  s_waitcnt vmcnt(15)
  v_cmp_eq_u32 vcc, s59, v24
  s_nop 3
  s_and_b32 s53, vcc_lo, 0xff
  s_cmp_eq_u32 s53, 0xff
  s_cbranch_scc0 L_spin_AQ
L_spin_ret_AQ:
  s_waitcnt lgkmcnt(5)
  v_mfma_f32_32x32x16_bf16 v[128:143], v[104:107], a[8:11], v[128:143]
  ds_read_b64_tr_b16 v[116:117], v6 offset:2048
  buffer_load_dwordx4 v10, s[8:11], s43 offen offset:1024 lds
  s_waitcnt lgkmcnt(3)
  v_mfma_f32_32x32x16_bf16 v[128:143], v[108:111], a[12:15], v[128:143]
  ds_read_b64_tr_b16 v[118:119], v6 offset:2560
  v_mfma_f32_32x32x16_bf16 v[144:159], v[96:99], a[16:19], v[144:159]
  ds_read_b64_tr_b16 v[120:121], v6 offset:4096
  buffer_load_dwordx4 v11, s[8:11], s43 offen offset:2048 lds
  v_mfma_f32_32x32x16_bf16 v[144:159], v[100:103], a[20:23], v[144:159]
  ds_read_b64_tr_b16 v[122:123], v6 offset:4608
  v_mfma_f32_32x32x16_bf16 v[144:159], v[104:107], a[24:27], v[144:159]
  ds_read_b64_tr_b16 v[124:125], v6 offset:6144
  s_waitcnt vmcnt(13)
  ds_read_b128 a[32:35], v28
  buffer_load_dwordx4 v12, s[8:11], s43 offen offset:3072 lds
  v_mfma_f32_32x32x16_bf16 v[144:159], v[108:111], a[28:31], v[144:159]
  ds_read_b64_tr_b16 v[126:127], v6 offset:6656
  s_waitcnt vmcnt(19)
  s_barrier
  ds_read_b128 a[36:39], v29
  s_waitcnt lgkmcnt(8)
  v_mfma_f32_32x32x16_bf16 v[160:175], v[112:115], a[0:3], v[160:175]
  ds_read_b64_tr_b16 v[96:97], v5 offset:16384
  ds_read_b128 a[40:43], v30
  s_lshr_b32 s55, s46, 1
  s_add_u32 m0, s55, 0x24000
  s_waitcnt lgkmcnt(8)
  v_mfma_f32_32x32x16_bf16 v[160:175], v[116:119], a[4:7], v[160:175]
  ds_read_b64_tr_b16 v[98:99], v5 offset:16896
  ds_read_b128 a[44:47], v31
  buffer_load_dwordx4 v17, s[12:15], s44 offen lds
  buffer_load_dwordx4 v18, s[12:15], s44 offen offset:1024 lds
  s_waitcnt lgkmcnt(8)
  v_mfma_f32_32x32x16_bf16 v[160:175], v[120:123], a[8:11], v[160:175]
  ds_read_b64_tr_b16 v[100:101], v5 offset:18432
  ds_read_b128 a[48:51], v28 offset:4096
  s_add_u32 s44, s44, 0x30000
  s_add_u32 m0, s99, 4096
  s_waitcnt lgkmcnt(7)
  v_mfma_f32_32x32x16_bf16 v[160:175], v[124:127], a[12:15], v[160:175]
  ds_read_b64_tr_b16 v[102:103], v5 offset:18944
  ds_read_b128 a[52:55], v29 offset:4096
  buffer_load_dwordx4 v13, s[8:11], s43 offen lds
  buffer_load_dwordx4 v14, s[8:11], s43 offen offset:1024 lds
  v_mfma_f32_32x32x16_bf16 v[176:191], v[112:115], a[16:19], v[176:191]
  ds_read_b64_tr_b16 v[104:105], v5 offset:20480
  ds_read_b128 a[56:59], v30 offset:4096
  buffer_load_dwordx4 v15, s[8:11], s43 offen offset:2048 lds
  buffer_load_dwordx4 v16, s[8:11], s43 offen offset:3072 lds
  v_mfma_f32_32x32x16_bf16 v[176:191], v[116:119], a[20:23], v[176:191]
  ds_read_b64_tr_b16 v[106:107], v5 offset:20992
  ds_read_b128 a[60:63], v31 offset:4096
  s_add_u32 s43, s43, 128
  v_mfma_f32_32x32x16_bf16 v[176:191], v[120:123], a[24:27], v[176:191]
  ds_read_b64_tr_b16 v[108:109], v5 offset:22528
  v_mfma_f32_32x32x16_bf16 v[176:191], v[124:127], a[28:31], v[176:191]
  ds_read_b64_tr_b16 v[110:111], v5 offset:23040
  s_waitcnt lgkmcnt(11)
  v_mfma_f32_32x32x16_bf16 v[128:143], v[96:99], a[32:35], v[128:143]
  ds_read_b64_tr_b16 v[112:113], v6 offset:16384
  v_add_u32 v28, s98, v28
  s_waitcnt lgkmcnt(8)
  v_mfma_f32_32x32x16_bf16 v[128:143], v[100:103], a[36:39], v[128:143]
  ds_read_b64_tr_b16 v[114:115], v6 offset:16896
  v_add_u32 v29, s98, v29
  s_waitcnt lgkmcnt(5)
  v_mfma_f32_32x32x16_bf16 v[128:143], v[104:107], a[40:43], v[128:143]
  ds_read_b64_tr_b16 v[116:117], v6 offset:18432
  v_add_u32 v30, s98, v30
  s_waitcnt lgkmcnt(3)
  v_mfma_f32_32x32x16_bf16 v[128:143], v[108:111], a[44:47], v[128:143]
  ds_read_b64_tr_b16 v[118:119], v6 offset:18944
  v_add_u32 v31, s98, v31
  v_mfma_f32_32x32x16_bf16 v[144:159], v[96:99], a[48:51], v[144:159]
  ds_read_b64_tr_b16 v[120:121], v6 offset:20480
  v_mfma_f32_32x32x16_bf16 v[144:159], v[100:103], a[52:55], v[144:159]
  ds_read_b64_tr_b16 v[122:123], v6 offset:20992
  v_mfma_f32_32x32x16_bf16 v[144:159], v[104:107], a[56:59], v[144:159]
  ds_read_b64_tr_b16 v[124:125], v6 offset:22528
  s_waitcnt vmcnt(10)
  ds_read_b128 a[0:3], v1
  v_mfma_f32_32x32x16_bf16 v[144:159], v[108:111], a[60:63], v[144:159]
  ds_read_b64_tr_b16 v[126:127], v6 offset:23040
  s_waitcnt vmcnt(14)
  s_barrier
  ds_read_b128 a[4:7], v2
  s_waitcnt lgkmcnt(8)
  v_mfma_f32_32x32x16_bf16 v[160:175], v[112:115], a[32:35], v[160:175]
  ds_read_b64_tr_b16 v[96:97], v5 offset:32768
  ds_read_b128 a[8:11], v3
  s_lshl_b32 s76, s42, 12
  v_add_u32 v25, s76, v21
  s_waitcnt lgkmcnt(8)
  v_mfma_f32_32x32x16_bf16 v[160:175], v[116:119], a[36:39], v[160:175]
  ds_read_b64_tr_b16 v[98:99], v5 offset:33280
  s_add_u32 m0, s68, 0
  ds_read_b128 a[12:15], v4
  buffer_load_dwordx4 v25, s[60:63], s72 offen sc1 lds
  buffer_load_dwordx4 v25, s[60:63], s72 offen offset:1024 sc1 lds
  s_waitcnt lgkmcnt(8)
  v_mfma_f32_32x32x16_bf16 v[160:175], v[120:123], a[40:43], v[160:175]
  ds_read_b64_tr_b16 v[100:101], v5 offset:34816
  ds_read_b128 a[16:19], v1 offset:4096
  buffer_load_dwordx4 v25, s[60:63], s72 offen offset:2048 sc1 lds
  buffer_load_dwordx4 v25, s[60:63], s72 offen offset:3072 sc1 lds
  s_add_u32 s72, s72, 16384
  s_waitcnt lgkmcnt(7)
  v_mfma_f32_32x32x16_bf16 v[160:175], v[124:127], a[44:47], v[160:175]
  ds_read_b64_tr_b16 v[102:103], v5 offset:35328
  s_add_u32 m0, s68, 0x4000
  ds_read_b128 a[20:23], v2 offset:4096
  buffer_load_dwordx4 v25, s[60:63], s72 offen sc1 lds
  buffer_load_dwordx4 v25, s[60:63], s72 offen offset:1024 sc1 lds
  v_mfma_f32_32x32x16_bf16 v[176:191], v[112:115], a[48:51], v[176:191]
  ds_read_b64_tr_b16 v[104:105], v5 offset:36864
  ds_read_b128 a[24:27], v3 offset:4096
  buffer_load_dwordx4 v25, s[60:63], s72 offen offset:2048 sc1 lds
  buffer_load_dwordx4 v25, s[60:63], s72 offen offset:3072 sc1 lds
  s_add_u32 s72, s72, 16384
  v_mfma_f32_32x32x16_bf16 v[176:191], v[116:119], a[52:55], v[176:191]
  ds_read_b64_tr_b16 v[106:107], v5 offset:37376
  ds_read_b128 a[28:31], v4 offset:4096
  v_mfma_f32_32x32x16_bf16 v[176:191], v[120:123], a[56:59], v[176:191]
  ds_read_b64_tr_b16 v[108:109], v5 offset:38912
  v_mfma_f32_32x32x16_bf16 v[176:191], v[124:127], a[60:63], v[176:191]
  ds_read_b64_tr_b16 v[110:111], v5 offset:39424
  s_waitcnt lgkmcnt(11)
  v_mfma_f32_32x32x16_bf16 v[128:143], v[96:99], a[0:3], v[128:143]
  ds_read_b64_tr_b16 v[112:113], v6 offset:32768
  s_waitcnt lgkmcnt(8)
  v_mfma_f32_32x32x16_bf16 v[128:143], v[100:103], a[4:7], v[128:143]
  ds_read_b64_tr_b16 v[114:115], v6 offset:33280
  s_waitcnt lgkmcnt(5)
  v_mfma_f32_32x32x16_bf16 v[128:143], v[104:107], a[8:11], v[128:143]
  ds_read_b64_tr_b16 v[116:117], v6 offset:34816
  s_waitcnt lgkmcnt(3)
  v_mfma_f32_32x32x16_bf16 v[128:143], v[108:111], a[12:15], v[128:143]
  ds_read_b64_tr_b16 v[118:119], v6 offset:35328
  v_mfma_f32_32x32x16_bf16 v[144:159], v[96:99], a[16:19], v[144:159]
  ds_read_b64_tr_b16 v[120:121], v6 offset:36864
  v_mfma_f32_32x32x16_bf16 v[144:159], v[100:103], a[20:23], v[144:159]
  ds_read_b64_tr_b16 v[122:123], v6 offset:37376
  v_mfma_f32_32x32x16_bf16 v[144:159], v[104:107], a[24:27], v[144:159]
  ds_read_b64_tr_b16 v[124:125], v6 offset:38912
  s_waitcnt vmcnt(8)
  ds_read_b128 a[32:35], v28
  v_mfma_f32_32x32x16_bf16 v[144:159], v[108:111], a[28:31], v[144:159]
  ds_read_b64_tr_b16 v[126:127], v6 offset:39424
  s_waitcnt vmcnt(12)
  s_barrier
  ds_read_b128 a[36:39], v29
  s_waitcnt lgkmcnt(8)
  v_mfma_f32_32x32x16_bf16 v[160:175], v[112:115], a[0:3], v[160:175]
  ds_read_b64_tr_b16 v[96:97], v5 offset:49152
  ds_read_b128 a[40:43], v30
  s_waitcnt lgkmcnt(8)
  v_mfma_f32_32x32x16_bf16 v[160:175], v[116:119], a[4:7], v[160:175]
  ds_read_b64_tr_b16 v[98:99], v5 offset:49664
  s_add_u32 m0, s69, 0
  ds_read_b128 a[44:47], v31
  buffer_load_dwordx4 v25, s[60:63], s72 offen sc1 lds
  buffer_load_dwordx4 v25, s[60:63], s72 offen offset:1024 sc1 lds
  s_waitcnt lgkmcnt(8)
  v_mfma_f32_32x32x16_bf16 v[160:175], v[120:123], a[8:11], v[160:175]
  ds_read_b64_tr_b16 v[100:101], v5 offset:51200
  ds_read_b128 a[48:51], v28 offset:4096
  buffer_load_dwordx4 v25, s[60:63], s72 offen offset:2048 sc1 lds
  buffer_load_dwordx4 v25, s[60:63], s72 offen offset:3072 sc1 lds
  s_add_u32 s72, s72, 16384
  s_waitcnt lgkmcnt(7)
  v_mfma_f32_32x32x16_bf16 v[160:175], v[124:127], a[12:15], v[160:175]
  ds_read_b64_tr_b16 v[102:103], v5 offset:51712
  s_add_u32 m0, s70, 0
  ds_read_b128 a[52:55], v29 offset:4096
  buffer_load_dwordx4 v25, s[64:67], s73 offen sc1 lds
  buffer_load_dwordx4 v25, s[64:67], s73 offen offset:1024 sc1 lds
  v_mfma_f32_32x32x16_bf16 v[176:191], v[112:115], a[16:19], v[176:191]
  ds_read_b64_tr_b16 v[104:105], v5 offset:53248
  ds_read_b128 a[56:59], v30 offset:4096
  buffer_load_dwordx4 v25, s[64:67], s73 offen offset:2048 sc1 lds
  buffer_load_dwordx4 v25, s[64:67], s73 offen offset:3072 sc1 lds
  s_add_u32 s73, s73, 16384
  v_mfma_f32_32x32x16_bf16 v[176:191], v[116:119], a[20:23], v[176:191]
  ds_read_b64_tr_b16 v[106:107], v5 offset:53760
  s_add_u32 m0, s70, 0x4000
  ds_read_b128 a[60:63], v31 offset:4096
  buffer_load_dwordx4 v25, s[64:67], s73 offen sc1 lds
  buffer_load_dwordx4 v25, s[64:67], s73 offen offset:1024 sc1 lds
  v_mfma_f32_32x32x16_bf16 v[176:191], v[120:123], a[24:27], v[176:191]
  ds_read_b64_tr_b16 v[108:109], v5 offset:55296
  buffer_load_dwordx4 v25, s[64:67], s73 offen offset:2048 sc1 lds
  buffer_load_dwordx4 v25, s[64:67], s73 offen offset:3072 sc1 lds
  s_add_u32 s73, s73, 16384
  v_mfma_f32_32x32x16_bf16 v[176:191], v[124:127], a[28:31], v[176:191]
  ds_read_b64_tr_b16 v[110:111], v5 offset:55808
  s_waitcnt lgkmcnt(11)
  v_mfma_f32_32x32x16_bf16 v[128:143], v[96:99], a[32:35], v[128:143]
  ds_read_b64_tr_b16 v[112:113], v6 offset:49152
  s_lshl_b32 s52, s40, 3
  s_lshl_b32 s53, s42, 1
  s_add_u32 s52, s52, s53
  s_lshr_b32 s53, s41, 3
  s_waitcnt lgkmcnt(8)
  v_mfma_f32_32x32x16_bf16 v[128:143], v[100:103], a[36:39], v[128:143]
  ds_read_b64_tr_b16 v[114:115], v6 offset:49664
  s_lshl_b32 s53, s53, 21
  s_and_b32 s54, s41, 7
  s_lshl_b32 s54, s54, 18
  s_add_u32 s53, s53, s54
  s_waitcnt lgkmcnt(5)
  v_mfma_f32_32x32x16_bf16 v[128:143], v[104:107], a[40:43], v[128:143]
  ds_read_b64_tr_b16 v[116:117], v6 offset:51200
  s_lshl_b32 s52, s52, 10
  s_add_u32 s52, s52, s53
  s_add_u32 s54, s52, 0x4000000
  s_add_u32 s55, s54, 1024
  s_waitcnt lgkmcnt(3)
  v_mfma_f32_32x32x16_bf16 v[128:143], v[108:111], a[44:47], v[128:143]
  ds_read_b64_tr_b16 v[118:119], v6 offset:51712
  s_mov_b32 s56, 0x3eb8aa3b
  s_mov_b32 s57, 0x3eb8aa3b
  v_mfma_f32_32x32x16_bf16 v[144:159], v[96:99], a[48:51], v[144:159]
  ds_read_b64_tr_b16 v[120:121], v6 offset:53248
  s_add_u32 s92, s54, 0
  s_add_u32 s93, s54, 0x10000
  v_mfma_f32_32x32x16_bf16 v[144:159], v[100:103], a[52:55], v[144:159]
  ds_read_b64_tr_b16 v[122:123], v6 offset:53760
  s_add_u32 s94, s55, 0
  s_add_u32 s95, s55, 0x10000
  v_mfma_f32_32x32x16_bf16 v[144:159], v[104:107], a[56:59], v[144:159]
  ds_read_b64_tr_b16 v[124:125], v6 offset:55296
  s_add_u32 s96, s54, 0x20000
  s_add_u32 s97, s54, 0x30000
  v_mfma_f32_32x32x16_bf16 v[144:159], v[108:111], a[60:63], v[144:159]
  ds_read_b64_tr_b16 v[126:127], v6 offset:55808
  s_add_u32 s98, s55, 0x20000
  s_add_u32 s99, s55, 0x30000
  s_waitcnt lgkmcnt(6)
  v_mfma_f32_32x32x16_bf16 v[160:175], v[112:115], a[32:35], v[160:175]
  v_mul_f32 v128, s56, v128
  v_mul_f32 v129, s56, v129
  v_mul_f32 v130, s56, v130
  v_mul_f32 v131, s56, v131
  v_mul_f32 v132, s56, v132
  s_waitcnt lgkmcnt(4)
  v_mfma_f32_32x32x16_bf16 v[160:175], v[116:119], a[36:39], v[160:175]
  v_mul_f32 v133, s56, v133
  v_mul_f32 v134, s56, v134
  v_mul_f32 v135, s56, v135
  v_mul_f32 v136, s56, v136
  v_mul_f32 v137, s56, v137
  s_waitcnt lgkmcnt(2)
  v_mfma_f32_32x32x16_bf16 v[160:175], v[120:123], a[40:43], v[160:175]
  v_mul_f32 v138, s56, v138
  v_mul_f32 v139, s56, v139
  v_mul_f32 v140, s56, v140
  v_mul_f32 v141, s56, v141
  v_mul_f32 v142, s56, v142
  s_waitcnt lgkmcnt(0)
  v_mfma_f32_32x32x16_bf16 v[160:175], v[124:127], a[44:47], v[160:175]
  v_mul_f32 v143, s56, v143
  v_cvt_pk_bf16_f32 v96, v128, v129
  v_cvt_pk_bf16_f32 v97, v130, v131
  v_cvt_pk_bf16_f32 v98, v132, v133
  v_cvt_pk_bf16_f32 v99, v134, v135
  v_mfma_f32_32x32x16_bf16 v[176:191], v[112:115], a[48:51], v[176:191]
  v_cvt_pk_bf16_f32 v100, v136, v137
  v_cvt_pk_bf16_f32 v101, v138, v139
  v_cvt_pk_bf16_f32 v102, v140, v141
  v_cvt_pk_bf16_f32 v103, v142, v143
  v_mul_f32 v144, s56, v144
  v_mul_f32 v145, s56, v145
  v_mul_f32 v146, s56, v146
  v_mul_f32 v147, s56, v147
  v_mul_f32 v148, s56, v148
  v_mfma_f32_32x32x16_bf16 v[176:191], v[116:119], a[52:55], v[176:191]
  v_mul_f32 v149, s56, v149
  v_mul_f32 v150, s56, v150
  v_mul_f32 v151, s56, v151
  v_mul_f32 v152, s56, v152
  v_mul_f32 v153, s56, v153
  v_mfma_f32_32x32x16_bf16 v[176:191], v[120:123], a[56:59], v[176:191]
  v_mul_f32 v154, s56, v154
  v_mul_f32 v155, s56, v155
  v_mul_f32 v156, s56, v156
  v_mul_f32 v157, s56, v157
  v_mul_f32 v158, s56, v158
  v_mfma_f32_32x32x16_bf16 v[176:191], v[124:127], a[60:63], v[176:191]
  v_mul_f32 v159, s56, v159
  v_cvt_pk_bf16_f32 v104, v144, v145
  v_cvt_pk_bf16_f32 v105, v146, v147
  v_cvt_pk_bf16_f32 v106, v148, v149
  v_cvt_pk_bf16_f32 v107, v150, v151
  s_waitcnt lgkmcnt(0)
  s_barrier
  v_cvt_pk_bf16_f32 v108, v152, v153
  v_cvt_pk_bf16_f32 v109, v154, v155
  v_cvt_pk_bf16_f32 v110, v156, v157
  v_cvt_pk_bf16_f32 v111, v158, v159
  v_mul_f32 v160, s56, v160
  v_mul_f32 v161, s56, v161
  v_mul_f32 v162, s56, v162
  v_mul_f32 v163, s56, v163
  v_mul_f32 v164, s56, v164
  v_mul_f32 v165, s56, v165
  v_mul_f32 v166, s56, v166
  v_mul_f32 v167, s56, v167
  v_mul_f32 v168, s56, v168
  v_mul_f32 v169, s56, v169
  v_mul_f32 v170, s56, v170
  v_mul_f32 v171, s56, v171
  v_mul_f32 v172, s56, v172
  v_mul_f32 v173, s56, v173
  v_mul_f32 v174, s56, v174
  v_mul_f32 v175, s56, v175
  v_cvt_pk_bf16_f32 v112, v160, v161
  v_cvt_pk_bf16_f32 v113, v162, v163
  v_cvt_pk_bf16_f32 v114, v164, v165
  v_cvt_pk_bf16_f32 v115, v166, v167
  v_cvt_pk_bf16_f32 v116, v168, v169
  v_cvt_pk_bf16_f32 v117, v170, v171
  v_cvt_pk_bf16_f32 v118, v172, v173
  v_cvt_pk_bf16_f32 v119, v174, v175
  v_mul_f32 v176, s56, v176
  v_mul_f32 v177, s56, v177
  v_mul_f32 v178, s56, v178
  v_mul_f32 v179, s56, v179
  v_mul_f32 v180, s56, v180
  v_mul_f32 v181, s56, v181
  v_mul_f32 v182, s56, v182
  v_mul_f32 v183, s56, v183
  v_mul_f32 v184, s56, v184
  v_mul_f32 v185, s56, v185
  v_mul_f32 v186, s56, v186
  v_mul_f32 v187, s56, v187
  v_mul_f32 v188, s56, v188
  v_mul_f32 v189, s56, v189
  v_mul_f32 v190, s56, v190
  v_mul_f32 v191, s56, v191
  v_cvt_pk_bf16_f32 v120, v176, v177
  v_cvt_pk_bf16_f32 v121, v178, v179
  v_cvt_pk_bf16_f32 v122, v180, v181
  v_cvt_pk_bf16_f32 v123, v182, v183
  v_cvt_pk_bf16_f32 v124, v184, v185
  v_cvt_pk_bf16_f32 v125, v186, v187
  v_cvt_pk_bf16_f32 v126, v188, v189
  v_cvt_pk_bf16_f32 v127, v190, v191
  v_mov_b32 v26, v21
  s_branch L_b_start2
L_proj_AK:
  s_waitcnt lgkmcnt(10)
  v_mfma_f32_32x32x16_bf16 v[128:143], v[96:99], a[0:3], 0
  ds_read_b64_tr_b16 v[112:113], v6
  s_lshl_b32 s99, s42, 14
  v_cvt_pk_bf16_f32 v58, v228, v229
  v_cvt_pk_bf16_f32 v59, v230, v231
  s_waitcnt lgkmcnt(8)
  v_mfma_f32_32x32x16_bf16 v[128:143], v[100:103], a[4:7], v[128:143]
  ds_read_b64_tr_b16 v[114:115], v6 offset:512
  s_add_u32 s99, s99, 0x1a000
  v_cvt_pk_bf16_f32 v60, v232, v233
  v_cvt_pk_bf16_f32 v61, v234, v235
  s_waitcnt lgkmcnt(6)
  v_mfma_f32_32x32x16_bf16 v[128:143], v[104:107], a[8:11], v[128:143]
  ds_read_b64_tr_b16 v[116:117], v6 offset:2048
  s_lshl_b32 s98, s42, 13
  v_cvt_pk_bf16_f32 v62, v236, v237
  v_cvt_pk_bf16_f32 v63, v238, v239
  s_waitcnt lgkmcnt(4)
  v_mfma_f32_32x32x16_bf16 v[128:143], v[108:111], a[12:15], v[128:143]
  ds_read_b64_tr_b16 v[118:119], v6 offset:2560
  s_add_u32 s98, s98, 40960
  v_cvt_pk_bf16_f32 v88, v240, v241
  v_cvt_pk_bf16_f32 v89, v242, v243
  v_mfma_f32_32x32x16_bf16 v[144:159], v[96:99], a[16:19], 0
  ds_read_b64_tr_b16 v[120:121], v6 offset:4096
  v_cvt_pk_bf16_f32 v90, v244, v245
  v_cvt_pk_bf16_f32 v91, v246, v247
  v_mfma_f32_32x32x16_bf16 v[144:159], v[100:103], a[20:23], v[144:159]
  ds_read_b64_tr_b16 v[122:123], v6 offset:4608
  v_cvt_pk_bf16_f32 v92, v248, v249
  v_cvt_pk_bf16_f32 v93, v250, v251
  v_mfma_f32_32x32x16_bf16 v[144:159], v[104:107], a[24:27], v[144:159]
  ds_read_b64_tr_b16 v[124:125], v6 offset:6144
  s_waitcnt vmcnt(12)
  ds_read_b128 a[32:35], v28
  v_cvt_pk_bf16_f32 v94, v252, v253
  v_cvt_pk_bf16_f32 v95, v254, v255
  s_waitcnt lgkmcnt(8)
  v_mfma_f32_32x32x16_bf16 v[144:159], v[108:111], a[28:31], v[144:159]
  ds_read_b64_tr_b16 v[126:127], v6 offset:6656
  s_waitcnt vmcnt(10)
  s_barrier
  ds_read_b128 a[36:39], v29
  s_waitcnt lgkmcnt(8)
  v_mfma_f32_32x32x16_bf16 v[160:175], v[112:115], a[0:3], 0
  ds_read_b64_tr_b16 v[96:97], v5 offset:16384
  ds_read_b128 a[40:43], v30
  s_lshr_b32 s55, s46, 1
  s_add_u32 m0, s55, 0x24000
  s_waitcnt lgkmcnt(8)
  v_mfma_f32_32x32x16_bf16 v[160:175], v[116:119], a[4:7], v[160:175]
  ds_read_b64_tr_b16 v[98:99], v5 offset:16896
  ds_read_b128 a[44:47], v31
  buffer_load_dwordx4 v17, s[12:15], s44 offen lds
  buffer_load_dwordx4 v18, s[12:15], s44 offen offset:1024 lds
  s_waitcnt lgkmcnt(8)
  v_mfma_f32_32x32x16_bf16 v[160:175], v[120:123], a[8:11], v[160:175]
  ds_read_b64_tr_b16 v[100:101], v5 offset:18432
  ds_read_b128 a[48:51], v28 offset:4096
  s_add_u32 s44, s44, 0x30000
  s_add_u32 m0, s99, 0
  s_waitcnt lgkmcnt(7)
  v_mfma_f32_32x32x16_bf16 v[160:175], v[124:127], a[12:15], v[160:175]
  ds_read_b64_tr_b16 v[102:103], v5 offset:18944
  ds_read_b128 a[52:55], v29 offset:4096
  buffer_load_dwordx4 v9, s[8:11], s43 offen lds
  buffer_load_dwordx4 v10, s[8:11], s43 offen offset:1024 lds
  v_mfma_f32_32x32x16_bf16 v[176:191], v[112:115], a[16:19], 0
  ds_read_b64_tr_b16 v[104:105], v5 offset:20480
  ds_read_b128 a[56:59], v30 offset:4096
  buffer_load_dwordx4 v11, s[8:11], s43 offen offset:2048 lds
  buffer_load_dwordx4 v12, s[8:11], s43 offen offset:3072 lds
  v_mfma_f32_32x32x16_bf16 v[176:191], v[116:119], a[20:23], v[176:191]
  ds_read_b64_tr_b16 v[106:107], v5 offset:20992
  s_add_u32 m0, s99, 4096
  ds_read_b128 a[60:63], v31 offset:4096
  buffer_load_dwordx4 v13, s[8:11], s43 offen lds
  v_mfma_f32_32x32x16_bf16 v[176:191], v[120:123], a[24:27], v[176:191]
  ds_read_b64_tr_b16 v[108:109], v5 offset:22528
  buffer_load_dwordx4 v14, s[8:11], s43 offen offset:1024 lds
  buffer_load_dwordx4 v15, s[8:11], s43 offen offset:2048 lds
  v_mfma_f32_32x32x16_bf16 v[176:191], v[124:127], a[28:31], v[176:191]
  ds_read_b64_tr_b16 v[110:111], v5 offset:23040
  buffer_load_dwordx4 v16, s[8:11], s43 offen offset:3072 lds
  s_add_u32 s43, s43, 128
  s_waitcnt lgkmcnt(11)
  v_mfma_f32_32x32x16_bf16 v[128:143], v[96:99], a[32:35], v[128:143]
  s_add_u32 m0, s45, 0x8000
  ds_read_b64_tr_b16 v[112:113], v6 offset:16384
  buffer_load_dwordx4 v9, s[8:11], s43 offen lds
  v_add_u32 v28, s98, v28
  s_lshl_b32 s76, s40, 2
  s_sub_u32 s85, 64, s76
  s_mul_i32 s76, s41, 0x80000
  s_waitcnt lgkmcnt(8)
  v_mfma_f32_32x32x16_bf16 v[128:143], v[100:103], a[36:39], v[128:143]
  ds_read_b64_tr_b16 v[114:115], v6 offset:16896
  v_add_u32 v29, s98, v29
  s_add_u32 s76, s76, 0x1000000
  s_add_u32 s60, s38, s76
  s_addc_u32 s61, s39, 0
  s_waitcnt lgkmcnt(5)
  v_mfma_f32_32x32x16_bf16 v[128:143], v[104:107], a[40:43], v[128:143]
  ds_read_b64_tr_b16 v[116:117], v6 offset:18432
  buffer_load_dwordx4 v10, s[8:11], s43 offen offset:1024 lds
  v_add_u32 v30, s98, v30
  s_and_b32 s61, s61, 0xffff
  s_lshl_b32 s62, s85, 13
  s_mov_b32 s63, 0x20000
  s_waitcnt lgkmcnt(3)
  v_mfma_f32_32x32x16_bf16 v[128:143], v[108:111], a[44:47], v[128:143]
  ds_read_b64_tr_b16 v[118:119], v6 offset:18944
  v_add_u32 v31, s98, v31
  s_mul_i32 s76, s41, 0x80000
  s_add_u32 s76, s76, 0x2000000
  s_add_u32 s64, s38, s76
  v_mfma_f32_32x32x16_bf16 v[144:159], v[96:99], a[48:51], v[144:159]
  ds_read_b64_tr_b16 v[120:121], v6 offset:20480
  buffer_load_dwordx4 v11, s[8:11], s43 offen offset:2048 lds
  s_addc_u32 s65, s39, 0
  s_and_b32 s65, s65, 0xffff
  s_lshl_b32 s66, s85, 13
  v_mfma_f32_32x32x16_bf16 v[144:159], v[100:103], a[52:55], v[144:159]
  ds_read_b64_tr_b16 v[122:123], v6 offset:20992
  s_mov_b32 s67, 0x20000
  s_mov_b32 s82, 0
  s_lshl_b32 s76, s42, 12
  v_mfma_f32_32x32x16_bf16 v[144:159], v[104:107], a[56:59], v[144:159]
  ds_read_b64_tr_b16 v[124:125], v6 offset:22528
  s_waitcnt vmcnt(15)
  ds_read_b128 a[0:3], v1
  buffer_load_dwordx4 v12, s[8:11], s43 offen offset:3072 lds
  s_add_u32 s68, s76, 0x8000
  s_add_u32 s69, s76, 0
  s_add_u32 s70, s76, 0x10000
  v_mfma_f32_32x32x16_bf16 v[144:159], v[108:111], a[60:63], v[144:159]
  ds_read_b64_tr_b16 v[126:127], v6 offset:23040
  s_waitcnt vmcnt(14)
  s_barrier
  ds_read_b128 a[4:7], v2
  s_add_u32 s71, s70, 0x8000
  s_mov_b32 s72, 0
  s_mov_b32 s73, 0
  s_waitcnt lgkmcnt(8)
  v_mfma_f32_32x32x16_bf16 v[160:175], v[112:115], a[32:35], v[160:175]
  ds_read_b64_tr_b16 v[96:97], v5 offset:32768
  ds_read_b128 a[8:11], v3
  s_lshr_b32 s55, s46, 1
  s_add_u32 m0, s55, 0x18000
  s_waitcnt lgkmcnt(8)
  v_mfma_f32_32x32x16_bf16 v[160:175], v[116:119], a[36:39], v[160:175]
  ds_read_b64_tr_b16 v[98:99], v5 offset:33280
  ds_read_b128 a[12:15], v4
  buffer_load_dwordx4 v17, s[12:15], s44 offen lds
  buffer_load_dwordx4 v18, s[12:15], s44 offen offset:1024 lds
  s_waitcnt lgkmcnt(8)
  v_mfma_f32_32x32x16_bf16 v[160:175], v[120:123], a[40:43], v[160:175]
  ds_read_b64_tr_b16 v[100:101], v5 offset:34816
  ds_read_b128 a[16:19], v1 offset:4096
  s_add_u32 s44, s44, 0x30000
  s_add_u32 m0, s45, 0x9000
  s_waitcnt lgkmcnt(7)
  v_mfma_f32_32x32x16_bf16 v[160:175], v[124:127], a[44:47], v[160:175]
  ds_read_b64_tr_b16 v[102:103], v5 offset:35328
  ds_read_b128 a[20:23], v2 offset:4096
  buffer_load_dwordx4 v13, s[8:11], s43 offen lds
  buffer_load_dwordx4 v14, s[8:11], s43 offen offset:1024 lds
  v_mfma_f32_32x32x16_bf16 v[176:191], v[112:115], a[48:51], v[176:191]
  ds_read_b64_tr_b16 v[104:105], v5 offset:36864
  ds_read_b128 a[24:27], v3 offset:4096
  buffer_load_dwordx4 v15, s[8:11], s43 offen offset:2048 lds
  buffer_load_dwordx4 v16, s[8:11], s43 offen offset:3072 lds
  v_mfma_f32_32x32x16_bf16 v[176:191], v[116:119], a[52:55], v[176:191]
  ds_read_b64_tr_b16 v[106:107], v5 offset:37376
  ds_read_b128 a[28:31], v4 offset:4096
  s_add_u32 s43, s43, 128
  v_mfma_f32_32x32x16_bf16 v[176:191], v[120:123], a[56:59], v[176:191]
  ds_read_b64_tr_b16 v[108:109], v5 offset:38912
  v_mfma_f32_32x32x16_bf16 v[176:191], v[124:127], a[60:63], v[176:191]
  ds_read_b64_tr_b16 v[110:111], v5 offset:39424
  s_waitcnt lgkmcnt(11)
  v_mfma_f32_32x32x16_bf16 v[128:143], v[96:99], a[0:3], v[128:143]
  s_add_u32 m0, s45, 0x10000
  ds_read_b64_tr_b16 v[112:113], v6 offset:32768
  buffer_load_dwordx4 v9, s[8:11], s43 offen lds
  s_waitcnt lgkmcnt(8)
  v_mfma_f32_32x32x16_bf16 v[128:143], v[100:103], a[4:7], v[128:143]
  ds_read_b64_tr_b16 v[114:115], v6 offset:33280
  s_waitcnt lgkmcnt(5)
  v_mfma_f32_32x32x16_bf16 v[128:143], v[104:107], a[8:11], v[128:143]
  ds_read_b64_tr_b16 v[116:117], v6 offset:34816
  buffer_load_dwordx4 v10, s[8:11], s43 offen offset:1024 lds
  s_waitcnt lgkmcnt(3)
  v_mfma_f32_32x32x16_bf16 v[128:143], v[108:111], a[12:15], v[128:143]
  ds_read_b64_tr_b16 v[118:119], v6 offset:35328
  v_mfma_f32_32x32x16_bf16 v[144:159], v[96:99], a[16:19], v[144:159]
  ds_read_b64_tr_b16 v[120:121], v6 offset:36864
  buffer_load_dwordx4 v11, s[8:11], s43 offen offset:2048 lds
  v_mfma_f32_32x32x16_bf16 v[144:159], v[100:103], a[20:23], v[144:159]
  ds_read_b64_tr_b16 v[122:123], v6 offset:37376
  v_mfma_f32_32x32x16_bf16 v[144:159], v[104:107], a[24:27], v[144:159]
  ds_read_b64_tr_b16 v[124:125], v6 offset:38912
  s_waitcnt vmcnt(13)
  ds_read_b128 a[32:35], v28
  buffer_load_dwordx4 v12, s[8:11], s43 offen offset:3072 lds
  v_mfma_f32_32x32x16_bf16 v[144:159], v[108:111], a[28:31], v[144:159]
  ds_read_b64_tr_b16 v[126:127], v6 offset:39424
  s_waitcnt vmcnt(22)
  s_barrier
  ds_read_b128 a[36:39], v29
  s_waitcnt lgkmcnt(8)
  v_mfma_f32_32x32x16_bf16 v[160:175], v[112:115], a[0:3], v[160:175]
  ds_read_b64_tr_b16 v[96:97], v5 offset:49152
  ds_read_b128 a[40:43], v30
  s_lshr_b32 s55, s46, 1
  s_add_u32 m0, s55, 0x1c000
  s_lshl_b32 s75, s41, 7
  s_add_u32 s75, s75, 0x4d00000
  s_waitcnt lgkmcnt(8)
  v_mfma_f32_32x32x16_bf16 v[160:175], v[116:119], a[4:7], v[160:175]
  ds_read_b64_tr_b16 v[98:99], v5 offset:49664
  ds_read_b128 a[44:47], v31
  buffer_load_dwordx4 v17, s[12:15], s44 offen lds
  buffer_load_dwordx4 v18, s[12:15], s44 offen offset:1024 lds
  v_lshlrev_b32 v25, 2, v27
  buffer_load_dword v24, v25, s[16:19], s75 offen sc1
  s_waitcnt lgkmcnt(8)
  v_mfma_f32_32x32x16_bf16 v[160:175], v[120:123], a[8:11], v[160:175]
  ds_read_b64_tr_b16 v[100:101], v5 offset:51200
  ds_read_b128 a[48:51], v28 offset:4096
  s_add_u32 s44, s44, 0x30000
  s_add_u32 m0, s45, 0x11000
  s_waitcnt lgkmcnt(7)
  v_mfma_f32_32x32x16_bf16 v[160:175], v[124:127], a[12:15], v[160:175]
  ds_read_b64_tr_b16 v[102:103], v5 offset:51712
  ds_read_b128 a[52:55], v29 offset:4096
  buffer_load_dwordx4 v13, s[8:11], s43 offen lds
  buffer_load_dwordx4 v14, s[8:11], s43 offen offset:1024 lds
  v_mfma_f32_32x32x16_bf16 v[176:191], v[112:115], a[16:19], v[176:191]
  ds_read_b64_tr_b16 v[104:105], v5 offset:53248
  ds_read_b128 a[56:59], v30 offset:4096
  buffer_load_dwordx4 v15, s[8:11], s43 offen offset:2048 lds
  buffer_load_dwordx4 v16, s[8:11], s43 offen offset:3072 lds
  v_mfma_f32_32x32x16_bf16 v[176:191], v[116:119], a[20:23], v[176:191]
  ds_read_b64_tr_b16 v[106:107], v5 offset:53760
  ds_read_b128 a[60:63], v31 offset:4096
  s_add_u32 s43, s43, 128
  v_mfma_f32_32x32x16_bf16 v[176:191], v[120:123], a[24:27], v[176:191]
  ds_read_b64_tr_b16 v[108:109], v5 offset:55296
  v_mfma_f32_32x32x16_bf16 v[176:191], v[124:127], a[28:31], v[176:191]
  ds_read_b64_tr_b16 v[110:111], v5 offset:55808
  s_waitcnt lgkmcnt(11)
  v_mfma_f32_32x32x16_bf16 v[128:143], v[96:99], a[32:35], v[128:143]
  s_add_u32 m0, s45, 0
  ds_read_b64_tr_b16 v[112:113], v6 offset:49152
  buffer_load_dwordx4 v9, s[8:11], s43 offen lds
  v_subrev_u32 v28, s98, v28
  s_waitcnt lgkmcnt(8)
  v_mfma_f32_32x32x16_bf16 v[128:143], v[100:103], a[36:39], v[128:143]
  ds_read_b64_tr_b16 v[114:115], v6 offset:49664
  v_subrev_u32 v29, s98, v29
  s_waitcnt lgkmcnt(5)
  v_mfma_f32_32x32x16_bf16 v[128:143], v[104:107], a[40:43], v[128:143]
  ds_read_b64_tr_b16 v[116:117], v6 offset:51200
  buffer_load_dwordx4 v10, s[8:11], s43 offen offset:1024 lds
  v_subrev_u32 v30, s98, v30
  s_waitcnt lgkmcnt(3)
  v_mfma_f32_32x32x16_bf16 v[128:143], v[108:111], a[44:47], v[128:143]
  ds_read_b64_tr_b16 v[118:119], v6 offset:51712
  v_subrev_u32 v31, s98, v31
  v_mfma_f32_32x32x16_bf16 v[144:159], v[96:99], a[48:51], v[144:159]
  ds_read_b64_tr_b16 v[120:121], v6 offset:53248
  buffer_load_dwordx4 v11, s[8:11], s43 offen offset:2048 lds
  v_mfma_f32_32x32x16_bf16 v[144:159], v[100:103], a[52:55], v[144:159]
  ds_read_b64_tr_b16 v[122:123], v6 offset:53760
  v_mfma_f32_32x32x16_bf16 v[144:159], v[104:107], a[56:59], v[144:159]
  ds_read_b64_tr_b16 v[124:125], v6 offset:55296
  s_waitcnt vmcnt(14)
  ds_read_b128 a[0:3], v1 offset:32768
  buffer_load_dwordx4 v12, s[8:11], s43 offen offset:3072 lds
  v_mfma_f32_32x32x16_bf16 v[144:159], v[108:111], a[60:63], v[144:159]
  ds_read_b64_tr_b16 v[126:127], v6 offset:55808
  s_waitcnt vmcnt(19)
  s_barrier
  ds_read_b128 a[4:7], v2 offset:32768
  s_waitcnt lgkmcnt(8)
  v_mfma_f32_32x32x16_bf16 v[160:175], v[112:115], a[32:35], v[160:175]
  ds_read_b64_tr_b16 v[96:97], v5
  ds_read_b128 a[8:11], v3 offset:32768
  s_lshr_b32 s55, s46, 1
  s_add_u32 m0, s55, 0x20000
  s_waitcnt lgkmcnt(8)
  v_mfma_f32_32x32x16_bf16 v[160:175], v[116:119], a[36:39], v[160:175]
  ds_read_b64_tr_b16 v[98:99], v5 offset:512
  ds_read_b128 a[12:15], v4 offset:32768
  buffer_load_dwordx4 v17, s[12:15], s44 offen lds
  buffer_load_dwordx4 v18, s[12:15], s44 offen offset:1024 lds
  s_waitcnt lgkmcnt(8)
  v_mfma_f32_32x32x16_bf16 v[160:175], v[120:123], a[40:43], v[160:175]
  ds_read_b64_tr_b16 v[100:101], v5 offset:2048
  ds_read_b128 a[16:19], v1 offset:36864
  s_add_u32 s44, s44, 0x30000
  s_add_u32 m0, s45, 0x1000
  s_waitcnt lgkmcnt(7)
  v_mfma_f32_32x32x16_bf16 v[160:175], v[124:127], a[44:47], v[160:175]
  ds_read_b64_tr_b16 v[102:103], v5 offset:2560
  ds_read_b128 a[20:23], v2 offset:36864
  buffer_load_dwordx4 v13, s[8:11], s43 offen lds
  buffer_load_dwordx4 v14, s[8:11], s43 offen offset:1024 lds
  v_mfma_f32_32x32x16_bf16 v[176:191], v[112:115], a[48:51], v[176:191]
  ds_read_b64_tr_b16 v[104:105], v5 offset:4096
  ds_read_b128 a[24:27], v3 offset:36864
  buffer_load_dwordx4 v15, s[8:11], s43 offen offset:2048 lds
  buffer_load_dwordx4 v16, s[8:11], s43 offen offset:3072 lds
  v_mfma_f32_32x32x16_bf16 v[176:191], v[116:119], a[52:55], v[176:191]
  ds_read_b64_tr_b16 v[106:107], v5 offset:4608
  ds_read_b128 a[28:31], v4 offset:36864
  s_add_u32 s43, s43, 128
  v_mfma_f32_32x32x16_bf16 v[176:191], v[120:123], a[56:59], v[176:191]
  ds_read_b64_tr_b16 v[108:109], v5 offset:6144
  v_mfma_f32_32x32x16_bf16 v[176:191], v[124:127], a[60:63], v[176:191]
  ds_read_b64_tr_b16 v[110:111], v5 offset:6656
  s_waitcnt lgkmcnt(11)
  v_mfma_f32_32x32x16_bf16 v[128:143], v[96:99], a[0:3], v[128:143]
  s_add_u32 m0, s99, 0
  ds_read_b64_tr_b16 v[112:113], v6
  buffer_load_dwordx4 v9, s[8:11], s43 offen lds
  s_waitcnt lgkmcnt(8)
  v_mfma_f32_32x32x16_bf16 v[128:143], v[100:103], a[4:7], v[128:143]
  ds_read_b64_tr_b16 v[114:115], v6 offset:512
  s_waitcnt vmcnt(15)
  v_cmp_eq_u32 vcc, s59, v24
  s_nop 3
  s_and_b32 s53, vcc_lo, 0xff
  s_cmp_eq_u32 s53, 0xff
  s_cbranch_scc0 L_spin_AK
L_spin_ret_AK:
  s_waitcnt lgkmcnt(5)
  v_mfma_f32_32x32x16_bf16 v[128:143], v[104:107], a[8:11], v[128:143]
  ds_read_b64_tr_b16 v[116:117], v6 offset:2048
  buffer_load_dwordx4 v10, s[8:11], s43 offen offset:1024 lds
  s_waitcnt lgkmcnt(3)
  v_mfma_f32_32x32x16_bf16 v[128:143], v[108:111], a[12:15], v[128:143]
  ds_read_b64_tr_b16 v[118:119], v6 offset:2560
  v_mfma_f32_32x32x16_bf16 v[144:159], v[96:99], a[16:19], v[144:159]
  ds_read_b64_tr_b16 v[120:121], v6 offset:4096
  buffer_load_dwordx4 v11, s[8:11], s43 offen offset:2048 lds
  v_mfma_f32_32x32x16_bf16 v[144:159], v[100:103], a[20:23], v[144:159]
  ds_read_b64_tr_b16 v[122:123], v6 offset:4608
  v_mfma_f32_32x32x16_bf16 v[144:159], v[104:107], a[24:27], v[144:159]
  ds_read_b64_tr_b16 v[124:125], v6 offset:6144
  s_waitcnt vmcnt(13)
  ds_read_b128 a[32:35], v28
  buffer_load_dwordx4 v12, s[8:11], s43 offen offset:3072 lds
  v_mfma_f32_32x32x16_bf16 v[144:159], v[108:111], a[28:31], v[144:159]
  ds_read_b64_tr_b16 v[126:127], v6 offset:6656
  s_waitcnt vmcnt(19)
  s_barrier
  ds_read_b128 a[36:39], v29
  s_waitcnt lgkmcnt(8)
  v_mfma_f32_32x32x16_bf16 v[160:175], v[112:115], a[0:3], v[160:175]
  ds_read_b64_tr_b16 v[96:97], v5 offset:16384
  ds_read_b128 a[40:43], v30
  s_lshr_b32 s55, s46, 1
  s_add_u32 m0, s55, 0x24000
  s_waitcnt lgkmcnt(8)
  v_mfma_f32_32x32x16_bf16 v[160:175], v[116:119], a[4:7], v[160:175]
  ds_read_b64_tr_b16 v[98:99], v5 offset:16896
  ds_read_b128 a[44:47], v31
  buffer_load_dwordx4 v17, s[12:15], s44 offen lds
  buffer_load_dwordx4 v18, s[12:15], s44 offen offset:1024 lds
  s_waitcnt lgkmcnt(8)
  v_mfma_f32_32x32x16_bf16 v[160:175], v[120:123], a[8:11], v[160:175]
  ds_read_b64_tr_b16 v[100:101], v5 offset:18432
  ds_read_b128 a[48:51], v28 offset:4096
  s_add_u32 s44, s44, 0x30000
  s_add_u32 m0, s99, 4096
  s_waitcnt lgkmcnt(7)
  v_mfma_f32_32x32x16_bf16 v[160:175], v[124:127], a[12:15], v[160:175]
  ds_read_b64_tr_b16 v[102:103], v5 offset:18944
  ds_read_b128 a[52:55], v29 offset:4096
  buffer_load_dwordx4 v13, s[8:11], s43 offen lds
  buffer_load_dwordx4 v14, s[8:11], s43 offen offset:1024 lds
  v_mfma_f32_32x32x16_bf16 v[176:191], v[112:115], a[16:19], v[176:191]
  ds_read_b64_tr_b16 v[104:105], v5 offset:20480
  ds_read_b128 a[56:59], v30 offset:4096
  buffer_load_dwordx4 v15, s[8:11], s43 offen offset:2048 lds
  buffer_load_dwordx4 v16, s[8:11], s43 offen offset:3072 lds
  v_mfma_f32_32x32x16_bf16 v[176:191], v[116:119], a[20:23], v[176:191]
  ds_read_b64_tr_b16 v[106:107], v5 offset:20992
  ds_read_b128 a[60:63], v31 offset:4096
  s_add_u32 s43, s43, 128
  v_mfma_f32_32x32x16_bf16 v[176:191], v[120:123], a[24:27], v[176:191]
  ds_read_b64_tr_b16 v[108:109], v5 offset:22528
  v_mfma_f32_32x32x16_bf16 v[176:191], v[124:127], a[28:31], v[176:191]
  ds_read_b64_tr_b16 v[110:111], v5 offset:23040
  s_waitcnt lgkmcnt(11)
  v_mfma_f32_32x32x16_bf16 v[128:143], v[96:99], a[32:35], v[128:143]
  ds_read_b64_tr_b16 v[112:113], v6 offset:16384
  v_add_u32 v28, s98, v28
  s_waitcnt lgkmcnt(8)
  v_mfma_f32_32x32x16_bf16 v[128:143], v[100:103], a[36:39], v[128:143]
  ds_read_b64_tr_b16 v[114:115], v6 offset:16896
  v_add_u32 v29, s98, v29
  s_waitcnt lgkmcnt(5)
  v_mfma_f32_32x32x16_bf16 v[128:143], v[104:107], a[40:43], v[128:143]
  ds_read_b64_tr_b16 v[116:117], v6 offset:18432
  v_add_u32 v30, s98, v30
  s_waitcnt lgkmcnt(3)
  v_mfma_f32_32x32x16_bf16 v[128:143], v[108:111], a[44:47], v[128:143]
  ds_read_b64_tr_b16 v[118:119], v6 offset:18944
  v_add_u32 v31, s98, v31
  v_mfma_f32_32x32x16_bf16 v[144:159], v[96:99], a[48:51], v[144:159]
  ds_read_b64_tr_b16 v[120:121], v6 offset:20480
  v_mfma_f32_32x32x16_bf16 v[144:159], v[100:103], a[52:55], v[144:159]
  ds_read_b64_tr_b16 v[122:123], v6 offset:20992
  v_mfma_f32_32x32x16_bf16 v[144:159], v[104:107], a[56:59], v[144:159]
  ds_read_b64_tr_b16 v[124:125], v6 offset:22528
  s_waitcnt vmcnt(10)
  ds_read_b128 a[0:3], v1
  v_mfma_f32_32x32x16_bf16 v[144:159], v[108:111], a[60:63], v[144:159]
  ds_read_b64_tr_b16 v[126:127], v6 offset:23040
  s_waitcnt vmcnt(14)
  s_barrier
  ds_read_b128 a[4:7], v2
  s_waitcnt lgkmcnt(8)
  v_mfma_f32_32x32x16_bf16 v[160:175], v[112:115], a[32:35], v[160:175]
  ds_read_b64_tr_b16 v[96:97], v5 offset:32768
  ds_read_b128 a[8:11], v3
  s_lshl_b32 s76, s42, 12
  v_add_u32 v25, s76, v21
  s_waitcnt lgkmcnt(8)
  v_mfma_f32_32x32x16_bf16 v[160:175], v[116:119], a[36:39], v[160:175]
  ds_read_b64_tr_b16 v[98:99], v5 offset:33280
  s_add_u32 m0, s68, 0
  ds_read_b128 a[12:15], v4
  buffer_load_dwordx4 v25, s[60:63], s72 offen sc1 lds
  buffer_load_dwordx4 v25, s[60:63], s72 offen offset:1024 sc1 lds
  s_waitcnt lgkmcnt(8)
  v_mfma_f32_32x32x16_bf16 v[160:175], v[120:123], a[40:43], v[160:175]
  ds_read_b64_tr_b16 v[100:101], v5 offset:34816
  ds_read_b128 a[16:19], v1 offset:4096
  buffer_load_dwordx4 v25, s[60:63], s72 offen offset:2048 sc1 lds
  buffer_load_dwordx4 v25, s[60:63], s72 offen offset:3072 sc1 lds
  s_add_u32 s72, s72, 16384
  s_waitcnt lgkmcnt(7)
  v_mfma_f32_32x32x16_bf16 v[160:175], v[124:127], a[44:47], v[160:175]
  ds_read_b64_tr_b16 v[102:103], v5 offset:35328
  s_add_u32 m0, s68, 0x4000
  ds_read_b128 a[20:23], v2 offset:4096
  buffer_load_dwordx4 v25, s[60:63], s72 offen sc1 lds
  buffer_load_dwordx4 v25, s[60:63], s72 offen offset:1024 sc1 lds
  v_mfma_f32_32x32x16_bf16 v[176:191], v[112:115], a[48:51], v[176:191]
  ds_read_b64_tr_b16 v[104:105], v5 offset:36864
  ds_read_b128 a[24:27], v3 offset:4096
  buffer_load_dwordx4 v25, s[60:63], s72 offen offset:2048 sc1 lds
  buffer_load_dwordx4 v25, s[60:63], s72 offen offset:3072 sc1 lds
  s_add_u32 s72, s72, 16384
  v_mfma_f32_32x32x16_bf16 v[176:191], v[116:119], a[52:55], v[176:191]
  ds_read_b64_tr_b16 v[106:107], v5 offset:37376
  ds_read_b128 a[28:31], v4 offset:4096
  v_mfma_f32_32x32x16_bf16 v[176:191], v[120:123], a[56:59], v[176:191]
  ds_read_b64_tr_b16 v[108:109], v5 offset:38912
  v_mfma_f32_32x32x16_bf16 v[176:191], v[124:127], a[60:63], v[176:191]
  ds_read_b64_tr_b16 v[110:111], v5 offset:39424
  s_waitcnt lgkmcnt(11)
  v_mfma_f32_32x32x16_bf16 v[128:143], v[96:99], a[0:3], v[128:143]
  ds_read_b64_tr_b16 v[112:113], v6 offset:32768
  s_waitcnt lgkmcnt(8)
  v_mfma_f32_32x32x16_bf16 v[128:143], v[100:103], a[4:7], v[128:143]
  ds_read_b64_tr_b16 v[114:115], v6 offset:33280
  s_waitcnt lgkmcnt(5)
  v_mfma_f32_32x32x16_bf16 v[128:143], v[104:107], a[8:11], v[128:143]
  ds_read_b64_tr_b16 v[116:117], v6 offset:34816
  s_waitcnt lgkmcnt(3)
  v_mfma_f32_32x32x16_bf16 v[128:143], v[108:111], a[12:15], v[128:143]
  ds_read_b64_tr_b16 v[118:119], v6 offset:35328
  v_mfma_f32_32x32x16_bf16 v[144:159], v[96:99], a[16:19], v[144:159]
  ds_read_b64_tr_b16 v[120:121], v6 offset:36864
  v_mfma_f32_32x32x16_bf16 v[144:159], v[100:103], a[20:23], v[144:159]
  ds_read_b64_tr_b16 v[122:123], v6 offset:37376
  v_mfma_f32_32x32x16_bf16 v[144:159], v[104:107], a[24:27], v[144:159]
  ds_read_b64_tr_b16 v[124:125], v6 offset:38912
  s_waitcnt vmcnt(8)
  ds_read_b128 a[32:35], v28
  v_mfma_f32_32x32x16_bf16 v[144:159], v[108:111], a[28:31], v[144:159]
  ds_read_b64_tr_b16 v[126:127], v6 offset:39424
  s_waitcnt vmcnt(12)
  s_barrier
  ds_read_b128 a[36:39], v29
  s_waitcnt lgkmcnt(8)
  v_mfma_f32_32x32x16_bf16 v[160:175], v[112:115], a[0:3], v[160:175]
  ds_read_b64_tr_b16 v[96:97], v5 offset:49152
  ds_read_b128 a[40:43], v30
  s_waitcnt lgkmcnt(8)
  v_mfma_f32_32x32x16_bf16 v[160:175], v[116:119], a[4:7], v[160:175]
  ds_read_b64_tr_b16 v[98:99], v5 offset:49664
  s_add_u32 m0, s69, 0
  ds_read_b128 a[44:47], v31
  buffer_load_dwordx4 v25, s[60:63], s72 offen sc1 lds
  buffer_load_dwordx4 v25, s[60:63], s72 offen offset:1024 sc1 lds
  s_waitcnt lgkmcnt(8)
  v_mfma_f32_32x32x16_bf16 v[160:175], v[120:123], a[8:11], v[160:175]
  ds_read_b64_tr_b16 v[100:101], v5 offset:51200
  ds_read_b128 a[48:51], v28 offset:4096
  buffer_load_dwordx4 v25, s[60:63], s72 offen offset:2048 sc1 lds
  buffer_load_dwordx4 v25, s[60:63], s72 offen offset:3072 sc1 lds
  s_add_u32 s72, s72, 16384
  s_waitcnt lgkmcnt(7)
  v_mfma_f32_32x32x16_bf16 v[160:175], v[124:127], a[12:15], v[160:175]
  ds_read_b64_tr_b16 v[102:103], v5 offset:51712
  s_add_u32 m0, s70, 0
  ds_read_b128 a[52:55], v29 offset:4096
  buffer_load_dwordx4 v25, s[64:67], s73 offen sc1 lds
  buffer_load_dwordx4 v25, s[64:67], s73 offen offset:1024 sc1 lds
  v_mfma_f32_32x32x16_bf16 v[176:191], v[112:115], a[16:19], v[176:191]
  ds_read_b64_tr_b16 v[104:105], v5 offset:53248
  ds_read_b128 a[56:59], v30 offset:4096
  buffer_load_dwordx4 v25, s[64:67], s73 offen offset:2048 sc1 lds
  buffer_load_dwordx4 v25, s[64:67], s73 offen offset:3072 sc1 lds
  s_add_u32 s73, s73, 16384
  v_mfma_f32_32x32x16_bf16 v[176:191], v[116:119], a[20:23], v[176:191]
  ds_read_b64_tr_b16 v[106:107], v5 offset:53760
  s_add_u32 m0, s70, 0x4000
  ds_read_b128 a[60:63], v31 offset:4096
  buffer_load_dwordx4 v25, s[64:67], s73 offen sc1 lds
  buffer_load_dwordx4 v25, s[64:67], s73 offen offset:1024 sc1 lds
  v_mfma_f32_32x32x16_bf16 v[176:191], v[120:123], a[24:27], v[176:191]
  ds_read_b64_tr_b16 v[108:109], v5 offset:55296
  buffer_load_dwordx4 v25, s[64:67], s73 offen offset:2048 sc1 lds
  buffer_load_dwordx4 v25, s[64:67], s73 offen offset:3072 sc1 lds
  s_add_u32 s73, s73, 16384
  v_mfma_f32_32x32x16_bf16 v[176:191], v[124:127], a[28:31], v[176:191]
  ds_read_b64_tr_b16 v[110:111], v5 offset:55808
  s_waitcnt lgkmcnt(11)
  v_mfma_f32_32x32x16_bf16 v[128:143], v[96:99], a[32:35], v[128:143]
  ds_read_b64_tr_b16 v[112:113], v6 offset:49152
  s_lshl_b32 s52, s40, 3
  s_lshl_b32 s53, s42, 1
  s_add_u32 s52, s52, s53
  s_waitcnt lgkmcnt(8)
  v_mfma_f32_32x32x16_bf16 v[128:143], v[100:103], a[36:39], v[128:143]
  ds_read_b64_tr_b16 v[114:115], v6 offset:49664
  s_lshr_b32 s53, s41, 3
  s_lshl_b32 s53, s53, 21
  s_and_b32 s54, s41, 7
  s_waitcnt lgkmcnt(5)
  v_mfma_f32_32x32x16_bf16 v[128:143], v[104:107], a[40:43], v[128:143]
  ds_read_b64_tr_b16 v[116:117], v6 offset:51200
  s_lshl_b32 s54, s54, 18
  s_add_u32 s53, s53, s54
  s_lshl_b32 s52, s52, 10
  s_waitcnt lgkmcnt(3)
  v_mfma_f32_32x32x16_bf16 v[128:143], v[108:111], a[44:47], v[128:143]
  ds_read_b64_tr_b16 v[118:119], v6 offset:51712
  s_add_u32 s52, s52, s53
  s_add_u32 s54, s52, 0x4000000
  s_add_u32 s55, s54, 1024
  v_mfma_f32_32x32x16_bf16 v[144:159], v[96:99], a[48:51], v[144:159]
  ds_read_b64_tr_b16 v[120:121], v6 offset:53248
  s_add_u32 s92, s54, 0
  s_add_u32 s93, s54, 0x10000
  v_mfma_f32_32x32x16_bf16 v[144:159], v[100:103], a[52:55], v[144:159]
  ds_read_b64_tr_b16 v[122:123], v6 offset:53760
  s_add_u32 s94, s55, 0
  s_add_u32 s95, s55, 0x10000
  v_mfma_f32_32x32x16_bf16 v[144:159], v[104:107], a[56:59], v[144:159]
  ds_read_b64_tr_b16 v[124:125], v6 offset:55296
  s_add_u32 s96, s54, 0x20000
  s_add_u32 s97, s54, 0x30000
  v_mfma_f32_32x32x16_bf16 v[144:159], v[108:111], a[60:63], v[144:159]
  ds_read_b64_tr_b16 v[126:127], v6 offset:55808
  s_add_u32 s98, s55, 0x20000
  s_add_u32 s99, s55, 0x30000
  s_waitcnt lgkmcnt(6)
  v_mfma_f32_32x32x16_bf16 v[160:175], v[112:115], a[32:35], v[160:175]
  v_cvt_pk_bf16_f32 v96, v128, v129
  v_cvt_pk_bf16_f32 v97, v130, v131
  v_cvt_pk_bf16_f32 v98, v132, v133
  v_cvt_pk_bf16_f32 v99, v134, v135
  v_cvt_pk_bf16_f32 v100, v136, v137
  s_waitcnt lgkmcnt(4)
  v_mfma_f32_32x32x16_bf16 v[160:175], v[116:119], a[36:39], v[160:175]
  v_cvt_pk_bf16_f32 v101, v138, v139
  v_cvt_pk_bf16_f32 v102, v140, v141
  v_cvt_pk_bf16_f32 v103, v142, v143
  s_waitcnt lgkmcnt(2)
  v_mfma_f32_32x32x16_bf16 v[160:175], v[120:123], a[40:43], v[160:175]
  s_waitcnt lgkmcnt(0)
  v_mfma_f32_32x32x16_bf16 v[160:175], v[124:127], a[44:47], v[160:175]
  v_mfma_f32_32x32x16_bf16 v[176:191], v[112:115], a[48:51], v[176:191]
  v_cvt_pk_bf16_f32 v104, v144, v145
  v_cvt_pk_bf16_f32 v105, v146, v147
  v_cvt_pk_bf16_f32 v106, v148, v149
  v_cvt_pk_bf16_f32 v107, v150, v151
  v_cvt_pk_bf16_f32 v108, v152, v153
  v_mfma_f32_32x32x16_bf16 v[176:191], v[116:119], a[52:55], v[176:191]
  v_cvt_pk_bf16_f32 v109, v154, v155
  v_cvt_pk_bf16_f32 v110, v156, v157
  v_cvt_pk_bf16_f32 v111, v158, v159
  v_mfma_f32_32x32x16_bf16 v[176:191], v[120:123], a[56:59], v[176:191]
  v_mfma_f32_32x32x16_bf16 v[176:191], v[124:127], a[60:63], v[176:191]
  s_waitcnt lgkmcnt(0)
  s_barrier
  v_cvt_pk_bf16_f32 v112, v160, v161
  v_cvt_pk_bf16_f32 v113, v162, v163
  v_cvt_pk_bf16_f32 v114, v164, v165
  v_cvt_pk_bf16_f32 v115, v166, v167
  v_cvt_pk_bf16_f32 v116, v168, v169
  v_cvt_pk_bf16_f32 v117, v170, v171
  v_cvt_pk_bf16_f32 v118, v172, v173
  v_cvt_pk_bf16_f32 v119, v174, v175
  s_nop 2
  v_cvt_pk_bf16_f32 v120, v176, v177
  v_cvt_pk_bf16_f32 v121, v178, v179
  v_cvt_pk_bf16_f32 v122, v180, v181
  v_cvt_pk_bf16_f32 v123, v182, v183
  v_cvt_pk_bf16_f32 v124, v184, v185
  v_cvt_pk_bf16_f32 v125, v186, v187
  v_cvt_pk_bf16_f32 v126, v188, v189
  v_cvt_pk_bf16_f32 v127, v190, v191
  v_mov_b32 v26, v21
  s_branch L_b_start2
L_proj_AV:
  s_waitcnt lgkmcnt(10)
  v_mfma_f32_32x32x16_bf16 v[128:143], a[0:3], v[96:99], 0
  ds_read_b64_tr_b16 v[112:113], v6
  s_lshl_b32 s99, s42, 14
  v_cvt_pk_bf16_f32 v58, v228, v229
  v_cvt_pk_bf16_f32 v59, v230, v231
  s_waitcnt lgkmcnt(8)
  v_mfma_f32_32x32x16_bf16 v[128:143], a[4:7], v[100:103], v[128:143]
  ds_read_b64_tr_b16 v[114:115], v6 offset:512
  s_add_u32 s99, s99, 0x1a000
  v_cvt_pk_bf16_f32 v60, v232, v233
  v_cvt_pk_bf16_f32 v61, v234, v235
  s_waitcnt lgkmcnt(6)
  v_mfma_f32_32x32x16_bf16 v[128:143], a[8:11], v[104:107], v[128:143]
  ds_read_b64_tr_b16 v[116:117], v6 offset:2048
  s_lshl_b32 s98, s42, 13
  v_cvt_pk_bf16_f32 v62, v236, v237
  v_cvt_pk_bf16_f32 v63, v238, v239
  s_waitcnt lgkmcnt(4)
  v_mfma_f32_32x32x16_bf16 v[128:143], a[12:15], v[108:111], v[128:143]
  ds_read_b64_tr_b16 v[118:119], v6 offset:2560
  s_add_u32 s98, s98, 40960
  v_cvt_pk_bf16_f32 v88, v240, v241
  v_cvt_pk_bf16_f32 v89, v242, v243
  v_mfma_f32_32x32x16_bf16 v[144:159], a[16:19], v[96:99], 0
  ds_read_b64_tr_b16 v[120:121], v6 offset:4096
  v_cvt_pk_bf16_f32 v90, v244, v245
  v_cvt_pk_bf16_f32 v91, v246, v247
  v_mfma_f32_32x32x16_bf16 v[144:159], a[20:23], v[100:103], v[144:159]
  ds_read_b64_tr_b16 v[122:123], v6 offset:4608
  v_cvt_pk_bf16_f32 v92, v248, v249
  v_cvt_pk_bf16_f32 v93, v250, v251
  v_mfma_f32_32x32x16_bf16 v[144:159], a[24:27], v[104:107], v[144:159]
  ds_read_b64_tr_b16 v[124:125], v6 offset:6144
  s_waitcnt vmcnt(12)
  ds_read_b128 a[32:35], v28
  v_cvt_pk_bf16_f32 v94, v252, v253
  v_cvt_pk_bf16_f32 v95, v254, v255
  s_waitcnt lgkmcnt(8)
  v_mfma_f32_32x32x16_bf16 v[144:159], a[28:31], v[108:111], v[144:159]
  ds_read_b64_tr_b16 v[126:127], v6 offset:6656
  s_waitcnt vmcnt(10)
  s_barrier
  ds_read_b128 a[36:39], v29
  s_waitcnt lgkmcnt(8)
  v_mfma_f32_32x32x16_bf16 v[160:175], a[0:3], v[112:115], 0
  ds_read_b64_tr_b16 v[96:97], v5 offset:16384
  ds_read_b128 a[40:43], v30
  s_lshr_b32 s55, s46, 1
  s_add_u32 m0, s55, 0x24000
  s_waitcnt lgkmcnt(8)
  v_mfma_f32_32x32x16_bf16 v[160:175], a[4:7], v[116:119], v[160:175]
  ds_read_b64_tr_b16 v[98:99], v5 offset:16896
  ds_read_b128 a[44:47], v31
  buffer_load_dwordx4 v17, s[12:15], s44 offen lds
  buffer_load_dwordx4 v18, s[12:15], s44 offen offset:1024 lds
  s_waitcnt lgkmcnt(8)
  v_mfma_f32_32x32x16_bf16 v[160:175], a[8:11], v[120:123], v[160:175]
  ds_read_b64_tr_b16 v[100:101], v5 offset:18432
  ds_read_b128 a[48:51], v28 offset:4096
  s_add_u32 s44, s44, 0x30000
  s_add_u32 m0, s99, 0
  s_waitcnt lgkmcnt(7)
  v_mfma_f32_32x32x16_bf16 v[160:175], a[12:15], v[124:127], v[160:175]
  ds_read_b64_tr_b16 v[102:103], v5 offset:18944
  ds_read_b128 a[52:55], v29 offset:4096
  buffer_load_dwordx4 v9, s[8:11], s43 offen lds
  buffer_load_dwordx4 v10, s[8:11], s43 offen offset:1024 lds
  v_mfma_f32_32x32x16_bf16 v[176:191], a[16:19], v[112:115], 0
  ds_read_b64_tr_b16 v[104:105], v5 offset:20480
  ds_read_b128 a[56:59], v30 offset:4096
  buffer_load_dwordx4 v11, s[8:11], s43 offen offset:2048 lds
  buffer_load_dwordx4 v12, s[8:11], s43 offen offset:3072 lds
  v_mfma_f32_32x32x16_bf16 v[176:191], a[20:23], v[116:119], v[176:191]
  ds_read_b64_tr_b16 v[106:107], v5 offset:20992
  s_add_u32 m0, s99, 4096
  ds_read_b128 a[60:63], v31 offset:4096
  buffer_load_dwordx4 v13, s[8:11], s43 offen lds
  v_mfma_f32_32x32x16_bf16 v[176:191], a[24:27], v[120:123], v[176:191]
  ds_read_b64_tr_b16 v[108:109], v5 offset:22528
  buffer_load_dwordx4 v14, s[8:11], s43 offen offset:1024 lds
  buffer_load_dwordx4 v15, s[8:11], s43 offen offset:2048 lds
  v_mfma_f32_32x32x16_bf16 v[176:191], a[28:31], v[124:127], v[176:191]
  ds_read_b64_tr_b16 v[110:111], v5 offset:23040
  buffer_load_dwordx4 v16, s[8:11], s43 offen offset:3072 lds
  s_add_u32 s43, s43, 128
  s_waitcnt lgkmcnt(11)
  v_mfma_f32_32x32x16_bf16 v[128:143], a[32:35], v[96:99], v[128:143]
  s_add_u32 m0, s45, 0x8000
  ds_read_b64_tr_b16 v[112:113], v6 offset:16384
  buffer_load_dwordx4 v9, s[8:11], s43 offen lds
  v_add_u32 v28, s98, v28
  s_lshl_b32 s76, s40, 2
  s_sub_u32 s85, 64, s76
  s_mul_i32 s76, s41, 0x80000
  s_waitcnt lgkmcnt(8)
  v_mfma_f32_32x32x16_bf16 v[128:143], a[36:39], v[100:103], v[128:143]
  ds_read_b64_tr_b16 v[114:115], v6 offset:16896
  v_add_u32 v29, s98, v29
  s_add_u32 s76, s76, 0x1000000
  s_add_u32 s60, s38, s76
  s_addc_u32 s61, s39, 0
  s_waitcnt lgkmcnt(5)
  v_mfma_f32_32x32x16_bf16 v[128:143], a[40:43], v[104:107], v[128:143]
  ds_read_b64_tr_b16 v[116:117], v6 offset:18432
  buffer_load_dwordx4 v10, s[8:11], s43 offen offset:1024 lds
  v_add_u32 v30, s98, v30
  s_and_b32 s61, s61, 0xffff
  s_lshl_b32 s62, s85, 13
  s_mov_b32 s63, 0x20000
  s_waitcnt lgkmcnt(3)
  v_mfma_f32_32x32x16_bf16 v[128:143], a[44:47], v[108:111], v[128:143]
  ds_read_b64_tr_b16 v[118:119], v6 offset:18944
  v_add_u32 v31, s98, v31
  s_mul_i32 s76, s41, 0x80000
  s_add_u32 s76, s76, 0x2000000
  s_add_u32 s64, s38, s76
  v_mfma_f32_32x32x16_bf16 v[144:159], a[48:51], v[96:99], v[144:159]
  ds_read_b64_tr_b16 v[120:121], v6 offset:20480
  buffer_load_dwordx4 v11, s[8:11], s43 offen offset:2048 lds
  s_addc_u32 s65, s39, 0
  s_and_b32 s65, s65, 0xffff
  s_lshl_b32 s66, s85, 13
  v_mfma_f32_32x32x16_bf16 v[144:159], a[52:55], v[100:103], v[144:159]
  ds_read_b64_tr_b16 v[122:123], v6 offset:20992
  s_mov_b32 s67, 0x20000
  s_mov_b32 s82, 0
  s_lshl_b32 s76, s42, 12
  v_mfma_f32_32x32x16_bf16 v[144:159], a[56:59], v[104:107], v[144:159]
  ds_read_b64_tr_b16 v[124:125], v6 offset:22528
  s_waitcnt vmcnt(15)
  ds_read_b128 a[0:3], v1
  buffer_load_dwordx4 v12, s[8:11], s43 offen offset:3072 lds
  s_add_u32 s68, s76, 0x8000
  s_add_u32 s69, s76, 0
  s_add_u32 s70, s76, 0x10000
  v_mfma_f32_32x32x16_bf16 v[144:159], a[60:63], v[108:111], v[144:159]
  ds_read_b64_tr_b16 v[126:127], v6 offset:23040
  s_waitcnt vmcnt(14)
  s_barrier
  ds_read_b128 a[4:7], v2
  s_add_u32 s71, s70, 0x8000
  s_mov_b32 s72, 0
  s_mov_b32 s73, 0
  s_waitcnt lgkmcnt(8)
  v_mfma_f32_32x32x16_bf16 v[160:175], a[32:35], v[112:115], v[160:175]
  ds_read_b64_tr_b16 v[96:97], v5 offset:32768
  ds_read_b128 a[8:11], v3
  s_lshr_b32 s55, s46, 1
  s_add_u32 m0, s55, 0x18000
  s_waitcnt lgkmcnt(8)
  v_mfma_f32_32x32x16_bf16 v[160:175], a[36:39], v[116:119], v[160:175]
  ds_read_b64_tr_b16 v[98:99], v5 offset:33280
  ds_read_b128 a[12:15], v4
  buffer_load_dwordx4 v17, s[12:15], s44 offen lds
  buffer_load_dwordx4 v18, s[12:15], s44 offen offset:1024 lds
  s_waitcnt lgkmcnt(8)
  v_mfma_f32_32x32x16_bf16 v[160:175], a[40:43], v[120:123], v[160:175]
  ds_read_b64_tr_b16 v[100:101], v5 offset:34816
  ds_read_b128 a[16:19], v1 offset:4096
  s_add_u32 s44, s44, 0x30000
  s_add_u32 m0, s45, 0x9000
  s_waitcnt lgkmcnt(7)
  v_mfma_f32_32x32x16_bf16 v[160:175], a[44:47], v[124:127], v[160:175]
  ds_read_b64_tr_b16 v[102:103], v5 offset:35328
  ds_read_b128 a[20:23], v2 offset:4096
  buffer_load_dwordx4 v13, s[8:11], s43 offen lds
  buffer_load_dwordx4 v14, s[8:11], s43 offen offset:1024 lds
  v_mfma_f32_32x32x16_bf16 v[176:191], a[48:51], v[112:115], v[176:191]
  ds_read_b64_tr_b16 v[104:105], v5 offset:36864
  ds_read_b128 a[24:27], v3 offset:4096
  buffer_load_dwordx4 v15, s[8:11], s43 offen offset:2048 lds
  buffer_load_dwordx4 v16, s[8:11], s43 offen offset:3072 lds
  v_mfma_f32_32x32x16_bf16 v[176:191], a[52:55], v[116:119], v[176:191]
  ds_read_b64_tr_b16 v[106:107], v5 offset:37376
  ds_read_b128 a[28:31], v4 offset:4096
  s_add_u32 s43, s43, 128
  v_mfma_f32_32x32x16_bf16 v[176:191], a[56:59], v[120:123], v[176:191]
  ds_read_b64_tr_b16 v[108:109], v5 offset:38912
  v_mfma_f32_32x32x16_bf16 v[176:191], a[60:63], v[124:127], v[176:191]
  ds_read_b64_tr_b16 v[110:111], v5 offset:39424
  s_waitcnt lgkmcnt(11)
  v_mfma_f32_32x32x16_bf16 v[128:143], a[0:3], v[96:99], v[128:143]
  s_add_u32 m0, s45, 0x10000
  ds_read_b64_tr_b16 v[112:113], v6 offset:32768
  buffer_load_dwordx4 v9, s[8:11], s43 offen lds
  s_waitcnt lgkmcnt(8)
  v_mfma_f32_32x32x16_bf16 v[128:143], a[4:7], v[100:103], v[128:143]
  ds_read_b64_tr_b16 v[114:115], v6 offset:33280
  s_waitcnt lgkmcnt(5)
  v_mfma_f32_32x32x16_bf16 v[128:143], a[8:11], v[104:107], v[128:143]
  ds_read_b64_tr_b16 v[116:117], v6 offset:34816
  buffer_load_dwordx4 v10, s[8:11], s43 offen offset:1024 lds
  s_waitcnt lgkmcnt(3)
  v_mfma_f32_32x32x16_bf16 v[128:143], a[12:15], v[108:111], v[128:143]
  ds_read_b64_tr_b16 v[118:119], v6 offset:35328
  v_mfma_f32_32x32x16_bf16 v[144:159], a[16:19], v[96:99], v[144:159]
  ds_read_b64_tr_b16 v[120:121], v6 offset:36864
  buffer_load_dwordx4 v11, s[8:11], s43 offen offset:2048 lds
  v_mfma_f32_32x32x16_bf16 v[144:159], a[20:23], v[100:103], v[144:159]
  ds_read_b64_tr_b16 v[122:123], v6 offset:37376
  v_mfma_f32_32x32x16_bf16 v[144:159], a[24:27], v[104:107], v[144:159]
  ds_read_b64_tr_b16 v[124:125], v6 offset:38912
  s_waitcnt vmcnt(13)
  ds_read_b128 a[32:35], v28
  buffer_load_dwordx4 v12, s[8:11], s43 offen offset:3072 lds
  v_mfma_f32_32x32x16_bf16 v[144:159], a[28:31], v[108:111], v[144:159]
  ds_read_b64_tr_b16 v[126:127], v6 offset:39424
  s_waitcnt vmcnt(22)
  s_barrier
  ds_read_b128 a[36:39], v29
  s_waitcnt lgkmcnt(8)
  v_mfma_f32_32x32x16_bf16 v[160:175], a[0:3], v[112:115], v[160:175]
  ds_read_b64_tr_b16 v[96:97], v5 offset:49152
  ds_read_b128 a[40:43], v30
  s_lshr_b32 s55, s46, 1
  s_add_u32 m0, s55, 0x1c000
  s_lshl_b32 s75, s41, 7
  s_add_u32 s75, s75, 0x4d00000
  s_waitcnt lgkmcnt(8)
  v_mfma_f32_32x32x16_bf16 v[160:175], a[4:7], v[116:119], v[160:175]
  ds_read_b64_tr_b16 v[98:99], v5 offset:49664
  ds_read_b128 a[44:47], v31
  buffer_load_dwordx4 v17, s[12:15], s44 offen lds
  buffer_load_dwordx4 v18, s[12:15], s44 offen offset:1024 lds
  v_lshlrev_b32 v25, 2, v27
  buffer_load_dword v24, v25, s[16:19], s75 offen sc1
  s_waitcnt lgkmcnt(8)
  v_mfma_f32_32x32x16_bf16 v[160:175], a[8:11], v[120:123], v[160:175]
  ds_read_b64_tr_b16 v[100:101], v5 offset:51200
  ds_read_b128 a[48:51], v28 offset:4096
  s_add_u32 s44, s44, 0x30000
  s_add_u32 m0, s45, 0x11000
  s_waitcnt lgkmcnt(7)
  v_mfma_f32_32x32x16_bf16 v[160:175], a[12:15], v[124:127], v[160:175]
  ds_read_b64_tr_b16 v[102:103], v5 offset:51712
  ds_read_b128 a[52:55], v29 offset:4096
  buffer_load_dwordx4 v13, s[8:11], s43 offen lds
  buffer_load_dwordx4 v14, s[8:11], s43 offen offset:1024 lds
  v_mfma_f32_32x32x16_bf16 v[176:191], a[16:19], v[112:115], v[176:191]
  ds_read_b64_tr_b16 v[104:105], v5 offset:53248
  ds_read_b128 a[56:59], v30 offset:4096
  buffer_load_dwordx4 v15, s[8:11], s43 offen offset:2048 lds
  buffer_load_dwordx4 v16, s[8:11], s43 offen offset:3072 lds
  v_mfma_f32_32x32x16_bf16 v[176:191], a[20:23], v[116:119], v[176:191]
  ds_read_b64_tr_b16 v[106:107], v5 offset:53760
  ds_read_b128 a[60:63], v31 offset:4096
  s_add_u32 s43, s43, 128
  v_mfma_f32_32x32x16_bf16 v[176:191], a[24:27], v[120:123], v[176:191]
  ds_read_b64_tr_b16 v[108:109], v5 offset:55296
  v_mfma_f32_32x32x16_bf16 v[176:191], a[28:31], v[124:127], v[176:191]
  ds_read_b64_tr_b16 v[110:111], v5 offset:55808
  s_waitcnt lgkmcnt(11)
  v_mfma_f32_32x32x16_bf16 v[128:143], a[32:35], v[96:99], v[128:143]
  s_add_u32 m0, s45, 0
  ds_read_b64_tr_b16 v[112:113], v6 offset:49152
  buffer_load_dwordx4 v9, s[8:11], s43 offen lds
  v_subrev_u32 v28, s98, v28
  s_waitcnt lgkmcnt(8)
  v_mfma_f32_32x32x16_bf16 v[128:143], a[36:39], v[100:103], v[128:143]
  ds_read_b64_tr_b16 v[114:115], v6 offset:49664
  v_subrev_u32 v29, s98, v29
  s_waitcnt lgkmcnt(5)
  v_mfma_f32_32x32x16_bf16 v[128:143], a[40:43], v[104:107], v[128:143]
  ds_read_b64_tr_b16 v[116:117], v6 offset:51200
  buffer_load_dwordx4 v10, s[8:11], s43 offen offset:1024 lds
  v_subrev_u32 v30, s98, v30
  s_waitcnt lgkmcnt(3)
  v_mfma_f32_32x32x16_bf16 v[128:143], a[44:47], v[108:111], v[128:143]
  ds_read_b64_tr_b16 v[118:119], v6 offset:51712
  v_subrev_u32 v31, s98, v31
  v_mfma_f32_32x32x16_bf16 v[144:159], a[48:51], v[96:99], v[144:159]
  ds_read_b64_tr_b16 v[120:121], v6 offset:53248
  buffer_load_dwordx4 v11, s[8:11], s43 offen offset:2048 lds
  v_mfma_f32_32x32x16_bf16 v[144:159], a[52:55], v[100:103], v[144:159]
  ds_read_b64_tr_b16 v[122:123], v6 offset:53760
  v_mfma_f32_32x32x16_bf16 v[144:159], a[56:59], v[104:107], v[144:159]
  ds_read_b64_tr_b16 v[124:125], v6 offset:55296
  s_waitcnt vmcnt(14)
  ds_read_b128 a[0:3], v1 offset:32768
  buffer_load_dwordx4 v12, s[8:11], s43 offen offset:3072 lds
  v_mfma_f32_32x32x16_bf16 v[144:159], a[60:63], v[108:111], v[144:159]
  ds_read_b64_tr_b16 v[126:127], v6 offset:55808
  s_waitcnt vmcnt(19)
  s_barrier
  ds_read_b128 a[4:7], v2 offset:32768
  s_waitcnt lgkmcnt(8)
  v_mfma_f32_32x32x16_bf16 v[160:175], a[32:35], v[112:115], v[160:175]
  ds_read_b64_tr_b16 v[96:97], v5
  ds_read_b128 a[8:11], v3 offset:32768
  s_lshr_b32 s55, s46, 1
  s_add_u32 m0, s55, 0x20000
  s_waitcnt lgkmcnt(8)
  v_mfma_f32_32x32x16_bf16 v[160:175], a[36:39], v[116:119], v[160:175]
  ds_read_b64_tr_b16 v[98:99], v5 offset:512
  ds_read_b128 a[12:15], v4 offset:32768
  buffer_load_dwordx4 v17, s[12:15], s44 offen lds
  buffer_load_dwordx4 v18, s[12:15], s44 offen offset:1024 lds
  s_waitcnt lgkmcnt(8)
  v_mfma_f32_32x32x16_bf16 v[160:175], a[40:43], v[120:123], v[160:175]
  ds_read_b64_tr_b16 v[100:101], v5 offset:2048
  ds_read_b128 a[16:19], v1 offset:36864
  s_add_u32 s44, s44, 0x30000
  s_add_u32 m0, s45, 0x1000
  s_waitcnt lgkmcnt(7)
  v_mfma_f32_32x32x16_bf16 v[160:175], a[44:47], v[124:127], v[160:175]
  ds_read_b64_tr_b16 v[102:103], v5 offset:2560
  ds_read_b128 a[20:23], v2 offset:36864
  buffer_load_dwordx4 v13, s[8:11], s43 offen lds
  buffer_load_dwordx4 v14, s[8:11], s43 offen offset:1024 lds
  v_mfma_f32_32x32x16_bf16 v[176:191], a[48:51], v[112:115], v[176:191]
  ds_read_b64_tr_b16 v[104:105], v5 offset:4096
  ds_read_b128 a[24:27], v3 offset:36864
  buffer_load_dwordx4 v15, s[8:11], s43 offen offset:2048 lds
  buffer_load_dwordx4 v16, s[8:11], s43 offen offset:3072 lds
  v_mfma_f32_32x32x16_bf16 v[176:191], a[52:55], v[116:119], v[176:191]
  ds_read_b64_tr_b16 v[106:107], v5 offset:4608
  ds_read_b128 a[28:31], v4 offset:36864
  s_add_u32 s43, s43, 128
  v_mfma_f32_32x32x16_bf16 v[176:191], a[56:59], v[120:123], v[176:191]
  ds_read_b64_tr_b16 v[108:109], v5 offset:6144
  v_mfma_f32_32x32x16_bf16 v[176:191], a[60:63], v[124:127], v[176:191]
  ds_read_b64_tr_b16 v[110:111], v5 offset:6656
  s_waitcnt lgkmcnt(11)
  v_mfma_f32_32x32x16_bf16 v[128:143], a[0:3], v[96:99], v[128:143]
  s_add_u32 m0, s99, 0
  ds_read_b64_tr_b16 v[112:113], v6
  buffer_load_dwordx4 v9, s[8:11], s43 offen lds
  s_waitcnt lgkmcnt(8)
  v_mfma_f32_32x32x16_bf16 v[128:143], a[4:7], v[100:103], v[128:143]
  ds_read_b64_tr_b16 v[114:115], v6 offset:512
  s_waitcnt vmcnt(15)
  v_cmp_eq_u32 vcc, s59, v24
  s_nop 3
  s_and_b32 s53, vcc_lo, 0xff
  s_cmp_eq_u32 s53, 0xff
  s_cbranch_scc0 L_spin_AV
L_spin_ret_AV:
  s_waitcnt lgkmcnt(5)
  v_mfma_f32_32x32x16_bf16 v[128:143], a[8:11], v[104:107], v[128:143]
  ds_read_b64_tr_b16 v[116:117], v6 offset:2048
  buffer_load_dwordx4 v10, s[8:11], s43 offen offset:1024 lds
  s_waitcnt lgkmcnt(3)
  v_mfma_f32_32x32x16_bf16 v[128:143], a[12:15], v[108:111], v[128:143]
  ds_read_b64_tr_b16 v[118:119], v6 offset:2560
  v_mfma_f32_32x32x16_bf16 v[144:159], a[16:19], v[96:99], v[144:159]
  ds_read_b64_tr_b16 v[120:121], v6 offset:4096
  buffer_load_dwordx4 v11, s[8:11], s43 offen offset:2048 lds
  v_mfma_f32_32x32x16_bf16 v[144:159], a[20:23], v[100:103], v[144:159]
  ds_read_b64_tr_b16 v[122:123], v6 offset:4608
  v_mfma_f32_32x32x16_bf16 v[144:159], a[24:27], v[104:107], v[144:159]
  ds_read_b64_tr_b16 v[124:125], v6 offset:6144
  s_waitcnt vmcnt(13)
  ds_read_b128 a[32:35], v28
  buffer_load_dwordx4 v12, s[8:11], s43 offen offset:3072 lds
  v_mfma_f32_32x32x16_bf16 v[144:159], a[28:31], v[108:111], v[144:159]
  ds_read_b64_tr_b16 v[126:127], v6 offset:6656
  s_waitcnt vmcnt(19)
  s_barrier
  ds_read_b128 a[36:39], v29
  s_waitcnt lgkmcnt(8)
  v_mfma_f32_32x32x16_bf16 v[160:175], a[0:3], v[112:115], v[160:175]
  ds_read_b64_tr_b16 v[96:97], v5 offset:16384
  ds_read_b128 a[40:43], v30
  s_lshr_b32 s55, s46, 1
  s_add_u32 m0, s55, 0x24000
  s_waitcnt lgkmcnt(8)
  v_mfma_f32_32x32x16_bf16 v[160:175], a[4:7], v[116:119], v[160:175]
  ds_read_b64_tr_b16 v[98:99], v5 offset:16896
  ds_read_b128 a[44:47], v31
  buffer_load_dwordx4 v17, s[12:15], s44 offen lds
  buffer_load_dwordx4 v18, s[12:15], s44 offen offset:1024 lds
  s_waitcnt lgkmcnt(8)
  v_mfma_f32_32x32x16_bf16 v[160:175], a[8:11], v[120:123], v[160:175]
  ds_read_b64_tr_b16 v[100:101], v5 offset:18432
  ds_read_b128 a[48:51], v28 offset:4096
  s_add_u32 s44, s44, 0x30000
  s_add_u32 m0, s99, 4096
  s_waitcnt lgkmcnt(7)
  v_mfma_f32_32x32x16_bf16 v[160:175], a[12:15], v[124:127], v[160:175]
  ds_read_b64_tr_b16 v[102:103], v5 offset:18944
  ds_read_b128 a[52:55], v29 offset:4096
  buffer_load_dwordx4 v13, s[8:11], s43 offen lds
  buffer_load_dwordx4 v14, s[8:11], s43 offen offset:1024 lds
  v_mfma_f32_32x32x16_bf16 v[176:191], a[16:19], v[112:115], v[176:191]
  ds_read_b64_tr_b16 v[104:105], v5 offset:20480
  ds_read_b128 a[56:59], v30 offset:4096
  buffer_load_dwordx4 v15, s[8:11], s43 offen offset:2048 lds
  buffer_load_dwordx4 v16, s[8:11], s43 offen offset:3072 lds
  v_mfma_f32_32x32x16_bf16 v[176:191], a[20:23], v[116:119], v[176:191]
  ds_read_b64_tr_b16 v[106:107], v5 offset:20992
  ds_read_b128 a[60:63], v31 offset:4096
  s_add_u32 s43, s43, 128
  v_mfma_f32_32x32x16_bf16 v[176:191], a[24:27], v[120:123], v[176:191]
  ds_read_b64_tr_b16 v[108:109], v5 offset:22528
  v_mfma_f32_32x32x16_bf16 v[176:191], a[28:31], v[124:127], v[176:191]
  ds_read_b64_tr_b16 v[110:111], v5 offset:23040
  s_waitcnt lgkmcnt(11)
  v_mfma_f32_32x32x16_bf16 v[128:143], a[32:35], v[96:99], v[128:143]
  ds_read_b64_tr_b16 v[112:113], v6 offset:16384
  v_add_u32 v28, s98, v28
  s_waitcnt lgkmcnt(8)
  v_mfma_f32_32x32x16_bf16 v[128:143], a[36:39], v[100:103], v[128:143]
  ds_read_b64_tr_b16 v[114:115], v6 offset:16896
  v_add_u32 v29, s98, v29
  s_waitcnt lgkmcnt(5)
  v_mfma_f32_32x32x16_bf16 v[128:143], a[40:43], v[104:107], v[128:143]
  ds_read_b64_tr_b16 v[116:117], v6 offset:18432
  v_add_u32 v30, s98, v30
  s_waitcnt lgkmcnt(3)
  v_mfma_f32_32x32x16_bf16 v[128:143], a[44:47], v[108:111], v[128:143]
  ds_read_b64_tr_b16 v[118:119], v6 offset:18944
  v_add_u32 v31, s98, v31
  v_mfma_f32_32x32x16_bf16 v[144:159], a[48:51], v[96:99], v[144:159]
  ds_read_b64_tr_b16 v[120:121], v6 offset:20480
  v_mfma_f32_32x32x16_bf16 v[144:159], a[52:55], v[100:103], v[144:159]
  ds_read_b64_tr_b16 v[122:123], v6 offset:20992
  v_mfma_f32_32x32x16_bf16 v[144:159], a[56:59], v[104:107], v[144:159]
  ds_read_b64_tr_b16 v[124:125], v6 offset:22528
  s_waitcnt vmcnt(10)
  ds_read_b128 a[0:3], v1
  v_mfma_f32_32x32x16_bf16 v[144:159], a[60:63], v[108:111], v[144:159]
  ds_read_b64_tr_b16 v[126:127], v6 offset:23040
  s_waitcnt vmcnt(14)
  s_barrier
  ds_read_b128 a[4:7], v2
  s_waitcnt lgkmcnt(8)
  v_mfma_f32_32x32x16_bf16 v[160:175], a[32:35], v[112:115], v[160:175]
  ds_read_b64_tr_b16 v[96:97], v5 offset:32768
  ds_read_b128 a[8:11], v3
  s_lshl_b32 s76, s42, 12
  v_add_u32 v25, s76, v21
  s_waitcnt lgkmcnt(8)
  v_mfma_f32_32x32x16_bf16 v[160:175], a[36:39], v[116:119], v[160:175]
  ds_read_b64_tr_b16 v[98:99], v5 offset:33280
  s_add_u32 m0, s68, 0
  ds_read_b128 a[12:15], v4
  buffer_load_dwordx4 v25, s[60:63], s72 offen sc1 lds
  buffer_load_dwordx4 v25, s[60:63], s72 offen offset:1024 sc1 lds
  s_waitcnt lgkmcnt(8)
  v_mfma_f32_32x32x16_bf16 v[160:175], a[40:43], v[120:123], v[160:175]
  ds_read_b64_tr_b16 v[100:101], v5 offset:34816
  ds_read_b128 a[16:19], v1 offset:4096
  buffer_load_dwordx4 v25, s[60:63], s72 offen offset:2048 sc1 lds
  buffer_load_dwordx4 v25, s[60:63], s72 offen offset:3072 sc1 lds
  s_add_u32 s72, s72, 16384
  s_waitcnt lgkmcnt(7)
  v_mfma_f32_32x32x16_bf16 v[160:175], a[44:47], v[124:127], v[160:175]
  ds_read_b64_tr_b16 v[102:103], v5 offset:35328
  s_add_u32 m0, s68, 0x4000
  ds_read_b128 a[20:23], v2 offset:4096
  buffer_load_dwordx4 v25, s[60:63], s72 offen sc1 lds
  buffer_load_dwordx4 v25, s[60:63], s72 offen offset:1024 sc1 lds
  v_mfma_f32_32x32x16_bf16 v[176:191], a[48:51], v[112:115], v[176:191]
  ds_read_b64_tr_b16 v[104:105], v5 offset:36864
  ds_read_b128 a[24:27], v3 offset:4096
  buffer_load_dwordx4 v25, s[60:63], s72 offen offset:2048 sc1 lds
  buffer_load_dwordx4 v25, s[60:63], s72 offen offset:3072 sc1 lds
  s_add_u32 s72, s72, 16384
  v_mfma_f32_32x32x16_bf16 v[176:191], a[52:55], v[116:119], v[176:191]
  ds_read_b64_tr_b16 v[106:107], v5 offset:37376
  ds_read_b128 a[28:31], v4 offset:4096
  v_mfma_f32_32x32x16_bf16 v[176:191], a[56:59], v[120:123], v[176:191]
  ds_read_b64_tr_b16 v[108:109], v5 offset:38912
  v_mfma_f32_32x32x16_bf16 v[176:191], a[60:63], v[124:127], v[176:191]
  ds_read_b64_tr_b16 v[110:111], v5 offset:39424
  s_waitcnt lgkmcnt(11)
  v_mfma_f32_32x32x16_bf16 v[128:143], a[0:3], v[96:99], v[128:143]
  ds_read_b64_tr_b16 v[112:113], v6 offset:32768
  s_waitcnt lgkmcnt(8)
  v_mfma_f32_32x32x16_bf16 v[128:143], a[4:7], v[100:103], v[128:143]
  ds_read_b64_tr_b16 v[114:115], v6 offset:33280
  s_waitcnt lgkmcnt(5)
  v_mfma_f32_32x32x16_bf16 v[128:143], a[8:11], v[104:107], v[128:143]
  ds_read_b64_tr_b16 v[116:117], v6 offset:34816
  s_waitcnt lgkmcnt(3)
  v_mfma_f32_32x32x16_bf16 v[128:143], a[12:15], v[108:111], v[128:143]
  ds_read_b64_tr_b16 v[118:119], v6 offset:35328
  v_mfma_f32_32x32x16_bf16 v[144:159], a[16:19], v[96:99], v[144:159]
  ds_read_b64_tr_b16 v[120:121], v6 offset:36864
  v_mfma_f32_32x32x16_bf16 v[144:159], a[20:23], v[100:103], v[144:159]
  ds_read_b64_tr_b16 v[122:123], v6 offset:37376
  v_mfma_f32_32x32x16_bf16 v[144:159], a[24:27], v[104:107], v[144:159]
  ds_read_b64_tr_b16 v[124:125], v6 offset:38912
  s_waitcnt vmcnt(8)
  ds_read_b128 a[32:35], v28
  v_mfma_f32_32x32x16_bf16 v[144:159], a[28:31], v[108:111], v[144:159]
  ds_read_b64_tr_b16 v[126:127], v6 offset:39424
  s_waitcnt vmcnt(12)
  s_barrier
  ds_read_b128 a[36:39], v29
  s_waitcnt lgkmcnt(8)
  v_mfma_f32_32x32x16_bf16 v[160:175], a[0:3], v[112:115], v[160:175]
  ds_read_b64_tr_b16 v[96:97], v5 offset:49152
  ds_read_b128 a[40:43], v30
  s_waitcnt lgkmcnt(8)
  v_mfma_f32_32x32x16_bf16 v[160:175], a[4:7], v[116:119], v[160:175]
  ds_read_b64_tr_b16 v[98:99], v5 offset:49664
  s_add_u32 m0, s69, 0
  ds_read_b128 a[44:47], v31
  buffer_load_dwordx4 v25, s[60:63], s72 offen sc1 lds
  buffer_load_dwordx4 v25, s[60:63], s72 offen offset:1024 sc1 lds
  s_waitcnt lgkmcnt(8)
  v_mfma_f32_32x32x16_bf16 v[160:175], a[8:11], v[120:123], v[160:175]
  ds_read_b64_tr_b16 v[100:101], v5 offset:51200
  ds_read_b128 a[48:51], v28 offset:4096
  buffer_load_dwordx4 v25, s[60:63], s72 offen offset:2048 sc1 lds
  buffer_load_dwordx4 v25, s[60:63], s72 offen offset:3072 sc1 lds
  s_add_u32 s72, s72, 16384
  s_waitcnt lgkmcnt(7)
  v_mfma_f32_32x32x16_bf16 v[160:175], a[12:15], v[124:127], v[160:175]
  ds_read_b64_tr_b16 v[102:103], v5 offset:51712
  s_add_u32 m0, s70, 0
  ds_read_b128 a[52:55], v29 offset:4096
  buffer_load_dwordx4 v25, s[64:67], s73 offen sc1 lds
  buffer_load_dwordx4 v25, s[64:67], s73 offen offset:1024 sc1 lds
  v_mfma_f32_32x32x16_bf16 v[176:191], a[16:19], v[112:115], v[176:191]
  ds_read_b64_tr_b16 v[104:105], v5 offset:53248
  ds_read_b128 a[56:59], v30 offset:4096
  buffer_load_dwordx4 v25, s[64:67], s73 offen offset:2048 sc1 lds
  buffer_load_dwordx4 v25, s[64:67], s73 offen offset:3072 sc1 lds
  s_add_u32 s73, s73, 16384
  v_mfma_f32_32x32x16_bf16 v[176:191], a[20:23], v[116:119], v[176:191]
  ds_read_b64_tr_b16 v[106:107], v5 offset:53760
  s_add_u32 m0, s70, 0x4000
  ds_read_b128 a[60:63], v31 offset:4096
  buffer_load_dwordx4 v25, s[64:67], s73 offen sc1 lds
  buffer_load_dwordx4 v25, s[64:67], s73 offen offset:1024 sc1 lds
  v_mfma_f32_32x32x16_bf16 v[176:191], a[24:27], v[120:123], v[176:191]
  ds_read_b64_tr_b16 v[108:109], v5 offset:55296
  buffer_load_dwordx4 v25, s[64:67], s73 offen offset:2048 sc1 lds
  buffer_load_dwordx4 v25, s[64:67], s73 offen offset:3072 sc1 lds
  s_add_u32 s73, s73, 16384
  v_mfma_f32_32x32x16_bf16 v[176:191], a[28:31], v[124:127], v[176:191]
  ds_read_b64_tr_b16 v[110:111], v5 offset:55808
  s_waitcnt lgkmcnt(11)
  v_mfma_f32_32x32x16_bf16 v[128:143], a[32:35], v[96:99], v[128:143]
  ds_read_b64_tr_b16 v[112:113], v6 offset:49152
  s_lshl_b32 s52, s40, 3
  s_lshl_b32 s53, s42, 1
  s_add_u32 s52, s52, s53
  s_waitcnt lgkmcnt(8)
  v_mfma_f32_32x32x16_bf16 v[128:143], a[36:39], v[100:103], v[128:143]
  ds_read_b64_tr_b16 v[114:115], v6 offset:49664
  s_lshr_b32 s53, s41, 3
  s_lshl_b32 s53, s53, 21
  s_and_b32 s54, s41, 7
  s_waitcnt lgkmcnt(5)
  v_mfma_f32_32x32x16_bf16 v[128:143], a[40:43], v[104:107], v[128:143]
  ds_read_b64_tr_b16 v[116:117], v6 offset:51200
  s_lshl_b32 s54, s54, 18
  s_add_u32 s53, s53, s54
  s_lshl_b32 s52, s52, 10
  s_waitcnt lgkmcnt(3)
  v_mfma_f32_32x32x16_bf16 v[128:143], a[44:47], v[108:111], v[128:143]
  ds_read_b64_tr_b16 v[118:119], v6 offset:51712
  s_add_u32 s52, s52, s53
  s_add_u32 s54, s52, 0x4000000
  s_add_u32 s55, s54, 1024
  v_mfma_f32_32x32x16_bf16 v[144:159], a[48:51], v[96:99], v[144:159]
  ds_read_b64_tr_b16 v[120:121], v6 offset:53248
  s_add_u32 s92, s54, 0
  s_add_u32 s93, s54, 0x200
  v_mfma_f32_32x32x16_bf16 v[144:159], a[52:55], v[100:103], v[144:159]
  ds_read_b64_tr_b16 v[122:123], v6 offset:53760
  s_add_u32 s94, s55, 0
  s_add_u32 s95, s55, 0x200
  v_mfma_f32_32x32x16_bf16 v[144:159], a[56:59], v[104:107], v[144:159]
  ds_read_b64_tr_b16 v[124:125], v6 offset:55296
  s_add_u32 s96, s54, 0x20000
  s_add_u32 s97, s54, 0x20200
  v_mfma_f32_32x32x16_bf16 v[144:159], a[60:63], v[108:111], v[144:159]
  ds_read_b64_tr_b16 v[126:127], v6 offset:55808
  s_add_u32 s98, s55, 0x20000
  s_add_u32 s99, s55, 0x20200
  s_waitcnt lgkmcnt(6)
  v_mfma_f32_32x32x16_bf16 v[160:175], a[32:35], v[112:115], v[160:175]
  v_cvt_pk_bf16_f32 v96, v128, v129
  v_cvt_pk_bf16_f32 v97, v130, v131
  v_cvt_pk_bf16_f32 v98, v132, v133
  v_cvt_pk_bf16_f32 v99, v134, v135
  v_cvt_pk_bf16_f32 v100, v136, v137
  s_waitcnt lgkmcnt(4)
  v_mfma_f32_32x32x16_bf16 v[160:175], a[36:39], v[116:119], v[160:175]
  v_cvt_pk_bf16_f32 v101, v138, v139
  v_cvt_pk_bf16_f32 v102, v140, v141
  v_cvt_pk_bf16_f32 v103, v142, v143
  s_waitcnt lgkmcnt(2)
  v_mfma_f32_32x32x16_bf16 v[160:175], a[40:43], v[120:123], v[160:175]
  s_waitcnt lgkmcnt(0)
  v_mfma_f32_32x32x16_bf16 v[160:175], a[44:47], v[124:127], v[160:175]
  v_mfma_f32_32x32x16_bf16 v[176:191], a[48:51], v[112:115], v[176:191]
  v_cvt_pk_bf16_f32 v104, v144, v145
  v_cvt_pk_bf16_f32 v105, v146, v147
  v_cvt_pk_bf16_f32 v106, v148, v149
  v_cvt_pk_bf16_f32 v107, v150, v151
  v_cvt_pk_bf16_f32 v108, v152, v153
  v_mfma_f32_32x32x16_bf16 v[176:191], a[52:55], v[116:119], v[176:191]
  v_cvt_pk_bf16_f32 v109, v154, v155
  v_cvt_pk_bf16_f32 v110, v156, v157
  v_cvt_pk_bf16_f32 v111, v158, v159
  v_mfma_f32_32x32x16_bf16 v[176:191], a[56:59], v[120:123], v[176:191]
  v_mfma_f32_32x32x16_bf16 v[176:191], a[60:63], v[124:127], v[176:191]
  s_waitcnt lgkmcnt(0)
  s_barrier
  v_cvt_pk_bf16_f32 v112, v160, v161
  v_cvt_pk_bf16_f32 v113, v162, v163
  v_cvt_pk_bf16_f32 v114, v164, v165
  v_cvt_pk_bf16_f32 v115, v166, v167
  v_cvt_pk_bf16_f32 v116, v168, v169
  v_cvt_pk_bf16_f32 v117, v170, v171
  v_cvt_pk_bf16_f32 v118, v172, v173
  v_cvt_pk_bf16_f32 v119, v174, v175
  s_nop 2
  v_cvt_pk_bf16_f32 v120, v176, v177
  v_cvt_pk_bf16_f32 v121, v178, v179
  v_cvt_pk_bf16_f32 v122, v180, v181
  v_cvt_pk_bf16_f32 v123, v182, v183
  v_cvt_pk_bf16_f32 v124, v184, v185
  v_cvt_pk_bf16_f32 v125, v186, v187
  v_cvt_pk_bf16_f32 v126, v188, v189
  v_cvt_pk_bf16_f32 v127, v190, v191
  v_bfe_u32 v22, v27, 4, 1
  v_lshlrev_b32 v22, 16, v22
  v_lshrrev_b32 v23, 5, v27
  v_lshl_add_u32 v22, v23, 8, v22
  v_and_b32 v23, 15, v27
  v_lshl_add_u32 v26, v23, 4, v22
  s_branch L_b_start2
L_proj_TR:
  v_cvt_pk_bf16_f32 v58, v228, v229
  v_cvt_pk_bf16_f32 v59, v230, v231
  v_cvt_pk_bf16_f32 v60, v232, v233
  v_cvt_pk_bf16_f32 v61, v234, v235
  v_cvt_pk_bf16_f32 v62, v236, v237
  v_cvt_pk_bf16_f32 v63, v238, v239
  v_cvt_pk_bf16_f32 v88, v240, v241
  v_cvt_pk_bf16_f32 v89, v242, v243
  v_cvt_pk_bf16_f32 v90, v244, v245
  v_cvt_pk_bf16_f32 v91, v246, v247
  v_cvt_pk_bf16_f32 v92, v248, v249
  v_cvt_pk_bf16_f32 v93, v250, v251
  v_cvt_pk_bf16_f32 v94, v252, v253
  v_cvt_pk_bf16_f32 v95, v254, v255
  s_lshl_b32 s76, s40, 2
  s_sub_u32 s85, 64, s76
  s_mul_i32 s76, s41, 0x80000
  s_add_u32 s76, s76, 0x1000000
  s_add_u32 s60, s38, s76
  s_addc_u32 s61, s39, 0
  s_and_b32 s61, s61, 0xffff
  s_lshl_b32 s62, s85, 13
  s_mov_b32 s63, 0x20000
  s_mul_i32 s76, s41, 0x80000
  s_add_u32 s76, s76, 0x2000000
  s_add_u32 s64, s38, s76
  s_addc_u32 s65, s39, 0
  s_and_b32 s65, s65, 0xffff
  s_lshl_b32 s66, s85, 13
  s_mov_b32 s67, 0x20000
  s_mov_b32 s82, 0
  s_lshl_b32 s76, s42, 12
  s_add_u32 s68, s76, 0x8000
  s_add_u32 s69, s76, 0
  s_add_u32 s70, s76, 0x10000
  s_add_u32 s71, s70, 0x8000
  s_mov_b32 s72, 0
  s_mov_b32 s73, 0
  s_waitcnt vmcnt(0)
  s_waitcnt lgkmcnt(0)
  s_barrier
  s_lshl_b32 s58, s40, 3
  s_add_u32 s58, s58, s41
  s_sub_u32 s58, s58, 24
  v_and_b32 v22, 15, v27
  v_lshrrev_b32 v23, 2, v22
  v_lshrrev_b32 v24, 5, v27
  v_lshl_add_u32 v24, v24, 2, v23
  v_lshlrev_b32 v24, 8, v24
  v_bfe_u32 v25, v27, 4, 1
  v_lshl_add_u32 v24, v25, 5, v24
  v_and_b32 v25, 3, v22
  v_lshl_add_u32 v24, v25, 3, v24
  v_add_u32 v24, 0x18000, v24
  v_xor_b32 v25, 0, v23
  v_lshl_add_u32 v5, v25, 6, v24
  v_xor_b32 v25, 1, v23
  v_lshl_add_u32 v6, v25, 6, v24
  v_xor_b32 v25, 2, v23
  v_lshl_add_u32 v7, v25, 6, v24
  v_xor_b32 v25, 3, v23
  v_lshl_add_u32 v8, v25, 6, v24
  v_lshrrev_b32 v22, 4, v27
  v_lshlrev_b32 v23, 2, v22
  v_and_b32 v24, 15, v27
  v_xor_b32 v23, v23, v24
  v_mul_u32_u24 v22, 0x400, v22
  v_lshl_add_u32 v22, v23, 4, v22
  v_add_u32 v17, 0, v22
  v_add_u32 v18, 0xc00, v22
  v_add_u32 v19, 0x1800, v22
  v_add_u32 v20, 0x2400, v22
  s_mov_b32 s12, s36
  s_and_b32 s13, s37, 0xffff
  s_mov_b32 s14, 0x400000
  s_mov_b32 s15, 0x20000
  s_lshl_b32 s44, s58, 16
  s_lshl_b32 s52, s42, 14
  s_add_u32 s44, s44, s52
  s_add_u32 m0, s46, 0x18000
  s_nop 0
  buffer_load_dwordx4 v17, s[12:15], s44 offen lds
  buffer_load_dwordx4 v18, s[12:15], s44 offen offset:1024 lds
  buffer_load_dwordx4 v19, s[12:15], s44 offen offset:2048 lds
  buffer_load_dwordx4 v20, s[12:15], s44 offen offset:3072 lds
  s_add_u32 s44, s44, 256
  s_add_u32 m0, s46, 0x1c000
  s_nop 0
  buffer_load_dwordx4 v17, s[12:15], s44 offen lds
  buffer_load_dwordx4 v18, s[12:15], s44 offen offset:1024 lds
  buffer_load_dwordx4 v19, s[12:15], s44 offen offset:2048 lds
  buffer_load_dwordx4 v20, s[12:15], s44 offen offset:3072 lds
  s_add_u32 s44, s44, 256
  s_add_u32 m0, s46, 0x20000
  s_nop 0
  buffer_load_dwordx4 v17, s[12:15], s44 offen lds
  buffer_load_dwordx4 v18, s[12:15], s44 offen offset:1024 lds
  buffer_load_dwordx4 v19, s[12:15], s44 offen offset:2048 lds
  buffer_load_dwordx4 v20, s[12:15], s44 offen offset:3072 lds
  s_add_u32 s44, s44, 256
  s_add_u32 m0, s46, 0x24000
  s_nop 0
  buffer_load_dwordx4 v17, s[12:15], s44 offen lds
  buffer_load_dwordx4 v18, s[12:15], s44 offen offset:1024 lds
  buffer_load_dwordx4 v19, s[12:15], s44 offen offset:2048 lds
  buffer_load_dwordx4 v20, s[12:15], s44 offen offset:3072 lds
  s_add_u32 s44, s44, 256
  s_mov_b32 s12, s24
  s_and_b32 s13, s25, 0xffff
  s_mov_b32 s14, 0x80000
  s_mov_b32 s15, 0x20000
  s_lshr_b32 s52, s58, 2
  s_and_b32 s52, s52, 7
  s_lshl_b32 s44, s52, 16
  s_and_b32 s53, s58, 3
  s_lshl_b32 s53, s53, 8
  s_add_u32 s44, s44, s53
  s_lshl_b32 s52, s42, 14
  s_add_u32 s44, s44, s52
  s_mov_b32 m0, s46
  s_nop 0
  buffer_load_dwordx4 v17, s[12:15], s44 offen lds
  buffer_load_dwordx4 v18, s[12:15], s44 offen offset:1024 lds
  buffer_load_dwordx4 v19, s[12:15], s44 offen offset:2048 lds
  buffer_load_dwordx4 v20, s[12:15], s44 offen offset:3072 lds
  s_waitcnt vmcnt(0)
  s_barrier
  s_lshl_b32 s75, s41, 7
  s_add_u32 s75, s75, 0x4d00000
  v_lshlrev_b32 v10, 2, v27
  buffer_load_dword v9, v10, s[16:19], s75 offen sc1
  v_and_b32 v22, 15, v27
  v_lshrrev_b32 v23, 2, v22
  v_xor_b32 v23, s42, v23
  v_lshlrev_b32 v23, 6, v23
  v_lshrrev_b32 v24, 2, v22
  v_lshlrev_b32 v24, 6, v24
  v_sub_u32 v24, v5, v24
  v_add_u32 v25, v24, v23
  v_subrev_u32 v26, 0x18000, v25
  s_lshl_b32 s52, s42, 18
  s_lshl_b32 s53, s58, 12
  s_add_u32 s52, s52, s53
  s_add_u32 s54, s52, 0x4800000
  ds_read_b64_tr_b16 v[128:129], v25
  ds_read_b64_tr_b16 v[130:131], v25 offset:2048
  ds_read_b64_tr_b16 v[132:133], v25 offset:4096
  ds_read_b64_tr_b16 v[134:135], v25 offset:6144
  ds_read_b64_tr_b16 v[136:137], v25 offset:8192
  ds_read_b64_tr_b16 v[138:139], v25 offset:10240
  ds_read_b64_tr_b16 v[140:141], v25 offset:12288
  ds_read_b64_tr_b16 v[142:143], v25 offset:14336
  ds_read_b64_tr_b16 v[144:145], v25 offset:16384
  ds_read_b64_tr_b16 v[146:147], v25 offset:18432
  ds_read_b64_tr_b16 v[148:149], v25 offset:20480
  ds_read_b64_tr_b16 v[150:151], v25 offset:22528
  ds_read_b64_tr_b16 v[152:153], v25 offset:24576
  ds_read_b64_tr_b16 v[154:155], v25 offset:26624
  ds_read_b64_tr_b16 v[156:157], v25 offset:28672
  ds_read_b64_tr_b16 v[158:159], v25 offset:30720
  ds_read_b64_tr_b16 v[160:161], v25 offset:32768
  ds_read_b64_tr_b16 v[162:163], v25 offset:34816
  ds_read_b64_tr_b16 v[164:165], v25 offset:36864
  ds_read_b64_tr_b16 v[166:167], v25 offset:38912
  ds_read_b64_tr_b16 v[168:169], v25 offset:40960
  ds_read_b64_tr_b16 v[170:171], v25 offset:43008
  ds_read_b64_tr_b16 v[172:173], v25 offset:45056
  ds_read_b64_tr_b16 v[174:175], v25 offset:47104
  ds_read_b64_tr_b16 v[176:177], v25 offset:49152
  ds_read_b64_tr_b16 v[178:179], v25 offset:51200
  ds_read_b64_tr_b16 v[180:181], v25 offset:53248
  ds_read_b64_tr_b16 v[182:183], v25 offset:55296
  ds_read_b64_tr_b16 v[184:185], v25 offset:57344
  ds_read_b64_tr_b16 v[186:187], v25 offset:59392
  ds_read_b64_tr_b16 v[188:189], v25 offset:61440
  ds_read_b64_tr_b16 v[190:191], v25 offset:63488
  ds_read_b64_tr_b16 v[192:193], v26
  ds_read_b64_tr_b16 v[194:195], v26 offset:2048
  ds_read_b64_tr_b16 v[196:197], v26 offset:4096
  ds_read_b64_tr_b16 v[198:199], v26 offset:6144
  ds_read_b64_tr_b16 v[200:201], v26 offset:8192
  ds_read_b64_tr_b16 v[202:203], v26 offset:10240
  ds_read_b64_tr_b16 v[204:205], v26 offset:12288
  ds_read_b64_tr_b16 v[206:207], v26 offset:14336
  s_waitcnt vmcnt(0)
  v_cmp_eq_u32 vcc, s59, v9
  s_nop 3
  s_and_b32 s53, vcc_lo, 0xff
  s_cmp_eq_u32 s53, 0xff
  s_cbranch_scc0 L_spin_TR
L_spin_ret_TR:
  s_waitcnt lgkmcnt(0)
  s_barrier
  s_lshl_b32 s76, s42, 12
  v_add_u32 v25, s76, v21
  s_add_u32 m0, s68, 0
  s_nop 0
  buffer_load_dwordx4 v25, s[60:63], s72 offen sc1 lds
  buffer_load_dwordx4 v25, s[60:63], s72 offen offset:1024 sc1 lds
  buffer_load_dwordx4 v25, s[60:63], s72 offen offset:2048 sc1 lds
  buffer_load_dwordx4 v25, s[60:63], s72 offen offset:3072 sc1 lds
  s_add_u32 s72, s72, 16384
  s_add_u32 m0, s68, 0x4000
  s_nop 0
  buffer_load_dwordx4 v25, s[60:63], s72 offen sc1 lds
  buffer_load_dwordx4 v25, s[60:63], s72 offen offset:1024 sc1 lds
  buffer_load_dwordx4 v25, s[60:63], s72 offen offset:2048 sc1 lds
  buffer_load_dwordx4 v25, s[60:63], s72 offen offset:3072 sc1 lds
  s_add_u32 s72, s72, 16384
  s_add_u32 m0, s69, 0
  s_nop 0
  buffer_load_dwordx4 v25, s[60:63], s72 offen sc1 lds
  buffer_load_dwordx4 v25, s[60:63], s72 offen offset:1024 sc1 lds
  buffer_load_dwordx4 v25, s[60:63], s72 offen offset:2048 sc1 lds
  buffer_load_dwordx4 v25, s[60:63], s72 offen offset:3072 sc1 lds
  s_add_u32 s72, s72, 16384
  s_add_u32 m0, s70, 0
  s_nop 0
  buffer_load_dwordx4 v25, s[64:67], s73 offen sc1 lds
  buffer_load_dwordx4 v25, s[64:67], s73 offen offset:1024 sc1 lds
  buffer_load_dwordx4 v25, s[64:67], s73 offen offset:2048 sc1 lds
  buffer_load_dwordx4 v25, s[64:67], s73 offen offset:3072 sc1 lds
  s_add_u32 s73, s73, 16384
  s_add_u32 m0, s70, 0x4000
  s_nop 0
  buffer_load_dwordx4 v25, s[64:67], s73 offen sc1 lds
  buffer_load_dwordx4 v25, s[64:67], s73 offen offset:1024 sc1 lds
  buffer_load_dwordx4 v25, s[64:67], s73 offen offset:2048 sc1 lds
  buffer_load_dwordx4 v25, s[64:67], s73 offen offset:3072 sc1 lds
  s_add_u32 s73, s73, 16384
  buffer_store_dwordx4 v[128:131], v21, s[16:19], s54 offen sc1
  buffer_store_dwordx4 v[132:135], v21, s[16:19], s54 offen offset:1024 sc1
  buffer_store_dwordx4 v[136:139], v21, s[16:19], s54 offen offset:2048 sc1
  buffer_store_dwordx4 v[140:143], v21, s[16:19], s54 offen offset:3072 sc1
  s_add_u32 s54, s54, 0x100000
  buffer_store_dwordx4 v[144:147], v21, s[16:19], s54 offen sc1
  buffer_store_dwordx4 v[148:151], v21, s[16:19], s54 offen offset:1024 sc1
  buffer_store_dwordx4 v[152:155], v21, s[16:19], s54 offen offset:2048 sc1
  buffer_store_dwordx4 v[156:159], v21, s[16:19], s54 offen offset:3072 sc1
  s_add_u32 s54, s54, 0x100000
  buffer_store_dwordx4 v[160:163], v21, s[16:19], s54 offen sc1
  buffer_store_dwordx4 v[164:167], v21, s[16:19], s54 offen offset:1024 sc1
  buffer_store_dwordx4 v[168:171], v21, s[16:19], s54 offen offset:2048 sc1
  buffer_store_dwordx4 v[172:175], v21, s[16:19], s54 offen offset:3072 sc1
  s_add_u32 s54, s54, 0x100000
  buffer_store_dwordx4 v[176:179], v21, s[16:19], s54 offen sc1
  buffer_store_dwordx4 v[180:183], v21, s[16:19], s54 offen offset:1024 sc1
  buffer_store_dwordx4 v[184:187], v21, s[16:19], s54 offen offset:2048 sc1
  buffer_store_dwordx4 v[188:191], v21, s[16:19], s54 offen offset:3072 sc1
  s_add_u32 s54, s54, 0x100000
  s_cmp_ge_u32 s58, 32
  s_cbranch_scc1 L_TR_done
  s_and_b32 s52, s58, 3
  s_lshl_b32 s52, s52, 2
  s_add_u32 s52, s52, s42
  s_lshl_b32 s52, s52, 15
  s_lshr_b32 s53, s58, 2
  s_lshl_b32 s53, s53, 12
  s_add_u32 s52, s52, s53
  s_add_u32 s54, s52, 0x4c00000
  buffer_store_dwordx4 v[192:195], v21, s[16:19], s54 offen sc1
  buffer_store_dwordx4 v[196:199], v21, s[16:19], s54 offen offset:1024 sc1
  buffer_store_dwordx4 v[200:203], v21, s[16:19], s54 offen offset:2048 sc1
  buffer_store_dwordx4 v[204:207], v21, s[16:19], s54 offen offset:3072 sc1
L_TR_done:
  s_mov_b32 s92, 0xf0000000
  s_mov_b32 s93, 0xf0000000
  s_mov_b32 s94, 0xf0000000
  s_mov_b32 s95, 0xf0000000
  s_mov_b32 s96, 0xf0000000
  s_mov_b32 s97, 0xf0000000
  s_mov_b32 s98, 0xf0000000
  s_mov_b32 s99, 0xf0000000
  v_mov_b32 v26, v21
  s_branch L_b_start2
L_spin_AQ:
  s_mov_b32 s55, 400000
L_spin_loop_AQ:
  s_sleep 2
  buffer_load_dword v24, v25, s[16:19], s75 offen sc1
  s_waitcnt vmcnt(0)
  v_cmp_eq_u32 vcc, s59, v24
  s_nop 3
  s_and_b32 s53, vcc_lo, 0xff
  s_cmp_eq_u32 s53, 0xff
  s_cbranch_scc1 L_spin_ret_AQ
  s_sub_u32 s55, s55, 1
  s_cmp_lg_u32 s55, 0
  s_cbranch_scc1 L_spin_loop_AQ
  s_branch L_spin_ret_AQ
L_spin_AK:
  s_mov_b32 s55, 400000
L_spin_loop_AK:
  s_sleep 2
  buffer_load_dword v24, v25, s[16:19], s75 offen sc1
  s_waitcnt vmcnt(0)
  v_cmp_eq_u32 vcc, s59, v24
  s_nop 3
  s_and_b32 s53, vcc_lo, 0xff
  s_cmp_eq_u32 s53, 0xff
  s_cbranch_scc1 L_spin_ret_AK
  s_sub_u32 s55, s55, 1
  s_cmp_lg_u32 s55, 0
  s_cbranch_scc1 L_spin_loop_AK
  s_branch L_spin_ret_AK
L_spin_AV:
  s_mov_b32 s55, 400000
L_spin_loop_AV:
  s_sleep 2
  buffer_load_dword v24, v25, s[16:19], s75 offen sc1
  s_waitcnt vmcnt(0)
  v_cmp_eq_u32 vcc, s59, v24
  s_nop 3
  s_and_b32 s53, vcc_lo, 0xff
  s_cmp_eq_u32 s53, 0xff
  s_cbranch_scc1 L_spin_ret_AV
  s_sub_u32 s55, s55, 1
  s_cmp_lg_u32 s55, 0
  s_cbranch_scc1 L_spin_loop_AV
  s_branch L_spin_ret_AV
L_spin_TR:
  s_mov_b32 s55, 400000
L_spin_loop_TR:
  s_sleep 2
  buffer_load_dword v9, v10, s[16:19], s75 offen sc1
  s_waitcnt vmcnt(0)
  v_cmp_eq_u32 vcc, s59, v9
  s_nop 3
  s_and_b32 s53, vcc_lo, 0xff
  s_cmp_eq_u32 s53, 0xff
  s_cbranch_scc1 L_spin_ret_TR
  s_sub_u32 s55, s55, 1
  s_cmp_lg_u32 s55, 0
  s_cbranch_scc1 L_spin_loop_TR
  s_branch L_spin_ret_TR
L_p_spin_A:
  s_mov_b32 s79, 400000
L_p_spinl_A:
  s_sleep 2
  buffer_load_dword v22, v24, s[16:19], s75 offen sc1
  s_waitcnt vmcnt(0)
  v_cmp_eq_u32 vcc, s59, v22
  s_nop 3
  s_and_b32 s77, vcc_lo, 0x1ffff
  s_cmp_eq_u32 s77, 0x1ffff
  s_cbranch_scc0 L_p_spinc_A
  s_branch L_p_spinr_A
L_p_spinc_A:
  s_sub_u32 s79, s79, 1
  s_cmp_lg_u32 s79, 0
  s_cbranch_scc1 L_p_spinl_A
  s_branch L_p_spinr_A
L_p_spin_B:
  s_mov_b32 s79, 400000
L_p_spinl_B:
  s_sleep 2
  buffer_load_dword v18, v52, s[16:19], s52 offen sc1
  buffer_load_dword v19, v53, s[16:19], s53 offen sc1
  s_waitcnt vmcnt(0)
  v_cmp_eq_u32 vcc, s59, v18
  s_nop 3
  s_and_b32 s77, vcc_lo, 0xffffffff
  s_cmp_eq_u32 s77, 0xffffffff
  s_cbranch_scc0 L_p_spinc_B
  v_cmp_eq_u32 vcc, s59, v19
  s_nop 3
  s_and_b32 s77, vcc_lo, 0xffffffff
  s_and_b32 s81, vcc_hi, 0xffffffff
  s_and_b32 s77, s77, s81
  s_cmp_eq_u32 s77, 0xffffffff
  s_cbranch_scc0 L_p_spinc_B
  s_branch L_p_spinr_B
L_p_spinc_B:
  s_sub_u32 s79, s79, 1
  s_cmp_lg_u32 s79, 0
  s_cbranch_scc1 L_p_spinl_B
  s_branch L_p_spinr_B
L_p_spin_C:
  s_mov_b32 s79, 400000
L_p_spinl_C:
  s_sleep 2
  buffer_load_dword v18, v52, s[16:19], s52 offen sc1
  s_waitcnt vmcnt(0)
  v_cmp_eq_u32 vcc, s59, v18
  s_nop 3
  s_and_b32 s77, vcc_lo, 0xffffffff
  s_cmp_eq_u32 s77, 0xffffffff
  s_cbranch_scc0 L_p_spinc_C
  s_branch L_p_spinr_C
L_p_spinc_C:
  s_sub_u32 s79, s79, 1
  s_cmp_lg_u32 s79, 0
  s_cbranch_scc1 L_p_spinl_C
  s_branch L_p_spinr_C
L_nspin:
  s_mov_b32 s55, 400000
L_nspin_loop:
  s_sleep 2
  buffer_load_dword v24, v25, s[4:7], 0 offen sc1
  s_waitcnt vmcnt(0)
  v_readfirstlane_b32 s59, v24
  s_nop 3
  s_cmp_lg_u32 s59, 0
  s_cbranch_scc1 L_nspin_ret
  s_sub_u32 s55, s55, 1
  s_cmp_lg_u32 s55, 0
  s_cbranch_scc1 L_nspin_loop
  s_branch L_nspin_ret
L_b_start:
  s_lshl_b32 s76, s42, 12
  s_add_u32 s68, s76, 0x8000
  s_add_u32 s69, s76, 0
  s_add_u32 s70, s76, 0x10000
  s_add_u32 s71, s70, 0x8000
  s_mov_b32 s72, 0
  s_mov_b32 s73, 0
  s_add_u32 m0, s68, 0
  s_nop 0
  buffer_load_dwordx4 v25, s[60:63], s72 offen sc1 lds
  buffer_load_dwordx4 v25, s[60:63], s72 offen offset:1024 sc1 lds
  buffer_load_dwordx4 v25, s[60:63], s72 offen offset:2048 sc1 lds
  buffer_load_dwordx4 v25, s[60:63], s72 offen offset:3072 sc1 lds
  s_add_u32 s72, s72, 16384
  s_add_u32 m0, s68, 0x4000
  s_nop 0
  buffer_load_dwordx4 v25, s[60:63], s72 offen sc1 lds
  buffer_load_dwordx4 v25, s[60:63], s72 offen offset:1024 sc1 lds
  buffer_load_dwordx4 v25, s[60:63], s72 offen offset:2048 sc1 lds
  buffer_load_dwordx4 v25, s[60:63], s72 offen offset:3072 sc1 lds
  s_add_u32 s72, s72, 16384
  s_add_u32 m0, s70, 0
  s_nop 0
  buffer_load_dwordx4 v25, s[64:67], s73 offen sc1 lds
  buffer_load_dwordx4 v25, s[64:67], s73 offen offset:1024 sc1 lds
  buffer_load_dwordx4 v25, s[64:67], s73 offen offset:2048 sc1 lds
  buffer_load_dwordx4 v25, s[64:67], s73 offen offset:3072 sc1 lds
  s_add_u32 s73, s73, 16384
  s_add_u32 m0, s69, 0
  s_nop 0
  buffer_load_dwordx4 v25, s[60:63], s72 offen sc1 lds
  buffer_load_dwordx4 v25, s[60:63], s72 offen offset:1024 sc1 lds
  buffer_load_dwordx4 v25, s[60:63], s72 offen offset:2048 sc1 lds
  buffer_load_dwordx4 v25, s[60:63], s72 offen offset:3072 sc1 lds
  s_add_u32 s72, s72, 16384
  s_add_u32 m0, s70, 0x4000
  s_nop 0
  buffer_load_dwordx4 v25, s[64:67], s73 offen sc1 lds
  buffer_load_dwordx4 v25, s[64:67], s73 offen offset:1024 sc1 lds
  buffer_load_dwordx4 v25, s[64:67], s73 offen offset:2048 sc1 lds
  buffer_load_dwordx4 v25, s[64:67], s73 offen offset:3072 sc1 lds
  s_add_u32 s73, s73, 16384
L_b_start2:
  v_add_u32 v10, 0x8000, v21
  v_add_u32 v11, 0, v21
  v_add_u32 v12, 0x10000, v21
  v_add_u32 v13, 0x8000, v12
  v_mov_b32 v2, 0
  v_mov_b32 v3, 0x21000
  v_mov_b32 v16, 0
  v_mov_b32 v17, 0
  v_mov_b32 v18, 0
  v_mov_b32 v19, 0
  v_mov_b32 v20, 0
  ds_write_b32 v3, v2
  s_waitcnt vmcnt(16)
  s_waitcnt lgkmcnt(0)
  s_barrier
  ds_read_b128 a[192:195], v10
  ds_read_b128 a[196:199], v10 offset:1024
  ds_read_b128 a[200:203], v10 offset:2048
  ds_read_b128 a[204:207], v10 offset:3072
  ds_read_b128 a[208:211], v10 offset:4096
  ds_read_b128 a[212:215], v10 offset:5120
  ds_read_b128 a[216:219], v10 offset:6144
  ds_read_b128 a[220:223], v10 offset:7168
  s_cmp_lg_u32 s82, 0
  s_cselect_b64 vcc, -1, 0
  s_waitcnt lgkmcnt(7)
  v_mfma_f32_32x32x16_bf16 v[144:159], a[192:195], v[64:67], 0
  s_waitcnt lgkmcnt(6)
  v_mfma_f32_32x32x16_bf16 v[144:159], a[196:199], v[68:71], v[144:159]
  s_waitcnt lgkmcnt(5)
  v_mfma_f32_32x32x16_bf16 v[144:159], a[200:203], v[72:75], v[144:159]
  s_waitcnt lgkmcnt(4)
  v_mfma_f32_32x32x16_bf16 v[144:159], a[204:207], v[76:79], v[144:159]
  s_waitcnt lgkmcnt(3)
  v_mfma_f32_32x32x16_bf16 v[144:159], a[208:211], v[80:83], v[144:159]
  s_waitcnt lgkmcnt(2)
  v_mfma_f32_32x32x16_bf16 v[144:159], a[212:215], v[84:87], v[144:159]
  s_waitcnt lgkmcnt(1)
  v_mfma_f32_32x32x16_bf16 v[144:159], a[216:219], v[88:91], v[144:159]
  s_waitcnt lgkmcnt(0)
  v_mfma_f32_32x32x16_bf16 v[144:159], a[220:223], v[92:95], v[144:159]
  v_mfma_f32_32x32x16_bf16 v[128:143], a[192:195], v[32:35], 0
  v_mfma_f32_32x32x16_bf16 v[128:143], a[196:199], v[36:39], v[128:143]
  v_mfma_f32_32x32x16_bf16 v[128:143], a[200:203], v[40:43], v[128:143]
  v_mfma_f32_32x32x16_bf16 v[128:143], a[204:207], v[44:47], v[128:143]
  s_nop 7
  v_max3_f32 v5, v144, v145, v146
  v_max3_f32 v5, v5, v147, v148
  v_max3_f32 v5, v5, v149, v150
  v_max3_f32 v5, v5, v151, v152
  v_max3_f32 v5, v5, v153, v154
  v_max3_f32 v5, v5, v155, v156
  v_max3_f32 v5, v5, v157, v158
  v_max_f32 v5, v5, v159
  v_mov_b32 v3, v5
  v_mfma_f32_32x32x16_bf16 v[128:143], a[208:211], v[48:51], v[128:143]
  s_nop 1
  v_permlane32_swap_b32 v3, v5
  v_max_f32 v5, v5, v3
  v_cndmask_b32 v15, v5, v15, vcc
  v_sub_f32 v144, v144, v15
  v_sub_f32 v145, v145, v15
  v_sub_f32 v146, v146, v15
  v_sub_f32 v147, v147, v15
  v_sub_f32 v148, v148, v15
  v_mfma_f32_32x32x16_bf16 v[128:143], a[212:215], v[52:55], v[128:143]
  v_sub_f32 v149, v149, v15
  v_sub_f32 v150, v150, v15
  v_sub_f32 v151, v151, v15
  v_sub_f32 v152, v152, v15
  v_sub_f32 v153, v153, v15
  v_sub_f32 v154, v154, v15
  v_sub_f32 v155, v155, v15
  v_sub_f32 v156, v156, v15
  v_sub_f32 v157, v157, v15
  v_mfma_f32_32x32x16_bf16 v[128:143], a[216:219], v[56:59], v[128:143]
  v_sub_f32 v158, v158, v15
  v_sub_f32 v159, v159, v15
  v_sub_f32 v240, 0, v15
  v_sub_f32 v241, 0, v15
  v_sub_f32 v242, 0, v15
  v_sub_f32 v243, 0, v15
  v_sub_f32 v244, 0, v15
  v_sub_f32 v245, 0, v15
  v_sub_f32 v246, 0, v15
  v_mfma_f32_32x32x16_bf16 v[128:143], a[220:223], v[60:63], v[128:143]
  v_sub_f32 v247, 0, v15
  v_sub_f32 v248, 0, v15
  v_sub_f32 v249, 0, v15
  v_sub_f32 v250, 0, v15
  v_sub_f32 v251, 0, v15
  v_sub_f32 v252, 0, v15
  v_sub_f32 v253, 0, v15
  v_sub_f32 v254, 0, v15
  v_sub_f32 v255, 0, v15
  s_or_b32 s76, s40, s42
  s_cmp_lg_u32 s76, 0
  s_cbranch_scc1 L_b_p_1
  v_accvgpr_read_b32 v8, a128
  v_add_f32 v128, v128, v8
  v_accvgpr_read_b32 v9, a129
  v_add_f32 v129, v129, v9
  v_accvgpr_read_b32 v8, a130
  v_add_f32 v130, v130, v8
  v_accvgpr_read_b32 v9, a131
  v_add_f32 v131, v131, v9
  v_accvgpr_read_b32 v8, a132
  v_add_f32 v132, v132, v8
  v_accvgpr_read_b32 v9, a133
  v_add_f32 v133, v133, v9
  v_accvgpr_read_b32 v8, a134
  v_add_f32 v134, v134, v8
  v_accvgpr_read_b32 v9, a135
  v_add_f32 v135, v135, v9
  v_accvgpr_read_b32 v8, a136
  v_add_f32 v136, v136, v8
  v_accvgpr_read_b32 v9, a137
  v_add_f32 v137, v137, v9
  v_accvgpr_read_b32 v8, a138
  v_add_f32 v138, v138, v8
  v_accvgpr_read_b32 v9, a139
  v_add_f32 v139, v139, v9
  v_accvgpr_read_b32 v8, a140
  v_add_f32 v140, v140, v8
  v_accvgpr_read_b32 v9, a141
  v_add_f32 v141, v141, v9
  v_accvgpr_read_b32 v8, a142
  v_add_f32 v142, v142, v8
  v_accvgpr_read_b32 v9, a143
  v_add_f32 v143, v143, v9
L_b_p_1:
  v_max3_f32 v4, v128, v129, v130
  v_max3_f32 v4, v4, v131, v132
  v_max3_f32 v4, v4, v133, v134
  v_max3_f32 v4, v4, v135, v136
  v_max3_f32 v4, v4, v137, v138
  v_max3_f32 v4, v4, v139, v140
  v_max3_f32 v4, v4, v141, v142
  v_max_f32 v4, v4, v143
  v_mov_b32 v2, v4
  s_nop 1
  v_permlane32_swap_b32 v2, v4
  v_max_f32 v4, v4, v2
  v_cndmask_b32 v14, v4, v14, vcc
  v_sub_f32 v128, v128, v14
  v_sub_f32 v129, v129, v14
  v_sub_f32 v130, v130, v14
  v_sub_f32 v131, v131, v14
  v_sub_f32 v132, v132, v14
  v_sub_f32 v133, v133, v14
  v_sub_f32 v134, v134, v14
  v_sub_f32 v135, v135, v14
  v_sub_f32 v136, v136, v14
  v_sub_f32 v137, v137, v14
  v_sub_f32 v138, v138, v14
  v_sub_f32 v139, v139, v14
  v_sub_f32 v140, v140, v14
  v_sub_f32 v141, v141, v14
  v_sub_f32 v142, v142, v14
  v_sub_f32 v143, v143, v14
  v_sub_f32 v224, 0, v14
  v_sub_f32 v225, 0, v14
  v_sub_f32 v226, 0, v14
  v_sub_f32 v227, 0, v14
  v_sub_f32 v228, 0, v14
  v_sub_f32 v229, 0, v14
  v_sub_f32 v230, 0, v14
  v_sub_f32 v231, 0, v14
  v_sub_f32 v232, 0, v14
  v_sub_f32 v233, 0, v14
  v_sub_f32 v234, 0, v14
  v_sub_f32 v235, 0, v14
  v_sub_f32 v236, 0, v14
  v_sub_f32 v237, 0, v14
  v_sub_f32 v238, 0, v14
  v_sub_f32 v239, 0, v14
  s_cmp_eq_u32 s40, 0
  s_cbranch_scc1 L_b_FM
L_b_F:
  s_waitcnt vmcnt(12)
  s_barrier
  s_add_u32 m0, s69, 0x4000
  s_nop 0
  buffer_load_dwordx4 v25, s[60:63], s72 offen sc1 lds
  buffer_load_dwordx4 v25, s[60:63], s72 offen offset:1024 sc1 lds
  buffer_load_dwordx4 v25, s[60:63], s72 offen offset:2048 sc1 lds
  buffer_load_dwordx4 v25, s[60:63], s72 offen offset:3072 sc1 lds
  s_add_u32 s72, s72, 16384
  ds_read_b128 a[192:195], v10 offset:8192
  ds_read_b128 a[196:199], v10 offset:9216
  ds_read_b128 a[200:203], v10 offset:10240
  ds_read_b128 a[204:207], v10 offset:11264
  ds_read_b128 a[208:211], v10 offset:12288
  s_waitcnt lgkmcnt(3)
  v_mfma_f32_32x32x16_bf16 v[160:175], a[192:195], v[32:35], v[224:239]
  v_exp_f32 v128, v128
  v_exp_f32 v129, v129
  v_exp_f32 v130, v130
  v_exp_f32 v131, v131
  v_add_f32 v16, v16, v128
  v_mfma_f32_32x32x16_bf16 v[176:191], a[192:195], v[64:67], v[240:255]
  s_add_u32 m0, s71, 0
  v_add_f32 v17, v17, v129
  v_cvt_pk_bf16_f32 v192, v128, v129
  v_exp_f32 v132, v132
  v_exp_f32 v133, v133
  v_add_f32 v16, v16, v130
  v_add_f32 v17, v17, v131
  v_mfma_f32_32x32x16_bf16 v[160:175], a[196:199], v[36:39], v[160:175]
  ds_read_b128 a[212:215], v10 offset:13312
  v_cvt_pk_bf16_f32 v193, v130, v131
  v_exp_f32 v134, v134
  v_exp_f32 v135, v135
  v_add_f32 v16, v16, v132
  v_add_f32 v17, v17, v133
  v_mfma_f32_32x32x16_bf16 v[176:191], a[196:199], v[68:71], v[176:191]
  buffer_load_dwordx4 v25, s[64:67], s73 offen sc1 lds
  v_cvt_pk_bf16_f32 v194, v132, v133
  v_exp_f32 v136, v136
  v_exp_f32 v137, v137
  s_waitcnt lgkmcnt(2)
  v_mfma_f32_32x32x16_bf16 v[160:175], a[200:203], v[40:43], v[160:175]
  ds_read_b128 a[216:219], v10 offset:14336
  v_add_f32 v16, v16, v134
  v_add_f32 v17, v17, v135
  v_cvt_pk_bf16_f32 v195, v134, v135
  v_exp_f32 v138, v138
  v_exp_f32 v139, v139
  v_mfma_f32_32x32x16_bf16 v[176:191], a[200:203], v[72:75], v[176:191]
  buffer_load_dwordx4 v25, s[64:67], s73 offen offset:1024 sc1 lds
  v_add_f32 v16, v16, v136
  v_add_f32 v17, v17, v137
  v_cvt_pk_bf16_f32 v196, v136, v137
  v_exp_f32 v140, v140
  v_mfma_f32_32x32x16_bf16 v[160:175], a[204:207], v[44:47], v[160:175]
  ds_read_b128 a[220:223], v10 offset:15360
  v_exp_f32 v141, v141
  v_add_f32 v16, v16, v138
  v_add_f32 v17, v17, v139
  v_cvt_pk_bf16_f32 v197, v138, v139
  v_exp_f32 v142, v142
  v_mfma_f32_32x32x16_bf16 v[176:191], a[204:207], v[76:79], v[176:191]
  buffer_load_dwordx4 v25, s[64:67], s73 offen offset:2048 sc1 lds
  v_exp_f32 v143, v143
  v_add_f32 v16, v16, v140
  v_add_f32 v17, v17, v141
  v_cvt_pk_bf16_f32 v198, v140, v141
  s_waitcnt lgkmcnt(2)
  v_mfma_f32_32x32x16_bf16 v[160:175], a[208:211], v[48:51], v[160:175]
  v_add_f32 v16, v16, v142
  v_add_f32 v17, v17, v143
  v_cvt_pk_bf16_f32 v199, v142, v143
  v_exp_f32 v144, v144
  v_exp_f32 v145, v145
  v_exp_f32 v146, v146
  v_mfma_f32_32x32x16_bf16 v[176:191], a[208:211], v[80:83], v[176:191]
  buffer_load_dwordx4 v25, s[64:67], s73 offen offset:3072 sc1 lds
  v_exp_f32 v147, v147
  v_add_f32 v18, v18, v144
  v_add_f32 v19, v19, v145
  v_cvt_pk_bf16_f32 v200, v144, v145
  v_mfma_f32_32x32x16_bf16 v[160:175], a[212:215], v[52:55], v[160:175]
  ds_read_b128 a[192:195], v10 offset:16384
  v_exp_f32 v148, v148
  v_exp_f32 v149, v149
  v_add_f32 v18, v18, v146
  v_add_f32 v19, v19, v147
  v_cvt_pk_bf16_f32 v201, v146, v147
  v_mfma_f32_32x32x16_bf16 v[176:191], a[212:215], v[84:87], v[176:191]
  ds_read_b128 a[196:199], v10 offset:17408
  s_add_u32 s73, s73, 16384
  v_exp_f32 v150, v150
  v_exp_f32 v151, v151
  v_add_f32 v18, v18, v148
  v_add_f32 v19, v19, v149
  s_waitcnt lgkmcnt(2)
  v_mfma_f32_32x32x16_bf16 v[160:175], a[216:219], v[56:59], v[160:175]
  ds_read_b128 a[200:203], v10 offset:18432
  v_cvt_pk_bf16_f32 v202, v148, v149
  v_exp_f32 v152, v152
  v_exp_f32 v153, v153
  v_add_f32 v18, v18, v150
  v_add_f32 v19, v19, v151
  v_cvt_pk_bf16_f32 v203, v150, v151
  v_mfma_f32_32x32x16_bf16 v[176:191], a[216:219], v[88:91], v[176:191]
  ds_read_b128 a[204:207], v10 offset:19456
  v_exp_f32 v154, v154
  v_exp_f32 v155, v155
  v_add_f32 v18, v18, v152
  v_add_f32 v19, v19, v153
  v_cvt_pk_bf16_f32 v204, v152, v153
  v_mfma_f32_32x32x16_bf16 v[160:175], a[220:223], v[60:63], v[160:175]
  ds_read_b128 a[208:211], v10 offset:20480
  v_exp_f32 v156, v156
  v_exp_f32 v157, v157
  v_add_f32 v18, v18, v154
  v_add_f32 v19, v19, v155
  v_cvt_pk_bf16_f32 v205, v154, v155
  v_mfma_f32_32x32x16_bf16 v[176:191], a[220:223], v[92:95], v[176:191]
  v_exp_f32 v158, v158
  v_exp_f32 v159, v159
  v_add_f32 v18, v18, v156
  v_add_f32 v19, v19, v157
  v_cvt_pk_bf16_f32 v206, v156, v157
  v_add_f32 v18, v18, v158
  v_add_f32 v19, v19, v159
  v_cvt_pk_bf16_f32 v207, v158, v159
  s_waitcnt lgkmcnt(3)
  v_mfma_f32_32x32x16_bf16 v[128:143], a[192:195], v[32:35], v[224:239]
  s_waitcnt vmcnt(12)
  s_barrier
  v_exp_f32 v160, v160
  v_mfma_f32_32x32x16_bf16 v[144:159], a[192:195], v[64:67], v[240:255]
  s_add_u32 m0, s68, 0
  v_exp_f32 v161, v161
  v_exp_f32 v162, v162
  v_mfma_f32_32x32x16_bf16 v[128:143], a[196:199], v[36:39], v[128:143]
  ds_read_b128 a[212:215], v10 offset:21504
  v_exp_f32 v163, v163
  v_add_f32 v16, v16, v160
  v_add_f32 v17, v17, v161
  v_mfma_f32_32x32x16_bf16 v[144:159], a[196:199], v[68:71], v[144:159]
  v_cvt_pk_bf16_f32 v208, v160, v161
  v_exp_f32 v164, v164
  v_exp_f32 v165, v165
  s_waitcnt lgkmcnt(2)
  v_mfma_f32_32x32x16_bf16 v[128:143], a[200:203], v[40:43], v[128:143]
  ds_read_b128 a[216:219], v10 offset:22528
  v_add_f32 v16, v16, v162
  v_add_f32 v17, v17, v163
  v_cvt_pk_bf16_f32 v209, v162, v163
  v_mfma_f32_32x32x16_bf16 v[144:159], a[200:203], v[72:75], v[144:159]
  buffer_load_dwordx4 v25, s[60:63], s72 offen sc1 lds
  v_exp_f32 v166, v166
  v_mfma_f32_32x32x16_bf16 v[128:143], a[204:207], v[44:47], v[128:143]
  ds_read_b128 a[220:223], v10 offset:23552
  v_exp_f32 v167, v167
  v_add_f32 v16, v16, v164
  v_mfma_f32_32x32x16_bf16 v[144:159], a[204:207], v[76:79], v[144:159]
  v_add_f32 v17, v17, v165
  v_cvt_pk_bf16_f32 v210, v164, v165
  v_exp_f32 v168, v168
  s_waitcnt lgkmcnt(2)
  v_mfma_f32_32x32x16_bf16 v[128:143], a[208:211], v[48:51], v[128:143]
  ds_read_b128 a[224:227], v12
  v_exp_f32 v169, v169
  v_add_f32 v16, v16, v166
  v_add_f32 v17, v17, v167
  v_mfma_f32_32x32x16_bf16 v[144:159], a[208:211], v[80:83], v[144:159]
  v_cvt_pk_bf16_f32 v211, v166, v167
  v_exp_f32 v170, v170
  v_exp_f32 v171, v171
  v_mfma_f32_32x32x16_bf16 v[128:143], a[212:215], v[52:55], v[128:143]
  ds_read_b128 a[228:231], v12 offset:1024
  buffer_load_dwordx4 v25, s[60:63], s72 offen offset:1024 sc1 lds
  v_mfma_f32_32x32x16_bf16 v[144:159], a[212:215], v[84:87], v[144:159]
  v_add_f32 v16, v16, v168
  v_add_f32 v17, v17, v169
  v_cvt_pk_bf16_f32 v212, v168, v169
  v_exp_f32 v172, v172
  s_waitcnt lgkmcnt(2)
  v_mfma_f32_32x32x16_bf16 v[128:143], a[216:219], v[56:59], v[128:143]
  ds_read_b128 a[232:235], v12 offset:2048
  v_exp_f32 v173, v173
  v_add_f32 v16, v16, v170
  v_mfma_f32_32x32x16_bf16 v[144:159], a[216:219], v[88:91], v[144:159]
  v_add_f32 v17, v17, v171
  v_cvt_pk_bf16_f32 v213, v170, v171
  v_exp_f32 v174, v174
  v_mfma_f32_32x32x16_bf16 v[128:143], a[220:223], v[60:63], v[128:143]
  ds_read_b128 a[236:239], v12 offset:3072
  v_exp_f32 v175, v175
  v_add_f32 v16, v16, v172
  v_add_f32 v17, v17, v173
  v_mfma_f32_32x32x16_bf16 v[144:159], a[220:223], v[92:95], v[144:159]
  buffer_load_dwordx4 v25, s[60:63], s72 offen offset:2048 sc1 lds
  v_cvt_pk_bf16_f32 v214, v172, v173
  v_add_f32 v16, v16, v174
  s_waitcnt lgkmcnt(2)
  v_mfma_f32_32x32x16_bf16 a[0:15], a[224:227], v[192:195], 0
  ds_read_b128 a[240:243], v12 offset:4096
  v_add_f32 v17, v17, v175
  v_cvt_pk_bf16_f32 v215, v174, v175
  v_exp_f32 v176, v176
  v_mfma_f32_32x32x16_bf16 a[64:79], a[224:227], v[200:203], 0
  v_exp_f32 v177, v177
  v_exp_f32 v178, v178
  v_mfma_f32_32x32x16_bf16 a[16:31], a[228:231], v[192:195], 0
  ds_read_b128 a[244:247], v12 offset:5120
  v_exp_f32 v179, v179
  v_add_f32 v18, v18, v176
  v_mfma_f32_32x32x16_bf16 a[80:95], a[228:231], v[200:203], 0
  v_add_f32 v19, v19, v177
  v_cvt_pk_bf16_f32 v216, v176, v177
  v_exp_f32 v180, v180
  s_waitcnt lgkmcnt(2)
  v_mfma_f32_32x32x16_bf16 a[32:47], a[232:235], v[192:195], 0
  ds_read_b128 a[248:251], v12 offset:6144
  buffer_load_dwordx4 v25, s[60:63], s72 offen offset:3072 sc1 lds
  v_exp_f32 v181, v181
  v_mfma_f32_32x32x16_bf16 a[96:111], a[232:235], v[200:203], 0
  v_add_f32 v18, v18, v178
  v_add_f32 v19, v19, v179
  v_cvt_pk_bf16_f32 v217, v178, v179
  v_mfma_f32_32x32x16_bf16 a[48:63], a[236:239], v[192:195], 0
  ds_read_b128 a[252:255], v12 offset:7168
  v_exp_f32 v182, v182
  v_exp_f32 v183, v183
  v_mfma_f32_32x32x16_bf16 a[112:127], a[236:239], v[200:203], 0
  v_add_f32 v18, v18, v180
  v_add_f32 v19, v19, v181
  v_cvt_pk_bf16_f32 v218, v180, v181
  v_exp_f32 v184, v184
  s_waitcnt lgkmcnt(2)
  v_mfma_f32_32x32x16_bf16 a[0:15], a[240:243], v[196:199], a[0:15]
  v_exp_f32 v185, v185
  v_add_f32 v18, v18, v182
  v_add_f32 v19, v19, v183
  v_mfma_f32_32x32x16_bf16 a[64:79], a[240:243], v[204:207], a[64:79]
  s_add_u32 s72, s72, 16384
  v_cvt_pk_bf16_f32 v219, v182, v183
  v_exp_f32 v186, v186
  v_mfma_f32_32x32x16_bf16 a[16:31], a[244:247], v[196:199], a[16:31]
  ds_read_b128 a[192:195], v10 offset:24576
  v_exp_f32 v187, v187
  v_add_f32 v18, v18, v184
  v_add_f32 v19, v19, v185
  v_mfma_f32_32x32x16_bf16 a[80:95], a[244:247], v[204:207], a[80:95]
  ds_read_b128 a[196:199], v10 offset:25600
  v_cvt_pk_bf16_f32 v220, v184, v185
  v_exp_f32 v188, v188
  s_waitcnt lgkmcnt(2)
  v_mfma_f32_32x32x16_bf16 a[32:47], a[248:251], v[196:199], a[32:47]
  ds_read_b128 a[200:203], v10 offset:26624
  v_exp_f32 v189, v189
  v_add_f32 v18, v18, v186
  v_add_f32 v19, v19, v187
  v_mfma_f32_32x32x16_bf16 a[96:111], a[248:251], v[204:207], a[96:111]
  ds_read_b128 a[204:207], v10 offset:27648
  v_cvt_pk_bf16_f32 v221, v186, v187
  v_exp_f32 v190, v190
  v_mfma_f32_32x32x16_bf16 a[48:63], a[252:255], v[196:199], a[48:63]
  ds_read_b128 a[208:211], v10 offset:28672
  v_exp_f32 v191, v191
  v_add_f32 v18, v18, v188
  v_add_f32 v19, v19, v189
  v_mfma_f32_32x32x16_bf16 a[112:127], a[252:255], v[204:207], a[112:127]
  v_cvt_pk_bf16_f32 v222, v188, v189
  v_add_f32 v18, v18, v190
  v_add_f32 v19, v19, v191
  v_cvt_pk_bf16_f32 v223, v190, v191
  s_waitcnt lgkmcnt(3)
  v_mfma_f32_32x32x16_bf16 v[160:175], a[192:195], v[32:35], v[224:239]
  v_exp_f32 v128, v128
  v_exp_f32 v129, v129
  v_mfma_f32_32x32x16_bf16 v[176:191], a[192:195], v[64:67], v[240:255]
  s_add_u32 m0, s71, 0x4000
  v_exp_f32 v130, v130
  v_exp_f32 v131, v131
  v_mfma_f32_32x32x16_bf16 v[160:175], a[196:199], v[36:39], v[160:175]
  ds_read_b128 a[212:215], v10 offset:29696
  v_add_f32 v16, v16, v128
  v_add_f32 v17, v17, v129
  v_cvt_pk_bf16_f32 v192, v128, v129
  v_mfma_f32_32x32x16_bf16 v[176:191], a[196:199], v[68:71], v[176:191]
  v_exp_f32 v132, v132
  v_exp_f32 v133, v133
  v_add_f32 v16, v16, v130
  s_waitcnt lgkmcnt(2)
  v_mfma_f32_32x32x16_bf16 v[160:175], a[200:203], v[40:43], v[160:175]
  ds_read_b128 a[216:219], v10 offset:30720
  buffer_load_dwordx4 v25, s[64:67], s73 offen sc1 lds
  v_add_f32 v17, v17, v131
  v_mfma_f32_32x32x16_bf16 v[176:191], a[200:203], v[72:75], v[176:191]
  v_cvt_pk_bf16_f32 v193, v130, v131
  v_exp_f32 v134, v134
  v_exp_f32 v135, v135
  v_mfma_f32_32x32x16_bf16 v[160:175], a[204:207], v[44:47], v[160:175]
  ds_read_b128 a[220:223], v10 offset:31744
  v_add_f32 v16, v16, v132
  v_add_f32 v17, v17, v133
  v_cvt_pk_bf16_f32 v194, v132, v133
  v_mfma_f32_32x32x16_bf16 v[176:191], a[204:207], v[76:79], v[176:191]
  v_xor_b32 v10, 0x8000, v10
  v_exp_f32 v136, v136
  v_exp_f32 v137, v137
  s_waitcnt lgkmcnt(2)
  v_mfma_f32_32x32x16_bf16 v[160:175], a[208:211], v[48:51], v[160:175]
  ds_read_b128 a[224:227], v12 offset:8192
  buffer_load_dwordx4 v25, s[64:67], s73 offen offset:1024 sc1 lds
  v_xor_b32 v11, 0x8000, v11
  v_add_f32 v16, v16, v134
  v_mfma_f32_32x32x16_bf16 v[176:191], a[208:211], v[80:83], v[176:191]
  v_add_f32 v17, v17, v135
  v_cvt_pk_bf16_f32 v195, v134, v135
  v_exp_f32 v138, v138
  v_mfma_f32_32x32x16_bf16 v[160:175], a[212:215], v[52:55], v[160:175]
  ds_read_b128 a[228:231], v12 offset:9216
  v_exp_f32 v139, v139
  v_add_f32 v16, v16, v136
  v_add_f32 v17, v17, v137
  v_mfma_f32_32x32x16_bf16 v[176:191], a[212:215], v[84:87], v[176:191]
  v_cvt_pk_bf16_f32 v196, v136, v137
  v_exp_f32 v140, v140
  v_exp_f32 v141, v141
  s_waitcnt lgkmcnt(2)
  v_mfma_f32_32x32x16_bf16 v[160:175], a[216:219], v[56:59], v[160:175]
  ds_read_b128 a[232:235], v12 offset:10240
  buffer_load_dwordx4 v25, s[64:67], s73 offen offset:2048 sc1 lds
  v_add_f32 v16, v16, v138
  v_mfma_f32_32x32x16_bf16 v[176:191], a[216:219], v[88:91], v[176:191]
  v_add_f32 v17, v17, v139
  v_cvt_pk_bf16_f32 v197, v138, v139
  v_exp_f32 v142, v142
  v_mfma_f32_32x32x16_bf16 v[160:175], a[220:223], v[60:63], v[160:175]
  ds_read_b128 a[236:239], v12 offset:11264
  v_exp_f32 v143, v143
  v_add_f32 v16, v16, v140
  v_add_f32 v17, v17, v141
  v_mfma_f32_32x32x16_bf16 v[176:191], a[220:223], v[92:95], v[176:191]
  v_cvt_pk_bf16_f32 v198, v140, v141
  v_add_f32 v16, v16, v142
  v_add_f32 v17, v17, v143
  v_cvt_pk_bf16_f32 v199, v142, v143
  s_waitcnt lgkmcnt(2)
  v_mfma_f32_32x32x16_bf16 a[0:15], a[224:227], v[208:211], a[0:15]
  ds_read_b128 a[240:243], v12 offset:12288
  buffer_load_dwordx4 v25, s[64:67], s73 offen offset:3072 sc1 lds
  v_exp_f32 v144, v144
  v_mfma_f32_32x32x16_bf16 a[64:79], a[224:227], v[216:219], a[64:79]
  v_exp_f32 v145, v145
  v_exp_f32 v146, v146
  v_mfma_f32_32x32x16_bf16 a[16:31], a[228:231], v[208:211], a[16:31]
  ds_read_b128 a[244:247], v12 offset:13312
  v_exp_f32 v147, v147
  v_add_f32 v18, v18, v144
  v_mfma_f32_32x32x16_bf16 a[80:95], a[228:231], v[216:219], a[80:95]
  v_add_f32 v19, v19, v145
  v_cvt_pk_bf16_f32 v200, v144, v145
  v_exp_f32 v148, v148
  s_waitcnt lgkmcnt(2)
  v_mfma_f32_32x32x16_bf16 a[32:47], a[232:235], v[208:211], a[32:47]
  ds_read_b128 a[248:251], v12 offset:14336
  s_add_u32 s73, s73, 16384
  v_exp_f32 v149, v149
  v_add_f32 v18, v18, v146
  v_add_f32 v19, v19, v147
  v_mfma_f32_32x32x16_bf16 a[96:111], a[232:235], v[216:219], a[96:111]
  s_xor_b32 s68, s68, 0x8000
  s_xor_b32 s69, s69, 0x8000
  v_cvt_pk_bf16_f32 v201, v146, v147
  v_exp_f32 v150, v150
  v_mfma_f32_32x32x16_bf16 a[48:63], a[236:239], v[208:211], a[48:63]
  ds_read_b128 a[252:255], v12 offset:15360
  s_xor_b32 s70, s70, 0x8000
  s_xor_b32 s71, s71, 0x8000
  v_exp_f32 v151, v151
  v_mfma_f32_32x32x16_bf16 a[112:127], a[236:239], v[216:219], a[112:127]
  v_xor_b32 v12, 0x8000, v12
  v_add_f32 v18, v18, v148
  v_add_f32 v19, v19, v149
  v_cvt_pk_bf16_f32 v202, v148, v149
  s_waitcnt lgkmcnt(2)
  v_mfma_f32_32x32x16_bf16 a[0:15], a[240:243], v[212:215], a[0:15]
  v_xor_b32 v13, 0x8000, v13
  v_exp_f32 v152, v152
  v_exp_f32 v153, v153
  v_mfma_f32_32x32x16_bf16 a[64:79], a[240:243], v[220:223], a[64:79]
  v_add_f32 v18, v18, v150
  v_add_f32 v19, v19, v151
  v_cvt_pk_bf16_f32 v203, v150, v151
  v_exp_f32 v154, v154
  v_mfma_f32_32x32x16_bf16 a[16:31], a[244:247], v[212:215], a[16:31]
  ds_read_b128 a[192:195], v10
  v_exp_f32 v155, v155
  v_add_f32 v18, v18, v152
  v_mfma_f32_32x32x16_bf16 a[80:95], a[244:247], v[220:223], a[80:95]
  ds_read_b128 a[196:199], v10 offset:1024
  v_add_f32 v19, v19, v153
  v_cvt_pk_bf16_f32 v204, v152, v153
  v_exp_f32 v156, v156
  s_waitcnt lgkmcnt(2)
  v_mfma_f32_32x32x16_bf16 a[32:47], a[248:251], v[212:215], a[32:47]
  ds_read_b128 a[200:203], v10 offset:2048
  v_exp_f32 v157, v157
  v_add_f32 v18, v18, v154
  v_mfma_f32_32x32x16_bf16 a[96:111], a[248:251], v[220:223], a[96:111]
  ds_read_b128 a[204:207], v10 offset:3072
  v_add_f32 v19, v19, v155
  v_cvt_pk_bf16_f32 v205, v154, v155
  v_exp_f32 v158, v158
  v_mfma_f32_32x32x16_bf16 a[48:63], a[252:255], v[212:215], a[48:63]
  ds_read_b128 a[208:211], v10 offset:4096
  v_exp_f32 v159, v159
  v_add_f32 v18, v18, v156
  v_add_f32 v19, v19, v157
  v_mfma_f32_32x32x16_bf16 a[112:127], a[252:255], v[220:223], a[112:127]
  v_cvt_pk_bf16_f32 v206, v156, v157
  v_add_f32 v18, v18, v158
  v_add_f32 v19, v19, v159
  v_cvt_pk_bf16_f32 v207, v158, v159
  buffer_store_dwordx4 v[96:99], v26, s[16:19], s92 offen sc1
  buffer_store_dwordx4 v[100:103], v26, s[16:19], s93 offen sc1
  buffer_store_dwordx4 v[104:107], v26, s[16:19], s94 offen sc1
  buffer_store_dwordx4 v[108:111], v26, s[16:19], s95 offen sc1
  buffer_store_dwordx4 v[112:115], v26, s[16:19], s96 offen sc1
  buffer_store_dwordx4 v[116:119], v26, s[16:19], s97 offen sc1
  buffer_store_dwordx4 v[120:123], v26, s[16:19], s98 offen sc1
  buffer_store_dwordx4 v[124:127], v26, s[16:19], s99 offen sc1
  s_sub_u32 s74, s40, 1
  s_cmp_eq_u32 s74, 0
  s_cbranch_scc1 L_b_DM
L_b_D:
  s_waitcnt lgkmcnt(3)
  v_mfma_f32_32x32x16_bf16 v[128:143], a[192:195], v[32:35], v[224:239]
  s_waitcnt vmcnt(12)
  s_barrier
  v_exp_f32 v160, v160
  v_mfma_f32_32x32x16_bf16 v[144:159], a[192:195], v[64:67], v[240:255]
  s_add_u32 m0, s69, 0x4000
  v_exp_f32 v161, v161
  v_exp_f32 v162, v162
  v_mfma_f32_32x32x16_bf16 v[128:143], a[196:199], v[36:39], v[128:143]
  ds_read_b128 a[212:215], v10 offset:5120
  v_exp_f32 v163, v163
  v_add_f32 v16, v16, v160
  v_add_f32 v17, v17, v161
  v_mfma_f32_32x32x16_bf16 v[144:159], a[196:199], v[68:71], v[144:159]
  v_cvt_pk_bf16_f32 v208, v160, v161
  v_exp_f32 v164, v164
  v_exp_f32 v165, v165
  s_waitcnt lgkmcnt(2)
  v_mfma_f32_32x32x16_bf16 v[128:143], a[200:203], v[40:43], v[128:143]
  ds_read_b128 a[216:219], v10 offset:6144
  v_add_f32 v16, v16, v162
  v_add_f32 v17, v17, v163
  v_cvt_pk_bf16_f32 v209, v162, v163
  v_mfma_f32_32x32x16_bf16 v[144:159], a[200:203], v[72:75], v[144:159]
  buffer_load_dwordx4 v25, s[60:63], s72 offen sc1 lds
  v_exp_f32 v166, v166
  v_mfma_f32_32x32x16_bf16 v[128:143], a[204:207], v[44:47], v[128:143]
  ds_read_b128 a[220:223], v10 offset:7168
  v_exp_f32 v167, v167
  v_add_f32 v16, v16, v164
  v_mfma_f32_32x32x16_bf16 v[144:159], a[204:207], v[76:79], v[144:159]
  v_add_f32 v17, v17, v165
  v_cvt_pk_bf16_f32 v210, v164, v165
  v_exp_f32 v168, v168
  s_waitcnt lgkmcnt(2)
  v_mfma_f32_32x32x16_bf16 v[128:143], a[208:211], v[48:51], v[128:143]
  ds_read_b128 a[224:227], v13 offset:16384
  v_exp_f32 v169, v169
  v_add_f32 v16, v16, v166
  v_add_f32 v17, v17, v167
  v_mfma_f32_32x32x16_bf16 v[144:159], a[208:211], v[80:83], v[144:159]
  v_cvt_pk_bf16_f32 v211, v166, v167
  v_exp_f32 v170, v170
  v_exp_f32 v171, v171
  v_mfma_f32_32x32x16_bf16 v[128:143], a[212:215], v[52:55], v[128:143]
  ds_read_b128 a[228:231], v13 offset:17408
  buffer_load_dwordx4 v25, s[60:63], s72 offen offset:1024 sc1 lds
  v_mfma_f32_32x32x16_bf16 v[144:159], a[212:215], v[84:87], v[144:159]
  v_add_f32 v16, v16, v168
  v_add_f32 v17, v17, v169
  v_cvt_pk_bf16_f32 v212, v168, v169
  v_exp_f32 v172, v172
  s_waitcnt lgkmcnt(2)
  v_mfma_f32_32x32x16_bf16 v[128:143], a[216:219], v[56:59], v[128:143]
  ds_read_b128 a[232:235], v13 offset:18432
  v_exp_f32 v173, v173
  v_add_f32 v16, v16, v170
  v_mfma_f32_32x32x16_bf16 v[144:159], a[216:219], v[88:91], v[144:159]
  v_add_f32 v17, v17, v171
  v_cvt_pk_bf16_f32 v213, v170, v171
  v_exp_f32 v174, v174
  v_mfma_f32_32x32x16_bf16 v[128:143], a[220:223], v[60:63], v[128:143]
  ds_read_b128 a[236:239], v13 offset:19456
  v_exp_f32 v175, v175
  v_add_f32 v16, v16, v172
  v_add_f32 v17, v17, v173
  v_mfma_f32_32x32x16_bf16 v[144:159], a[220:223], v[92:95], v[144:159]
  buffer_load_dwordx4 v25, s[60:63], s72 offen offset:2048 sc1 lds
  v_cvt_pk_bf16_f32 v214, v172, v173
  v_add_f32 v16, v16, v174
  s_waitcnt lgkmcnt(2)
  v_mfma_f32_32x32x16_bf16 a[0:15], a[224:227], v[192:195], a[0:15]
  ds_read_b128 a[240:243], v13 offset:20480
  v_add_f32 v17, v17, v175
  v_cvt_pk_bf16_f32 v215, v174, v175
  v_exp_f32 v176, v176
  v_mfma_f32_32x32x16_bf16 a[64:79], a[224:227], v[200:203], a[64:79]
  v_exp_f32 v177, v177
  v_exp_f32 v178, v178
  v_mfma_f32_32x32x16_bf16 a[16:31], a[228:231], v[192:195], a[16:31]
  ds_read_b128 a[244:247], v13 offset:21504
  v_exp_f32 v179, v179
  v_add_f32 v18, v18, v176
  v_mfma_f32_32x32x16_bf16 a[80:95], a[228:231], v[200:203], a[80:95]
  v_add_f32 v19, v19, v177
  v_cvt_pk_bf16_f32 v216, v176, v177
  v_exp_f32 v180, v180
  s_waitcnt lgkmcnt(2)
  v_mfma_f32_32x32x16_bf16 a[32:47], a[232:235], v[192:195], a[32:47]
  ds_read_b128 a[248:251], v13 offset:22528
  buffer_load_dwordx4 v25, s[60:63], s72 offen offset:3072 sc1 lds
  v_exp_f32 v181, v181
  v_mfma_f32_32x32x16_bf16 a[96:111], a[232:235], v[200:203], a[96:111]
  v_add_f32 v18, v18, v178
  v_add_f32 v19, v19, v179
  v_cvt_pk_bf16_f32 v217, v178, v179
  v_mfma_f32_32x32x16_bf16 a[48:63], a[236:239], v[192:195], a[48:63]
  ds_read_b128 a[252:255], v13 offset:23552
  v_exp_f32 v182, v182
  v_exp_f32 v183, v183
  v_mfma_f32_32x32x16_bf16 a[112:127], a[236:239], v[200:203], a[112:127]
  v_add_f32 v18, v18, v180
  v_add_f32 v19, v19, v181
  v_cvt_pk_bf16_f32 v218, v180, v181
  v_exp_f32 v184, v184
  s_waitcnt lgkmcnt(2)
  v_mfma_f32_32x32x16_bf16 a[0:15], a[240:243], v[196:199], a[0:15]
  v_exp_f32 v185, v185
  v_add_f32 v18, v18, v182
  v_add_f32 v19, v19, v183
  v_mfma_f32_32x32x16_bf16 a[64:79], a[240:243], v[204:207], a[64:79]
  s_add_u32 s72, s72, 16384
  v_cvt_pk_bf16_f32 v219, v182, v183
  v_exp_f32 v186, v186
  v_mfma_f32_32x32x16_bf16 a[16:31], a[244:247], v[196:199], a[16:31]
  ds_read_b128 a[192:195], v10 offset:8192
  v_exp_f32 v187, v187
  v_add_f32 v18, v18, v184
  v_add_f32 v19, v19, v185
  v_mfma_f32_32x32x16_bf16 a[80:95], a[244:247], v[204:207], a[80:95]
  ds_read_b128 a[196:199], v10 offset:9216
  v_cvt_pk_bf16_f32 v220, v184, v185
  v_exp_f32 v188, v188
  s_waitcnt lgkmcnt(2)
  v_mfma_f32_32x32x16_bf16 a[32:47], a[248:251], v[196:199], a[32:47]
  ds_read_b128 a[200:203], v10 offset:10240
  v_exp_f32 v189, v189
  v_add_f32 v18, v18, v186
  v_add_f32 v19, v19, v187
  v_mfma_f32_32x32x16_bf16 a[96:111], a[248:251], v[204:207], a[96:111]
  ds_read_b128 a[204:207], v10 offset:11264
  v_cvt_pk_bf16_f32 v221, v186, v187
  v_exp_f32 v190, v190
  v_mfma_f32_32x32x16_bf16 a[48:63], a[252:255], v[196:199], a[48:63]
  ds_read_b128 a[208:211], v10 offset:12288
  v_exp_f32 v191, v191
  v_add_f32 v18, v18, v188
  v_add_f32 v19, v19, v189
  v_mfma_f32_32x32x16_bf16 a[112:127], a[252:255], v[204:207], a[112:127]
  v_cvt_pk_bf16_f32 v222, v188, v189
  v_add_f32 v18, v18, v190
  v_add_f32 v19, v19, v191
  v_cvt_pk_bf16_f32 v223, v190, v191
  s_waitcnt lgkmcnt(3)
  v_mfma_f32_32x32x16_bf16 v[160:175], a[192:195], v[32:35], v[224:239]
  v_exp_f32 v128, v128
  v_exp_f32 v129, v129
  v_mfma_f32_32x32x16_bf16 v[176:191], a[192:195], v[64:67], v[240:255]
  s_add_u32 m0, s71, 0
  v_exp_f32 v130, v130
  v_exp_f32 v131, v131
  v_mfma_f32_32x32x16_bf16 v[160:175], a[196:199], v[36:39], v[160:175]
  ds_read_b128 a[212:215], v10 offset:13312
  v_add_f32 v16, v16, v128
  v_add_f32 v17, v17, v129
  v_cvt_pk_bf16_f32 v192, v128, v129
  v_mfma_f32_32x32x16_bf16 v[176:191], a[196:199], v[68:71], v[176:191]
  v_exp_f32 v132, v132
  v_exp_f32 v133, v133
  s_waitcnt lgkmcnt(2)
  v_mfma_f32_32x32x16_bf16 v[160:175], a[200:203], v[40:43], v[160:175]
  ds_read_b128 a[216:219], v10 offset:14336
  v_add_f32 v16, v16, v130
  v_add_f32 v17, v17, v131
  v_cvt_pk_bf16_f32 v193, v130, v131
  v_mfma_f32_32x32x16_bf16 v[176:191], a[200:203], v[72:75], v[176:191]
  buffer_load_dwordx4 v25, s[64:67], s73 offen sc1 lds
  v_exp_f32 v134, v134
  v_mfma_f32_32x32x16_bf16 v[160:175], a[204:207], v[44:47], v[160:175]
  ds_read_b128 a[220:223], v10 offset:15360
  v_exp_f32 v135, v135
  v_add_f32 v16, v16, v132
  v_add_f32 v17, v17, v133
  v_mfma_f32_32x32x16_bf16 v[176:191], a[204:207], v[76:79], v[176:191]
  v_cvt_pk_bf16_f32 v194, v132, v133
  v_exp_f32 v136, v136
  v_exp_f32 v137, v137
  s_waitcnt lgkmcnt(2)
  v_mfma_f32_32x32x16_bf16 v[160:175], a[208:211], v[48:51], v[160:175]
  ds_read_b128 a[224:227], v13 offset:24576
  v_add_f32 v16, v16, v134
  v_add_f32 v17, v17, v135
  v_cvt_pk_bf16_f32 v195, v134, v135
  v_mfma_f32_32x32x16_bf16 v[176:191], a[208:211], v[80:83], v[176:191]
  v_exp_f32 v138, v138
  v_exp_f32 v139, v139
  v_mfma_f32_32x32x16_bf16 v[160:175], a[212:215], v[52:55], v[160:175]
  ds_read_b128 a[228:231], v13 offset:25600
  buffer_load_dwordx4 v25, s[64:67], s73 offen offset:1024 sc1 lds
  v_add_f32 v16, v16, v136
  v_mfma_f32_32x32x16_bf16 v[176:191], a[212:215], v[84:87], v[176:191]
  v_add_f32 v17, v17, v137
  v_cvt_pk_bf16_f32 v196, v136, v137
  v_exp_f32 v140, v140
  s_waitcnt lgkmcnt(2)
  v_mfma_f32_32x32x16_bf16 v[160:175], a[216:219], v[56:59], v[160:175]
  ds_read_b128 a[232:235], v13 offset:26624
  v_exp_f32 v141, v141
  v_add_f32 v16, v16, v138
  v_add_f32 v17, v17, v139
  v_mfma_f32_32x32x16_bf16 v[176:191], a[216:219], v[88:91], v[176:191]
  v_cvt_pk_bf16_f32 v197, v138, v139
  v_exp_f32 v142, v142
  v_exp_f32 v143, v143
  v_mfma_f32_32x32x16_bf16 v[160:175], a[220:223], v[60:63], v[160:175]
  ds_read_b128 a[236:239], v13 offset:27648
  v_add_f32 v16, v16, v140
  v_add_f32 v17, v17, v141
  v_cvt_pk_bf16_f32 v198, v140, v141
  v_mfma_f32_32x32x16_bf16 v[176:191], a[220:223], v[92:95], v[176:191]
  buffer_load_dwordx4 v25, s[64:67], s73 offen offset:2048 sc1 lds
  v_add_f32 v16, v16, v142
  v_add_f32 v17, v17, v143
  s_waitcnt lgkmcnt(2)
  v_mfma_f32_32x32x16_bf16 a[0:15], a[224:227], v[208:211], a[0:15]
  ds_read_b128 a[240:243], v13 offset:28672
  v_cvt_pk_bf16_f32 v199, v142, v143
  v_exp_f32 v144, v144
  v_mfma_f32_32x32x16_bf16 a[64:79], a[224:227], v[216:219], a[64:79]
  v_exp_f32 v145, v145
  v_exp_f32 v146, v146
  v_mfma_f32_32x32x16_bf16 a[16:31], a[228:231], v[208:211], a[16:31]
  ds_read_b128 a[244:247], v13 offset:29696
  v_exp_f32 v147, v147
  v_add_f32 v18, v18, v144
  v_add_f32 v19, v19, v145
  v_mfma_f32_32x32x16_bf16 a[80:95], a[228:231], v[216:219], a[80:95]
  v_cvt_pk_bf16_f32 v200, v144, v145
  v_exp_f32 v148, v148
  s_waitcnt lgkmcnt(2)
  v_mfma_f32_32x32x16_bf16 a[32:47], a[232:235], v[208:211], a[32:47]
  ds_read_b128 a[248:251], v13 offset:30720
  buffer_load_dwordx4 v25, s[64:67], s73 offen offset:3072 sc1 lds
  v_exp_f32 v149, v149
  v_mfma_f32_32x32x16_bf16 a[96:111], a[232:235], v[216:219], a[96:111]
  v_add_f32 v18, v18, v146
  v_add_f32 v19, v19, v147
  v_cvt_pk_bf16_f32 v201, v146, v147
  v_exp_f32 v150, v150
  v_mfma_f32_32x32x16_bf16 a[48:63], a[236:239], v[208:211], a[48:63]
  ds_read_b128 a[252:255], v13 offset:31744
  v_exp_f32 v151, v151
  v_add_f32 v18, v18, v148
  v_mfma_f32_32x32x16_bf16 a[112:127], a[236:239], v[216:219], a[112:127]
  v_add_f32 v19, v19, v149
  v_cvt_pk_bf16_f32 v202, v148, v149
  v_exp_f32 v152, v152
  s_waitcnt lgkmcnt(2)
  v_mfma_f32_32x32x16_bf16 a[0:15], a[240:243], v[212:215], a[0:15]
  v_exp_f32 v153, v153
  v_add_f32 v18, v18, v150
  v_add_f32 v19, v19, v151
  v_mfma_f32_32x32x16_bf16 a[64:79], a[240:243], v[220:223], a[64:79]
  s_add_u32 s73, s73, 16384
  v_cvt_pk_bf16_f32 v203, v150, v151
  v_exp_f32 v154, v154
  v_mfma_f32_32x32x16_bf16 a[16:31], a[244:247], v[212:215], a[16:31]
  ds_read_b128 a[192:195], v10 offset:16384
  v_exp_f32 v155, v155
  v_add_f32 v18, v18, v152
  v_add_f32 v19, v19, v153
  v_mfma_f32_32x32x16_bf16 a[80:95], a[244:247], v[220:223], a[80:95]
  ds_read_b128 a[196:199], v10 offset:17408
  v_cvt_pk_bf16_f32 v204, v152, v153
  v_exp_f32 v156, v156
  s_waitcnt lgkmcnt(2)
  v_mfma_f32_32x32x16_bf16 a[32:47], a[248:251], v[212:215], a[32:47]
  ds_read_b128 a[200:203], v10 offset:18432
  v_exp_f32 v157, v157
  v_add_f32 v18, v18, v154
  v_add_f32 v19, v19, v155
  v_mfma_f32_32x32x16_bf16 a[96:111], a[248:251], v[220:223], a[96:111]
  ds_read_b128 a[204:207], v10 offset:19456
  v_cvt_pk_bf16_f32 v205, v154, v155
  v_exp_f32 v158, v158
  v_mfma_f32_32x32x16_bf16 a[48:63], a[252:255], v[212:215], a[48:63]
  ds_read_b128 a[208:211], v10 offset:20480
  v_exp_f32 v159, v159
  v_add_f32 v18, v18, v156
  v_add_f32 v19, v19, v157
  v_mfma_f32_32x32x16_bf16 a[112:127], a[252:255], v[220:223], a[112:127]
  v_cvt_pk_bf16_f32 v206, v156, v157
  v_add_f32 v18, v18, v158
  v_add_f32 v19, v19, v159
  v_cvt_pk_bf16_f32 v207, v158, v159
  s_waitcnt lgkmcnt(3)
  v_mfma_f32_32x32x16_bf16 v[128:143], a[192:195], v[32:35], v[224:239]
  s_waitcnt vmcnt(12)
  s_barrier
  v_exp_f32 v160, v160
  v_mfma_f32_32x32x16_bf16 v[144:159], a[192:195], v[64:67], v[240:255]
  s_add_u32 m0, s68, 0
  v_exp_f32 v161, v161
  v_exp_f32 v162, v162
  v_mfma_f32_32x32x16_bf16 v[128:143], a[196:199], v[36:39], v[128:143]
  ds_read_b128 a[212:215], v10 offset:21504
  v_exp_f32 v163, v163
  v_add_f32 v16, v16, v160
  v_add_f32 v17, v17, v161
  v_mfma_f32_32x32x16_bf16 v[144:159], a[196:199], v[68:71], v[144:159]
  v_cvt_pk_bf16_f32 v208, v160, v161
  v_exp_f32 v164, v164
  v_exp_f32 v165, v165
  s_waitcnt lgkmcnt(2)
  v_mfma_f32_32x32x16_bf16 v[128:143], a[200:203], v[40:43], v[128:143]
  ds_read_b128 a[216:219], v10 offset:22528
  v_add_f32 v16, v16, v162
  v_add_f32 v17, v17, v163
  v_cvt_pk_bf16_f32 v209, v162, v163
  v_mfma_f32_32x32x16_bf16 v[144:159], a[200:203], v[72:75], v[144:159]
  buffer_load_dwordx4 v25, s[60:63], s72 offen sc1 lds
  v_exp_f32 v166, v166
  v_mfma_f32_32x32x16_bf16 v[128:143], a[204:207], v[44:47], v[128:143]
  ds_read_b128 a[220:223], v10 offset:23552
  v_exp_f32 v167, v167
  v_add_f32 v16, v16, v164
  v_mfma_f32_32x32x16_bf16 v[144:159], a[204:207], v[76:79], v[144:159]
  v_add_f32 v17, v17, v165
  v_cvt_pk_bf16_f32 v210, v164, v165
  v_exp_f32 v168, v168
  s_waitcnt lgkmcnt(2)
  v_mfma_f32_32x32x16_bf16 v[128:143], a[208:211], v[48:51], v[128:143]
  ds_read_b128 a[224:227], v12
  v_exp_f32 v169, v169
  v_add_f32 v16, v16, v166
  v_add_f32 v17, v17, v167
  v_mfma_f32_32x32x16_bf16 v[144:159], a[208:211], v[80:83], v[144:159]
  v_cvt_pk_bf16_f32 v211, v166, v167
  v_exp_f32 v170, v170
  v_exp_f32 v171, v171
  v_mfma_f32_32x32x16_bf16 v[128:143], a[212:215], v[52:55], v[128:143]
  ds_read_b128 a[228:231], v12 offset:1024
  buffer_load_dwordx4 v25, s[60:63], s72 offen offset:1024 sc1 lds
  v_mfma_f32_32x32x16_bf16 v[144:159], a[212:215], v[84:87], v[144:159]
  v_add_f32 v16, v16, v168
  v_add_f32 v17, v17, v169
  v_cvt_pk_bf16_f32 v212, v168, v169
  v_exp_f32 v172, v172
  s_waitcnt lgkmcnt(2)
  v_mfma_f32_32x32x16_bf16 v[128:143], a[216:219], v[56:59], v[128:143]
  ds_read_b128 a[232:235], v12 offset:2048
  v_exp_f32 v173, v173
  v_add_f32 v16, v16, v170
  v_mfma_f32_32x32x16_bf16 v[144:159], a[216:219], v[88:91], v[144:159]
  v_add_f32 v17, v17, v171
  v_cvt_pk_bf16_f32 v213, v170, v171
  v_exp_f32 v174, v174
  v_mfma_f32_32x32x16_bf16 v[128:143], a[220:223], v[60:63], v[128:143]
  ds_read_b128 a[236:239], v12 offset:3072
  v_exp_f32 v175, v175
  v_add_f32 v16, v16, v172
  v_add_f32 v17, v17, v173
  v_mfma_f32_32x32x16_bf16 v[144:159], a[220:223], v[92:95], v[144:159]
  buffer_load_dwordx4 v25, s[60:63], s72 offen offset:2048 sc1 lds
  v_cvt_pk_bf16_f32 v214, v172, v173
  v_add_f32 v16, v16, v174
  s_waitcnt lgkmcnt(2)
  v_mfma_f32_32x32x16_bf16 a[0:15], a[224:227], v[192:195], a[0:15]
  ds_read_b128 a[240:243], v12 offset:4096
  v_add_f32 v17, v17, v175
  v_cvt_pk_bf16_f32 v215, v174, v175
  v_exp_f32 v176, v176
  v_mfma_f32_32x32x16_bf16 a[64:79], a[224:227], v[200:203], a[64:79]
  v_exp_f32 v177, v177
  v_exp_f32 v178, v178
  v_mfma_f32_32x32x16_bf16 a[16:31], a[228:231], v[192:195], a[16:31]
  ds_read_b128 a[244:247], v12 offset:5120
  v_exp_f32 v179, v179
  v_add_f32 v18, v18, v176
  v_mfma_f32_32x32x16_bf16 a[80:95], a[228:231], v[200:203], a[80:95]
  v_add_f32 v19, v19, v177
  v_cvt_pk_bf16_f32 v216, v176, v177
  v_exp_f32 v180, v180
  s_waitcnt lgkmcnt(2)
  v_mfma_f32_32x32x16_bf16 a[32:47], a[232:235], v[192:195], a[32:47]
  ds_read_b128 a[248:251], v12 offset:6144
  buffer_load_dwordx4 v25, s[60:63], s72 offen offset:3072 sc1 lds
  v_exp_f32 v181, v181
  v_mfma_f32_32x32x16_bf16 a[96:111], a[232:235], v[200:203], a[96:111]
  v_add_f32 v18, v18, v178
  v_add_f32 v19, v19, v179
  v_cvt_pk_bf16_f32 v217, v178, v179
  v_mfma_f32_32x32x16_bf16 a[48:63], a[236:239], v[192:195], a[48:63]
  ds_read_b128 a[252:255], v12 offset:7168
  v_exp_f32 v182, v182
  v_exp_f32 v183, v183
  v_mfma_f32_32x32x16_bf16 a[112:127], a[236:239], v[200:203], a[112:127]
  v_add_f32 v18, v18, v180
  v_add_f32 v19, v19, v181
  v_cvt_pk_bf16_f32 v218, v180, v181
  v_exp_f32 v184, v184
  s_waitcnt lgkmcnt(2)
  v_mfma_f32_32x32x16_bf16 a[0:15], a[240:243], v[196:199], a[0:15]
  v_exp_f32 v185, v185
  v_add_f32 v18, v18, v182
  v_add_f32 v19, v19, v183
  v_mfma_f32_32x32x16_bf16 a[64:79], a[240:243], v[204:207], a[64:79]
  s_add_u32 s72, s72, 16384
  v_cvt_pk_bf16_f32 v219, v182, v183
  v_exp_f32 v186, v186
  v_mfma_f32_32x32x16_bf16 a[16:31], a[244:247], v[196:199], a[16:31]
  ds_read_b128 a[192:195], v10 offset:24576
  v_exp_f32 v187, v187
  v_add_f32 v18, v18, v184
  v_add_f32 v19, v19, v185
  v_mfma_f32_32x32x16_bf16 a[80:95], a[244:247], v[204:207], a[80:95]
  ds_read_b128 a[196:199], v10 offset:25600
  v_cvt_pk_bf16_f32 v220, v184, v185
  v_exp_f32 v188, v188
  s_waitcnt lgkmcnt(2)
  v_mfma_f32_32x32x16_bf16 a[32:47], a[248:251], v[196:199], a[32:47]
  ds_read_b128 a[200:203], v10 offset:26624
  v_exp_f32 v189, v189
  v_add_f32 v18, v18, v186
  v_add_f32 v19, v19, v187
  v_mfma_f32_32x32x16_bf16 a[96:111], a[248:251], v[204:207], a[96:111]
  ds_read_b128 a[204:207], v10 offset:27648
  v_cvt_pk_bf16_f32 v221, v186, v187
  v_exp_f32 v190, v190
  v_mfma_f32_32x32x16_bf16 a[48:63], a[252:255], v[196:199], a[48:63]
  ds_read_b128 a[208:211], v10 offset:28672
  v_exp_f32 v191, v191
  v_add_f32 v18, v18, v188
  v_add_f32 v19, v19, v189
  v_mfma_f32_32x32x16_bf16 a[112:127], a[252:255], v[204:207], a[112:127]
  v_cvt_pk_bf16_f32 v222, v188, v189
  v_add_f32 v18, v18, v190
  v_add_f32 v19, v19, v191
  v_cvt_pk_bf16_f32 v223, v190, v191
  s_waitcnt lgkmcnt(3)
  v_mfma_f32_32x32x16_bf16 v[160:175], a[192:195], v[32:35], v[224:239]
  v_exp_f32 v128, v128
  v_exp_f32 v129, v129
  v_mfma_f32_32x32x16_bf16 v[176:191], a[192:195], v[64:67], v[240:255]
  s_add_u32 m0, s71, 0x4000
  v_exp_f32 v130, v130
  v_exp_f32 v131, v131
  v_mfma_f32_32x32x16_bf16 v[160:175], a[196:199], v[36:39], v[160:175]
  ds_read_b128 a[212:215], v10 offset:29696
  v_add_f32 v16, v16, v128
  v_add_f32 v17, v17, v129
  v_cvt_pk_bf16_f32 v192, v128, v129
  v_exp_f32 v132, v132
  v_mfma_f32_32x32x16_bf16 v[176:191], a[196:199], v[68:71], v[176:191]
  v_exp_f32 v133, v133
  v_add_f32 v16, v16, v130
  v_add_f32 v17, v17, v131
  s_waitcnt lgkmcnt(2)
  v_mfma_f32_32x32x16_bf16 v[160:175], a[200:203], v[40:43], v[160:175]
  ds_read_b128 a[216:219], v10 offset:30720
  buffer_load_dwordx4 v25, s[64:67], s73 offen sc1 lds
  v_cvt_pk_bf16_f32 v193, v130, v131
  v_mfma_f32_32x32x16_bf16 v[176:191], a[200:203], v[72:75], v[176:191]
  v_exp_f32 v134, v134
  v_exp_f32 v135, v135
  v_add_f32 v16, v16, v132
  v_mfma_f32_32x32x16_bf16 v[160:175], a[204:207], v[44:47], v[160:175]
  ds_read_b128 a[220:223], v10 offset:31744
  v_add_f32 v17, v17, v133
  v_cvt_pk_bf16_f32 v194, v132, v133
  v_exp_f32 v136, v136
  v_mfma_f32_32x32x16_bf16 v[176:191], a[204:207], v[76:79], v[176:191]
  v_xor_b32 v10, 0x8000, v10
  v_exp_f32 v137, v137
  v_add_f32 v16, v16, v134
  s_waitcnt lgkmcnt(2)
  v_mfma_f32_32x32x16_bf16 v[160:175], a[208:211], v[48:51], v[160:175]
  ds_read_b128 a[224:227], v12 offset:8192
  buffer_load_dwordx4 v25, s[64:67], s73 offen offset:1024 sc1 lds
  v_xor_b32 v11, 0x8000, v11
  v_add_f32 v17, v17, v135
  v_mfma_f32_32x32x16_bf16 v[176:191], a[208:211], v[80:83], v[176:191]
  v_cvt_pk_bf16_f32 v195, v134, v135
  v_exp_f32 v138, v138
  v_exp_f32 v139, v139
  v_mfma_f32_32x32x16_bf16 v[160:175], a[212:215], v[52:55], v[160:175]
  ds_read_b128 a[228:231], v12 offset:9216
  v_add_f32 v16, v16, v136
  v_add_f32 v17, v17, v137
  v_cvt_pk_bf16_f32 v196, v136, v137
  v_mfma_f32_32x32x16_bf16 v[176:191], a[212:215], v[84:87], v[176:191]
  v_exp_f32 v140, v140
  v_exp_f32 v141, v141
  v_add_f32 v16, v16, v138
  s_waitcnt lgkmcnt(2)
  v_mfma_f32_32x32x16_bf16 v[160:175], a[216:219], v[56:59], v[160:175]
  ds_read_b128 a[232:235], v12 offset:10240
  buffer_load_dwordx4 v25, s[64:67], s73 offen offset:2048 sc1 lds
  v_add_f32 v17, v17, v139
  v_mfma_f32_32x32x16_bf16 v[176:191], a[216:219], v[88:91], v[176:191]
  v_cvt_pk_bf16_f32 v197, v138, v139
  v_exp_f32 v142, v142
  v_exp_f32 v143, v143
  v_mfma_f32_32x32x16_bf16 v[160:175], a[220:223], v[60:63], v[160:175]
  ds_read_b128 a[236:239], v12 offset:11264
  v_add_f32 v16, v16, v140
  v_add_f32 v17, v17, v141
  v_cvt_pk_bf16_f32 v198, v140, v141
  v_mfma_f32_32x32x16_bf16 v[176:191], a[220:223], v[92:95], v[176:191]
  v_add_f32 v16, v16, v142
  v_add_f32 v17, v17, v143
  v_cvt_pk_bf16_f32 v199, v142, v143
  v_exp_f32 v144, v144
  s_waitcnt lgkmcnt(2)
  v_mfma_f32_32x32x16_bf16 a[0:15], a[224:227], v[208:211], a[0:15]
  ds_read_b128 a[240:243], v12 offset:12288
  buffer_load_dwordx4 v25, s[64:67], s73 offen offset:3072 sc1 lds
  v_exp_f32 v145, v145
  v_mfma_f32_32x32x16_bf16 a[64:79], a[224:227], v[216:219], a[64:79]
  v_exp_f32 v146, v146
  v_exp_f32 v147, v147
  v_mfma_f32_32x32x16_bf16 a[16:31], a[228:231], v[208:211], a[16:31]
  ds_read_b128 a[244:247], v12 offset:13312
  v_add_f32 v18, v18, v144
  v_add_f32 v19, v19, v145
  v_cvt_pk_bf16_f32 v200, v144, v145
  v_mfma_f32_32x32x16_bf16 a[80:95], a[228:231], v[216:219], a[80:95]
  v_exp_f32 v148, v148
  v_exp_f32 v149, v149
  v_add_f32 v18, v18, v146
  s_waitcnt lgkmcnt(2)
  v_mfma_f32_32x32x16_bf16 a[32:47], a[232:235], v[208:211], a[32:47]
  ds_read_b128 a[248:251], v12 offset:14336
  s_add_u32 s73, s73, 16384
  v_add_f32 v19, v19, v147
  v_cvt_pk_bf16_f32 v201, v146, v147
  v_exp_f32 v150, v150
  v_mfma_f32_32x32x16_bf16 a[96:111], a[232:235], v[216:219], a[96:111]
  s_xor_b32 s68, s68, 0x8000
  s_xor_b32 s69, s69, 0x8000
  v_exp_f32 v151, v151
  v_mfma_f32_32x32x16_bf16 a[48:63], a[236:239], v[208:211], a[48:63]
  ds_read_b128 a[252:255], v12 offset:15360
  s_xor_b32 s70, s70, 0x8000
  s_xor_b32 s71, s71, 0x8000
  v_add_f32 v18, v18, v148
  v_add_f32 v19, v19, v149
  v_mfma_f32_32x32x16_bf16 a[112:127], a[236:239], v[216:219], a[112:127]
  v_xor_b32 v12, 0x8000, v12
  s_sub_u32 s74, s74, 1
  v_cvt_pk_bf16_f32 v202, v148, v149
  v_exp_f32 v152, v152
  s_waitcnt lgkmcnt(2)
  v_mfma_f32_32x32x16_bf16 a[0:15], a[240:243], v[212:215], a[0:15]
  v_xor_b32 v13, 0x8000, v13
  v_exp_f32 v153, v153
  v_add_f32 v18, v18, v150
  v_add_f32 v19, v19, v151
  v_mfma_f32_32x32x16_bf16 a[64:79], a[240:243], v[220:223], a[64:79]
  v_cvt_pk_bf16_f32 v203, v150, v151
  v_exp_f32 v154, v154
  v_exp_f32 v155, v155
  v_mfma_f32_32x32x16_bf16 a[16:31], a[244:247], v[212:215], a[16:31]
  ds_read_b128 a[192:195], v10
  v_add_f32 v18, v18, v152
  v_add_f32 v19, v19, v153
  v_cvt_pk_bf16_f32 v204, v152, v153
  v_mfma_f32_32x32x16_bf16 a[80:95], a[244:247], v[220:223], a[80:95]
  ds_read_b128 a[196:199], v10 offset:1024
  v_exp_f32 v156, v156
  v_exp_f32 v157, v157
  s_waitcnt lgkmcnt(2)
  v_mfma_f32_32x32x16_bf16 a[32:47], a[248:251], v[212:215], a[32:47]
  ds_read_b128 a[200:203], v10 offset:2048
  v_add_f32 v18, v18, v154
  v_add_f32 v19, v19, v155
  v_cvt_pk_bf16_f32 v205, v154, v155
  v_mfma_f32_32x32x16_bf16 a[96:111], a[248:251], v[220:223], a[96:111]
  ds_read_b128 a[204:207], v10 offset:3072
  v_exp_f32 v158, v158
  v_exp_f32 v159, v159
  v_add_f32 v18, v18, v156
  v_mfma_f32_32x32x16_bf16 a[48:63], a[252:255], v[212:215], a[48:63]
  ds_read_b128 a[208:211], v10 offset:4096
  v_add_f32 v19, v19, v157
  v_cvt_pk_bf16_f32 v206, v156, v157
  v_add_f32 v18, v18, v158
  v_mfma_f32_32x32x16_bf16 a[112:127], a[252:255], v[220:223], a[112:127]
  v_add_f32 v19, v19, v159
  v_cvt_pk_bf16_f32 v207, v158, v159
  s_cmp_lg_u32 s74, 0
  s_cbranch_scc1 L_b_D
L_b_DM:
  s_cmp_lg_u32 s42, 0
  s_cbranch_scc1 L_b_ev_8
  v_accvgpr_read_b32 v8, a128
  v_add_f32 v224, v224, v8
  v_accvgpr_read_b32 v9, a129
  v_add_f32 v225, v225, v9
  v_accvgpr_read_b32 v8, a130
  v_add_f32 v226, v226, v8
  v_accvgpr_read_b32 v9, a131
  v_add_f32 v227, v227, v9
  v_accvgpr_read_b32 v8, a132
  v_add_f32 v228, v228, v8
  v_accvgpr_read_b32 v9, a133
  v_add_f32 v229, v229, v9
  v_accvgpr_read_b32 v8, a134
  v_add_f32 v230, v230, v8
  v_accvgpr_read_b32 v9, a135
  v_add_f32 v231, v231, v9
  v_accvgpr_read_b32 v8, a136
  v_add_f32 v232, v232, v8
  v_accvgpr_read_b32 v9, a137
  v_add_f32 v233, v233, v9
  v_accvgpr_read_b32 v8, a138
  v_add_f32 v234, v234, v8
  v_accvgpr_read_b32 v9, a139
  v_add_f32 v235, v235, v9
  v_accvgpr_read_b32 v8, a140
  v_add_f32 v236, v236, v8
  v_accvgpr_read_b32 v9, a141
  v_add_f32 v237, v237, v9
  v_accvgpr_read_b32 v8, a142
  v_add_f32 v238, v238, v8
  v_accvgpr_read_b32 v9, a143
  v_add_f32 v239, v239, v9
L_b_ev_8:
  s_nop 1
  s_waitcnt lgkmcnt(3)
  v_mfma_f32_32x32x16_bf16 v[128:143], a[192:195], v[32:35], v[224:239]
  s_waitcnt vmcnt(12)
  s_barrier
  v_exp_f32 v160, v160
  v_mfma_f32_32x32x16_bf16 v[144:159], a[192:195], v[64:67], v[240:255]
  s_add_u32 m0, s69, 0x4000
  v_exp_f32 v161, v161
  v_exp_f32 v162, v162
  v_mfma_f32_32x32x16_bf16 v[128:143], a[196:199], v[36:39], v[128:143]
  ds_read_b128 a[212:215], v10 offset:5120
  v_exp_f32 v163, v163
  v_add_f32 v16, v16, v160
  v_add_f32 v17, v17, v161
  v_mfma_f32_32x32x16_bf16 v[144:159], a[196:199], v[68:71], v[144:159]
  v_cvt_pk_bf16_f32 v208, v160, v161
  v_exp_f32 v164, v164
  v_exp_f32 v165, v165
  s_waitcnt lgkmcnt(2)
  v_mfma_f32_32x32x16_bf16 v[128:143], a[200:203], v[40:43], v[128:143]
  ds_read_b128 a[216:219], v10 offset:6144
  v_add_f32 v16, v16, v162
  v_add_f32 v17, v17, v163
  v_cvt_pk_bf16_f32 v209, v162, v163
  v_mfma_f32_32x32x16_bf16 v[144:159], a[200:203], v[72:75], v[144:159]
  buffer_load_dwordx4 v25, s[60:63], s72 offen sc1 lds
  v_exp_f32 v166, v166
  v_mfma_f32_32x32x16_bf16 v[128:143], a[204:207], v[44:47], v[128:143]
  ds_read_b128 a[220:223], v10 offset:7168
  v_exp_f32 v167, v167
  v_add_f32 v16, v16, v164
  v_mfma_f32_32x32x16_bf16 v[144:159], a[204:207], v[76:79], v[144:159]
  v_add_f32 v17, v17, v165
  v_cvt_pk_bf16_f32 v210, v164, v165
  v_exp_f32 v168, v168
  s_waitcnt lgkmcnt(2)
  v_mfma_f32_32x32x16_bf16 v[128:143], a[208:211], v[48:51], v[128:143]
  ds_read_b128 a[224:227], v13 offset:16384
  v_exp_f32 v169, v169
  v_add_f32 v16, v16, v166
  v_add_f32 v17, v17, v167
  v_mfma_f32_32x32x16_bf16 v[144:159], a[208:211], v[80:83], v[144:159]
  v_cvt_pk_bf16_f32 v211, v166, v167
  v_exp_f32 v170, v170
  v_exp_f32 v171, v171
  v_mfma_f32_32x32x16_bf16 v[128:143], a[212:215], v[52:55], v[128:143]
  ds_read_b128 a[228:231], v13 offset:17408
  buffer_load_dwordx4 v25, s[60:63], s72 offen offset:1024 sc1 lds
  v_mfma_f32_32x32x16_bf16 v[144:159], a[212:215], v[84:87], v[144:159]
  v_add_f32 v16, v16, v168
  v_add_f32 v17, v17, v169
  v_cvt_pk_bf16_f32 v212, v168, v169
  v_exp_f32 v172, v172
  s_waitcnt lgkmcnt(2)
  v_mfma_f32_32x32x16_bf16 v[128:143], a[216:219], v[56:59], v[128:143]
  ds_read_b128 a[232:235], v13 offset:18432
  v_exp_f32 v173, v173
  v_add_f32 v16, v16, v170
  v_mfma_f32_32x32x16_bf16 v[144:159], a[216:219], v[88:91], v[144:159]
  v_add_f32 v17, v17, v171
  v_cvt_pk_bf16_f32 v213, v170, v171
  v_exp_f32 v174, v174
  v_mfma_f32_32x32x16_bf16 v[128:143], a[220:223], v[60:63], v[128:143]
  ds_read_b128 a[236:239], v13 offset:19456
  v_exp_f32 v175, v175
  v_add_f32 v16, v16, v172
  v_add_f32 v17, v17, v173
  v_mfma_f32_32x32x16_bf16 v[144:159], a[220:223], v[92:95], v[144:159]
  buffer_load_dwordx4 v25, s[60:63], s72 offen offset:2048 sc1 lds
  v_cvt_pk_bf16_f32 v214, v172, v173
  v_add_f32 v16, v16, v174
  s_waitcnt lgkmcnt(2)
  v_mfma_f32_32x32x16_bf16 a[0:15], a[224:227], v[192:195], a[0:15]
  ds_read_b128 a[240:243], v13 offset:20480
  v_add_f32 v17, v17, v175
  v_cvt_pk_bf16_f32 v215, v174, v175
  v_exp_f32 v176, v176
  v_mfma_f32_32x32x16_bf16 a[64:79], a[224:227], v[200:203], a[64:79]
  v_exp_f32 v177, v177
  v_exp_f32 v178, v178
  v_mfma_f32_32x32x16_bf16 a[16:31], a[228:231], v[192:195], a[16:31]
  ds_read_b128 a[244:247], v13 offset:21504
  v_exp_f32 v179, v179
  v_add_f32 v18, v18, v176
  v_mfma_f32_32x32x16_bf16 a[80:95], a[228:231], v[200:203], a[80:95]
  v_add_f32 v19, v19, v177
  v_cvt_pk_bf16_f32 v216, v176, v177
  v_exp_f32 v180, v180
  s_waitcnt lgkmcnt(2)
  v_mfma_f32_32x32x16_bf16 a[32:47], a[232:235], v[192:195], a[32:47]
  ds_read_b128 a[248:251], v13 offset:22528
  buffer_load_dwordx4 v25, s[60:63], s72 offen offset:3072 sc1 lds
  v_exp_f32 v181, v181
  v_mfma_f32_32x32x16_bf16 a[96:111], a[232:235], v[200:203], a[96:111]
  v_add_f32 v18, v18, v178
  v_add_f32 v19, v19, v179
  v_cvt_pk_bf16_f32 v217, v178, v179
  v_mfma_f32_32x32x16_bf16 a[48:63], a[236:239], v[192:195], a[48:63]
  ds_read_b128 a[252:255], v13 offset:23552
  v_exp_f32 v182, v182
  v_exp_f32 v183, v183
  v_mfma_f32_32x32x16_bf16 a[112:127], a[236:239], v[200:203], a[112:127]
  v_add_f32 v18, v18, v180
  v_add_f32 v19, v19, v181
  v_cvt_pk_bf16_f32 v218, v180, v181
  v_exp_f32 v184, v184
  s_waitcnt lgkmcnt(2)
  v_mfma_f32_32x32x16_bf16 a[0:15], a[240:243], v[196:199], a[0:15]
  v_exp_f32 v185, v185
  v_add_f32 v18, v18, v182
  v_add_f32 v19, v19, v183
  v_mfma_f32_32x32x16_bf16 a[64:79], a[240:243], v[204:207], a[64:79]
  s_add_u32 s72, s72, 16384
  v_cvt_pk_bf16_f32 v219, v182, v183
  v_exp_f32 v186, v186
  v_mfma_f32_32x32x16_bf16 a[16:31], a[244:247], v[196:199], a[16:31]
  ds_read_b128 a[192:195], v10 offset:8192
  v_exp_f32 v187, v187
  v_add_f32 v18, v18, v184
  v_add_f32 v19, v19, v185
  v_mfma_f32_32x32x16_bf16 a[80:95], a[244:247], v[204:207], a[80:95]
  ds_read_b128 a[196:199], v10 offset:9216
  v_cvt_pk_bf16_f32 v220, v184, v185
  v_exp_f32 v188, v188
  s_waitcnt lgkmcnt(2)
  v_mfma_f32_32x32x16_bf16 a[32:47], a[248:251], v[196:199], a[32:47]
  ds_read_b128 a[200:203], v10 offset:10240
  v_exp_f32 v189, v189
  v_add_f32 v18, v18, v186
  v_add_f32 v19, v19, v187
  v_mfma_f32_32x32x16_bf16 a[96:111], a[248:251], v[204:207], a[96:111]
  ds_read_b128 a[204:207], v10 offset:11264
  v_cvt_pk_bf16_f32 v221, v186, v187
  v_exp_f32 v190, v190
  v_mfma_f32_32x32x16_bf16 a[48:63], a[252:255], v[196:199], a[48:63]
  ds_read_b128 a[208:211], v10 offset:12288
  v_exp_f32 v191, v191
  v_add_f32 v18, v18, v188
  v_add_f32 v19, v19, v189
  v_mfma_f32_32x32x16_bf16 a[112:127], a[252:255], v[204:207], a[112:127]
  v_cvt_pk_bf16_f32 v222, v188, v189
  v_add_f32 v18, v18, v190
  v_add_f32 v19, v19, v191
  v_cvt_pk_bf16_f32 v223, v190, v191
  s_cmp_lg_u32 s42, 1
  s_cbranch_scc1 L_b_ev_10
  v_accvgpr_read_b32 v8, a128
  v_add_f32 v224, v224, v8
  v_accvgpr_read_b32 v9, a129
  v_add_f32 v225, v225, v9
  v_accvgpr_read_b32 v8, a130
  v_add_f32 v226, v226, v8
  v_accvgpr_read_b32 v9, a131
  v_add_f32 v227, v227, v9
  v_accvgpr_read_b32 v8, a132
  v_add_f32 v228, v228, v8
  v_accvgpr_read_b32 v9, a133
  v_add_f32 v229, v229, v9
  v_accvgpr_read_b32 v8, a134
  v_add_f32 v230, v230, v8
  v_accvgpr_read_b32 v9, a135
  v_add_f32 v231, v231, v9
  v_accvgpr_read_b32 v8, a136
  v_add_f32 v232, v232, v8
  v_accvgpr_read_b32 v9, a137
  v_add_f32 v233, v233, v9
  v_accvgpr_read_b32 v8, a138
  v_add_f32 v234, v234, v8
  v_accvgpr_read_b32 v9, a139
  v_add_f32 v235, v235, v9
  v_accvgpr_read_b32 v8, a140
  v_add_f32 v236, v236, v8
  v_accvgpr_read_b32 v9, a141
  v_add_f32 v237, v237, v9
  v_accvgpr_read_b32 v8, a142
  v_add_f32 v238, v238, v8
  v_accvgpr_read_b32 v9, a143
  v_add_f32 v239, v239, v9
L_b_ev_10:
  s_cmp_lg_u32 s42, 0
  s_cbranch_scc1 L_b_ev_11
  v_mov_b32 v224, 0xff800000
  v_mov_b32 v225, 0xff800000
  v_mov_b32 v226, 0xff800000
  v_mov_b32 v227, 0xff800000
  v_mov_b32 v228, 0xff800000
  v_mov_b32 v229, 0xff800000
  v_mov_b32 v230, 0xff800000
  v_mov_b32 v231, 0xff800000
  v_mov_b32 v232, 0xff800000
  v_mov_b32 v233, 0xff800000
  v_mov_b32 v234, 0xff800000
  v_mov_b32 v235, 0xff800000
  v_mov_b32 v236, 0xff800000
  v_mov_b32 v237, 0xff800000
  v_mov_b32 v238, 0xff800000
  v_mov_b32 v239, 0xff800000
L_b_ev_11:
  s_nop 1
  s_waitcnt lgkmcnt(3)
  v_mfma_f32_32x32x16_bf16 v[160:175], a[192:195], v[32:35], v[224:239]
  v_exp_f32 v128, v128
  v_exp_f32 v129, v129
  v_mfma_f32_32x32x16_bf16 v[176:191], a[192:195], v[64:67], v[240:255]
  s_add_u32 m0, s71, 0
  v_exp_f32 v130, v130
  v_exp_f32 v131, v131
  v_mfma_f32_32x32x16_bf16 v[160:175], a[196:199], v[36:39], v[160:175]
  ds_read_b128 a[212:215], v10 offset:13312
  v_add_f32 v16, v16, v128
  v_add_f32 v17, v17, v129
  v_cvt_pk_bf16_f32 v192, v128, v129
  v_mfma_f32_32x32x16_bf16 v[176:191], a[196:199], v[68:71], v[176:191]
  v_exp_f32 v132, v132
  v_exp_f32 v133, v133
  s_waitcnt lgkmcnt(2)
  v_mfma_f32_32x32x16_bf16 v[160:175], a[200:203], v[40:43], v[160:175]
  ds_read_b128 a[216:219], v10 offset:14336
  v_add_f32 v16, v16, v130
  v_add_f32 v17, v17, v131
  v_cvt_pk_bf16_f32 v193, v130, v131
  v_mfma_f32_32x32x16_bf16 v[176:191], a[200:203], v[72:75], v[176:191]
  buffer_load_dwordx4 v25, s[64:67], s73 offen sc1 lds
  v_exp_f32 v134, v134
  v_mfma_f32_32x32x16_bf16 v[160:175], a[204:207], v[44:47], v[160:175]
  ds_read_b128 a[220:223], v10 offset:15360
  v_exp_f32 v135, v135
  v_add_f32 v16, v16, v132
  v_add_f32 v17, v17, v133
  v_mfma_f32_32x32x16_bf16 v[176:191], a[204:207], v[76:79], v[176:191]
  v_cvt_pk_bf16_f32 v194, v132, v133
  v_exp_f32 v136, v136
  v_exp_f32 v137, v137
  s_waitcnt lgkmcnt(2)
  v_mfma_f32_32x32x16_bf16 v[160:175], a[208:211], v[48:51], v[160:175]
  ds_read_b128 a[224:227], v13 offset:24576
  v_add_f32 v16, v16, v134
  v_add_f32 v17, v17, v135
  v_cvt_pk_bf16_f32 v195, v134, v135
  v_mfma_f32_32x32x16_bf16 v[176:191], a[208:211], v[80:83], v[176:191]
  v_exp_f32 v138, v138
  v_exp_f32 v139, v139
  v_mfma_f32_32x32x16_bf16 v[160:175], a[212:215], v[52:55], v[160:175]
  ds_read_b128 a[228:231], v13 offset:25600
  buffer_load_dwordx4 v25, s[64:67], s73 offen offset:1024 sc1 lds
  v_add_f32 v16, v16, v136
  v_mfma_f32_32x32x16_bf16 v[176:191], a[212:215], v[84:87], v[176:191]
  v_add_f32 v17, v17, v137
  v_cvt_pk_bf16_f32 v196, v136, v137
  v_exp_f32 v140, v140
  s_waitcnt lgkmcnt(2)
  v_mfma_f32_32x32x16_bf16 v[160:175], a[216:219], v[56:59], v[160:175]
  ds_read_b128 a[232:235], v13 offset:26624
  v_exp_f32 v141, v141
  v_add_f32 v16, v16, v138
  v_add_f32 v17, v17, v139
  v_mfma_f32_32x32x16_bf16 v[176:191], a[216:219], v[88:91], v[176:191]
  v_cvt_pk_bf16_f32 v197, v138, v139
  v_exp_f32 v142, v142
  v_exp_f32 v143, v143
  v_mfma_f32_32x32x16_bf16 v[160:175], a[220:223], v[60:63], v[160:175]
  ds_read_b128 a[236:239], v13 offset:27648
  v_add_f32 v16, v16, v140
  v_add_f32 v17, v17, v141
  v_cvt_pk_bf16_f32 v198, v140, v141
  v_mfma_f32_32x32x16_bf16 v[176:191], a[220:223], v[92:95], v[176:191]
  buffer_load_dwordx4 v25, s[64:67], s73 offen offset:2048 sc1 lds
  v_add_f32 v16, v16, v142
  v_add_f32 v17, v17, v143
  s_waitcnt lgkmcnt(2)
  v_mfma_f32_32x32x16_bf16 a[0:15], a[224:227], v[208:211], a[0:15]
  ds_read_b128 a[240:243], v13 offset:28672
  v_cvt_pk_bf16_f32 v199, v142, v143
  v_exp_f32 v144, v144
  v_mfma_f32_32x32x16_bf16 a[64:79], a[224:227], v[216:219], a[64:79]
  v_exp_f32 v145, v145
  v_exp_f32 v146, v146
  v_mfma_f32_32x32x16_bf16 a[16:31], a[228:231], v[208:211], a[16:31]
  ds_read_b128 a[244:247], v13 offset:29696
  v_exp_f32 v147, v147
  v_add_f32 v18, v18, v144
  v_add_f32 v19, v19, v145
  v_mfma_f32_32x32x16_bf16 a[80:95], a[228:231], v[216:219], a[80:95]
  v_cvt_pk_bf16_f32 v200, v144, v145
  v_exp_f32 v148, v148
  s_waitcnt lgkmcnt(2)
  v_mfma_f32_32x32x16_bf16 a[32:47], a[232:235], v[208:211], a[32:47]
  ds_read_b128 a[248:251], v13 offset:30720
  buffer_load_dwordx4 v25, s[64:67], s73 offen offset:3072 sc1 lds
  v_exp_f32 v149, v149
  v_mfma_f32_32x32x16_bf16 a[96:111], a[232:235], v[216:219], a[96:111]
  v_add_f32 v18, v18, v146
  v_add_f32 v19, v19, v147
  v_cvt_pk_bf16_f32 v201, v146, v147
  v_exp_f32 v150, v150
  v_mfma_f32_32x32x16_bf16 a[48:63], a[236:239], v[208:211], a[48:63]
  ds_read_b128 a[252:255], v13 offset:31744
  v_exp_f32 v151, v151
  v_add_f32 v18, v18, v148
  v_mfma_f32_32x32x16_bf16 a[112:127], a[236:239], v[216:219], a[112:127]
  v_add_f32 v19, v19, v149
  v_cvt_pk_bf16_f32 v202, v148, v149
  v_exp_f32 v152, v152
  s_waitcnt lgkmcnt(2)
  v_mfma_f32_32x32x16_bf16 a[0:15], a[240:243], v[212:215], a[0:15]
  v_exp_f32 v153, v153
  v_add_f32 v18, v18, v150
  v_add_f32 v19, v19, v151
  v_mfma_f32_32x32x16_bf16 a[64:79], a[240:243], v[220:223], a[64:79]
  s_add_u32 s73, s73, 16384
  v_cvt_pk_bf16_f32 v203, v150, v151
  v_exp_f32 v154, v154
  v_mfma_f32_32x32x16_bf16 a[16:31], a[244:247], v[212:215], a[16:31]
  ds_read_b128 a[192:195], v10 offset:16384
  v_exp_f32 v155, v155
  v_add_f32 v18, v18, v152
  v_add_f32 v19, v19, v153
  v_mfma_f32_32x32x16_bf16 a[80:95], a[244:247], v[220:223], a[80:95]
  ds_read_b128 a[196:199], v10 offset:17408
  v_cvt_pk_bf16_f32 v204, v152, v153
  v_exp_f32 v156, v156
  s_waitcnt lgkmcnt(2)
  v_mfma_f32_32x32x16_bf16 a[32:47], a[248:251], v[212:215], a[32:47]
  ds_read_b128 a[200:203], v10 offset:18432
  v_exp_f32 v157, v157
  v_add_f32 v18, v18, v154
  v_add_f32 v19, v19, v155
  v_mfma_f32_32x32x16_bf16 a[96:111], a[248:251], v[220:223], a[96:111]
  ds_read_b128 a[204:207], v10 offset:19456
  v_cvt_pk_bf16_f32 v205, v154, v155
  v_exp_f32 v158, v158
  v_mfma_f32_32x32x16_bf16 a[48:63], a[252:255], v[212:215], a[48:63]
  ds_read_b128 a[208:211], v10 offset:20480
  v_exp_f32 v159, v159
  v_add_f32 v18, v18, v156
  v_add_f32 v19, v19, v157
  v_mfma_f32_32x32x16_bf16 a[112:127], a[252:255], v[220:223], a[112:127]
  v_cvt_pk_bf16_f32 v206, v156, v157
  v_add_f32 v18, v18, v158
  v_add_f32 v19, v19, v159
  v_cvt_pk_bf16_f32 v207, v158, v159
  s_cmp_lg_u32 s42, 2
  s_cbranch_scc1 L_b_ev_12
  v_accvgpr_read_b32 v8, a128
  v_add_f32 v224, v224, v8
  v_accvgpr_read_b32 v9, a129
  v_add_f32 v225, v225, v9
  v_accvgpr_read_b32 v8, a130
  v_add_f32 v226, v226, v8
  v_accvgpr_read_b32 v9, a131
  v_add_f32 v227, v227, v9
  v_accvgpr_read_b32 v8, a132
  v_add_f32 v228, v228, v8
  v_accvgpr_read_b32 v9, a133
  v_add_f32 v229, v229, v9
  v_accvgpr_read_b32 v8, a134
  v_add_f32 v230, v230, v8
  v_accvgpr_read_b32 v9, a135
  v_add_f32 v231, v231, v9
  v_accvgpr_read_b32 v8, a136
  v_add_f32 v232, v232, v8
  v_accvgpr_read_b32 v9, a137
  v_add_f32 v233, v233, v9
  v_accvgpr_read_b32 v8, a138
  v_add_f32 v234, v234, v8
  v_accvgpr_read_b32 v9, a139
  v_add_f32 v235, v235, v9
  v_accvgpr_read_b32 v8, a140
  v_add_f32 v236, v236, v8
  v_accvgpr_read_b32 v9, a141
  v_add_f32 v237, v237, v9
  v_accvgpr_read_b32 v8, a142
  v_add_f32 v238, v238, v8
  v_accvgpr_read_b32 v9, a143
  v_add_f32 v239, v239, v9
L_b_ev_12:
  s_cmp_lg_u32 s42, 1
  s_cbranch_scc1 L_b_ev_13
  v_mov_b32 v224, 0xff800000
  v_mov_b32 v225, 0xff800000
  v_mov_b32 v226, 0xff800000
  v_mov_b32 v227, 0xff800000
  v_mov_b32 v228, 0xff800000
  v_mov_b32 v229, 0xff800000
  v_mov_b32 v230, 0xff800000
  v_mov_b32 v231, 0xff800000
  v_mov_b32 v232, 0xff800000
  v_mov_b32 v233, 0xff800000
  v_mov_b32 v234, 0xff800000
  v_mov_b32 v235, 0xff800000
  v_mov_b32 v236, 0xff800000
  v_mov_b32 v237, 0xff800000
  v_mov_b32 v238, 0xff800000
  v_mov_b32 v239, 0xff800000
L_b_ev_13:
  s_nop 1
  s_waitcnt lgkmcnt(3)
  v_mfma_f32_32x32x16_bf16 v[128:143], a[192:195], v[32:35], v[224:239]
  s_waitcnt vmcnt(12)
  s_barrier
  v_exp_f32 v160, v160
  v_mfma_f32_32x32x16_bf16 v[144:159], a[192:195], v[64:67], v[240:255]
  s_add_u32 m0, s68, 0
  v_exp_f32 v161, v161
  v_exp_f32 v162, v162
  v_mfma_f32_32x32x16_bf16 v[128:143], a[196:199], v[36:39], v[128:143]
  ds_read_b128 a[212:215], v10 offset:21504
  v_exp_f32 v163, v163
  v_add_f32 v16, v16, v160
  v_add_f32 v17, v17, v161
  v_mfma_f32_32x32x16_bf16 v[144:159], a[196:199], v[68:71], v[144:159]
  v_cvt_pk_bf16_f32 v208, v160, v161
  v_exp_f32 v164, v164
  v_exp_f32 v165, v165
  s_waitcnt lgkmcnt(2)
  v_mfma_f32_32x32x16_bf16 v[128:143], a[200:203], v[40:43], v[128:143]
  ds_read_b128 a[216:219], v10 offset:22528
  v_add_f32 v16, v16, v162
  v_add_f32 v17, v17, v163
  v_cvt_pk_bf16_f32 v209, v162, v163
  v_mfma_f32_32x32x16_bf16 v[144:159], a[200:203], v[72:75], v[144:159]
  buffer_load_dwordx4 v25, s[60:63], s72 offen sc1 lds
  v_exp_f32 v166, v166
  v_mfma_f32_32x32x16_bf16 v[128:143], a[204:207], v[44:47], v[128:143]
  ds_read_b128 a[220:223], v10 offset:23552
  v_exp_f32 v167, v167
  v_add_f32 v16, v16, v164
  v_mfma_f32_32x32x16_bf16 v[144:159], a[204:207], v[76:79], v[144:159]
  v_add_f32 v17, v17, v165
  v_cvt_pk_bf16_f32 v210, v164, v165
  v_exp_f32 v168, v168
  s_waitcnt lgkmcnt(2)
  v_mfma_f32_32x32x16_bf16 v[128:143], a[208:211], v[48:51], v[128:143]
  ds_read_b128 a[224:227], v12
  v_exp_f32 v169, v169
  v_add_f32 v16, v16, v166
  v_add_f32 v17, v17, v167
  v_mfma_f32_32x32x16_bf16 v[144:159], a[208:211], v[80:83], v[144:159]
  v_cvt_pk_bf16_f32 v211, v166, v167
  v_exp_f32 v170, v170
  v_exp_f32 v171, v171
  v_mfma_f32_32x32x16_bf16 v[128:143], a[212:215], v[52:55], v[128:143]
  ds_read_b128 a[228:231], v12 offset:1024
  buffer_load_dwordx4 v25, s[60:63], s72 offen offset:1024 sc1 lds
  v_mfma_f32_32x32x16_bf16 v[144:159], a[212:215], v[84:87], v[144:159]
  v_add_f32 v16, v16, v168
  v_add_f32 v17, v17, v169
  v_cvt_pk_bf16_f32 v212, v168, v169
  v_exp_f32 v172, v172
  s_waitcnt lgkmcnt(2)
  v_mfma_f32_32x32x16_bf16 v[128:143], a[216:219], v[56:59], v[128:143]
  ds_read_b128 a[232:235], v12 offset:2048
  v_exp_f32 v173, v173
  v_add_f32 v16, v16, v170
  v_mfma_f32_32x32x16_bf16 v[144:159], a[216:219], v[88:91], v[144:159]
  v_add_f32 v17, v17, v171
  v_cvt_pk_bf16_f32 v213, v170, v171
  v_exp_f32 v174, v174
  v_mfma_f32_32x32x16_bf16 v[128:143], a[220:223], v[60:63], v[128:143]
  ds_read_b128 a[236:239], v12 offset:3072
  v_exp_f32 v175, v175
  v_add_f32 v16, v16, v172
  v_add_f32 v17, v17, v173
  v_mfma_f32_32x32x16_bf16 v[144:159], a[220:223], v[92:95], v[144:159]
  buffer_load_dwordx4 v25, s[60:63], s72 offen offset:2048 sc1 lds
  v_cvt_pk_bf16_f32 v214, v172, v173
  v_add_f32 v16, v16, v174
  s_waitcnt lgkmcnt(2)
  v_mfma_f32_32x32x16_bf16 a[0:15], a[224:227], v[192:195], a[0:15]
  ds_read_b128 a[240:243], v12 offset:4096
  v_add_f32 v17, v17, v175
  v_cvt_pk_bf16_f32 v215, v174, v175
  v_exp_f32 v176, v176
  v_mfma_f32_32x32x16_bf16 a[64:79], a[224:227], v[200:203], a[64:79]
  v_exp_f32 v177, v177
  v_exp_f32 v178, v178
  v_mfma_f32_32x32x16_bf16 a[16:31], a[228:231], v[192:195], a[16:31]
  ds_read_b128 a[244:247], v12 offset:5120
  v_exp_f32 v179, v179
  v_add_f32 v18, v18, v176
  v_mfma_f32_32x32x16_bf16 a[80:95], a[228:231], v[200:203], a[80:95]
  v_add_f32 v19, v19, v177
  v_cvt_pk_bf16_f32 v216, v176, v177
  v_exp_f32 v180, v180
  s_waitcnt lgkmcnt(2)
  v_mfma_f32_32x32x16_bf16 a[32:47], a[232:235], v[192:195], a[32:47]
  ds_read_b128 a[248:251], v12 offset:6144
  buffer_load_dwordx4 v25, s[60:63], s72 offen offset:3072 sc1 lds
  v_exp_f32 v181, v181
  v_mfma_f32_32x32x16_bf16 a[96:111], a[232:235], v[200:203], a[96:111]
  v_add_f32 v18, v18, v178
  v_add_f32 v19, v19, v179
  v_cvt_pk_bf16_f32 v217, v178, v179
  v_mfma_f32_32x32x16_bf16 a[48:63], a[236:239], v[192:195], a[48:63]
  ds_read_b128 a[252:255], v12 offset:7168
  v_exp_f32 v182, v182
  v_exp_f32 v183, v183
  v_mfma_f32_32x32x16_bf16 a[112:127], a[236:239], v[200:203], a[112:127]
  v_add_f32 v18, v18, v180
  v_add_f32 v19, v19, v181
  v_cvt_pk_bf16_f32 v218, v180, v181
  v_exp_f32 v184, v184
  s_waitcnt lgkmcnt(2)
  v_mfma_f32_32x32x16_bf16 a[0:15], a[240:243], v[196:199], a[0:15]
  v_exp_f32 v185, v185
  v_add_f32 v18, v18, v182
  v_add_f32 v19, v19, v183
  v_mfma_f32_32x32x16_bf16 a[64:79], a[240:243], v[204:207], a[64:79]
  s_add_u32 s72, s72, 16384
  v_cvt_pk_bf16_f32 v219, v182, v183
  v_exp_f32 v186, v186
  v_mfma_f32_32x32x16_bf16 a[16:31], a[244:247], v[196:199], a[16:31]
  ds_read_b128 a[192:195], v10 offset:24576
  v_exp_f32 v187, v187
  v_add_f32 v18, v18, v184
  v_add_f32 v19, v19, v185
  v_mfma_f32_32x32x16_bf16 a[80:95], a[244:247], v[204:207], a[80:95]
  ds_read_b128 a[196:199], v10 offset:25600
  v_cvt_pk_bf16_f32 v220, v184, v185
  v_exp_f32 v188, v188
  s_waitcnt lgkmcnt(2)
  v_mfma_f32_32x32x16_bf16 a[32:47], a[248:251], v[196:199], a[32:47]
  ds_read_b128 a[200:203], v10 offset:26624
  v_exp_f32 v189, v189
  v_add_f32 v18, v18, v186
  v_add_f32 v19, v19, v187
  v_mfma_f32_32x32x16_bf16 a[96:111], a[248:251], v[204:207], a[96:111]
  ds_read_b128 a[204:207], v10 offset:27648
  v_cvt_pk_bf16_f32 v221, v186, v187
  v_exp_f32 v190, v190
  v_mfma_f32_32x32x16_bf16 a[48:63], a[252:255], v[196:199], a[48:63]
  ds_read_b128 a[208:211], v10 offset:28672
  v_exp_f32 v191, v191
  v_add_f32 v18, v18, v188
  v_add_f32 v19, v19, v189
  v_mfma_f32_32x32x16_bf16 a[112:127], a[252:255], v[204:207], a[112:127]
  v_cvt_pk_bf16_f32 v222, v188, v189
  v_add_f32 v18, v18, v190
  v_add_f32 v19, v19, v191
  v_cvt_pk_bf16_f32 v223, v190, v191
  s_cmp_lg_u32 s42, 3
  s_cbranch_scc1 L_b_ev_14
  v_accvgpr_read_b32 v8, a128
  v_add_f32 v224, v224, v8
  v_accvgpr_read_b32 v9, a129
  v_add_f32 v225, v225, v9
  v_accvgpr_read_b32 v8, a130
  v_add_f32 v226, v226, v8
  v_accvgpr_read_b32 v9, a131
  v_add_f32 v227, v227, v9
  v_accvgpr_read_b32 v8, a132
  v_add_f32 v228, v228, v8
  v_accvgpr_read_b32 v9, a133
  v_add_f32 v229, v229, v9
  v_accvgpr_read_b32 v8, a134
  v_add_f32 v230, v230, v8
  v_accvgpr_read_b32 v9, a135
  v_add_f32 v231, v231, v9
  v_accvgpr_read_b32 v8, a136
  v_add_f32 v232, v232, v8
  v_accvgpr_read_b32 v9, a137
  v_add_f32 v233, v233, v9
  v_accvgpr_read_b32 v8, a138
  v_add_f32 v234, v234, v8
  v_accvgpr_read_b32 v9, a139
  v_add_f32 v235, v235, v9
  v_accvgpr_read_b32 v8, a140
  v_add_f32 v236, v236, v8
  v_accvgpr_read_b32 v9, a141
  v_add_f32 v237, v237, v9
  v_accvgpr_read_b32 v8, a142
  v_add_f32 v238, v238, v8
  v_accvgpr_read_b32 v9, a143
  v_add_f32 v239, v239, v9
L_b_ev_14:
  s_cmp_lg_u32 s42, 2
  s_cbranch_scc1 L_b_ev_15
  v_mov_b32 v224, 0xff800000
  v_mov_b32 v225, 0xff800000
  v_mov_b32 v226, 0xff800000
  v_mov_b32 v227, 0xff800000
  v_mov_b32 v228, 0xff800000
  v_mov_b32 v229, 0xff800000
  v_mov_b32 v230, 0xff800000
  v_mov_b32 v231, 0xff800000
  v_mov_b32 v232, 0xff800000
  v_mov_b32 v233, 0xff800000
  v_mov_b32 v234, 0xff800000
  v_mov_b32 v235, 0xff800000
  v_mov_b32 v236, 0xff800000
  v_mov_b32 v237, 0xff800000
  v_mov_b32 v238, 0xff800000
  v_mov_b32 v239, 0xff800000
L_b_ev_15:
  s_nop 1
  s_waitcnt lgkmcnt(3)
  v_mfma_f32_32x32x16_bf16 v[160:175], a[192:195], v[32:35], v[224:239]
  v_exp_f32 v128, v128
  v_exp_f32 v129, v129
  v_mfma_f32_32x32x16_bf16 v[176:191], a[192:195], v[64:67], v[240:255]
  s_add_u32 m0, s71, 0x4000
  v_exp_f32 v130, v130
  v_exp_f32 v131, v131
  v_mfma_f32_32x32x16_bf16 v[160:175], a[196:199], v[36:39], v[160:175]
  ds_read_b128 a[212:215], v10 offset:29696
  v_add_f32 v16, v16, v128
  v_add_f32 v17, v17, v129
  v_cvt_pk_bf16_f32 v192, v128, v129
  v_mfma_f32_32x32x16_bf16 v[176:191], a[196:199], v[68:71], v[176:191]
  v_exp_f32 v132, v132
  v_exp_f32 v133, v133
  v_add_f32 v16, v16, v130
  s_waitcnt lgkmcnt(2)
  v_mfma_f32_32x32x16_bf16 v[160:175], a[200:203], v[40:43], v[160:175]
  ds_read_b128 a[216:219], v10 offset:30720
  buffer_load_dwordx4 v25, s[64:67], s73 offen sc1 lds
  v_add_f32 v17, v17, v131
  v_mfma_f32_32x32x16_bf16 v[176:191], a[200:203], v[72:75], v[176:191]
  v_cvt_pk_bf16_f32 v193, v130, v131
  v_exp_f32 v134, v134
  v_exp_f32 v135, v135
  v_mfma_f32_32x32x16_bf16 v[160:175], a[204:207], v[44:47], v[160:175]
  ds_read_b128 a[220:223], v10 offset:31744
  v_add_f32 v16, v16, v132
  v_add_f32 v17, v17, v133
  v_cvt_pk_bf16_f32 v194, v132, v133
  v_mfma_f32_32x32x16_bf16 v[176:191], a[204:207], v[76:79], v[176:191]
  v_xor_b32 v10, 0x8000, v10
  v_exp_f32 v136, v136
  v_exp_f32 v137, v137
  s_waitcnt lgkmcnt(2)
  v_mfma_f32_32x32x16_bf16 v[160:175], a[208:211], v[48:51], v[160:175]
  ds_read_b128 a[224:227], v12 offset:8192
  buffer_load_dwordx4 v25, s[64:67], s73 offen offset:1024 sc1 lds
  v_xor_b32 v11, 0x8000, v11
  v_add_f32 v16, v16, v134
  v_mfma_f32_32x32x16_bf16 v[176:191], a[208:211], v[80:83], v[176:191]
  v_add_f32 v17, v17, v135
  v_cvt_pk_bf16_f32 v195, v134, v135
  v_exp_f32 v138, v138
  v_mfma_f32_32x32x16_bf16 v[160:175], a[212:215], v[52:55], v[160:175]
  ds_read_b128 a[228:231], v12 offset:9216
  v_exp_f32 v139, v139
  v_add_f32 v16, v16, v136
  v_add_f32 v17, v17, v137
  v_mfma_f32_32x32x16_bf16 v[176:191], a[212:215], v[84:87], v[176:191]
  v_cvt_pk_bf16_f32 v196, v136, v137
  v_exp_f32 v140, v140
  v_exp_f32 v141, v141
  s_waitcnt lgkmcnt(2)
  v_mfma_f32_32x32x16_bf16 v[160:175], a[216:219], v[56:59], v[160:175]
  ds_read_b128 a[232:235], v12 offset:10240
  buffer_load_dwordx4 v25, s[64:67], s73 offen offset:2048 sc1 lds
  v_add_f32 v16, v16, v138
  v_mfma_f32_32x32x16_bf16 v[176:191], a[216:219], v[88:91], v[176:191]
  v_add_f32 v17, v17, v139
  v_cvt_pk_bf16_f32 v197, v138, v139
  v_exp_f32 v142, v142
  v_mfma_f32_32x32x16_bf16 v[160:175], a[220:223], v[60:63], v[160:175]
  ds_read_b128 a[236:239], v12 offset:11264
  v_exp_f32 v143, v143
  v_add_f32 v16, v16, v140
  v_add_f32 v17, v17, v141
  v_mfma_f32_32x32x16_bf16 v[176:191], a[220:223], v[92:95], v[176:191]
  v_cvt_pk_bf16_f32 v198, v140, v141
  v_add_f32 v16, v16, v142
  v_add_f32 v17, v17, v143
  v_cvt_pk_bf16_f32 v199, v142, v143
  s_waitcnt lgkmcnt(2)
  v_mfma_f32_32x32x16_bf16 a[0:15], a[224:227], v[208:211], a[0:15]
  ds_read_b128 a[240:243], v12 offset:12288
  buffer_load_dwordx4 v25, s[64:67], s73 offen offset:3072 sc1 lds
  v_exp_f32 v144, v144
  v_mfma_f32_32x32x16_bf16 a[64:79], a[224:227], v[216:219], a[64:79]
  v_exp_f32 v145, v145
  v_exp_f32 v146, v146
  v_mfma_f32_32x32x16_bf16 a[16:31], a[228:231], v[208:211], a[16:31]
  ds_read_b128 a[244:247], v12 offset:13312
  v_exp_f32 v147, v147
  v_add_f32 v18, v18, v144
  v_mfma_f32_32x32x16_bf16 a[80:95], a[228:231], v[216:219], a[80:95]
  v_add_f32 v19, v19, v145
  v_cvt_pk_bf16_f32 v200, v144, v145
  v_exp_f32 v148, v148
  s_waitcnt lgkmcnt(2)
  v_mfma_f32_32x32x16_bf16 a[32:47], a[232:235], v[208:211], a[32:47]
  ds_read_b128 a[248:251], v12 offset:14336
  s_add_u32 s73, s73, 16384
  v_exp_f32 v149, v149
  v_add_f32 v18, v18, v146
  v_add_f32 v19, v19, v147
  v_mfma_f32_32x32x16_bf16 a[96:111], a[232:235], v[216:219], a[96:111]
  s_xor_b32 s68, s68, 0x8000
  s_xor_b32 s69, s69, 0x8000
  v_cvt_pk_bf16_f32 v201, v146, v147
  v_exp_f32 v150, v150
  v_mfma_f32_32x32x16_bf16 a[48:63], a[236:239], v[208:211], a[48:63]
  ds_read_b128 a[252:255], v12 offset:15360
  s_xor_b32 s70, s70, 0x8000
  s_xor_b32 s71, s71, 0x8000
  v_exp_f32 v151, v151
  v_mfma_f32_32x32x16_bf16 a[112:127], a[236:239], v[216:219], a[112:127]
  v_xor_b32 v12, 0x8000, v12
  v_add_f32 v18, v18, v148
  v_add_f32 v19, v19, v149
  v_cvt_pk_bf16_f32 v202, v148, v149
  s_waitcnt lgkmcnt(2)
  v_mfma_f32_32x32x16_bf16 a[0:15], a[240:243], v[212:215], a[0:15]
  v_xor_b32 v13, 0x8000, v13
  v_exp_f32 v152, v152
  v_exp_f32 v153, v153
  v_mfma_f32_32x32x16_bf16 a[64:79], a[240:243], v[220:223], a[64:79]
  v_add_f32 v18, v18, v150
  v_add_f32 v19, v19, v151
  v_cvt_pk_bf16_f32 v203, v150, v151
  v_exp_f32 v154, v154
  v_mfma_f32_32x32x16_bf16 a[16:31], a[244:247], v[212:215], a[16:31]
  ds_read_b128 a[192:195], v10
  v_exp_f32 v155, v155
  v_add_f32 v18, v18, v152
  v_mfma_f32_32x32x16_bf16 a[80:95], a[244:247], v[220:223], a[80:95]
  ds_read_b128 a[196:199], v10 offset:1024
  v_add_f32 v19, v19, v153
  v_cvt_pk_bf16_f32 v204, v152, v153
  v_exp_f32 v156, v156
  s_waitcnt lgkmcnt(2)
  v_mfma_f32_32x32x16_bf16 a[32:47], a[248:251], v[212:215], a[32:47]
  ds_read_b128 a[200:203], v10 offset:2048
  v_exp_f32 v157, v157
  v_add_f32 v18, v18, v154
  v_mfma_f32_32x32x16_bf16 a[96:111], a[248:251], v[220:223], a[96:111]
  ds_read_b128 a[204:207], v10 offset:3072
  v_add_f32 v19, v19, v155
  v_cvt_pk_bf16_f32 v205, v154, v155
  v_exp_f32 v158, v158
  v_mfma_f32_32x32x16_bf16 a[48:63], a[252:255], v[212:215], a[48:63]
  ds_read_b128 a[208:211], v10 offset:4096
  v_exp_f32 v159, v159
  v_add_f32 v18, v18, v156
  v_add_f32 v19, v19, v157
  v_mfma_f32_32x32x16_bf16 a[112:127], a[252:255], v[220:223], a[112:127]
  v_cvt_pk_bf16_f32 v206, v156, v157
  v_add_f32 v18, v18, v158
  v_add_f32 v19, v19, v159
  v_cvt_pk_bf16_f32 v207, v158, v159
  s_cmp_eq_u32 s40, 7
  s_cbranch_scc1 L_b_TDM
  s_branch L_b_TD
L_b_FM:
  s_waitcnt vmcnt(12)
  s_barrier
  s_add_u32 m0, s69, 0x4000
  s_nop 0
  buffer_load_dwordx4 v25, s[60:63], s72 offen sc1 lds
  buffer_load_dwordx4 v25, s[60:63], s72 offen offset:1024 sc1 lds
  buffer_load_dwordx4 v25, s[60:63], s72 offen offset:2048 sc1 lds
  buffer_load_dwordx4 v25, s[60:63], s72 offen offset:3072 sc1 lds
  s_add_u32 s72, s72, 16384
  ds_read_b128 a[192:195], v10 offset:8192
  ds_read_b128 a[196:199], v10 offset:9216
  ds_read_b128 a[200:203], v10 offset:10240
  ds_read_b128 a[204:207], v10 offset:11264
  ds_read_b128 a[208:211], v10 offset:12288
  s_cmp_lg_u32 s42, 1
  s_cbranch_scc1 L_b_ev_2
  v_accvgpr_read_b32 v8, a128
  v_add_f32 v224, v224, v8
  v_accvgpr_read_b32 v9, a129
  v_add_f32 v225, v225, v9
  v_accvgpr_read_b32 v8, a130
  v_add_f32 v226, v226, v8
  v_accvgpr_read_b32 v9, a131
  v_add_f32 v227, v227, v9
  v_accvgpr_read_b32 v8, a132
  v_add_f32 v228, v228, v8
  v_accvgpr_read_b32 v9, a133
  v_add_f32 v229, v229, v9
  v_accvgpr_read_b32 v8, a134
  v_add_f32 v230, v230, v8
  v_accvgpr_read_b32 v9, a135
  v_add_f32 v231, v231, v9
  v_accvgpr_read_b32 v8, a136
  v_add_f32 v232, v232, v8
  v_accvgpr_read_b32 v9, a137
  v_add_f32 v233, v233, v9
  v_accvgpr_read_b32 v8, a138
  v_add_f32 v234, v234, v8
  v_accvgpr_read_b32 v9, a139
  v_add_f32 v235, v235, v9
  v_accvgpr_read_b32 v8, a140
  v_add_f32 v236, v236, v8
  v_accvgpr_read_b32 v9, a141
  v_add_f32 v237, v237, v9
  v_accvgpr_read_b32 v8, a142
  v_add_f32 v238, v238, v8
  v_accvgpr_read_b32 v9, a143
  v_add_f32 v239, v239, v9
L_b_ev_2:
  s_cmp_lg_u32 s42, 0
  s_cbranch_scc1 L_b_ev_3
  v_mov_b32 v224, 0xff800000
  v_mov_b32 v225, 0xff800000
  v_mov_b32 v226, 0xff800000
  v_mov_b32 v227, 0xff800000
  v_mov_b32 v228, 0xff800000
  v_mov_b32 v229, 0xff800000
  v_mov_b32 v230, 0xff800000
  v_mov_b32 v231, 0xff800000
  v_mov_b32 v232, 0xff800000
  v_mov_b32 v233, 0xff800000
  v_mov_b32 v234, 0xff800000
  v_mov_b32 v235, 0xff800000
  v_mov_b32 v236, 0xff800000
  v_mov_b32 v237, 0xff800000
  v_mov_b32 v238, 0xff800000
  v_mov_b32 v239, 0xff800000
L_b_ev_3:
  s_nop 1
  s_waitcnt lgkmcnt(3)
  v_mfma_f32_32x32x16_bf16 v[160:175], a[192:195], v[32:35], v[224:239]
  v_exp_f32 v128, v128
  v_exp_f32 v129, v129
  v_exp_f32 v130, v130
  v_exp_f32 v131, v131
  v_add_f32 v16, v16, v128
  v_mfma_f32_32x32x16_bf16 v[176:191], a[192:195], v[64:67], v[240:255]
  s_add_u32 m0, s71, 0
  v_add_f32 v17, v17, v129
  v_cvt_pk_bf16_f32 v192, v128, v129
  v_exp_f32 v132, v132
  v_exp_f32 v133, v133
  v_add_f32 v16, v16, v130
  v_add_f32 v17, v17, v131
  v_mfma_f32_32x32x16_bf16 v[160:175], a[196:199], v[36:39], v[160:175]
  ds_read_b128 a[212:215], v10 offset:13312
  v_cvt_pk_bf16_f32 v193, v130, v131
  v_exp_f32 v134, v134
  v_exp_f32 v135, v135
  v_add_f32 v16, v16, v132
  v_add_f32 v17, v17, v133
  v_mfma_f32_32x32x16_bf16 v[176:191], a[196:199], v[68:71], v[176:191]
  buffer_load_dwordx4 v25, s[64:67], s73 offen sc1 lds
  v_cvt_pk_bf16_f32 v194, v132, v133
  v_exp_f32 v136, v136
  v_exp_f32 v137, v137
  s_waitcnt lgkmcnt(2)
  v_mfma_f32_32x32x16_bf16 v[160:175], a[200:203], v[40:43], v[160:175]
  ds_read_b128 a[216:219], v10 offset:14336
  v_add_f32 v16, v16, v134
  v_add_f32 v17, v17, v135
  v_cvt_pk_bf16_f32 v195, v134, v135
  v_exp_f32 v138, v138
  v_exp_f32 v139, v139
  v_mfma_f32_32x32x16_bf16 v[176:191], a[200:203], v[72:75], v[176:191]
  buffer_load_dwordx4 v25, s[64:67], s73 offen offset:1024 sc1 lds
  v_add_f32 v16, v16, v136
  v_add_f32 v17, v17, v137
  v_cvt_pk_bf16_f32 v196, v136, v137
  v_exp_f32 v140, v140
  v_mfma_f32_32x32x16_bf16 v[160:175], a[204:207], v[44:47], v[160:175]
  ds_read_b128 a[220:223], v10 offset:15360
  v_exp_f32 v141, v141
  v_add_f32 v16, v16, v138
  v_add_f32 v17, v17, v139
  v_cvt_pk_bf16_f32 v197, v138, v139
  v_exp_f32 v142, v142
  v_mfma_f32_32x32x16_bf16 v[176:191], a[204:207], v[76:79], v[176:191]
  buffer_load_dwordx4 v25, s[64:67], s73 offen offset:2048 sc1 lds
  v_exp_f32 v143, v143
  v_add_f32 v16, v16, v140
  v_add_f32 v17, v17, v141
  v_cvt_pk_bf16_f32 v198, v140, v141
  s_waitcnt lgkmcnt(2)
  v_mfma_f32_32x32x16_bf16 v[160:175], a[208:211], v[48:51], v[160:175]
  v_add_f32 v16, v16, v142
  v_add_f32 v17, v17, v143
  v_cvt_pk_bf16_f32 v199, v142, v143
  v_exp_f32 v144, v144
  v_exp_f32 v145, v145
  v_exp_f32 v146, v146
  v_mfma_f32_32x32x16_bf16 v[176:191], a[208:211], v[80:83], v[176:191]
  buffer_load_dwordx4 v25, s[64:67], s73 offen offset:3072 sc1 lds
  v_exp_f32 v147, v147
  v_add_f32 v18, v18, v144
  v_add_f32 v19, v19, v145
  v_cvt_pk_bf16_f32 v200, v144, v145
  v_mfma_f32_32x32x16_bf16 v[160:175], a[212:215], v[52:55], v[160:175]
  ds_read_b128 a[192:195], v10 offset:16384
  v_exp_f32 v148, v148
  v_exp_f32 v149, v149
  v_add_f32 v18, v18, v146
  v_add_f32 v19, v19, v147
  v_cvt_pk_bf16_f32 v201, v146, v147
  v_mfma_f32_32x32x16_bf16 v[176:191], a[212:215], v[84:87], v[176:191]
  ds_read_b128 a[196:199], v10 offset:17408
  s_add_u32 s73, s73, 16384
  v_exp_f32 v150, v150
  v_exp_f32 v151, v151
  v_add_f32 v18, v18, v148
  v_add_f32 v19, v19, v149
  s_waitcnt lgkmcnt(2)
  v_mfma_f32_32x32x16_bf16 v[160:175], a[216:219], v[56:59], v[160:175]
  ds_read_b128 a[200:203], v10 offset:18432
  v_cvt_pk_bf16_f32 v202, v148, v149
  v_exp_f32 v152, v152
  v_exp_f32 v153, v153
  v_add_f32 v18, v18, v150
  v_add_f32 v19, v19, v151
  v_cvt_pk_bf16_f32 v203, v150, v151
  v_mfma_f32_32x32x16_bf16 v[176:191], a[216:219], v[88:91], v[176:191]
  ds_read_b128 a[204:207], v10 offset:19456
  v_exp_f32 v154, v154
  v_exp_f32 v155, v155
  v_add_f32 v18, v18, v152
  v_add_f32 v19, v19, v153
  v_cvt_pk_bf16_f32 v204, v152, v153
  v_mfma_f32_32x32x16_bf16 v[160:175], a[220:223], v[60:63], v[160:175]
  ds_read_b128 a[208:211], v10 offset:20480
  v_exp_f32 v156, v156
  v_exp_f32 v157, v157
  v_add_f32 v18, v18, v154
  v_add_f32 v19, v19, v155
  v_cvt_pk_bf16_f32 v205, v154, v155
  v_mfma_f32_32x32x16_bf16 v[176:191], a[220:223], v[92:95], v[176:191]
  v_exp_f32 v158, v158
  v_exp_f32 v159, v159
  v_add_f32 v18, v18, v156
  v_add_f32 v19, v19, v157
  v_cvt_pk_bf16_f32 v206, v156, v157
  v_add_f32 v18, v18, v158
  v_add_f32 v19, v19, v159
  v_cvt_pk_bf16_f32 v207, v158, v159
  s_cmp_lg_u32 s42, 2
  s_cbranch_scc1 L_b_ev_4
  v_accvgpr_read_b32 v8, a128
  v_add_f32 v224, v224, v8
  v_accvgpr_read_b32 v9, a129
  v_add_f32 v225, v225, v9
  v_accvgpr_read_b32 v8, a130
  v_add_f32 v226, v226, v8
  v_accvgpr_read_b32 v9, a131
  v_add_f32 v227, v227, v9
  v_accvgpr_read_b32 v8, a132
  v_add_f32 v228, v228, v8
  v_accvgpr_read_b32 v9, a133
  v_add_f32 v229, v229, v9
  v_accvgpr_read_b32 v8, a134
  v_add_f32 v230, v230, v8
  v_accvgpr_read_b32 v9, a135
  v_add_f32 v231, v231, v9
  v_accvgpr_read_b32 v8, a136
  v_add_f32 v232, v232, v8
  v_accvgpr_read_b32 v9, a137
  v_add_f32 v233, v233, v9
  v_accvgpr_read_b32 v8, a138
  v_add_f32 v234, v234, v8
  v_accvgpr_read_b32 v9, a139
  v_add_f32 v235, v235, v9
  v_accvgpr_read_b32 v8, a140
  v_add_f32 v236, v236, v8
  v_accvgpr_read_b32 v9, a141
  v_add_f32 v237, v237, v9
  v_accvgpr_read_b32 v8, a142
  v_add_f32 v238, v238, v8
  v_accvgpr_read_b32 v9, a143
  v_add_f32 v239, v239, v9
L_b_ev_4:
  s_cmp_lg_u32 s42, 1
  s_cbranch_scc1 L_b_ev_5
  v_mov_b32 v224, 0xff800000
  v_mov_b32 v225, 0xff800000
  v_mov_b32 v226, 0xff800000
  v_mov_b32 v227, 0xff800000
  v_mov_b32 v228, 0xff800000
  v_mov_b32 v229, 0xff800000
  v_mov_b32 v230, 0xff800000
  v_mov_b32 v231, 0xff800000
  v_mov_b32 v232, 0xff800000
  v_mov_b32 v233, 0xff800000
  v_mov_b32 v234, 0xff800000
  v_mov_b32 v235, 0xff800000
  v_mov_b32 v236, 0xff800000
  v_mov_b32 v237, 0xff800000
  v_mov_b32 v238, 0xff800000
  v_mov_b32 v239, 0xff800000
L_b_ev_5:
  s_nop 1
  s_waitcnt lgkmcnt(3)
  v_mfma_f32_32x32x16_bf16 v[128:143], a[192:195], v[32:35], v[224:239]
  s_waitcnt vmcnt(16)
  s_barrier
  v_exp_f32 v160, v160
  v_mfma_f32_32x32x16_bf16 v[144:159], a[192:195], v[64:67], v[240:255]
  s_add_u32 m0, s68, 0
  v_exp_f32 v161, v161
  v_exp_f32 v162, v162
  v_mfma_f32_32x32x16_bf16 v[128:143], a[196:199], v[36:39], v[128:143]
  ds_read_b128 a[212:215], v10 offset:21504
  v_exp_f32 v163, v163
  v_add_f32 v16, v16, v160
  v_add_f32 v17, v17, v161
  v_mfma_f32_32x32x16_bf16 v[144:159], a[196:199], v[68:71], v[144:159]
  v_cvt_pk_bf16_f32 v208, v160, v161
  v_exp_f32 v164, v164
  v_exp_f32 v165, v165
  s_waitcnt lgkmcnt(2)
  v_mfma_f32_32x32x16_bf16 v[128:143], a[200:203], v[40:43], v[128:143]
  ds_read_b128 a[216:219], v10 offset:22528
  v_add_f32 v16, v16, v162
  v_add_f32 v17, v17, v163
  v_cvt_pk_bf16_f32 v209, v162, v163
  v_mfma_f32_32x32x16_bf16 v[144:159], a[200:203], v[72:75], v[144:159]
  buffer_load_dwordx4 v25, s[60:63], s72 offen sc1 lds
  v_exp_f32 v166, v166
  v_mfma_f32_32x32x16_bf16 v[128:143], a[204:207], v[44:47], v[128:143]
  ds_read_b128 a[220:223], v10 offset:23552
  v_exp_f32 v167, v167
  v_add_f32 v16, v16, v164
  v_mfma_f32_32x32x16_bf16 v[144:159], a[204:207], v[76:79], v[144:159]
  v_add_f32 v17, v17, v165
  v_cvt_pk_bf16_f32 v210, v164, v165
  v_exp_f32 v168, v168
  s_waitcnt lgkmcnt(2)
  v_mfma_f32_32x32x16_bf16 v[128:143], a[208:211], v[48:51], v[128:143]
  ds_read_b128 a[224:227], v12
  v_exp_f32 v169, v169
  v_add_f32 v16, v16, v166
  v_add_f32 v17, v17, v167
  v_mfma_f32_32x32x16_bf16 v[144:159], a[208:211], v[80:83], v[144:159]
  v_cvt_pk_bf16_f32 v211, v166, v167
  v_exp_f32 v170, v170
  v_exp_f32 v171, v171
  v_mfma_f32_32x32x16_bf16 v[128:143], a[212:215], v[52:55], v[128:143]
  ds_read_b128 a[228:231], v12 offset:1024
  buffer_load_dwordx4 v25, s[60:63], s72 offen offset:1024 sc1 lds
  v_mfma_f32_32x32x16_bf16 v[144:159], a[212:215], v[84:87], v[144:159]
  v_add_f32 v16, v16, v168
  v_add_f32 v17, v17, v169
  v_cvt_pk_bf16_f32 v212, v168, v169
  v_exp_f32 v172, v172
  s_waitcnt lgkmcnt(2)
  v_mfma_f32_32x32x16_bf16 v[128:143], a[216:219], v[56:59], v[128:143]
  ds_read_b128 a[232:235], v12 offset:2048
  v_exp_f32 v173, v173
  v_add_f32 v16, v16, v170
  v_mfma_f32_32x32x16_bf16 v[144:159], a[216:219], v[88:91], v[144:159]
  v_add_f32 v17, v17, v171
  v_cvt_pk_bf16_f32 v213, v170, v171
  v_exp_f32 v174, v174
  v_mfma_f32_32x32x16_bf16 v[128:143], a[220:223], v[60:63], v[128:143]
  ds_read_b128 a[236:239], v12 offset:3072
  v_exp_f32 v175, v175
  v_add_f32 v16, v16, v172
  v_add_f32 v17, v17, v173
  v_mfma_f32_32x32x16_bf16 v[144:159], a[220:223], v[92:95], v[144:159]
  buffer_load_dwordx4 v25, s[60:63], s72 offen offset:2048 sc1 lds
  v_cvt_pk_bf16_f32 v214, v172, v173
  v_add_f32 v16, v16, v174
  s_waitcnt lgkmcnt(2)
  v_mfma_f32_32x32x16_bf16 a[0:15], a[224:227], v[192:195], 0
  ds_read_b128 a[240:243], v12 offset:4096
  v_add_f32 v17, v17, v175
  v_cvt_pk_bf16_f32 v215, v174, v175
  v_exp_f32 v176, v176
  v_mfma_f32_32x32x16_bf16 a[64:79], a[224:227], v[200:203], 0
  v_exp_f32 v177, v177
  v_exp_f32 v178, v178
  v_mfma_f32_32x32x16_bf16 a[16:31], a[228:231], v[192:195], 0
  ds_read_b128 a[244:247], v12 offset:5120
  v_exp_f32 v179, v179
  v_add_f32 v18, v18, v176
  v_mfma_f32_32x32x16_bf16 a[80:95], a[228:231], v[200:203], 0
  v_add_f32 v19, v19, v177
  v_cvt_pk_bf16_f32 v216, v176, v177
  v_exp_f32 v180, v180
  s_waitcnt lgkmcnt(2)
  v_mfma_f32_32x32x16_bf16 a[32:47], a[232:235], v[192:195], 0
  ds_read_b128 a[248:251], v12 offset:6144
  buffer_load_dwordx4 v25, s[60:63], s72 offen offset:3072 sc1 lds
  v_exp_f32 v181, v181
  v_mfma_f32_32x32x16_bf16 a[96:111], a[232:235], v[200:203], 0
  v_add_f32 v18, v18, v178
  v_add_f32 v19, v19, v179
  v_cvt_pk_bf16_f32 v217, v178, v179
  v_mfma_f32_32x32x16_bf16 a[48:63], a[236:239], v[192:195], 0
  ds_read_b128 a[252:255], v12 offset:7168
  v_exp_f32 v182, v182
  v_exp_f32 v183, v183
  v_mfma_f32_32x32x16_bf16 a[112:127], a[236:239], v[200:203], 0
  v_add_f32 v18, v18, v180
  v_add_f32 v19, v19, v181
  v_cvt_pk_bf16_f32 v218, v180, v181
  v_exp_f32 v184, v184
  s_waitcnt lgkmcnt(2)
  v_mfma_f32_32x32x16_bf16 a[0:15], a[240:243], v[196:199], a[0:15]
  v_exp_f32 v185, v185
  v_add_f32 v18, v18, v182
  v_add_f32 v19, v19, v183
  v_mfma_f32_32x32x16_bf16 a[64:79], a[240:243], v[204:207], a[64:79]
  s_add_u32 s72, s72, 16384
  v_cvt_pk_bf16_f32 v219, v182, v183
  v_exp_f32 v186, v186
  v_mfma_f32_32x32x16_bf16 a[16:31], a[244:247], v[196:199], a[16:31]
  ds_read_b128 a[192:195], v10 offset:24576
  v_exp_f32 v187, v187
  v_add_f32 v18, v18, v184
  v_add_f32 v19, v19, v185
  v_mfma_f32_32x32x16_bf16 a[80:95], a[244:247], v[204:207], a[80:95]
  ds_read_b128 a[196:199], v10 offset:25600
  v_cvt_pk_bf16_f32 v220, v184, v185
  v_exp_f32 v188, v188
  s_waitcnt lgkmcnt(2)
  v_mfma_f32_32x32x16_bf16 a[32:47], a[248:251], v[196:199], a[32:47]
  ds_read_b128 a[200:203], v10 offset:26624
  v_exp_f32 v189, v189
  v_add_f32 v18, v18, v186
  v_add_f32 v19, v19, v187
  v_mfma_f32_32x32x16_bf16 a[96:111], a[248:251], v[204:207], a[96:111]
  ds_read_b128 a[204:207], v10 offset:27648
  v_cvt_pk_bf16_f32 v221, v186, v187
  v_exp_f32 v190, v190
  v_mfma_f32_32x32x16_bf16 a[48:63], a[252:255], v[196:199], a[48:63]
  ds_read_b128 a[208:211], v10 offset:28672
  v_exp_f32 v191, v191
  v_add_f32 v18, v18, v188
  v_add_f32 v19, v19, v189
  v_mfma_f32_32x32x16_bf16 a[112:127], a[252:255], v[204:207], a[112:127]
  v_cvt_pk_bf16_f32 v222, v188, v189
  v_add_f32 v18, v18, v190
  v_add_f32 v19, v19, v191
  v_cvt_pk_bf16_f32 v223, v190, v191
  s_cmp_lg_u32 s42, 3
  s_cbranch_scc1 L_b_ev_6
  v_accvgpr_read_b32 v8, a128
  v_add_f32 v224, v224, v8
  v_accvgpr_read_b32 v9, a129
  v_add_f32 v225, v225, v9
  v_accvgpr_read_b32 v8, a130
  v_add_f32 v226, v226, v8
  v_accvgpr_read_b32 v9, a131
  v_add_f32 v227, v227, v9
  v_accvgpr_read_b32 v8, a132
  v_add_f32 v228, v228, v8
  v_accvgpr_read_b32 v9, a133
  v_add_f32 v229, v229, v9
  v_accvgpr_read_b32 v8, a134
  v_add_f32 v230, v230, v8
  v_accvgpr_read_b32 v9, a135
  v_add_f32 v231, v231, v9
  v_accvgpr_read_b32 v8, a136
  v_add_f32 v232, v232, v8
  v_accvgpr_read_b32 v9, a137
  v_add_f32 v233, v233, v9
  v_accvgpr_read_b32 v8, a138
  v_add_f32 v234, v234, v8
  v_accvgpr_read_b32 v9, a139
  v_add_f32 v235, v235, v9
  v_accvgpr_read_b32 v8, a140
  v_add_f32 v236, v236, v8
  v_accvgpr_read_b32 v9, a141
  v_add_f32 v237, v237, v9
  v_accvgpr_read_b32 v8, a142
  v_add_f32 v238, v238, v8
  v_accvgpr_read_b32 v9, a143
  v_add_f32 v239, v239, v9
L_b_ev_6:
  s_cmp_lg_u32 s42, 2
  s_cbranch_scc1 L_b_ev_7
  v_mov_b32 v224, 0xff800000
  v_mov_b32 v225, 0xff800000
  v_mov_b32 v226, 0xff800000
  v_mov_b32 v227, 0xff800000
  v_mov_b32 v228, 0xff800000
  v_mov_b32 v229, 0xff800000
  v_mov_b32 v230, 0xff800000
  v_mov_b32 v231, 0xff800000
  v_mov_b32 v232, 0xff800000
  v_mov_b32 v233, 0xff800000
  v_mov_b32 v234, 0xff800000
  v_mov_b32 v235, 0xff800000
  v_mov_b32 v236, 0xff800000
  v_mov_b32 v237, 0xff800000
  v_mov_b32 v238, 0xff800000
  v_mov_b32 v239, 0xff800000
L_b_ev_7:
  s_nop 1
  s_waitcnt lgkmcnt(3)
  v_mfma_f32_32x32x16_bf16 v[160:175], a[192:195], v[32:35], v[224:239]
  v_exp_f32 v128, v128
  v_exp_f32 v129, v129
  v_mfma_f32_32x32x16_bf16 v[176:191], a[192:195], v[64:67], v[240:255]
  s_add_u32 m0, s71, 0x4000
  v_exp_f32 v130, v130
  v_exp_f32 v131, v131
  v_mfma_f32_32x32x16_bf16 v[160:175], a[196:199], v[36:39], v[160:175]
  ds_read_b128 a[212:215], v10 offset:29696
  v_add_f32 v16, v16, v128
  v_add_f32 v17, v17, v129
  v_cvt_pk_bf16_f32 v192, v128, v129
  v_mfma_f32_32x32x16_bf16 v[176:191], a[196:199], v[68:71], v[176:191]
  v_exp_f32 v132, v132
  v_exp_f32 v133, v133
  v_add_f32 v16, v16, v130
  s_waitcnt lgkmcnt(2)
  v_mfma_f32_32x32x16_bf16 v[160:175], a[200:203], v[40:43], v[160:175]
  ds_read_b128 a[216:219], v10 offset:30720
  buffer_load_dwordx4 v25, s[64:67], s73 offen sc1 lds
  v_add_f32 v17, v17, v131
  v_mfma_f32_32x32x16_bf16 v[176:191], a[200:203], v[72:75], v[176:191]
  v_cvt_pk_bf16_f32 v193, v130, v131
  v_exp_f32 v134, v134
  v_exp_f32 v135, v135
  v_mfma_f32_32x32x16_bf16 v[160:175], a[204:207], v[44:47], v[160:175]
  ds_read_b128 a[220:223], v10 offset:31744
  v_add_f32 v16, v16, v132
  v_add_f32 v17, v17, v133
  v_cvt_pk_bf16_f32 v194, v132, v133
  v_mfma_f32_32x32x16_bf16 v[176:191], a[204:207], v[76:79], v[176:191]
  v_xor_b32 v10, 0x8000, v10
  v_exp_f32 v136, v136
  v_exp_f32 v137, v137
  s_waitcnt lgkmcnt(2)
  v_mfma_f32_32x32x16_bf16 v[160:175], a[208:211], v[48:51], v[160:175]
  ds_read_b128 a[224:227], v12 offset:8192
  buffer_load_dwordx4 v25, s[64:67], s73 offen offset:1024 sc1 lds
  v_xor_b32 v11, 0x8000, v11
  v_add_f32 v16, v16, v134
  v_mfma_f32_32x32x16_bf16 v[176:191], a[208:211], v[80:83], v[176:191]
  v_add_f32 v17, v17, v135
  v_cvt_pk_bf16_f32 v195, v134, v135
  v_exp_f32 v138, v138
  v_mfma_f32_32x32x16_bf16 v[160:175], a[212:215], v[52:55], v[160:175]
  ds_read_b128 a[228:231], v12 offset:9216
  v_exp_f32 v139, v139
  v_add_f32 v16, v16, v136
  v_add_f32 v17, v17, v137
  v_mfma_f32_32x32x16_bf16 v[176:191], a[212:215], v[84:87], v[176:191]
  v_cvt_pk_bf16_f32 v196, v136, v137
  v_exp_f32 v140, v140
  v_exp_f32 v141, v141
  s_waitcnt lgkmcnt(2)
  v_mfma_f32_32x32x16_bf16 v[160:175], a[216:219], v[56:59], v[160:175]
  ds_read_b128 a[232:235], v12 offset:10240
  buffer_load_dwordx4 v25, s[64:67], s73 offen offset:2048 sc1 lds
  v_add_f32 v16, v16, v138
  v_mfma_f32_32x32x16_bf16 v[176:191], a[216:219], v[88:91], v[176:191]
  v_add_f32 v17, v17, v139
  v_cvt_pk_bf16_f32 v197, v138, v139
  v_exp_f32 v142, v142
  v_mfma_f32_32x32x16_bf16 v[160:175], a[220:223], v[60:63], v[160:175]
  ds_read_b128 a[236:239], v12 offset:11264
  v_exp_f32 v143, v143
  v_add_f32 v16, v16, v140
  v_add_f32 v17, v17, v141
  v_mfma_f32_32x32x16_bf16 v[176:191], a[220:223], v[92:95], v[176:191]
  v_cvt_pk_bf16_f32 v198, v140, v141
  v_add_f32 v16, v16, v142
  v_add_f32 v17, v17, v143
  v_cvt_pk_bf16_f32 v199, v142, v143
  s_waitcnt lgkmcnt(2)
  v_mfma_f32_32x32x16_bf16 a[0:15], a[224:227], v[208:211], a[0:15]
  ds_read_b128 a[240:243], v12 offset:12288
  buffer_load_dwordx4 v25, s[64:67], s73 offen offset:3072 sc1 lds
  v_exp_f32 v144, v144
  v_mfma_f32_32x32x16_bf16 a[64:79], a[224:227], v[216:219], a[64:79]
  v_exp_f32 v145, v145
  v_exp_f32 v146, v146
  v_mfma_f32_32x32x16_bf16 a[16:31], a[228:231], v[208:211], a[16:31]
  ds_read_b128 a[244:247], v12 offset:13312
  v_exp_f32 v147, v147
  v_add_f32 v18, v18, v144
  v_mfma_f32_32x32x16_bf16 a[80:95], a[228:231], v[216:219], a[80:95]
  v_add_f32 v19, v19, v145
  v_cvt_pk_bf16_f32 v200, v144, v145
  v_exp_f32 v148, v148
  s_waitcnt lgkmcnt(2)
  v_mfma_f32_32x32x16_bf16 a[32:47], a[232:235], v[208:211], a[32:47]
  ds_read_b128 a[248:251], v12 offset:14336
  s_add_u32 s73, s73, 16384
  v_exp_f32 v149, v149
  v_add_f32 v18, v18, v146
  v_add_f32 v19, v19, v147
  v_mfma_f32_32x32x16_bf16 a[96:111], a[232:235], v[216:219], a[96:111]
  s_xor_b32 s68, s68, 0x8000
  s_xor_b32 s69, s69, 0x8000
  v_cvt_pk_bf16_f32 v201, v146, v147
  v_exp_f32 v150, v150
  v_mfma_f32_32x32x16_bf16 a[48:63], a[236:239], v[208:211], a[48:63]
  ds_read_b128 a[252:255], v12 offset:15360
  s_xor_b32 s70, s70, 0x8000
  s_xor_b32 s71, s71, 0x8000
  v_exp_f32 v151, v151
  v_mfma_f32_32x32x16_bf16 a[112:127], a[236:239], v[216:219], a[112:127]
  v_xor_b32 v12, 0x8000, v12
  v_add_f32 v18, v18, v148
  v_add_f32 v19, v19, v149
  v_cvt_pk_bf16_f32 v202, v148, v149
  s_waitcnt lgkmcnt(2)
  v_mfma_f32_32x32x16_bf16 a[0:15], a[240:243], v[212:215], a[0:15]
  v_xor_b32 v13, 0x8000, v13
  v_exp_f32 v152, v152
  v_exp_f32 v153, v153
  v_mfma_f32_32x32x16_bf16 a[64:79], a[240:243], v[220:223], a[64:79]
  v_add_f32 v18, v18, v150
  v_add_f32 v19, v19, v151
  v_cvt_pk_bf16_f32 v203, v150, v151
  v_exp_f32 v154, v154
  v_mfma_f32_32x32x16_bf16 a[16:31], a[244:247], v[212:215], a[16:31]
  ds_read_b128 a[192:195], v10
  v_exp_f32 v155, v155
  v_add_f32 v18, v18, v152
  v_mfma_f32_32x32x16_bf16 a[80:95], a[244:247], v[220:223], a[80:95]
  ds_read_b128 a[196:199], v10 offset:1024
  v_add_f32 v19, v19, v153
  v_cvt_pk_bf16_f32 v204, v152, v153
  v_exp_f32 v156, v156
  s_waitcnt lgkmcnt(2)
  v_mfma_f32_32x32x16_bf16 a[32:47], a[248:251], v[212:215], a[32:47]
  ds_read_b128 a[200:203], v10 offset:2048
  v_exp_f32 v157, v157
  v_add_f32 v18, v18, v154
  v_mfma_f32_32x32x16_bf16 a[96:111], a[248:251], v[220:223], a[96:111]
  ds_read_b128 a[204:207], v10 offset:3072
  v_add_f32 v19, v19, v155
  v_cvt_pk_bf16_f32 v205, v154, v155
  v_exp_f32 v158, v158
  v_mfma_f32_32x32x16_bf16 a[48:63], a[252:255], v[212:215], a[48:63]
  ds_read_b128 a[208:211], v10 offset:4096
  v_exp_f32 v159, v159
  v_add_f32 v18, v18, v156
  v_add_f32 v19, v19, v157
  v_mfma_f32_32x32x16_bf16 a[112:127], a[252:255], v[220:223], a[112:127]
  v_cvt_pk_bf16_f32 v206, v156, v157
  v_add_f32 v18, v18, v158
  v_add_f32 v19, v19, v159
  v_cvt_pk_bf16_f32 v207, v158, v159
  buffer_store_dwordx4 v[96:99], v26, s[16:19], s92 offen sc1
  buffer_store_dwordx4 v[100:103], v26, s[16:19], s93 offen sc1
  buffer_store_dwordx4 v[104:107], v26, s[16:19], s94 offen sc1
  buffer_store_dwordx4 v[108:111], v26, s[16:19], s95 offen sc1
  buffer_store_dwordx4 v[112:115], v26, s[16:19], s96 offen sc1
  buffer_store_dwordx4 v[116:119], v26, s[16:19], s97 offen sc1
  buffer_store_dwordx4 v[120:123], v26, s[16:19], s98 offen sc1
  buffer_store_dwordx4 v[124:127], v26, s[16:19], s99 offen sc1
L_b_TD:
  s_waitcnt lgkmcnt(3)
  v_mfma_f32_32x32x16_bf16 v[144:159], a[192:195], v[64:67], v[240:255]
  s_waitcnt vmcnt(12)
  s_barrier
  ds_read_b128 a[212:215], v10 offset:5120
  ds_read_b128 a[216:219], v10 offset:6144
  ds_read_b128 a[220:223], v10 offset:7168
  ds_read_b128 a[224:227], v13 offset:16384
  v_mfma_f32_32x32x16_bf16 v[144:159], a[196:199], v[68:71], v[144:159]
  s_add_u32 m0, s69, 0x4000
  v_exp_f32 v160, v160
  v_exp_f32 v161, v161
  v_exp_f32 v162, v162
  s_waitcnt lgkmcnt(5)
  v_mfma_f32_32x32x16_bf16 v[144:159], a[200:203], v[72:75], v[144:159]
  ds_read_b128 a[228:231], v13 offset:17408
  v_exp_f32 v163, v163
  v_add_f32 v16, v16, v160
  v_add_f32 v17, v17, v161
  v_mfma_f32_32x32x16_bf16 v[144:159], a[204:207], v[76:79], v[144:159]
  v_cvt_pk_bf16_f32 v208, v160, v161
  v_exp_f32 v164, v164
  v_exp_f32 v165, v165
  v_add_f32 v16, v16, v162
  s_waitcnt lgkmcnt(4)
  v_mfma_f32_32x32x16_bf16 v[144:159], a[208:211], v[80:83], v[144:159]
  ds_read_b128 a[232:235], v13 offset:18432
  buffer_load_dwordx4 v25, s[60:63], s72 offen sc1 lds
  v_add_f32 v17, v17, v163
  v_cvt_pk_bf16_f32 v209, v162, v163
  v_mfma_f32_32x32x16_bf16 v[144:159], a[212:215], v[84:87], v[144:159]
  v_exp_f32 v166, v166
  v_exp_f32 v167, v167
  v_add_f32 v16, v16, v164
  v_add_f32 v17, v17, v165
  s_waitcnt lgkmcnt(3)
  v_mfma_f32_32x32x16_bf16 v[144:159], a[216:219], v[88:91], v[144:159]
  ds_read_b128 a[236:239], v13 offset:19456
  v_cvt_pk_bf16_f32 v210, v164, v165
  v_exp_f32 v168, v168
  v_exp_f32 v169, v169
  v_mfma_f32_32x32x16_bf16 v[144:159], a[220:223], v[92:95], v[144:159]
  v_add_f32 v16, v16, v166
  v_add_f32 v17, v17, v167
  v_cvt_pk_bf16_f32 v211, v166, v167
  v_exp_f32 v170, v170
  v_exp_f32 v171, v171
  s_waitcnt lgkmcnt(2)
  v_mfma_f32_32x32x16_bf16 a[0:15], a[224:227], v[192:195], a[0:15]
  ds_read_b128 a[240:243], v13 offset:20480
  buffer_load_dwordx4 v25, s[60:63], s72 offen offset:1024 sc1 lds
  v_add_f32 v16, v16, v168
  v_mfma_f32_32x32x16_bf16 a[64:79], a[224:227], v[200:203], a[64:79]
  v_add_f32 v17, v17, v169
  v_cvt_pk_bf16_f32 v212, v168, v169
  v_exp_f32 v172, v172
  v_exp_f32 v173, v173
  v_mfma_f32_32x32x16_bf16 a[16:31], a[228:231], v[192:195], a[16:31]
  ds_read_b128 a[244:247], v13 offset:21504
  v_add_f32 v16, v16, v170
  v_add_f32 v17, v17, v171
  v_cvt_pk_bf16_f32 v213, v170, v171
  v_exp_f32 v174, v174
  v_mfma_f32_32x32x16_bf16 a[80:95], a[228:231], v[200:203], a[80:95]
  buffer_load_dwordx4 v25, s[60:63], s72 offen offset:2048 sc1 lds
  v_exp_f32 v175, v175
  v_add_f32 v16, v16, v172
  s_waitcnt lgkmcnt(2)
  v_mfma_f32_32x32x16_bf16 a[32:47], a[232:235], v[192:195], a[32:47]
  ds_read_b128 a[248:251], v13 offset:22528
  v_add_f32 v17, v17, v173
  v_cvt_pk_bf16_f32 v214, v172, v173
  v_add_f32 v16, v16, v174
  v_add_f32 v17, v17, v175
  v_cvt_pk_bf16_f32 v215, v174, v175
  v_mfma_f32_32x32x16_bf16 a[96:111], a[232:235], v[200:203], a[96:111]
  v_exp_f32 v176, v176
  v_exp_f32 v177, v177
  v_exp_f32 v178, v178
  v_mfma_f32_32x32x16_bf16 a[48:63], a[236:239], v[192:195], a[48:63]
  ds_read_b128 a[252:255], v13 offset:23552
  v_exp_f32 v179, v179
  v_add_f32 v18, v18, v176
  v_add_f32 v19, v19, v177
  v_cvt_pk_bf16_f32 v216, v176, v177
  v_mfma_f32_32x32x16_bf16 a[112:127], a[236:239], v[200:203], a[112:127]
  buffer_load_dwordx4 v25, s[60:63], s72 offen offset:3072 sc1 lds
  v_exp_f32 v180, v180
  v_exp_f32 v181, v181
  s_waitcnt lgkmcnt(2)
  v_mfma_f32_32x32x16_bf16 a[0:15], a[240:243], v[196:199], a[0:15]
  v_add_f32 v18, v18, v178
  v_add_f32 v19, v19, v179
  v_cvt_pk_bf16_f32 v217, v178, v179
  v_exp_f32 v182, v182
  v_mfma_f32_32x32x16_bf16 a[64:79], a[240:243], v[204:207], a[64:79]
  v_exp_f32 v183, v183
  v_add_f32 v18, v18, v180
  v_add_f32 v19, v19, v181
  v_cvt_pk_bf16_f32 v218, v180, v181
  v_exp_f32 v184, v184
  v_mfma_f32_32x32x16_bf16 a[16:31], a[244:247], v[196:199], a[16:31]
  ds_read_b128 a[192:195], v10 offset:8192
  s_add_u32 s72, s72, 16384
  v_exp_f32 v185, v185
  v_add_f32 v18, v18, v182
  v_mfma_f32_32x32x16_bf16 a[80:95], a[244:247], v[204:207], a[80:95]
  ds_read_b128 a[196:199], v10 offset:9216
  v_add_f32 v19, v19, v183
  v_cvt_pk_bf16_f32 v219, v182, v183
  v_exp_f32 v186, v186
  v_exp_f32 v187, v187
  s_waitcnt lgkmcnt(2)
  v_mfma_f32_32x32x16_bf16 a[32:47], a[248:251], v[196:199], a[32:47]
  ds_read_b128 a[200:203], v10 offset:10240
  v_add_f32 v18, v18, v184
  v_add_f32 v19, v19, v185
  v_cvt_pk_bf16_f32 v220, v184, v185
  v_exp_f32 v188, v188
  v_mfma_f32_32x32x16_bf16 a[96:111], a[248:251], v[204:207], a[96:111]
  ds_read_b128 a[204:207], v10 offset:11264
  v_exp_f32 v189, v189
  v_add_f32 v18, v18, v186
  v_add_f32 v19, v19, v187
  v_mfma_f32_32x32x16_bf16 a[48:63], a[252:255], v[196:199], a[48:63]
  ds_read_b128 a[208:211], v10 offset:12288
  v_cvt_pk_bf16_f32 v221, v186, v187
  v_exp_f32 v190, v190
  v_exp_f32 v191, v191
  v_mfma_f32_32x32x16_bf16 a[112:127], a[252:255], v[204:207], a[112:127]
  v_add_f32 v18, v18, v188
  v_add_f32 v19, v19, v189
  v_cvt_pk_bf16_f32 v222, v188, v189
  v_add_f32 v18, v18, v190
  v_add_f32 v19, v19, v191
  v_cvt_pk_bf16_f32 v223, v190, v191
  s_waitcnt lgkmcnt(3)
  v_mfma_f32_32x32x16_bf16 v[176:191], a[192:195], v[64:67], v[240:255]
  ds_read_b128 a[212:215], v10 offset:13312
  ds_read_b128 a[216:219], v10 offset:14336
  ds_read_b128 a[220:223], v10 offset:15360
  ds_read_b128 a[224:227], v13 offset:24576
  v_mfma_f32_32x32x16_bf16 v[176:191], a[196:199], v[68:71], v[176:191]
  s_add_u32 m0, s71, 0
  v_exp_f32 v144, v144
  v_exp_f32 v145, v145
  s_waitcnt lgkmcnt(5)
  v_mfma_f32_32x32x16_bf16 v[176:191], a[200:203], v[72:75], v[176:191]
  ds_read_b128 a[228:231], v13 offset:25600
  v_exp_f32 v146, v146
  v_mfma_f32_32x32x16_bf16 v[176:191], a[204:207], v[76:79], v[176:191]
  v_exp_f32 v147, v147
  v_add_f32 v18, v18, v144
  s_waitcnt lgkmcnt(4)
  v_mfma_f32_32x32x16_bf16 v[176:191], a[208:211], v[80:83], v[176:191]
  ds_read_b128 a[232:235], v13 offset:26624
  buffer_load_dwordx4 v25, s[64:67], s73 offen sc1 lds
  v_add_f32 v19, v19, v145
  v_mfma_f32_32x32x16_bf16 v[176:191], a[212:215], v[84:87], v[176:191]
  v_cvt_pk_bf16_f32 v200, v144, v145
  v_exp_f32 v148, v148
  s_waitcnt lgkmcnt(3)
  v_mfma_f32_32x32x16_bf16 v[176:191], a[216:219], v[88:91], v[176:191]
  ds_read_b128 a[236:239], v13 offset:27648
  v_exp_f32 v149, v149
  v_mfma_f32_32x32x16_bf16 v[176:191], a[220:223], v[92:95], v[176:191]
  v_add_f32 v18, v18, v146
  v_add_f32 v19, v19, v147
  v_cvt_pk_bf16_f32 v201, v146, v147
  s_waitcnt lgkmcnt(2)
  v_mfma_f32_32x32x16_bf16 a[0:15], a[224:227], v[208:211], a[0:15]
  ds_read_b128 a[240:243], v13 offset:28672
  buffer_load_dwordx4 v25, s[64:67], s73 offen offset:1024 sc1 lds
  v_exp_f32 v150, v150
  v_mfma_f32_32x32x16_bf16 a[64:79], a[224:227], v[216:219], a[64:79]
  v_exp_f32 v151, v151
  v_mfma_f32_32x32x16_bf16 a[16:31], a[228:231], v[208:211], a[16:31]
  ds_read_b128 a[244:247], v13 offset:29696
  v_add_f32 v18, v18, v148
  v_add_f32 v19, v19, v149
  v_cvt_pk_bf16_f32 v202, v148, v149
  v_mfma_f32_32x32x16_bf16 a[80:95], a[228:231], v[216:219], a[80:95]
  buffer_load_dwordx4 v25, s[64:67], s73 offen offset:2048 sc1 lds
  v_exp_f32 v152, v152
  s_waitcnt lgkmcnt(2)
  v_mfma_f32_32x32x16_bf16 a[32:47], a[232:235], v[208:211], a[32:47]
  ds_read_b128 a[248:251], v13 offset:30720
  v_exp_f32 v153, v153
  v_mfma_f32_32x32x16_bf16 a[96:111], a[232:235], v[216:219], a[96:111]
  v_add_f32 v18, v18, v150
  v_add_f32 v19, v19, v151
  v_mfma_f32_32x32x16_bf16 a[48:63], a[236:239], v[208:211], a[48:63]
  ds_read_b128 a[252:255], v13 offset:31744
  v_cvt_pk_bf16_f32 v203, v150, v151
  v_exp_f32 v154, v154
  v_mfma_f32_32x32x16_bf16 a[112:127], a[236:239], v[216:219], a[112:127]
  buffer_load_dwordx4 v25, s[64:67], s73 offen offset:3072 sc1 lds
  v_exp_f32 v155, v155
  s_waitcnt lgkmcnt(2)
  v_mfma_f32_32x32x16_bf16 a[0:15], a[240:243], v[212:215], a[0:15]
  v_add_f32 v18, v18, v152
  v_add_f32 v19, v19, v153
  v_mfma_f32_32x32x16_bf16 a[64:79], a[240:243], v[220:223], a[64:79]
  v_cvt_pk_bf16_f32 v204, v152, v153
  v_exp_f32 v156, v156
  v_mfma_f32_32x32x16_bf16 a[16:31], a[244:247], v[212:215], a[16:31]
  ds_read_b128 a[192:195], v10 offset:16384
  s_add_u32 s73, s73, 16384
  v_exp_f32 v157, v157
  v_mfma_f32_32x32x16_bf16 a[80:95], a[244:247], v[220:223], a[80:95]
  ds_read_b128 a[196:199], v10 offset:17408
  v_add_f32 v18, v18, v154
  v_add_f32 v19, v19, v155
  v_cvt_pk_bf16_f32 v205, v154, v155
  s_waitcnt lgkmcnt(2)
  v_mfma_f32_32x32x16_bf16 a[32:47], a[248:251], v[212:215], a[32:47]
  ds_read_b128 a[200:203], v10 offset:18432
  v_exp_f32 v158, v158
  v_mfma_f32_32x32x16_bf16 a[96:111], a[248:251], v[220:223], a[96:111]
  ds_read_b128 a[204:207], v10 offset:19456
  v_exp_f32 v159, v159
  v_add_f32 v18, v18, v156
  v_mfma_f32_32x32x16_bf16 a[48:63], a[252:255], v[212:215], a[48:63]
  ds_read_b128 a[208:211], v10 offset:20480
  v_add_f32 v19, v19, v157
  v_cvt_pk_bf16_f32 v206, v156, v157
  v_mfma_f32_32x32x16_bf16 a[112:127], a[252:255], v[220:223], a[112:127]
  v_add_f32 v18, v18, v158
  v_add_f32 v19, v19, v159
  v_cvt_pk_bf16_f32 v207, v158, v159
  s_waitcnt lgkmcnt(3)
  v_mfma_f32_32x32x16_bf16 v[144:159], a[192:195], v[64:67], v[240:255]
  s_waitcnt vmcnt(8)
  s_barrier
  s_cmp_lg_u32 s42, 0
  s_cbranch_scc1 L_sigA_L_b_TD
  s_lshl_b32 s80, s41, 7
  s_lshl_b32 s81, s40, 2
  s_add_u32 s80, s80, s81
  s_add_u32 s80, s80, 0x4d02000
  v_mov_b32 v2, 0
  v_mov_b32 v3, s59
  s_mov_b64 exec, 1
  s_nop 1
  buffer_store_dword v3, v2, s[16:19], s80 offen sc1
  s_mov_b64 exec, -1
  s_nop 3
L_sigA_L_b_TD:
  ds_read_b128 a[212:215], v10 offset:21504
  ds_read_b128 a[216:219], v10 offset:22528
  v_mfma_f32_32x32x16_bf16 v[144:159], a[196:199], v[68:71], v[144:159]
  ds_read_b128 a[220:223], v10 offset:23552
  s_add_u32 m0, s68, 0
  v_exp_f32 v176, v176
  v_exp_f32 v177, v177
  s_waitcnt lgkmcnt(4)
  v_mfma_f32_32x32x16_bf16 v[144:159], a[200:203], v[72:75], v[144:159]
  ds_read_b128 a[224:227], v12
  v_exp_f32 v178, v178
  v_exp_f32 v179, v179
  v_mfma_f32_32x32x16_bf16 v[144:159], a[204:207], v[76:79], v[144:159]
  ds_read_b128 a[228:231], v12 offset:1024
  buffer_load_dwordx4 v25, s[60:63], s72 offen sc1 lds
  v_add_f32 v18, v18, v176
  v_add_f32 v19, v19, v177
  s_waitcnt lgkmcnt(4)
  v_mfma_f32_32x32x16_bf16 v[144:159], a[208:211], v[80:83], v[144:159]
  ds_read_b128 a[232:235], v12 offset:2048
  v_cvt_pk_bf16_f32 v216, v176, v177
  v_exp_f32 v180, v180
  v_exp_f32 v181, v181
  v_mfma_f32_32x32x16_bf16 v[144:159], a[212:215], v[84:87], v[144:159]
  ds_read_b128 a[236:239], v12 offset:3072
  buffer_load_dwordx4 v25, s[60:63], s72 offen offset:1024 sc1 lds
  v_add_f32 v18, v18, v178
  s_waitcnt lgkmcnt(4)
  v_mfma_f32_32x32x16_bf16 v[144:159], a[216:219], v[88:91], v[144:159]
  ds_read_b128 a[240:243], v12 offset:4096
  v_add_f32 v19, v19, v179
  v_cvt_pk_bf16_f32 v217, v178, v179
  v_exp_f32 v182, v182
  v_mfma_f32_32x32x16_bf16 v[144:159], a[220:223], v[92:95], v[144:159]
  ds_read_b128 a[244:247], v12 offset:5120
  buffer_load_dwordx4 v25, s[60:63], s72 offen offset:2048 sc1 lds
  v_exp_f32 v183, v183
  v_add_f32 v18, v18, v180
  s_waitcnt lgkmcnt(4)
  v_mfma_f32_32x32x16_bf16 a[64:79], a[224:227], v[200:203], a[64:79]
  ds_read_b128 a[248:251], v12 offset:6144
  v_add_f32 v19, v19, v181
  v_cvt_pk_bf16_f32 v218, v180, v181
  v_exp_f32 v184, v184
  v_mfma_f32_32x32x16_bf16 a[80:95], a[228:231], v[200:203], a[80:95]
  ds_read_b128 a[252:255], v12 offset:7168
  buffer_load_dwordx4 v25, s[60:63], s72 offen offset:3072 sc1 lds
  v_exp_f32 v185, v185
  s_waitcnt lgkmcnt(4)
  v_mfma_f32_32x32x16_bf16 a[96:111], a[232:235], v[200:203], a[96:111]
  v_add_f32 v18, v18, v182
  v_add_f32 v19, v19, v183
  v_cvt_pk_bf16_f32 v219, v182, v183
  v_exp_f32 v186, v186
  v_mfma_f32_32x32x16_bf16 a[112:127], a[236:239], v[200:203], a[112:127]
  ds_read_b128 a[192:195], v10 offset:24576
  s_add_u32 s72, s72, 16384
  v_exp_f32 v187, v187
  v_add_f32 v18, v18, v184
  v_add_f32 v19, v19, v185
  s_waitcnt lgkmcnt(3)
  v_mfma_f32_32x32x16_bf16 a[64:79], a[240:243], v[204:207], a[64:79]
  ds_read_b128 a[196:199], v10 offset:25600
  v_cvt_pk_bf16_f32 v220, v184, v185
  v_exp_f32 v188, v188
  v_exp_f32 v189, v189
  v_mfma_f32_32x32x16_bf16 a[80:95], a[244:247], v[204:207], a[80:95]
  ds_read_b128 a[200:203], v10 offset:26624
  v_add_f32 v18, v18, v186
  v_add_f32 v19, v19, v187
  v_cvt_pk_bf16_f32 v221, v186, v187
  s_waitcnt lgkmcnt(3)
  v_mfma_f32_32x32x16_bf16 a[96:111], a[248:251], v[204:207], a[96:111]
  ds_read_b128 a[204:207], v10 offset:27648
  v_exp_f32 v190, v190
  v_exp_f32 v191, v191
  v_add_f32 v18, v18, v188
  v_mfma_f32_32x32x16_bf16 a[112:127], a[252:255], v[204:207], a[112:127]
  ds_read_b128 a[208:211], v10 offset:28672
  v_add_f32 v19, v19, v189
  v_cvt_pk_bf16_f32 v222, v188, v189
  v_add_f32 v18, v18, v190
  v_add_f32 v19, v19, v191
  v_cvt_pk_bf16_f32 v223, v190, v191
  s_waitcnt lgkmcnt(3)
  v_mfma_f32_32x32x16_bf16 v[176:191], a[192:195], v[64:67], v[240:255]
  ds_read_b128 a[212:215], v10 offset:29696
  ds_read_b128 a[216:219], v10 offset:30720
  v_exp_f32 v144, v144
  v_exp_f32 v145, v145
  v_mfma_f32_32x32x16_bf16 v[176:191], a[196:199], v[68:71], v[176:191]
  ds_read_b128 a[220:223], v10 offset:31744
  s_add_u32 m0, s71, 0x4000
  v_exp_f32 v146, v146
  v_exp_f32 v147, v147
  s_waitcnt lgkmcnt(4)
  v_mfma_f32_32x32x16_bf16 v[176:191], a[200:203], v[72:75], v[176:191]
  ds_read_b128 a[224:227], v12 offset:8192
  buffer_load_dwordx4 v25, s[64:67], s73 offen sc1 lds
  v_xor_b32 v10, 0x8000, v10
  v_add_f32 v18, v18, v144
  v_mfma_f32_32x32x16_bf16 v[176:191], a[204:207], v[76:79], v[176:191]
  ds_read_b128 a[228:231], v12 offset:9216
  buffer_load_dwordx4 v25, s[64:67], s73 offen offset:1024 sc1 lds
  v_xor_b32 v11, 0x8000, v11
  v_add_f32 v19, v19, v145
  s_waitcnt lgkmcnt(4)
  v_mfma_f32_32x32x16_bf16 v[176:191], a[208:211], v[80:83], v[176:191]
  ds_read_b128 a[232:235], v12 offset:10240
  buffer_load_dwordx4 v25, s[64:67], s73 offen offset:2048 sc1 lds
  v_cvt_pk_bf16_f32 v200, v144, v145
  v_mfma_f32_32x32x16_bf16 v[176:191], a[212:215], v[84:87], v[176:191]
  ds_read_b128 a[236:239], v12 offset:11264
  buffer_load_dwordx4 v25, s[64:67], s73 offen offset:3072 sc1 lds
  v_exp_f32 v148, v148
  s_waitcnt lgkmcnt(4)
  v_mfma_f32_32x32x16_bf16 v[176:191], a[216:219], v[88:91], v[176:191]
  ds_read_b128 a[240:243], v12 offset:12288
  s_add_u32 s73, s73, 16384
  v_exp_f32 v149, v149
  v_add_f32 v18, v18, v146
  v_add_f32 v19, v19, v147
  v_mfma_f32_32x32x16_bf16 v[176:191], a[220:223], v[92:95], v[176:191]
  ds_read_b128 a[244:247], v12 offset:13312
  s_xor_b32 s68, s68, 0x8000
  s_xor_b32 s69, s69, 0x8000
  v_cvt_pk_bf16_f32 v201, v146, v147
  v_exp_f32 v150, v150
  s_waitcnt lgkmcnt(4)
  v_mfma_f32_32x32x16_bf16 a[64:79], a[224:227], v[216:219], a[64:79]
  ds_read_b128 a[248:251], v12 offset:14336
  s_xor_b32 s70, s70, 0x8000
  s_xor_b32 s71, s71, 0x8000
  v_exp_f32 v151, v151
  v_add_f32 v18, v18, v148
  v_mfma_f32_32x32x16_bf16 a[80:95], a[228:231], v[216:219], a[80:95]
  ds_read_b128 a[252:255], v12 offset:15360
  v_add_f32 v19, v19, v149
  v_cvt_pk_bf16_f32 v202, v148, v149
  v_exp_f32 v152, v152
  v_exp_f32 v153, v153
  s_waitcnt lgkmcnt(4)
  v_mfma_f32_32x32x16_bf16 a[96:111], a[232:235], v[216:219], a[96:111]
  v_xor_b32 v12, 0x8000, v12
  v_add_f32 v18, v18, v150
  v_add_f32 v19, v19, v151
  v_cvt_pk_bf16_f32 v203, v150, v151
  v_mfma_f32_32x32x16_bf16 a[112:127], a[236:239], v[216:219], a[112:127]
  ds_read_b128 a[192:195], v10
  v_xor_b32 v13, 0x8000, v13
  v_exp_f32 v154, v154
  v_exp_f32 v155, v155
  v_add_f32 v18, v18, v152
  s_waitcnt lgkmcnt(3)
  v_mfma_f32_32x32x16_bf16 a[64:79], a[240:243], v[220:223], a[64:79]
  ds_read_b128 a[196:199], v10 offset:1024
  v_add_f32 v19, v19, v153
  v_cvt_pk_bf16_f32 v204, v152, v153
  v_exp_f32 v156, v156
  v_mfma_f32_32x32x16_bf16 a[80:95], a[244:247], v[220:223], a[80:95]
  ds_read_b128 a[200:203], v10 offset:2048
  v_exp_f32 v157, v157
  v_add_f32 v18, v18, v154
  v_add_f32 v19, v19, v155
  v_cvt_pk_bf16_f32 v205, v154, v155
  s_waitcnt lgkmcnt(3)
  v_mfma_f32_32x32x16_bf16 a[96:111], a[248:251], v[220:223], a[96:111]
  ds_read_b128 a[204:207], v10 offset:3072
  v_exp_f32 v158, v158
  v_exp_f32 v159, v159
  v_add_f32 v18, v18, v156
  v_mfma_f32_32x32x16_bf16 a[112:127], a[252:255], v[220:223], a[112:127]
  ds_read_b128 a[208:211], v10 offset:4096
  v_add_f32 v19, v19, v157
  v_cvt_pk_bf16_f32 v206, v156, v157
  v_add_f32 v18, v18, v158
  v_add_f32 v19, v19, v159
  v_cvt_pk_bf16_f32 v207, v158, v159
  s_lshl_b32 s78, s40, 2
  s_add_u32 s78, s78, s42
  s_lshl_b32 s78, s78, 18
  s_lshl_b32 s79, s41, 13
  s_add_u32 s78, s78, s79
  s_add_u32 s83, s78, 0x3000000
  s_add_u32 s76, s83, 4096
  v_mov_b32 v6, 0
  v_add_f32 v16, v16, v17
  v_mov_b32 v2, v16
  s_nop 1
  v_permlane32_swap_b32 v2, v16
  v_add_f32 v2, v2, v16
  v_mov_b32 v4, 0x71800000
  v_cmp_nle_f32 vcc, v2, v4
  v_rcp_f32 v3, v2
  v_mov_b32 v5, 0x7fc00000
  v_cndmask_b32 v20, v20, v5, vcc
  v_mov_b32 v8, v3
  v_mov_b32 v9, v3
  v_accvgpr_read_b32 v128, a0
  v_accvgpr_read_b32 v129, a1
  v_accvgpr_read_b32 v130, a2
  v_accvgpr_read_b32 v131, a3
  v_accvgpr_read_b32 v132, a4
  v_accvgpr_read_b32 v133, a5
  v_accvgpr_read_b32 v134, a6
  v_accvgpr_read_b32 v135, a7
  v_accvgpr_read_b32 v136, a8
  v_accvgpr_read_b32 v137, a9
  v_accvgpr_read_b32 v138, a10
  v_accvgpr_read_b32 v139, a11
  v_accvgpr_read_b32 v140, a12
  v_accvgpr_read_b32 v141, a13
  v_accvgpr_read_b32 v142, a14
  v_accvgpr_read_b32 v143, a15
  v_pk_mul_f32 v[128:129], v[128:129], v[8:9]
  v_pk_mul_f32 v[130:131], v[130:131], v[8:9]
  v_pk_mul_f32 v[132:133], v[132:133], v[8:9]
  v_pk_mul_f32 v[134:135], v[134:135], v[8:9]
  v_pk_mul_f32 v[136:137], v[136:137], v[8:9]
  v_pk_mul_f32 v[138:139], v[138:139], v[8:9]
  v_pk_mul_f32 v[140:141], v[140:141], v[8:9]
  v_pk_mul_f32 v[142:143], v[142:143], v[8:9]
  v_cvt_pk_bf16_f32 v192, v128, v129
  v_cvt_pk_bf16_f32 v193, v130, v131
  v_cvt_pk_bf16_f32 v194, v132, v133
  v_cvt_pk_bf16_f32 v195, v134, v135
  v_cvt_pk_bf16_f32 v196, v136, v137
  v_cvt_pk_bf16_f32 v197, v138, v139
  v_cvt_pk_bf16_f32 v198, v140, v141
  v_cvt_pk_bf16_f32 v199, v142, v143
  v_dot2_f32_bf16 v20, v192, v6, v20
  v_dot2_f32_bf16 v20, v193, v6, v20
  v_dot2_f32_bf16 v20, v194, v6, v20
  v_dot2_f32_bf16 v20, v195, v6, v20
  v_dot2_f32_bf16 v20, v196, v6, v20
  v_dot2_f32_bf16 v20, v197, v6, v20
  v_dot2_f32_bf16 v20, v198, v6, v20
  v_dot2_f32_bf16 v20, v199, v6, v20
  buffer_store_dwordx4 v[192:195], v21, s[16:19], s83 offen sc1
  buffer_store_dwordx4 v[196:199], v21, s[16:19], s83 offen offset:1024 sc1
  v_accvgpr_read_b32 v128, a16
  v_accvgpr_read_b32 v129, a17
  v_accvgpr_read_b32 v130, a18
  v_accvgpr_read_b32 v131, a19
  v_accvgpr_read_b32 v132, a20
  v_accvgpr_read_b32 v133, a21
  v_accvgpr_read_b32 v134, a22
  v_accvgpr_read_b32 v135, a23
  v_accvgpr_read_b32 v136, a24
  v_accvgpr_read_b32 v137, a25
  v_accvgpr_read_b32 v138, a26
  v_accvgpr_read_b32 v139, a27
  v_accvgpr_read_b32 v140, a28
  v_accvgpr_read_b32 v141, a29
  v_accvgpr_read_b32 v142, a30
  v_accvgpr_read_b32 v143, a31
  v_pk_mul_f32 v[128:129], v[128:129], v[8:9]
  v_pk_mul_f32 v[130:131], v[130:131], v[8:9]
  v_pk_mul_f32 v[132:133], v[132:133], v[8:9]
  v_pk_mul_f32 v[134:135], v[134:135], v[8:9]
  v_pk_mul_f32 v[136:137], v[136:137], v[8:9]
  v_pk_mul_f32 v[138:139], v[138:139], v[8:9]
  v_pk_mul_f32 v[140:141], v[140:141], v[8:9]
  v_pk_mul_f32 v[142:143], v[142:143], v[8:9]
  v_cvt_pk_bf16_f32 v192, v128, v129
  v_cvt_pk_bf16_f32 v193, v130, v131
  v_cvt_pk_bf16_f32 v194, v132, v133
  v_cvt_pk_bf16_f32 v195, v134, v135
  v_cvt_pk_bf16_f32 v196, v136, v137
  v_cvt_pk_bf16_f32 v197, v138, v139
  v_cvt_pk_bf16_f32 v198, v140, v141
  v_cvt_pk_bf16_f32 v199, v142, v143
  v_dot2_f32_bf16 v20, v192, v6, v20
  v_dot2_f32_bf16 v20, v193, v6, v20
  v_dot2_f32_bf16 v20, v194, v6, v20
  v_dot2_f32_bf16 v20, v195, v6, v20
  v_dot2_f32_bf16 v20, v196, v6, v20
  v_dot2_f32_bf16 v20, v197, v6, v20
  v_dot2_f32_bf16 v20, v198, v6, v20
  v_dot2_f32_bf16 v20, v199, v6, v20
  buffer_store_dwordx4 v[192:195], v21, s[16:19], s83 offen offset:2048 sc1
  buffer_store_dwordx4 v[196:199], v21, s[16:19], s83 offen offset:3072 sc1
  v_accvgpr_read_b32 v128, a32
  v_accvgpr_read_b32 v129, a33
  v_accvgpr_read_b32 v130, a34
  v_accvgpr_read_b32 v131, a35
  v_accvgpr_read_b32 v132, a36
  v_accvgpr_read_b32 v133, a37
  v_accvgpr_read_b32 v134, a38
  v_accvgpr_read_b32 v135, a39
  v_accvgpr_read_b32 v136, a40
  v_accvgpr_read_b32 v137, a41
  v_accvgpr_read_b32 v138, a42
  v_accvgpr_read_b32 v139, a43
  v_accvgpr_read_b32 v140, a44
  v_accvgpr_read_b32 v141, a45
  v_accvgpr_read_b32 v142, a46
  v_accvgpr_read_b32 v143, a47
  v_pk_mul_f32 v[128:129], v[128:129], v[8:9]
  v_pk_mul_f32 v[130:131], v[130:131], v[8:9]
  v_pk_mul_f32 v[132:133], v[132:133], v[8:9]
  v_pk_mul_f32 v[134:135], v[134:135], v[8:9]
  v_pk_mul_f32 v[136:137], v[136:137], v[8:9]
  v_pk_mul_f32 v[138:139], v[138:139], v[8:9]
  v_pk_mul_f32 v[140:141], v[140:141], v[8:9]
  v_pk_mul_f32 v[142:143], v[142:143], v[8:9]
  v_cvt_pk_bf16_f32 v192, v128, v129
  v_cvt_pk_bf16_f32 v193, v130, v131
  v_cvt_pk_bf16_f32 v194, v132, v133
  v_cvt_pk_bf16_f32 v195, v134, v135
  v_cvt_pk_bf16_f32 v196, v136, v137
  v_cvt_pk_bf16_f32 v197, v138, v139
  v_cvt_pk_bf16_f32 v198, v140, v141
  v_cvt_pk_bf16_f32 v199, v142, v143
  v_dot2_f32_bf16 v20, v192, v6, v20
  v_dot2_f32_bf16 v20, v193, v6, v20
  v_dot2_f32_bf16 v20, v194, v6, v20
  v_dot2_f32_bf16 v20, v195, v6, v20
  v_dot2_f32_bf16 v20, v196, v6, v20
  v_dot2_f32_bf16 v20, v197, v6, v20
  v_dot2_f32_bf16 v20, v198, v6, v20
  v_dot2_f32_bf16 v20, v199, v6, v20
  buffer_store_dwordx4 v[192:195], v21, s[16:19], s76 offen sc1
  buffer_store_dwordx4 v[196:199], v21, s[16:19], s76 offen offset:1024 sc1
  v_accvgpr_read_b32 v128, a48
  v_accvgpr_read_b32 v129, a49
  v_accvgpr_read_b32 v130, a50
  v_accvgpr_read_b32 v131, a51
  v_accvgpr_read_b32 v132, a52
  v_accvgpr_read_b32 v133, a53
  v_accvgpr_read_b32 v134, a54
  v_accvgpr_read_b32 v135, a55
  v_accvgpr_read_b32 v136, a56
  v_accvgpr_read_b32 v137, a57
  v_accvgpr_read_b32 v138, a58
  v_accvgpr_read_b32 v139, a59
  v_accvgpr_read_b32 v140, a60
  v_accvgpr_read_b32 v141, a61
  v_accvgpr_read_b32 v142, a62
  v_accvgpr_read_b32 v143, a63
  v_pk_mul_f32 v[128:129], v[128:129], v[8:9]
  v_pk_mul_f32 v[130:131], v[130:131], v[8:9]
  v_pk_mul_f32 v[132:133], v[132:133], v[8:9]
  v_pk_mul_f32 v[134:135], v[134:135], v[8:9]
  v_pk_mul_f32 v[136:137], v[136:137], v[8:9]
  v_pk_mul_f32 v[138:139], v[138:139], v[8:9]
  v_pk_mul_f32 v[140:141], v[140:141], v[8:9]
  v_pk_mul_f32 v[142:143], v[142:143], v[8:9]
  v_cvt_pk_bf16_f32 v192, v128, v129
  v_cvt_pk_bf16_f32 v193, v130, v131
  v_cvt_pk_bf16_f32 v194, v132, v133
  v_cvt_pk_bf16_f32 v195, v134, v135
  v_cvt_pk_bf16_f32 v196, v136, v137
  v_cvt_pk_bf16_f32 v197, v138, v139
  v_cvt_pk_bf16_f32 v198, v140, v141
  v_cvt_pk_bf16_f32 v199, v142, v143
  v_dot2_f32_bf16 v20, v192, v6, v20
  v_dot2_f32_bf16 v20, v193, v6, v20
  v_dot2_f32_bf16 v20, v194, v6, v20
  v_dot2_f32_bf16 v20, v195, v6, v20
  v_dot2_f32_bf16 v20, v196, v6, v20
  v_dot2_f32_bf16 v20, v197, v6, v20
  v_dot2_f32_bf16 v20, v198, v6, v20
  v_dot2_f32_bf16 v20, v199, v6, v20
  buffer_store_dwordx4 v[192:195], v21, s[16:19], s76 offen offset:2048 sc1
  buffer_store_dwordx4 v[196:199], v21, s[16:19], s76 offen offset:3072 sc1
  s_lshl_b32 s74, s40, 1
  s_sub_u32 s74, 13, s74
L_b_SF:
  s_waitcnt lgkmcnt(3)
  v_mfma_f32_32x32x16_bf16 v[144:159], a[192:195], v[64:67], v[240:255]
  s_waitcnt vmcnt(12)
  s_barrier
  ds_read_b128 a[212:215], v10 offset:5120
  ds_read_b128 a[216:219], v10 offset:6144
  v_exp_f32 v176, v176
  v_mfma_f32_32x32x16_bf16 v[144:159], a[196:199], v[68:71], v[144:159]
  ds_read_b128 a[220:223], v10 offset:7168
  s_add_u32 m0, s69, 0x4000
  v_exp_f32 v177, v177
  v_exp_f32 v178, v178
  s_waitcnt lgkmcnt(4)
  v_mfma_f32_32x32x16_bf16 v[144:159], a[200:203], v[72:75], v[144:159]
  ds_read_b128 a[224:227], v13 offset:16384
  v_exp_f32 v179, v179
  v_add_f32 v18, v18, v176
  v_add_f32 v19, v19, v177
  v_mfma_f32_32x32x16_bf16 v[144:159], a[204:207], v[76:79], v[144:159]
  ds_read_b128 a[228:231], v13 offset:17408
  buffer_load_dwordx4 v25, s[60:63], s72 offen sc1 lds
  v_cvt_pk_bf16_f32 v216, v176, v177
  s_waitcnt lgkmcnt(4)
  v_mfma_f32_32x32x16_bf16 v[144:159], a[208:211], v[80:83], v[144:159]
  ds_read_b128 a[232:235], v13 offset:18432
  v_exp_f32 v180, v180
  v_exp_f32 v181, v181
  v_add_f32 v18, v18, v178
  v_mfma_f32_32x32x16_bf16 v[144:159], a[212:215], v[84:87], v[144:159]
  ds_read_b128 a[236:239], v13 offset:19456
  buffer_load_dwordx4 v25, s[60:63], s72 offen offset:1024 sc1 lds
  v_add_f32 v19, v19, v179
  v_cvt_pk_bf16_f32 v217, v178, v179
  s_waitcnt lgkmcnt(4)
  v_mfma_f32_32x32x16_bf16 v[144:159], a[216:219], v[88:91], v[144:159]
  ds_read_b128 a[240:243], v13 offset:20480
  v_exp_f32 v182, v182
  v_exp_f32 v183, v183
  v_mfma_f32_32x32x16_bf16 v[144:159], a[220:223], v[92:95], v[144:159]
  ds_read_b128 a[244:247], v13 offset:21504
  buffer_load_dwordx4 v25, s[60:63], s72 offen offset:2048 sc1 lds
  v_add_f32 v18, v18, v180
  v_add_f32 v19, v19, v181
  s_waitcnt lgkmcnt(4)
  v_mfma_f32_32x32x16_bf16 a[64:79], a[224:227], v[200:203], a[64:79]
  ds_read_b128 a[248:251], v13 offset:22528
  v_cvt_pk_bf16_f32 v218, v180, v181
  v_exp_f32 v184, v184
  v_exp_f32 v185, v185
  v_mfma_f32_32x32x16_bf16 a[80:95], a[228:231], v[200:203], a[80:95]
  ds_read_b128 a[252:255], v13 offset:23552
  buffer_load_dwordx4 v25, s[60:63], s72 offen offset:3072 sc1 lds
  v_add_f32 v18, v18, v182
  s_waitcnt lgkmcnt(4)
  v_mfma_f32_32x32x16_bf16 a[96:111], a[232:235], v[200:203], a[96:111]
  v_add_f32 v19, v19, v183
  v_cvt_pk_bf16_f32 v219, v182, v183
  v_exp_f32 v186, v186
  v_exp_f32 v187, v187
  v_mfma_f32_32x32x16_bf16 a[112:127], a[236:239], v[200:203], a[112:127]
  ds_read_b128 a[192:195], v10 offset:8192
  s_add_u32 s72, s72, 16384
  v_add_f32 v18, v18, v184
  v_add_f32 v19, v19, v185
  v_cvt_pk_bf16_f32 v220, v184, v185
  s_waitcnt lgkmcnt(3)
  v_mfma_f32_32x32x16_bf16 a[64:79], a[240:243], v[204:207], a[64:79]
  ds_read_b128 a[196:199], v10 offset:9216
  v_exp_f32 v188, v188
  v_exp_f32 v189, v189
  v_mfma_f32_32x32x16_bf16 a[80:95], a[244:247], v[204:207], a[80:95]
  ds_read_b128 a[200:203], v10 offset:10240
  v_add_f32 v18, v18, v186
  v_add_f32 v19, v19, v187
  v_cvt_pk_bf16_f32 v221, v186, v187
  v_exp_f32 v190, v190
  s_waitcnt lgkmcnt(3)
  v_mfma_f32_32x32x16_bf16 a[96:111], a[248:251], v[204:207], a[96:111]
  ds_read_b128 a[204:207], v10 offset:11264
  v_exp_f32 v191, v191
  v_add_f32 v18, v18, v188
  v_add_f32 v19, v19, v189
  v_mfma_f32_32x32x16_bf16 a[112:127], a[252:255], v[204:207], a[112:127]
  ds_read_b128 a[208:211], v10 offset:12288
  v_cvt_pk_bf16_f32 v222, v188, v189
  v_add_f32 v18, v18, v190
  v_add_f32 v19, v19, v191
  v_cvt_pk_bf16_f32 v223, v190, v191
  s_waitcnt lgkmcnt(3)
  v_mfma_f32_32x32x16_bf16 v[176:191], a[192:195], v[64:67], v[240:255]
  ds_read_b128 a[212:215], v10 offset:13312
  ds_read_b128 a[216:219], v10 offset:14336
  v_exp_f32 v144, v144
  v_exp_f32 v145, v145
  v_mfma_f32_32x32x16_bf16 v[176:191], a[196:199], v[68:71], v[176:191]
  ds_read_b128 a[220:223], v10 offset:15360
  s_add_u32 m0, s71, 0
  v_exp_f32 v146, v146
  s_waitcnt lgkmcnt(4)
  v_mfma_f32_32x32x16_bf16 v[176:191], a[200:203], v[72:75], v[176:191]
  ds_read_b128 a[224:227], v13 offset:24576
  v_exp_f32 v147, v147
  v_add_f32 v18, v18, v144
  v_add_f32 v19, v19, v145
  v_cvt_pk_bf16_f32 v200, v144, v145
  v_mfma_f32_32x32x16_bf16 v[176:191], a[204:207], v[76:79], v[176:191]
  ds_read_b128 a[228:231], v13 offset:25600
  buffer_load_dwordx4 v25, s[64:67], s73 offen sc1 lds
  v_exp_f32 v148, v148
  s_waitcnt lgkmcnt(4)
  v_mfma_f32_32x32x16_bf16 v[176:191], a[208:211], v[80:83], v[176:191]
  ds_read_b128 a[232:235], v13 offset:26624
  v_exp_f32 v149, v149
  v_add_f32 v18, v18, v146
  v_add_f32 v19, v19, v147
  v_mfma_f32_32x32x16_bf16 v[176:191], a[212:215], v[84:87], v[176:191]
  ds_read_b128 a[236:239], v13 offset:27648
  buffer_load_dwordx4 v25, s[64:67], s73 offen offset:1024 sc1 lds
  v_cvt_pk_bf16_f32 v201, v146, v147
  s_waitcnt lgkmcnt(4)
  v_mfma_f32_32x32x16_bf16 v[176:191], a[216:219], v[88:91], v[176:191]
  ds_read_b128 a[240:243], v13 offset:28672
  v_exp_f32 v150, v150
  v_exp_f32 v151, v151
  v_add_f32 v18, v18, v148
  v_mfma_f32_32x32x16_bf16 v[176:191], a[220:223], v[92:95], v[176:191]
  ds_read_b128 a[244:247], v13 offset:29696
  buffer_load_dwordx4 v25, s[64:67], s73 offen offset:2048 sc1 lds
  v_add_f32 v19, v19, v149
  v_cvt_pk_bf16_f32 v202, v148, v149
  s_waitcnt lgkmcnt(4)
  v_mfma_f32_32x32x16_bf16 a[64:79], a[224:227], v[216:219], a[64:79]
  ds_read_b128 a[248:251], v13 offset:30720
  v_exp_f32 v152, v152
  v_exp_f32 v153, v153
  v_mfma_f32_32x32x16_bf16 a[80:95], a[228:231], v[216:219], a[80:95]
  ds_read_b128 a[252:255], v13 offset:31744
  buffer_load_dwordx4 v25, s[64:67], s73 offen offset:3072 sc1 lds
  v_add_f32 v18, v18, v150
  v_add_f32 v19, v19, v151
  s_waitcnt lgkmcnt(4)
  v_mfma_f32_32x32x16_bf16 a[96:111], a[232:235], v[216:219], a[96:111]
  v_cvt_pk_bf16_f32 v203, v150, v151
  v_exp_f32 v154, v154
  v_exp_f32 v155, v155
  v_mfma_f32_32x32x16_bf16 a[112:127], a[236:239], v[216:219], a[112:127]
  ds_read_b128 a[192:195], v10 offset:16384
  s_add_u32 s73, s73, 16384
  v_add_f32 v18, v18, v152
  v_add_f32 v19, v19, v153
  v_cvt_pk_bf16_f32 v204, v152, v153
  s_waitcnt lgkmcnt(3)
  v_mfma_f32_32x32x16_bf16 a[64:79], a[240:243], v[220:223], a[64:79]
  ds_read_b128 a[196:199], v10 offset:17408
  v_exp_f32 v156, v156
  v_exp_f32 v157, v157
  v_mfma_f32_32x32x16_bf16 a[80:95], a[244:247], v[220:223], a[80:95]
  ds_read_b128 a[200:203], v10 offset:18432
  v_add_f32 v18, v18, v154
  v_add_f32 v19, v19, v155
  v_cvt_pk_bf16_f32 v205, v154, v155
  v_exp_f32 v158, v158
  s_waitcnt lgkmcnt(3)
  v_mfma_f32_32x32x16_bf16 a[96:111], a[248:251], v[220:223], a[96:111]
  ds_read_b128 a[204:207], v10 offset:19456
  v_exp_f32 v159, v159
  v_add_f32 v18, v18, v156
  v_add_f32 v19, v19, v157
  v_mfma_f32_32x32x16_bf16 a[112:127], a[252:255], v[220:223], a[112:127]
  ds_read_b128 a[208:211], v10 offset:20480
  v_cvt_pk_bf16_f32 v206, v156, v157
  v_add_f32 v18, v18, v158
  v_add_f32 v19, v19, v159
  v_cvt_pk_bf16_f32 v207, v158, v159
  s_waitcnt lgkmcnt(3)
  v_mfma_f32_32x32x16_bf16 v[144:159], a[192:195], v[64:67], v[240:255]
  s_waitcnt vmcnt(12)
  s_barrier
  ds_read_b128 a[212:215], v10 offset:21504
  ds_read_b128 a[216:219], v10 offset:22528
  v_exp_f32 v176, v176
  v_mfma_f32_32x32x16_bf16 v[144:159], a[196:199], v[68:71], v[144:159]
  ds_read_b128 a[220:223], v10 offset:23552
  s_add_u32 m0, s68, 0
  v_exp_f32 v177, v177
  v_exp_f32 v178, v178
  s_waitcnt lgkmcnt(4)
  v_mfma_f32_32x32x16_bf16 v[144:159], a[200:203], v[72:75], v[144:159]
  ds_read_b128 a[224:227], v12
  v_exp_f32 v179, v179
  v_add_f32 v18, v18, v176
  v_add_f32 v19, v19, v177
  v_mfma_f32_32x32x16_bf16 v[144:159], a[204:207], v[76:79], v[144:159]
  ds_read_b128 a[228:231], v12 offset:1024
  buffer_load_dwordx4 v25, s[60:63], s72 offen sc1 lds
  v_cvt_pk_bf16_f32 v216, v176, v177
  s_waitcnt lgkmcnt(4)
  v_mfma_f32_32x32x16_bf16 v[144:159], a[208:211], v[80:83], v[144:159]
  ds_read_b128 a[232:235], v12 offset:2048
  v_exp_f32 v180, v180
  v_exp_f32 v181, v181
  v_add_f32 v18, v18, v178
  v_mfma_f32_32x32x16_bf16 v[144:159], a[212:215], v[84:87], v[144:159]
  ds_read_b128 a[236:239], v12 offset:3072
  buffer_load_dwordx4 v25, s[60:63], s72 offen offset:1024 sc1 lds
  v_add_f32 v19, v19, v179
  v_cvt_pk_bf16_f32 v217, v178, v179
  s_waitcnt lgkmcnt(4)
  v_mfma_f32_32x32x16_bf16 v[144:159], a[216:219], v[88:91], v[144:159]
  ds_read_b128 a[240:243], v12 offset:4096
  v_exp_f32 v182, v182
  v_exp_f32 v183, v183
  v_mfma_f32_32x32x16_bf16 v[144:159], a[220:223], v[92:95], v[144:159]
  ds_read_b128 a[244:247], v12 offset:5120
  buffer_load_dwordx4 v25, s[60:63], s72 offen offset:2048 sc1 lds
  v_add_f32 v18, v18, v180
  v_add_f32 v19, v19, v181
  s_waitcnt lgkmcnt(4)
  v_mfma_f32_32x32x16_bf16 a[64:79], a[224:227], v[200:203], a[64:79]
  ds_read_b128 a[248:251], v12 offset:6144
  v_cvt_pk_bf16_f32 v218, v180, v181
  v_exp_f32 v184, v184
  v_exp_f32 v185, v185
  v_mfma_f32_32x32x16_bf16 a[80:95], a[228:231], v[200:203], a[80:95]
  ds_read_b128 a[252:255], v12 offset:7168
  buffer_load_dwordx4 v25, s[60:63], s72 offen offset:3072 sc1 lds
  v_add_f32 v18, v18, v182
  s_waitcnt lgkmcnt(4)
  v_mfma_f32_32x32x16_bf16 a[96:111], a[232:235], v[200:203], a[96:111]
  v_add_f32 v19, v19, v183
  v_cvt_pk_bf16_f32 v219, v182, v183
  v_exp_f32 v186, v186
  v_exp_f32 v187, v187
  v_mfma_f32_32x32x16_bf16 a[112:127], a[236:239], v[200:203], a[112:127]
  ds_read_b128 a[192:195], v10 offset:24576
  s_add_u32 s72, s72, 16384
  v_add_f32 v18, v18, v184
  v_add_f32 v19, v19, v185
  v_cvt_pk_bf16_f32 v220, v184, v185
  s_waitcnt lgkmcnt(3)
  v_mfma_f32_32x32x16_bf16 a[64:79], a[240:243], v[204:207], a[64:79]
  ds_read_b128 a[196:199], v10 offset:25600
  v_exp_f32 v188, v188
  v_exp_f32 v189, v189
  v_mfma_f32_32x32x16_bf16 a[80:95], a[244:247], v[204:207], a[80:95]
  ds_read_b128 a[200:203], v10 offset:26624
  v_add_f32 v18, v18, v186
  v_add_f32 v19, v19, v187
  v_cvt_pk_bf16_f32 v221, v186, v187
  v_exp_f32 v190, v190
  s_waitcnt lgkmcnt(3)
  v_mfma_f32_32x32x16_bf16 a[96:111], a[248:251], v[204:207], a[96:111]
  ds_read_b128 a[204:207], v10 offset:27648
  v_exp_f32 v191, v191
  v_add_f32 v18, v18, v188
  v_add_f32 v19, v19, v189
  v_mfma_f32_32x32x16_bf16 a[112:127], a[252:255], v[204:207], a[112:127]
  ds_read_b128 a[208:211], v10 offset:28672
  v_cvt_pk_bf16_f32 v222, v188, v189
  v_add_f32 v18, v18, v190
  v_add_f32 v19, v19, v191
  v_cvt_pk_bf16_f32 v223, v190, v191
  s_waitcnt lgkmcnt(3)
  v_mfma_f32_32x32x16_bf16 v[176:191], a[192:195], v[64:67], v[240:255]
  ds_read_b128 a[212:215], v10 offset:29696
  ds_read_b128 a[216:219], v10 offset:30720
  v_exp_f32 v144, v144
  v_exp_f32 v145, v145
  v_mfma_f32_32x32x16_bf16 v[176:191], a[196:199], v[68:71], v[176:191]
  ds_read_b128 a[220:223], v10 offset:31744
  s_add_u32 m0, s71, 0x4000
  v_exp_f32 v146, v146
  v_exp_f32 v147, v147
  s_waitcnt lgkmcnt(4)
  v_mfma_f32_32x32x16_bf16 v[176:191], a[200:203], v[72:75], v[176:191]
  ds_read_b128 a[224:227], v12 offset:8192
  buffer_load_dwordx4 v25, s[64:67], s73 offen sc1 lds
  v_xor_b32 v10, 0x8000, v10
  v_add_f32 v18, v18, v144
  v_mfma_f32_32x32x16_bf16 v[176:191], a[204:207], v[76:79], v[176:191]
  ds_read_b128 a[228:231], v12 offset:9216
  buffer_load_dwordx4 v25, s[64:67], s73 offen offset:1024 sc1 lds
  v_xor_b32 v11, 0x8000, v11
  v_add_f32 v19, v19, v145
  s_waitcnt lgkmcnt(4)
  v_mfma_f32_32x32x16_bf16 v[176:191], a[208:211], v[80:83], v[176:191]
  ds_read_b128 a[232:235], v12 offset:10240
  buffer_load_dwordx4 v25, s[64:67], s73 offen offset:2048 sc1 lds
  v_cvt_pk_bf16_f32 v200, v144, v145
  v_exp_f32 v148, v148
  v_mfma_f32_32x32x16_bf16 v[176:191], a[212:215], v[84:87], v[176:191]
  ds_read_b128 a[236:239], v12 offset:11264
  buffer_load_dwordx4 v25, s[64:67], s73 offen offset:3072 sc1 lds
  v_exp_f32 v149, v149
  s_waitcnt lgkmcnt(4)
  v_mfma_f32_32x32x16_bf16 v[176:191], a[216:219], v[88:91], v[176:191]
  ds_read_b128 a[240:243], v12 offset:12288
  s_add_u32 s73, s73, 16384
  v_add_f32 v18, v18, v146
  v_add_f32 v19, v19, v147
  v_cvt_pk_bf16_f32 v201, v146, v147
  v_mfma_f32_32x32x16_bf16 v[176:191], a[220:223], v[92:95], v[176:191]
  ds_read_b128 a[244:247], v12 offset:13312
  s_xor_b32 s68, s68, 0x8000
  s_xor_b32 s69, s69, 0x8000
  v_exp_f32 v150, v150
  v_exp_f32 v151, v151
  s_waitcnt lgkmcnt(4)
  v_mfma_f32_32x32x16_bf16 a[64:79], a[224:227], v[216:219], a[64:79]
  ds_read_b128 a[248:251], v12 offset:14336
  s_xor_b32 s70, s70, 0x8000
  s_xor_b32 s71, s71, 0x8000
  v_add_f32 v18, v18, v148
  v_add_f32 v19, v19, v149
  v_cvt_pk_bf16_f32 v202, v148, v149
  v_mfma_f32_32x32x16_bf16 a[80:95], a[228:231], v[216:219], a[80:95]
  ds_read_b128 a[252:255], v12 offset:15360
  s_sub_u32 s74, s74, 1
  v_exp_f32 v152, v152
  v_exp_f32 v153, v153
  s_waitcnt lgkmcnt(4)
  v_mfma_f32_32x32x16_bf16 a[96:111], a[232:235], v[216:219], a[96:111]
  v_xor_b32 v12, 0x8000, v12
  v_add_f32 v18, v18, v150
  v_add_f32 v19, v19, v151
  v_cvt_pk_bf16_f32 v203, v150, v151
  v_exp_f32 v154, v154
  v_mfma_f32_32x32x16_bf16 a[112:127], a[236:239], v[216:219], a[112:127]
  ds_read_b128 a[192:195], v10
  v_xor_b32 v13, 0x8000, v13
  v_exp_f32 v155, v155
  v_add_f32 v18, v18, v152
  v_add_f32 v19, v19, v153
  s_waitcnt lgkmcnt(3)
  v_mfma_f32_32x32x16_bf16 a[64:79], a[240:243], v[220:223], a[64:79]
  ds_read_b128 a[196:199], v10 offset:1024
  v_cvt_pk_bf16_f32 v204, v152, v153
  v_exp_f32 v156, v156
  v_exp_f32 v157, v157
  v_add_f32 v18, v18, v154
  v_mfma_f32_32x32x16_bf16 a[80:95], a[244:247], v[220:223], a[80:95]
  ds_read_b128 a[200:203], v10 offset:2048
  v_add_f32 v19, v19, v155
  v_cvt_pk_bf16_f32 v205, v154, v155
  v_exp_f32 v158, v158
  s_waitcnt lgkmcnt(3)
  v_mfma_f32_32x32x16_bf16 a[96:111], a[248:251], v[220:223], a[96:111]
  ds_read_b128 a[204:207], v10 offset:3072
  v_exp_f32 v159, v159
  v_add_f32 v18, v18, v156
  v_add_f32 v19, v19, v157
  v_cvt_pk_bf16_f32 v206, v156, v157
  v_add_f32 v18, v18, v158
  v_mfma_f32_32x32x16_bf16 a[112:127], a[252:255], v[220:223], a[112:127]
  ds_read_b128 a[208:211], v10 offset:4096
  v_add_f32 v19, v19, v159
  v_cvt_pk_bf16_f32 v207, v158, v159
  s_cmp_lg_u32 s74, 0
  s_cbranch_scc1 L_b_SF
L_b_SM:
  s_cmp_lg_u32 s42, 0
  s_cbranch_scc1 L_b_ev_24
  v_accvgpr_read_b32 v8, a128
  v_add_f32 v240, v240, v8
  v_accvgpr_read_b32 v9, a129
  v_add_f32 v241, v241, v9
  v_accvgpr_read_b32 v8, a130
  v_add_f32 v242, v242, v8
  v_accvgpr_read_b32 v9, a131
  v_add_f32 v243, v243, v9
  v_accvgpr_read_b32 v8, a132
  v_add_f32 v244, v244, v8
  v_accvgpr_read_b32 v9, a133
  v_add_f32 v245, v245, v9
  v_accvgpr_read_b32 v8, a134
  v_add_f32 v246, v246, v8
  v_accvgpr_read_b32 v9, a135
  v_add_f32 v247, v247, v9
  v_accvgpr_read_b32 v8, a136
  v_add_f32 v248, v248, v8
  v_accvgpr_read_b32 v9, a137
  v_add_f32 v249, v249, v9
  v_accvgpr_read_b32 v8, a138
  v_add_f32 v250, v250, v8
  v_accvgpr_read_b32 v9, a139
  v_add_f32 v251, v251, v9
  v_accvgpr_read_b32 v8, a140
  v_add_f32 v252, v252, v8
  v_accvgpr_read_b32 v9, a141
  v_add_f32 v253, v253, v9
  v_accvgpr_read_b32 v8, a142
  v_add_f32 v254, v254, v8
  v_accvgpr_read_b32 v9, a143
  v_add_f32 v255, v255, v9
L_b_ev_24:
  s_nop 1
  s_waitcnt lgkmcnt(3)
  v_mfma_f32_32x32x16_bf16 v[144:159], a[192:195], v[64:67], v[240:255]
  s_waitcnt vmcnt(12)
  s_barrier
  s_lshr_b32 s75, s41, 2
  s_lshl_b32 s75, s75, 7
  s_add_u32 s75, s75, 0x4d02000
  v_and_b32 v24, 7, v27
  v_lshlrev_b32 v24, 2, v24
  v_lshrrev_b32 v22, 3, v27
  v_add_u32 v22, 1, v22
  v_lshlrev_b32 v22, 10, v22
  v_add_u32 v24, v24, v22
  s_lshl_b32 s81, s40, 2
  v_cmp_eq_u32 vcc, 16, v27
  v_mov_b32 v22, s81
  s_nop 0
  v_cndmask_b32 v24, v24, v22, vcc
  buffer_load_dword v22, v24, s[16:19], s75 offen sc1
  ds_read_b128 a[212:215], v10 offset:5120
  ds_read_b128 a[216:219], v10 offset:6144
  v_mfma_f32_32x32x16_bf16 v[144:159], a[196:199], v[68:71], v[144:159]
  ds_read_b128 a[220:223], v10 offset:7168
  s_add_u32 m0, s69, 0x4000
  v_exp_f32 v176, v176
  v_exp_f32 v177, v177
  s_waitcnt lgkmcnt(4)
  v_mfma_f32_32x32x16_bf16 v[144:159], a[200:203], v[72:75], v[144:159]
  ds_read_b128 a[224:227], v13 offset:16384
  v_exp_f32 v178, v178
  v_exp_f32 v179, v179
  v_mfma_f32_32x32x16_bf16 v[144:159], a[204:207], v[76:79], v[144:159]
  ds_read_b128 a[228:231], v13 offset:17408
  buffer_load_dwordx4 v25, s[60:63], s72 offen sc1 lds
  v_add_f32 v18, v18, v176
  v_add_f32 v19, v19, v177
  s_waitcnt lgkmcnt(4)
  v_mfma_f32_32x32x16_bf16 v[144:159], a[208:211], v[80:83], v[144:159]
  ds_read_b128 a[232:235], v13 offset:18432
  v_cvt_pk_bf16_f32 v216, v176, v177
  v_exp_f32 v180, v180
  v_exp_f32 v181, v181
  v_mfma_f32_32x32x16_bf16 v[144:159], a[212:215], v[84:87], v[144:159]
  ds_read_b128 a[236:239], v13 offset:19456
  buffer_load_dwordx4 v25, s[60:63], s72 offen offset:1024 sc1 lds
  v_add_f32 v18, v18, v178
  s_waitcnt lgkmcnt(4)
  v_mfma_f32_32x32x16_bf16 v[144:159], a[216:219], v[88:91], v[144:159]
  ds_read_b128 a[240:243], v13 offset:20480
  v_add_f32 v19, v19, v179
  v_cvt_pk_bf16_f32 v217, v178, v179
  v_exp_f32 v182, v182
  v_mfma_f32_32x32x16_bf16 v[144:159], a[220:223], v[92:95], v[144:159]
  ds_read_b128 a[244:247], v13 offset:21504
  buffer_load_dwordx4 v25, s[60:63], s72 offen offset:2048 sc1 lds
  v_exp_f32 v183, v183
  v_add_f32 v18, v18, v180
  s_waitcnt lgkmcnt(4)
  v_mfma_f32_32x32x16_bf16 a[64:79], a[224:227], v[200:203], a[64:79]
  ds_read_b128 a[248:251], v13 offset:22528
  v_add_f32 v19, v19, v181
  v_cvt_pk_bf16_f32 v218, v180, v181
  v_exp_f32 v184, v184
  v_mfma_f32_32x32x16_bf16 a[80:95], a[228:231], v[200:203], a[80:95]
  ds_read_b128 a[252:255], v13 offset:23552
  buffer_load_dwordx4 v25, s[60:63], s72 offen offset:3072 sc1 lds
  v_exp_f32 v185, v185
  s_waitcnt lgkmcnt(4)
  v_mfma_f32_32x32x16_bf16 a[96:111], a[232:235], v[200:203], a[96:111]
  v_add_f32 v18, v18, v182
  v_add_f32 v19, v19, v183
  v_cvt_pk_bf16_f32 v219, v182, v183
  v_exp_f32 v186, v186
  v_mfma_f32_32x32x16_bf16 a[112:127], a[236:239], v[200:203], a[112:127]
  ds_read_b128 a[192:195], v10 offset:8192
  s_add_u32 s72, s72, 16384
  v_exp_f32 v187, v187
  v_add_f32 v18, v18, v184
  v_add_f32 v19, v19, v185
  s_waitcnt lgkmcnt(3)
  v_mfma_f32_32x32x16_bf16 a[64:79], a[240:243], v[204:207], a[64:79]
  ds_read_b128 a[196:199], v10 offset:9216
  v_cvt_pk_bf16_f32 v220, v184, v185
  v_exp_f32 v188, v188
  v_exp_f32 v189, v189
  v_mfma_f32_32x32x16_bf16 a[80:95], a[244:247], v[204:207], a[80:95]
  ds_read_b128 a[200:203], v10 offset:10240
  v_add_f32 v18, v18, v186
  v_add_f32 v19, v19, v187
  v_cvt_pk_bf16_f32 v221, v186, v187
  s_waitcnt lgkmcnt(3)
  v_mfma_f32_32x32x16_bf16 a[96:111], a[248:251], v[204:207], a[96:111]
  ds_read_b128 a[204:207], v10 offset:11264
  v_exp_f32 v190, v190
  v_exp_f32 v191, v191
  v_add_f32 v18, v18, v188
  v_mfma_f32_32x32x16_bf16 a[112:127], a[252:255], v[204:207], a[112:127]
  ds_read_b128 a[208:211], v10 offset:12288
  v_add_f32 v19, v19, v189
  v_cvt_pk_bf16_f32 v222, v188, v189
  v_add_f32 v18, v18, v190
  v_add_f32 v19, v19, v191
  v_cvt_pk_bf16_f32 v223, v190, v191
  s_cmp_lg_u32 s42, 1
  s_cbranch_scc1 L_b_ev_26
  v_accvgpr_read_b32 v8, a128
  v_add_f32 v240, v240, v8
  v_accvgpr_read_b32 v9, a129
  v_add_f32 v241, v241, v9
  v_accvgpr_read_b32 v8, a130
  v_add_f32 v242, v242, v8
  v_accvgpr_read_b32 v9, a131
  v_add_f32 v243, v243, v9
  v_accvgpr_read_b32 v8, a132
  v_add_f32 v244, v244, v8
  v_accvgpr_read_b32 v9, a133
  v_add_f32 v245, v245, v9
  v_accvgpr_read_b32 v8, a134
  v_add_f32 v246, v246, v8
  v_accvgpr_read_b32 v9, a135
  v_add_f32 v247, v247, v9
  v_accvgpr_read_b32 v8, a136
  v_add_f32 v248, v248, v8
  v_accvgpr_read_b32 v9, a137
  v_add_f32 v249, v249, v9
  v_accvgpr_read_b32 v8, a138
  v_add_f32 v250, v250, v8
  v_accvgpr_read_b32 v9, a139
  v_add_f32 v251, v251, v9
  v_accvgpr_read_b32 v8, a140
  v_add_f32 v252, v252, v8
  v_accvgpr_read_b32 v9, a141
  v_add_f32 v253, v253, v9
  v_accvgpr_read_b32 v8, a142
  v_add_f32 v254, v254, v8
  v_accvgpr_read_b32 v9, a143
  v_add_f32 v255, v255, v9
L_b_ev_26:
  s_cmp_lg_u32 s42, 0
  s_cbranch_scc1 L_b_ev_27
  v_mov_b32 v240, 0xff800000
  v_mov_b32 v241, 0xff800000
  v_mov_b32 v242, 0xff800000
  v_mov_b32 v243, 0xff800000
  v_mov_b32 v244, 0xff800000
  v_mov_b32 v245, 0xff800000
  v_mov_b32 v246, 0xff800000
  v_mov_b32 v247, 0xff800000
  v_mov_b32 v248, 0xff800000
  v_mov_b32 v249, 0xff800000
  v_mov_b32 v250, 0xff800000
  v_mov_b32 v251, 0xff800000
  v_mov_b32 v252, 0xff800000
  v_mov_b32 v253, 0xff800000
  v_mov_b32 v254, 0xff800000
  v_mov_b32 v255, 0xff800000
L_b_ev_27:
  s_nop 1
  s_waitcnt lgkmcnt(3)
  v_mfma_f32_32x32x16_bf16 v[176:191], a[192:195], v[64:67], v[240:255]
  ds_read_b128 a[212:215], v10 offset:13312
  ds_read_b128 a[216:219], v10 offset:14336
  v_exp_f32 v144, v144
  v_exp_f32 v145, v145
  v_mfma_f32_32x32x16_bf16 v[176:191], a[196:199], v[68:71], v[176:191]
  ds_read_b128 a[220:223], v10 offset:15360
  s_add_u32 m0, s71, 0
  v_exp_f32 v146, v146
  s_waitcnt lgkmcnt(4)
  v_mfma_f32_32x32x16_bf16 v[176:191], a[200:203], v[72:75], v[176:191]
  ds_read_b128 a[224:227], v13 offset:24576
  v_exp_f32 v147, v147
  v_add_f32 v18, v18, v144
  v_add_f32 v19, v19, v145
  v_cvt_pk_bf16_f32 v200, v144, v145
  v_mfma_f32_32x32x16_bf16 v[176:191], a[204:207], v[76:79], v[176:191]
  ds_read_b128 a[228:231], v13 offset:25600
  buffer_load_dwordx4 v25, s[64:67], s73 offen sc1 lds
  v_exp_f32 v148, v148
  s_waitcnt lgkmcnt(4)
  v_mfma_f32_32x32x16_bf16 v[176:191], a[208:211], v[80:83], v[176:191]
  ds_read_b128 a[232:235], v13 offset:26624
  v_exp_f32 v149, v149
  v_add_f32 v18, v18, v146
  v_add_f32 v19, v19, v147
  v_mfma_f32_32x32x16_bf16 v[176:191], a[212:215], v[84:87], v[176:191]
  ds_read_b128 a[236:239], v13 offset:27648
  buffer_load_dwordx4 v25, s[64:67], s73 offen offset:1024 sc1 lds
  v_cvt_pk_bf16_f32 v201, v146, v147
  s_waitcnt lgkmcnt(4)
  v_mfma_f32_32x32x16_bf16 v[176:191], a[216:219], v[88:91], v[176:191]
  ds_read_b128 a[240:243], v13 offset:28672
  v_exp_f32 v150, v150
  v_exp_f32 v151, v151
  v_add_f32 v18, v18, v148
  v_mfma_f32_32x32x16_bf16 v[176:191], a[220:223], v[92:95], v[176:191]
  ds_read_b128 a[244:247], v13 offset:29696
  buffer_load_dwordx4 v25, s[64:67], s73 offen offset:2048 sc1 lds
  v_add_f32 v19, v19, v149
  v_cvt_pk_bf16_f32 v202, v148, v149
  s_waitcnt lgkmcnt(4)
  v_mfma_f32_32x32x16_bf16 a[64:79], a[224:227], v[216:219], a[64:79]
  ds_read_b128 a[248:251], v13 offset:30720
  v_exp_f32 v152, v152
  v_exp_f32 v153, v153
  v_mfma_f32_32x32x16_bf16 a[80:95], a[228:231], v[216:219], a[80:95]
  ds_read_b128 a[252:255], v13 offset:31744
  buffer_load_dwordx4 v25, s[64:67], s73 offen offset:3072 sc1 lds
  v_add_f32 v18, v18, v150
  v_add_f32 v19, v19, v151
  s_waitcnt lgkmcnt(4)
  v_mfma_f32_32x32x16_bf16 a[96:111], a[232:235], v[216:219], a[96:111]
  v_cvt_pk_bf16_f32 v203, v150, v151
  v_exp_f32 v154, v154
  v_exp_f32 v155, v155
  v_mfma_f32_32x32x16_bf16 a[112:127], a[236:239], v[216:219], a[112:127]
  ds_read_b128 a[192:195], v10 offset:16384
  s_add_u32 s73, s73, 16384
  v_add_f32 v18, v18, v152
  v_add_f32 v19, v19, v153
  v_cvt_pk_bf16_f32 v204, v152, v153
  s_waitcnt lgkmcnt(3)
  v_mfma_f32_32x32x16_bf16 a[64:79], a[240:243], v[220:223], a[64:79]
  ds_read_b128 a[196:199], v10 offset:17408
  v_exp_f32 v156, v156
  v_exp_f32 v157, v157
  v_mfma_f32_32x32x16_bf16 a[80:95], a[244:247], v[220:223], a[80:95]
  ds_read_b128 a[200:203], v10 offset:18432
  v_add_f32 v18, v18, v154
  v_add_f32 v19, v19, v155
  v_cvt_pk_bf16_f32 v205, v154, v155
  v_exp_f32 v158, v158
  s_waitcnt lgkmcnt(3)
  v_mfma_f32_32x32x16_bf16 a[96:111], a[248:251], v[220:223], a[96:111]
  ds_read_b128 a[204:207], v10 offset:19456
  v_exp_f32 v159, v159
  v_add_f32 v18, v18, v156
  v_add_f32 v19, v19, v157
  v_mfma_f32_32x32x16_bf16 a[112:127], a[252:255], v[220:223], a[112:127]
  ds_read_b128 a[208:211], v10 offset:20480
  v_cvt_pk_bf16_f32 v206, v156, v157
  v_add_f32 v18, v18, v158
  v_add_f32 v19, v19, v159
  v_cvt_pk_bf16_f32 v207, v158, v159
  s_cmp_lg_u32 s42, 2
  s_cbranch_scc1 L_b_ev_28
  v_accvgpr_read_b32 v8, a128
  v_add_f32 v240, v240, v8
  v_accvgpr_read_b32 v9, a129
  v_add_f32 v241, v241, v9
  v_accvgpr_read_b32 v8, a130
  v_add_f32 v242, v242, v8
  v_accvgpr_read_b32 v9, a131
  v_add_f32 v243, v243, v9
  v_accvgpr_read_b32 v8, a132
  v_add_f32 v244, v244, v8
  v_accvgpr_read_b32 v9, a133
  v_add_f32 v245, v245, v9
  v_accvgpr_read_b32 v8, a134
  v_add_f32 v246, v246, v8
  v_accvgpr_read_b32 v9, a135
  v_add_f32 v247, v247, v9
  v_accvgpr_read_b32 v8, a136
  v_add_f32 v248, v248, v8
  v_accvgpr_read_b32 v9, a137
  v_add_f32 v249, v249, v9
  v_accvgpr_read_b32 v8, a138
  v_add_f32 v250, v250, v8
  v_accvgpr_read_b32 v9, a139
  v_add_f32 v251, v251, v9
  v_accvgpr_read_b32 v8, a140
  v_add_f32 v252, v252, v8
  v_accvgpr_read_b32 v9, a141
  v_add_f32 v253, v253, v9
  v_accvgpr_read_b32 v8, a142
  v_add_f32 v254, v254, v8
  v_accvgpr_read_b32 v9, a143
  v_add_f32 v255, v255, v9
L_b_ev_28:
  s_cmp_lg_u32 s42, 1
  s_cbranch_scc1 L_b_ev_29
  v_mov_b32 v240, 0xff800000
  v_mov_b32 v241, 0xff800000
  v_mov_b32 v242, 0xff800000
  v_mov_b32 v243, 0xff800000
  v_mov_b32 v244, 0xff800000
  v_mov_b32 v245, 0xff800000
  v_mov_b32 v246, 0xff800000
  v_mov_b32 v247, 0xff800000
  v_mov_b32 v248, 0xff800000
  v_mov_b32 v249, 0xff800000
  v_mov_b32 v250, 0xff800000
  v_mov_b32 v251, 0xff800000
  v_mov_b32 v252, 0xff800000
  v_mov_b32 v253, 0xff800000
  v_mov_b32 v254, 0xff800000
  v_mov_b32 v255, 0xff800000
L_b_ev_29:
  s_nop 1
  s_waitcnt lgkmcnt(3)
  v_mfma_f32_32x32x16_bf16 v[144:159], a[192:195], v[64:67], v[240:255]
  s_waitcnt vmcnt(13)
  s_barrier
  ds_read_b128 a[212:215], v10 offset:21504
  ds_read_b128 a[216:219], v10 offset:22528
  v_exp_f32 v176, v176
  v_mfma_f32_32x32x16_bf16 v[144:159], a[196:199], v[68:71], v[144:159]
  ds_read_b128 a[220:223], v10 offset:23552
  s_add_u32 m0, s68, 0
  v_exp_f32 v177, v177
  v_exp_f32 v178, v178
  s_waitcnt lgkmcnt(4)
  v_mfma_f32_32x32x16_bf16 v[144:159], a[200:203], v[72:75], v[144:159]
  ds_read_b128 a[224:227], v12
  v_exp_f32 v179, v179
  v_add_f32 v18, v18, v176
  v_add_f32 v19, v19, v177
  v_mfma_f32_32x32x16_bf16 v[144:159], a[204:207], v[76:79], v[144:159]
  ds_read_b128 a[228:231], v12 offset:1024
  buffer_load_dwordx4 v25, s[60:63], s72 offen sc1 lds
  v_cvt_pk_bf16_f32 v216, v176, v177
  s_waitcnt lgkmcnt(4)
  v_mfma_f32_32x32x16_bf16 v[144:159], a[208:211], v[80:83], v[144:159]
  ds_read_b128 a[232:235], v12 offset:2048
  v_exp_f32 v180, v180
  v_exp_f32 v181, v181
  v_add_f32 v18, v18, v178
  v_mfma_f32_32x32x16_bf16 v[144:159], a[212:215], v[84:87], v[144:159]
  ds_read_b128 a[236:239], v12 offset:3072
  buffer_load_dwordx4 v25, s[60:63], s72 offen offset:1024 sc1 lds
  v_add_f32 v19, v19, v179
  v_cvt_pk_bf16_f32 v217, v178, v179
  s_waitcnt lgkmcnt(4)
  v_mfma_f32_32x32x16_bf16 v[144:159], a[216:219], v[88:91], v[144:159]
  ds_read_b128 a[240:243], v12 offset:4096
  v_exp_f32 v182, v182
  v_exp_f32 v183, v183
  v_mfma_f32_32x32x16_bf16 v[144:159], a[220:223], v[92:95], v[144:159]
  ds_read_b128 a[244:247], v12 offset:5120
  buffer_load_dwordx4 v25, s[60:63], s72 offen offset:2048 sc1 lds
  v_add_f32 v18, v18, v180
  v_add_f32 v19, v19, v181
  s_waitcnt lgkmcnt(4)
  v_mfma_f32_32x32x16_bf16 a[64:79], a[224:227], v[200:203], a[64:79]
  ds_read_b128 a[248:251], v12 offset:6144
  v_cvt_pk_bf16_f32 v218, v180, v181
  v_exp_f32 v184, v184
  v_exp_f32 v185, v185
  v_mfma_f32_32x32x16_bf16 a[80:95], a[228:231], v[200:203], a[80:95]
  ds_read_b128 a[252:255], v12 offset:7168
  buffer_load_dwordx4 v25, s[60:63], s72 offen offset:3072 sc1 lds
  v_add_f32 v18, v18, v182
  s_waitcnt lgkmcnt(4)
  v_mfma_f32_32x32x16_bf16 a[96:111], a[232:235], v[200:203], a[96:111]
  v_add_f32 v19, v19, v183
  v_cvt_pk_bf16_f32 v219, v182, v183
  v_exp_f32 v186, v186
  v_exp_f32 v187, v187
  v_mfma_f32_32x32x16_bf16 a[112:127], a[236:239], v[200:203], a[112:127]
  ds_read_b128 a[192:195], v10 offset:24576
  s_add_u32 s72, s72, 16384
  v_add_f32 v18, v18, v184
  v_add_f32 v19, v19, v185
  v_cvt_pk_bf16_f32 v220, v184, v185
  s_waitcnt lgkmcnt(3)
  v_mfma_f32_32x32x16_bf16 a[64:79], a[240:243], v[204:207], a[64:79]
  ds_read_b128 a[196:199], v10 offset:25600
  v_exp_f32 v188, v188
  v_exp_f32 v189, v189
  v_mfma_f32_32x32x16_bf16 a[80:95], a[244:247], v[204:207], a[80:95]
  ds_read_b128 a[200:203], v10 offset:26624
  v_add_f32 v18, v18, v186
  v_add_f32 v19, v19, v187
  v_cvt_pk_bf16_f32 v221, v186, v187
  v_exp_f32 v190, v190
  s_waitcnt lgkmcnt(3)
  v_mfma_f32_32x32x16_bf16 a[96:111], a[248:251], v[204:207], a[96:111]
  ds_read_b128 a[204:207], v10 offset:27648
  v_exp_f32 v191, v191
  v_add_f32 v18, v18, v188
  v_add_f32 v19, v19, v189
  v_mfma_f32_32x32x16_bf16 a[112:127], a[252:255], v[204:207], a[112:127]
  ds_read_b128 a[208:211], v10 offset:28672
  v_cvt_pk_bf16_f32 v222, v188, v189
  v_add_f32 v18, v18, v190
  v_add_f32 v19, v19, v191
  v_cvt_pk_bf16_f32 v223, v190, v191
  s_cmp_lg_u32 s42, 3
  s_cbranch_scc1 L_b_ev_30
  v_accvgpr_read_b32 v8, a128
  v_add_f32 v240, v240, v8
  v_accvgpr_read_b32 v9, a129
  v_add_f32 v241, v241, v9
  v_accvgpr_read_b32 v8, a130
  v_add_f32 v242, v242, v8
  v_accvgpr_read_b32 v9, a131
  v_add_f32 v243, v243, v9
  v_accvgpr_read_b32 v8, a132
  v_add_f32 v244, v244, v8
  v_accvgpr_read_b32 v9, a133
  v_add_f32 v245, v245, v9
  v_accvgpr_read_b32 v8, a134
  v_add_f32 v246, v246, v8
  v_accvgpr_read_b32 v9, a135
  v_add_f32 v247, v247, v9
  v_accvgpr_read_b32 v8, a136
  v_add_f32 v248, v248, v8
  v_accvgpr_read_b32 v9, a137
  v_add_f32 v249, v249, v9
  v_accvgpr_read_b32 v8, a138
  v_add_f32 v250, v250, v8
  v_accvgpr_read_b32 v9, a139
  v_add_f32 v251, v251, v9
  v_accvgpr_read_b32 v8, a140
  v_add_f32 v252, v252, v8
  v_accvgpr_read_b32 v9, a141
  v_add_f32 v253, v253, v9
  v_accvgpr_read_b32 v8, a142
  v_add_f32 v254, v254, v8
  v_accvgpr_read_b32 v9, a143
  v_add_f32 v255, v255, v9
L_b_ev_30:
  s_cmp_lg_u32 s42, 2
  s_cbranch_scc1 L_b_ev_31
  v_mov_b32 v240, 0xff800000
  v_mov_b32 v241, 0xff800000
  v_mov_b32 v242, 0xff800000
  v_mov_b32 v243, 0xff800000
  v_mov_b32 v244, 0xff800000
  v_mov_b32 v245, 0xff800000
  v_mov_b32 v246, 0xff800000
  v_mov_b32 v247, 0xff800000
  v_mov_b32 v248, 0xff800000
  v_mov_b32 v249, 0xff800000
  v_mov_b32 v250, 0xff800000
  v_mov_b32 v251, 0xff800000
  v_mov_b32 v252, 0xff800000
  v_mov_b32 v253, 0xff800000
  v_mov_b32 v254, 0xff800000
  v_mov_b32 v255, 0xff800000
L_b_ev_31:
  s_nop 1
  s_waitcnt lgkmcnt(3)
  v_mfma_f32_32x32x16_bf16 v[176:191], a[192:195], v[64:67], v[240:255]
  ds_read_b128 a[212:215], v10 offset:29696
  ds_read_b128 a[216:219], v10 offset:30720
  v_exp_f32 v144, v144
  v_exp_f32 v145, v145
  v_mfma_f32_32x32x16_bf16 v[176:191], a[196:199], v[68:71], v[176:191]
  ds_read_b128 a[220:223], v10 offset:31744
  s_add_u32 m0, s71, 0x4000
  v_exp_f32 v146, v146
  v_exp_f32 v147, v147
  s_waitcnt lgkmcnt(4)
  v_mfma_f32_32x32x16_bf16 v[176:191], a[200:203], v[72:75], v[176:191]
  ds_read_b128 a[224:227], v12 offset:8192
  buffer_load_dwordx4 v25, s[64:67], s73 offen sc1 lds
  v_xor_b32 v10, 0x8000, v10
  v_mfma_f32_32x32x16_bf16 v[176:191], a[204:207], v[76:79], v[176:191]
  ds_read_b128 a[228:231], v12 offset:9216
  buffer_load_dwordx4 v25, s[64:67], s73 offen offset:1024 sc1 lds
  v_xor_b32 v11, 0x8000, v11
  v_add_f32 v18, v18, v144
  s_waitcnt lgkmcnt(4)
  v_mfma_f32_32x32x16_bf16 v[176:191], a[208:211], v[80:83], v[176:191]
  ds_read_b128 a[232:235], v12 offset:10240
  buffer_load_dwordx4 v25, s[64:67], s73 offen offset:2048 sc1 lds
  v_add_f32 v19, v19, v145
  v_cvt_pk_bf16_f32 v200, v144, v145
  v_mfma_f32_32x32x16_bf16 v[176:191], a[212:215], v[84:87], v[176:191]
  ds_read_b128 a[236:239], v12 offset:11264
  buffer_load_dwordx4 v25, s[64:67], s73 offen offset:3072 sc1 lds
  v_exp_f32 v148, v148
  s_waitcnt lgkmcnt(4)
  v_mfma_f32_32x32x16_bf16 v[176:191], a[216:219], v[88:91], v[176:191]
  ds_read_b128 a[240:243], v12 offset:12288
  s_add_u32 s73, s73, 16384
  v_exp_f32 v149, v149
  v_add_f32 v18, v18, v146
  v_mfma_f32_32x32x16_bf16 v[176:191], a[220:223], v[92:95], v[176:191]
  ds_read_b128 a[244:247], v12 offset:13312
  s_xor_b32 s68, s68, 0x8000
  s_xor_b32 s69, s69, 0x8000
  v_add_f32 v19, v19, v147
  v_cvt_pk_bf16_f32 v201, v146, v147
  s_waitcnt lgkmcnt(4)
  v_mfma_f32_32x32x16_bf16 a[64:79], a[224:227], v[216:219], a[64:79]
  ds_read_b128 a[248:251], v12 offset:14336
  s_xor_b32 s70, s70, 0x8000
  s_xor_b32 s71, s71, 0x8000
  v_exp_f32 v150, v150
  v_exp_f32 v151, v151
  v_mfma_f32_32x32x16_bf16 a[80:95], a[228:231], v[216:219], a[80:95]
  ds_read_b128 a[252:255], v12 offset:15360
  v_add_f32 v18, v18, v148
  v_add_f32 v19, v19, v149
  v_cvt_pk_bf16_f32 v202, v148, v149
  s_waitcnt lgkmcnt(4)
  v_mfma_f32_32x32x16_bf16 a[96:111], a[232:235], v[216:219], a[96:111]
  v_xor_b32 v12, 0x8000, v12
  v_exp_f32 v152, v152
  v_exp_f32 v153, v153
  v_add_f32 v18, v18, v150
  v_mfma_f32_32x32x16_bf16 a[112:127], a[236:239], v[216:219], a[112:127]
  v_xor_b32 v13, 0x8000, v13
  v_add_f32 v19, v19, v151
  v_cvt_pk_bf16_f32 v203, v150, v151
  v_exp_f32 v154, v154
  s_waitcnt lgkmcnt(2)
  v_mfma_f32_32x32x16_bf16 a[64:79], a[240:243], v[220:223], a[64:79]
  v_exp_f32 v155, v155
  v_add_f32 v18, v18, v152
  v_add_f32 v19, v19, v153
  v_cvt_pk_bf16_f32 v204, v152, v153
  v_exp_f32 v156, v156
  v_mfma_f32_32x32x16_bf16 a[80:95], a[244:247], v[220:223], a[80:95]
  v_exp_f32 v157, v157
  v_add_f32 v18, v18, v154
  v_add_f32 v19, v19, v155
  s_waitcnt lgkmcnt(0)
  v_mfma_f32_32x32x16_bf16 a[96:111], a[248:251], v[220:223], a[96:111]
  v_cvt_pk_bf16_f32 v205, v154, v155
  v_exp_f32 v158, v158
  v_exp_f32 v159, v159
  v_add_f32 v18, v18, v156
  v_mfma_f32_32x32x16_bf16 a[112:127], a[252:255], v[220:223], a[112:127]
  v_add_f32 v19, v19, v157
  v_cvt_pk_bf16_f32 v206, v156, v157
  v_add_f32 v18, v18, v158
  v_add_f32 v19, v19, v159
  v_cvt_pk_bf16_f32 v207, v158, v159
  s_branch L_b_tail
L_b_TDM:
  s_cmp_lg_u32 s42, 0
  s_cbranch_scc1 L_b_ev_16
  v_accvgpr_read_b32 v8, a128
  v_add_f32 v240, v240, v8
  v_accvgpr_read_b32 v9, a129
  v_add_f32 v241, v241, v9
  v_accvgpr_read_b32 v8, a130
  v_add_f32 v242, v242, v8
  v_accvgpr_read_b32 v9, a131
  v_add_f32 v243, v243, v9
  v_accvgpr_read_b32 v8, a132
  v_add_f32 v244, v244, v8
  v_accvgpr_read_b32 v9, a133
  v_add_f32 v245, v245, v9
  v_accvgpr_read_b32 v8, a134
  v_add_f32 v246, v246, v8
  v_accvgpr_read_b32 v9, a135
  v_add_f32 v247, v247, v9
  v_accvgpr_read_b32 v8, a136
  v_add_f32 v248, v248, v8
  v_accvgpr_read_b32 v9, a137
  v_add_f32 v249, v249, v9
  v_accvgpr_read_b32 v8, a138
  v_add_f32 v250, v250, v8
  v_accvgpr_read_b32 v9, a139
  v_add_f32 v251, v251, v9
  v_accvgpr_read_b32 v8, a140
  v_add_f32 v252, v252, v8
  v_accvgpr_read_b32 v9, a141
  v_add_f32 v253, v253, v9
  v_accvgpr_read_b32 v8, a142
  v_add_f32 v254, v254, v8
  v_accvgpr_read_b32 v9, a143
  v_add_f32 v255, v255, v9
L_b_ev_16:
  s_nop 1
  s_waitcnt lgkmcnt(3)
  v_mfma_f32_32x32x16_bf16 v[144:159], a[192:195], v[64:67], v[240:255]
  s_waitcnt vmcnt(12)
  s_barrier
  s_lshr_b32 s75, s41, 2
  s_lshl_b32 s75, s75, 7
  s_add_u32 s75, s75, 0x4d02000
  v_and_b32 v24, 7, v27
  v_lshlrev_b32 v24, 2, v24
  v_lshrrev_b32 v22, 3, v27
  v_add_u32 v22, 1, v22
  v_lshlrev_b32 v22, 10, v22
  v_add_u32 v24, v24, v22
  s_lshl_b32 s81, s40, 2
  v_cmp_eq_u32 vcc, 16, v27
  v_mov_b32 v22, s81
  s_nop 0
  v_cndmask_b32 v24, v24, v22, vcc
  buffer_load_dword v22, v24, s[16:19], s75 offen sc1
  ds_read_b128 a[212:215], v10 offset:5120
  ds_read_b128 a[216:219], v10 offset:6144
  ds_read_b128 a[220:223], v10 offset:7168
  ds_read_b128 a[224:227], v13 offset:16384
  v_mfma_f32_32x32x16_bf16 v[144:159], a[196:199], v[68:71], v[144:159]
  s_add_u32 m0, s69, 0x4000
  v_exp_f32 v160, v160
  v_exp_f32 v161, v161
  v_exp_f32 v162, v162
  s_waitcnt lgkmcnt(5)
  v_mfma_f32_32x32x16_bf16 v[144:159], a[200:203], v[72:75], v[144:159]
  ds_read_b128 a[228:231], v13 offset:17408
  v_exp_f32 v163, v163
  v_add_f32 v16, v16, v160
  v_add_f32 v17, v17, v161
  v_mfma_f32_32x32x16_bf16 v[144:159], a[204:207], v[76:79], v[144:159]
  v_cvt_pk_bf16_f32 v208, v160, v161
  v_exp_f32 v164, v164
  v_exp_f32 v165, v165
  v_add_f32 v16, v16, v162
  s_waitcnt lgkmcnt(4)
  v_mfma_f32_32x32x16_bf16 v[144:159], a[208:211], v[80:83], v[144:159]
  ds_read_b128 a[232:235], v13 offset:18432
  buffer_load_dwordx4 v25, s[60:63], s72 offen sc1 lds
  v_add_f32 v17, v17, v163
  v_cvt_pk_bf16_f32 v209, v162, v163
  v_mfma_f32_32x32x16_bf16 v[144:159], a[212:215], v[84:87], v[144:159]
  v_exp_f32 v166, v166
  v_exp_f32 v167, v167
  v_add_f32 v16, v16, v164
  v_add_f32 v17, v17, v165
  s_waitcnt lgkmcnt(3)
  v_mfma_f32_32x32x16_bf16 v[144:159], a[216:219], v[88:91], v[144:159]
  ds_read_b128 a[236:239], v13 offset:19456
  v_cvt_pk_bf16_f32 v210, v164, v165
  v_exp_f32 v168, v168
  v_exp_f32 v169, v169
  v_mfma_f32_32x32x16_bf16 v[144:159], a[220:223], v[92:95], v[144:159]
  v_add_f32 v16, v16, v166
  v_add_f32 v17, v17, v167
  v_cvt_pk_bf16_f32 v211, v166, v167
  v_exp_f32 v170, v170
  v_exp_f32 v171, v171
  s_waitcnt lgkmcnt(2)
  v_mfma_f32_32x32x16_bf16 a[0:15], a[224:227], v[192:195], a[0:15]
  ds_read_b128 a[240:243], v13 offset:20480
  buffer_load_dwordx4 v25, s[60:63], s72 offen offset:1024 sc1 lds
  v_add_f32 v16, v16, v168
  v_mfma_f32_32x32x16_bf16 a[64:79], a[224:227], v[200:203], a[64:79]
  v_add_f32 v17, v17, v169
  v_cvt_pk_bf16_f32 v212, v168, v169
  v_exp_f32 v172, v172
  v_exp_f32 v173, v173
  v_mfma_f32_32x32x16_bf16 a[16:31], a[228:231], v[192:195], a[16:31]
  ds_read_b128 a[244:247], v13 offset:21504
  v_add_f32 v16, v16, v170
  v_add_f32 v17, v17, v171
  v_cvt_pk_bf16_f32 v213, v170, v171
  v_exp_f32 v174, v174
  v_mfma_f32_32x32x16_bf16 a[80:95], a[228:231], v[200:203], a[80:95]
  buffer_load_dwordx4 v25, s[60:63], s72 offen offset:2048 sc1 lds
  v_exp_f32 v175, v175
  v_add_f32 v16, v16, v172
  s_waitcnt lgkmcnt(2)
  v_mfma_f32_32x32x16_bf16 a[32:47], a[232:235], v[192:195], a[32:47]
  ds_read_b128 a[248:251], v13 offset:22528
  v_add_f32 v17, v17, v173
  v_cvt_pk_bf16_f32 v214, v172, v173
  v_add_f32 v16, v16, v174
  v_add_f32 v17, v17, v175
  v_cvt_pk_bf16_f32 v215, v174, v175
  v_mfma_f32_32x32x16_bf16 a[96:111], a[232:235], v[200:203], a[96:111]
  v_exp_f32 v176, v176
  v_exp_f32 v177, v177
  v_exp_f32 v178, v178
  v_mfma_f32_32x32x16_bf16 a[48:63], a[236:239], v[192:195], a[48:63]
  ds_read_b128 a[252:255], v13 offset:23552
  v_exp_f32 v179, v179
  v_add_f32 v18, v18, v176
  v_add_f32 v19, v19, v177
  v_cvt_pk_bf16_f32 v216, v176, v177
  v_mfma_f32_32x32x16_bf16 a[112:127], a[236:239], v[200:203], a[112:127]
  buffer_load_dwordx4 v25, s[60:63], s72 offen offset:3072 sc1 lds
  v_exp_f32 v180, v180
  v_exp_f32 v181, v181
  s_waitcnt lgkmcnt(2)
  v_mfma_f32_32x32x16_bf16 a[0:15], a[240:243], v[196:199], a[0:15]
  v_add_f32 v18, v18, v178
  v_add_f32 v19, v19, v179
  v_cvt_pk_bf16_f32 v217, v178, v179
  v_exp_f32 v182, v182
  v_mfma_f32_32x32x16_bf16 a[64:79], a[240:243], v[204:207], a[64:79]
  v_exp_f32 v183, v183
  v_add_f32 v18, v18, v180
  v_add_f32 v19, v19, v181
  v_cvt_pk_bf16_f32 v218, v180, v181
  v_exp_f32 v184, v184
  v_mfma_f32_32x32x16_bf16 a[16:31], a[244:247], v[196:199], a[16:31]
  ds_read_b128 a[192:195], v10 offset:8192
  s_add_u32 s72, s72, 16384
  v_exp_f32 v185, v185
  v_add_f32 v18, v18, v182
  v_mfma_f32_32x32x16_bf16 a[80:95], a[244:247], v[204:207], a[80:95]
  ds_read_b128 a[196:199], v10 offset:9216
  v_add_f32 v19, v19, v183
  v_cvt_pk_bf16_f32 v219, v182, v183
  v_exp_f32 v186, v186
  v_exp_f32 v187, v187
  s_waitcnt lgkmcnt(2)
  v_mfma_f32_32x32x16_bf16 a[32:47], a[248:251], v[196:199], a[32:47]
  ds_read_b128 a[200:203], v10 offset:10240
  v_add_f32 v18, v18, v184
  v_add_f32 v19, v19, v185
  v_cvt_pk_bf16_f32 v220, v184, v185
  v_exp_f32 v188, v188
  v_mfma_f32_32x32x16_bf16 a[96:111], a[248:251], v[204:207], a[96:111]
  ds_read_b128 a[204:207], v10 offset:11264
  v_exp_f32 v189, v189
  v_add_f32 v18, v18, v186
  v_add_f32 v19, v19, v187
  v_mfma_f32_32x32x16_bf16 a[48:63], a[252:255], v[196:199], a[48:63]
  ds_read_b128 a[208:211], v10 offset:12288
  v_cvt_pk_bf16_f32 v221, v186, v187
  v_exp_f32 v190, v190
  v_exp_f32 v191, v191
  v_mfma_f32_32x32x16_bf16 a[112:127], a[252:255], v[204:207], a[112:127]
  v_add_f32 v18, v18, v188
  v_add_f32 v19, v19, v189
  v_cvt_pk_bf16_f32 v222, v188, v189
  v_add_f32 v18, v18, v190
  v_add_f32 v19, v19, v191
  v_cvt_pk_bf16_f32 v223, v190, v191
  s_cmp_lg_u32 s42, 1
  s_cbranch_scc1 L_b_ev_18
  v_accvgpr_read_b32 v8, a128
  v_add_f32 v240, v240, v8
  v_accvgpr_read_b32 v9, a129
  v_add_f32 v241, v241, v9
  v_accvgpr_read_b32 v8, a130
  v_add_f32 v242, v242, v8
  v_accvgpr_read_b32 v9, a131
  v_add_f32 v243, v243, v9
  v_accvgpr_read_b32 v8, a132
  v_add_f32 v244, v244, v8
  v_accvgpr_read_b32 v9, a133
  v_add_f32 v245, v245, v9
  v_accvgpr_read_b32 v8, a134
  v_add_f32 v246, v246, v8
  v_accvgpr_read_b32 v9, a135
  v_add_f32 v247, v247, v9
  v_accvgpr_read_b32 v8, a136
  v_add_f32 v248, v248, v8
  v_accvgpr_read_b32 v9, a137
  v_add_f32 v249, v249, v9
  v_accvgpr_read_b32 v8, a138
  v_add_f32 v250, v250, v8
  v_accvgpr_read_b32 v9, a139
  v_add_f32 v251, v251, v9
  v_accvgpr_read_b32 v8, a140
  v_add_f32 v252, v252, v8
  v_accvgpr_read_b32 v9, a141
  v_add_f32 v253, v253, v9
  v_accvgpr_read_b32 v8, a142
  v_add_f32 v254, v254, v8
  v_accvgpr_read_b32 v9, a143
  v_add_f32 v255, v255, v9
L_b_ev_18:
  s_cmp_lg_u32 s42, 0
  s_cbranch_scc1 L_b_ev_19
  v_mov_b32 v240, 0xff800000
  v_mov_b32 v241, 0xff800000
  v_mov_b32 v242, 0xff800000
  v_mov_b32 v243, 0xff800000
  v_mov_b32 v244, 0xff800000
  v_mov_b32 v245, 0xff800000
  v_mov_b32 v246, 0xff800000
  v_mov_b32 v247, 0xff800000
  v_mov_b32 v248, 0xff800000
  v_mov_b32 v249, 0xff800000
  v_mov_b32 v250, 0xff800000
  v_mov_b32 v251, 0xff800000
  v_mov_b32 v252, 0xff800000
  v_mov_b32 v253, 0xff800000
  v_mov_b32 v254, 0xff800000
  v_mov_b32 v255, 0xff800000
L_b_ev_19:
  s_nop 1
  s_waitcnt lgkmcnt(3)
  v_mfma_f32_32x32x16_bf16 v[176:191], a[192:195], v[64:67], v[240:255]
  ds_read_b128 a[212:215], v10 offset:13312
  ds_read_b128 a[216:219], v10 offset:14336
  ds_read_b128 a[220:223], v10 offset:15360
  ds_read_b128 a[224:227], v13 offset:24576
  v_mfma_f32_32x32x16_bf16 v[176:191], a[196:199], v[68:71], v[176:191]
  s_add_u32 m0, s71, 0
  v_exp_f32 v144, v144
  v_exp_f32 v145, v145
  s_waitcnt lgkmcnt(5)
  v_mfma_f32_32x32x16_bf16 v[176:191], a[200:203], v[72:75], v[176:191]
  ds_read_b128 a[228:231], v13 offset:25600
  v_exp_f32 v146, v146
  v_mfma_f32_32x32x16_bf16 v[176:191], a[204:207], v[76:79], v[176:191]
  v_exp_f32 v147, v147
  v_add_f32 v18, v18, v144
  s_waitcnt lgkmcnt(4)
  v_mfma_f32_32x32x16_bf16 v[176:191], a[208:211], v[80:83], v[176:191]
  ds_read_b128 a[232:235], v13 offset:26624
  buffer_load_dwordx4 v25, s[64:67], s73 offen sc1 lds
  v_add_f32 v19, v19, v145
  v_mfma_f32_32x32x16_bf16 v[176:191], a[212:215], v[84:87], v[176:191]
  v_cvt_pk_bf16_f32 v200, v144, v145
  v_exp_f32 v148, v148
  s_waitcnt lgkmcnt(3)
  v_mfma_f32_32x32x16_bf16 v[176:191], a[216:219], v[88:91], v[176:191]
  ds_read_b128 a[236:239], v13 offset:27648
  v_exp_f32 v149, v149
  v_mfma_f32_32x32x16_bf16 v[176:191], a[220:223], v[92:95], v[176:191]
  v_add_f32 v18, v18, v146
  v_add_f32 v19, v19, v147
  v_cvt_pk_bf16_f32 v201, v146, v147
  s_waitcnt lgkmcnt(2)
  v_mfma_f32_32x32x16_bf16 a[0:15], a[224:227], v[208:211], a[0:15]
  ds_read_b128 a[240:243], v13 offset:28672
  buffer_load_dwordx4 v25, s[64:67], s73 offen offset:1024 sc1 lds
  v_exp_f32 v150, v150
  v_mfma_f32_32x32x16_bf16 a[64:79], a[224:227], v[216:219], a[64:79]
  v_exp_f32 v151, v151
  v_mfma_f32_32x32x16_bf16 a[16:31], a[228:231], v[208:211], a[16:31]
  ds_read_b128 a[244:247], v13 offset:29696
  v_add_f32 v18, v18, v148
  v_add_f32 v19, v19, v149
  v_cvt_pk_bf16_f32 v202, v148, v149
  v_mfma_f32_32x32x16_bf16 a[80:95], a[228:231], v[216:219], a[80:95]
  buffer_load_dwordx4 v25, s[64:67], s73 offen offset:2048 sc1 lds
  v_exp_f32 v152, v152
  s_waitcnt lgkmcnt(2)
  v_mfma_f32_32x32x16_bf16 a[32:47], a[232:235], v[208:211], a[32:47]
  ds_read_b128 a[248:251], v13 offset:30720
  v_exp_f32 v153, v153
  v_mfma_f32_32x32x16_bf16 a[96:111], a[232:235], v[216:219], a[96:111]
  v_add_f32 v18, v18, v150
  v_add_f32 v19, v19, v151
  v_mfma_f32_32x32x16_bf16 a[48:63], a[236:239], v[208:211], a[48:63]
  ds_read_b128 a[252:255], v13 offset:31744
  v_cvt_pk_bf16_f32 v203, v150, v151
  v_exp_f32 v154, v154
  v_mfma_f32_32x32x16_bf16 a[112:127], a[236:239], v[216:219], a[112:127]
  buffer_load_dwordx4 v25, s[64:67], s73 offen offset:3072 sc1 lds
  v_exp_f32 v155, v155
  s_waitcnt lgkmcnt(2)
  v_mfma_f32_32x32x16_bf16 a[0:15], a[240:243], v[212:215], a[0:15]
  v_add_f32 v18, v18, v152
  v_add_f32 v19, v19, v153
  v_mfma_f32_32x32x16_bf16 a[64:79], a[240:243], v[220:223], a[64:79]
  v_cvt_pk_bf16_f32 v204, v152, v153
  v_exp_f32 v156, v156
  v_mfma_f32_32x32x16_bf16 a[16:31], a[244:247], v[212:215], a[16:31]
  ds_read_b128 a[192:195], v10 offset:16384
  s_add_u32 s73, s73, 16384
  v_exp_f32 v157, v157
  v_mfma_f32_32x32x16_bf16 a[80:95], a[244:247], v[220:223], a[80:95]
  ds_read_b128 a[196:199], v10 offset:17408
  v_add_f32 v18, v18, v154
  v_add_f32 v19, v19, v155
  v_cvt_pk_bf16_f32 v205, v154, v155
  s_waitcnt lgkmcnt(2)
  v_mfma_f32_32x32x16_bf16 a[32:47], a[248:251], v[212:215], a[32:47]
  ds_read_b128 a[200:203], v10 offset:18432
  v_exp_f32 v158, v158
  v_mfma_f32_32x32x16_bf16 a[96:111], a[248:251], v[220:223], a[96:111]
  ds_read_b128 a[204:207], v10 offset:19456
  v_exp_f32 v159, v159
  v_add_f32 v18, v18, v156
  v_mfma_f32_32x32x16_bf16 a[48:63], a[252:255], v[212:215], a[48:63]
  ds_read_b128 a[208:211], v10 offset:20480
  v_add_f32 v19, v19, v157
  v_cvt_pk_bf16_f32 v206, v156, v157
  v_mfma_f32_32x32x16_bf16 a[112:127], a[252:255], v[220:223], a[112:127]
  v_add_f32 v18, v18, v158
  v_add_f32 v19, v19, v159
  v_cvt_pk_bf16_f32 v207, v158, v159
  s_cmp_lg_u32 s42, 2
  s_cbranch_scc1 L_b_ev_20
  v_accvgpr_read_b32 v8, a128
  v_add_f32 v240, v240, v8
  v_accvgpr_read_b32 v9, a129
  v_add_f32 v241, v241, v9
  v_accvgpr_read_b32 v8, a130
  v_add_f32 v242, v242, v8
  v_accvgpr_read_b32 v9, a131
  v_add_f32 v243, v243, v9
  v_accvgpr_read_b32 v8, a132
  v_add_f32 v244, v244, v8
  v_accvgpr_read_b32 v9, a133
  v_add_f32 v245, v245, v9
  v_accvgpr_read_b32 v8, a134
  v_add_f32 v246, v246, v8
  v_accvgpr_read_b32 v9, a135
  v_add_f32 v247, v247, v9
  v_accvgpr_read_b32 v8, a136
  v_add_f32 v248, v248, v8
  v_accvgpr_read_b32 v9, a137
  v_add_f32 v249, v249, v9
  v_accvgpr_read_b32 v8, a138
  v_add_f32 v250, v250, v8
  v_accvgpr_read_b32 v9, a139
  v_add_f32 v251, v251, v9
  v_accvgpr_read_b32 v8, a140
  v_add_f32 v252, v252, v8
  v_accvgpr_read_b32 v9, a141
  v_add_f32 v253, v253, v9
  v_accvgpr_read_b32 v8, a142
  v_add_f32 v254, v254, v8
  v_accvgpr_read_b32 v9, a143
  v_add_f32 v255, v255, v9
L_b_ev_20:
  s_cmp_lg_u32 s42, 1
  s_cbranch_scc1 L_b_ev_21
  v_mov_b32 v240, 0xff800000
  v_mov_b32 v241, 0xff800000
  v_mov_b32 v242, 0xff800000
  v_mov_b32 v243, 0xff800000
  v_mov_b32 v244, 0xff800000
  v_mov_b32 v245, 0xff800000
  v_mov_b32 v246, 0xff800000
  v_mov_b32 v247, 0xff800000
  v_mov_b32 v248, 0xff800000
  v_mov_b32 v249, 0xff800000
  v_mov_b32 v250, 0xff800000
  v_mov_b32 v251, 0xff800000
  v_mov_b32 v252, 0xff800000
  v_mov_b32 v253, 0xff800000
  v_mov_b32 v254, 0xff800000
  v_mov_b32 v255, 0xff800000
L_b_ev_21:
  s_nop 1
  s_waitcnt lgkmcnt(3)
  v_mfma_f32_32x32x16_bf16 v[144:159], a[192:195], v[64:67], v[240:255]
  s_waitcnt vmcnt(13)
  s_barrier
  s_cmp_lg_u32 s42, 0
  s_cbranch_scc1 L_sigA_L_b_TDM
  s_lshl_b32 s80, s41, 7
  s_lshl_b32 s81, s40, 2
  s_add_u32 s80, s80, s81
  s_add_u32 s80, s80, 0x4d02000
  v_mov_b32 v2, 0
  v_mov_b32 v3, s59
  s_mov_b64 exec, 1
  s_nop 1
  buffer_store_dword v3, v2, s[16:19], s80 offen sc1
  s_mov_b64 exec, -1
  s_nop 3
L_sigA_L_b_TDM:
  ds_read_b128 a[212:215], v10 offset:21504
  ds_read_b128 a[216:219], v10 offset:22528
  v_mfma_f32_32x32x16_bf16 v[144:159], a[196:199], v[68:71], v[144:159]
  ds_read_b128 a[220:223], v10 offset:23552
  s_add_u32 m0, s68, 0
  v_exp_f32 v176, v176
  v_exp_f32 v177, v177
  s_waitcnt lgkmcnt(4)
  v_mfma_f32_32x32x16_bf16 v[144:159], a[200:203], v[72:75], v[144:159]
  ds_read_b128 a[224:227], v12
  v_exp_f32 v178, v178
  v_exp_f32 v179, v179
  v_mfma_f32_32x32x16_bf16 v[144:159], a[204:207], v[76:79], v[144:159]
  ds_read_b128 a[228:231], v12 offset:1024
  buffer_load_dwordx4 v25, s[60:63], s72 offen sc1 lds
  v_add_f32 v18, v18, v176
  v_add_f32 v19, v19, v177
  s_waitcnt lgkmcnt(4)
  v_mfma_f32_32x32x16_bf16 v[144:159], a[208:211], v[80:83], v[144:159]
  ds_read_b128 a[232:235], v12 offset:2048
  v_cvt_pk_bf16_f32 v216, v176, v177
  v_exp_f32 v180, v180
  v_exp_f32 v181, v181
  v_mfma_f32_32x32x16_bf16 v[144:159], a[212:215], v[84:87], v[144:159]
  ds_read_b128 a[236:239], v12 offset:3072
  buffer_load_dwordx4 v25, s[60:63], s72 offen offset:1024 sc1 lds
  v_add_f32 v18, v18, v178
  s_waitcnt lgkmcnt(4)
  v_mfma_f32_32x32x16_bf16 v[144:159], a[216:219], v[88:91], v[144:159]
  ds_read_b128 a[240:243], v12 offset:4096
  v_add_f32 v19, v19, v179
  v_cvt_pk_bf16_f32 v217, v178, v179
  v_exp_f32 v182, v182
  v_mfma_f32_32x32x16_bf16 v[144:159], a[220:223], v[92:95], v[144:159]
  ds_read_b128 a[244:247], v12 offset:5120
  buffer_load_dwordx4 v25, s[60:63], s72 offen offset:2048 sc1 lds
  v_exp_f32 v183, v183
  v_add_f32 v18, v18, v180
  s_waitcnt lgkmcnt(4)
  v_mfma_f32_32x32x16_bf16 a[64:79], a[224:227], v[200:203], a[64:79]
  ds_read_b128 a[248:251], v12 offset:6144
  v_add_f32 v19, v19, v181
  v_cvt_pk_bf16_f32 v218, v180, v181
  v_exp_f32 v184, v184
  v_mfma_f32_32x32x16_bf16 a[80:95], a[228:231], v[200:203], a[80:95]
  ds_read_b128 a[252:255], v12 offset:7168
  buffer_load_dwordx4 v25, s[60:63], s72 offen offset:3072 sc1 lds
  v_exp_f32 v185, v185
  s_waitcnt lgkmcnt(4)
  v_mfma_f32_32x32x16_bf16 a[96:111], a[232:235], v[200:203], a[96:111]
  v_add_f32 v18, v18, v182
  v_add_f32 v19, v19, v183
  v_cvt_pk_bf16_f32 v219, v182, v183
  v_exp_f32 v186, v186
  v_mfma_f32_32x32x16_bf16 a[112:127], a[236:239], v[200:203], a[112:127]
  ds_read_b128 a[192:195], v10 offset:24576
  s_add_u32 s72, s72, 16384
  v_exp_f32 v187, v187
  v_add_f32 v18, v18, v184
  v_add_f32 v19, v19, v185
  s_waitcnt lgkmcnt(3)
  v_mfma_f32_32x32x16_bf16 a[64:79], a[240:243], v[204:207], a[64:79]
  ds_read_b128 a[196:199], v10 offset:25600
  v_cvt_pk_bf16_f32 v220, v184, v185
  v_exp_f32 v188, v188
  v_exp_f32 v189, v189
  v_mfma_f32_32x32x16_bf16 a[80:95], a[244:247], v[204:207], a[80:95]
  ds_read_b128 a[200:203], v10 offset:26624
  v_add_f32 v18, v18, v186
  v_add_f32 v19, v19, v187
  v_cvt_pk_bf16_f32 v221, v186, v187
  s_waitcnt lgkmcnt(3)
  v_mfma_f32_32x32x16_bf16 a[96:111], a[248:251], v[204:207], a[96:111]
  ds_read_b128 a[204:207], v10 offset:27648
  v_exp_f32 v190, v190
  v_exp_f32 v191, v191
  v_add_f32 v18, v18, v188
  v_mfma_f32_32x32x16_bf16 a[112:127], a[252:255], v[204:207], a[112:127]
  ds_read_b128 a[208:211], v10 offset:28672
  v_add_f32 v19, v19, v189
  v_cvt_pk_bf16_f32 v222, v188, v189
  v_add_f32 v18, v18, v190
  v_add_f32 v19, v19, v191
  v_cvt_pk_bf16_f32 v223, v190, v191
  s_cmp_lg_u32 s42, 3
  s_cbranch_scc1 L_b_ev_22
  v_accvgpr_read_b32 v8, a128
  v_add_f32 v240, v240, v8
  v_accvgpr_read_b32 v9, a129
  v_add_f32 v241, v241, v9
  v_accvgpr_read_b32 v8, a130
  v_add_f32 v242, v242, v8
  v_accvgpr_read_b32 v9, a131
  v_add_f32 v243, v243, v9
  v_accvgpr_read_b32 v8, a132
  v_add_f32 v244, v244, v8
  v_accvgpr_read_b32 v9, a133
  v_add_f32 v245, v245, v9
  v_accvgpr_read_b32 v8, a134
  v_add_f32 v246, v246, v8
  v_accvgpr_read_b32 v9, a135
  v_add_f32 v247, v247, v9
  v_accvgpr_read_b32 v8, a136
  v_add_f32 v248, v248, v8
  v_accvgpr_read_b32 v9, a137
  v_add_f32 v249, v249, v9
  v_accvgpr_read_b32 v8, a138
  v_add_f32 v250, v250, v8
  v_accvgpr_read_b32 v9, a139
  v_add_f32 v251, v251, v9
  v_accvgpr_read_b32 v8, a140
  v_add_f32 v252, v252, v8
  v_accvgpr_read_b32 v9, a141
  v_add_f32 v253, v253, v9
  v_accvgpr_read_b32 v8, a142
  v_add_f32 v254, v254, v8
  v_accvgpr_read_b32 v9, a143
  v_add_f32 v255, v255, v9
L_b_ev_22:
  s_cmp_lg_u32 s42, 2
  s_cbranch_scc1 L_b_ev_23
  v_mov_b32 v240, 0xff800000
  v_mov_b32 v241, 0xff800000
  v_mov_b32 v242, 0xff800000
  v_mov_b32 v243, 0xff800000
  v_mov_b32 v244, 0xff800000
  v_mov_b32 v245, 0xff800000
  v_mov_b32 v246, 0xff800000
  v_mov_b32 v247, 0xff800000
  v_mov_b32 v248, 0xff800000
  v_mov_b32 v249, 0xff800000
  v_mov_b32 v250, 0xff800000
  v_mov_b32 v251, 0xff800000
  v_mov_b32 v252, 0xff800000
  v_mov_b32 v253, 0xff800000
  v_mov_b32 v254, 0xff800000
  v_mov_b32 v255, 0xff800000
L_b_ev_23:
  s_nop 1
  s_waitcnt lgkmcnt(3)
  v_mfma_f32_32x32x16_bf16 v[176:191], a[192:195], v[64:67], v[240:255]
  ds_read_b128 a[212:215], v10 offset:29696
  ds_read_b128 a[216:219], v10 offset:30720
  v_exp_f32 v144, v144
  v_exp_f32 v145, v145
  v_mfma_f32_32x32x16_bf16 v[176:191], a[196:199], v[68:71], v[176:191]
  ds_read_b128 a[220:223], v10 offset:31744
  s_add_u32 m0, s71, 0x4000
  v_exp_f32 v146, v146
  v_exp_f32 v147, v147
  s_waitcnt lgkmcnt(4)
  v_mfma_f32_32x32x16_bf16 v[176:191], a[200:203], v[72:75], v[176:191]
  ds_read_b128 a[224:227], v12 offset:8192
  buffer_load_dwordx4 v25, s[64:67], s73 offen sc1 lds
  v_xor_b32 v10, 0x8000, v10
  v_mfma_f32_32x32x16_bf16 v[176:191], a[204:207], v[76:79], v[176:191]
  ds_read_b128 a[228:231], v12 offset:9216
  buffer_load_dwordx4 v25, s[64:67], s73 offen offset:1024 sc1 lds
  v_xor_b32 v11, 0x8000, v11
  v_add_f32 v18, v18, v144
  s_waitcnt lgkmcnt(4)
  v_mfma_f32_32x32x16_bf16 v[176:191], a[208:211], v[80:83], v[176:191]
  ds_read_b128 a[232:235], v12 offset:10240
  buffer_load_dwordx4 v25, s[64:67], s73 offen offset:2048 sc1 lds
  v_add_f32 v19, v19, v145
  v_cvt_pk_bf16_f32 v200, v144, v145
  v_mfma_f32_32x32x16_bf16 v[176:191], a[212:215], v[84:87], v[176:191]
  ds_read_b128 a[236:239], v12 offset:11264
  buffer_load_dwordx4 v25, s[64:67], s73 offen offset:3072 sc1 lds
  v_exp_f32 v148, v148
  s_waitcnt lgkmcnt(4)
  v_mfma_f32_32x32x16_bf16 v[176:191], a[216:219], v[88:91], v[176:191]
  ds_read_b128 a[240:243], v12 offset:12288
  s_add_u32 s73, s73, 16384
  v_exp_f32 v149, v149
  v_add_f32 v18, v18, v146
  v_mfma_f32_32x32x16_bf16 v[176:191], a[220:223], v[92:95], v[176:191]
  ds_read_b128 a[244:247], v12 offset:13312
  s_xor_b32 s68, s68, 0x8000
  s_xor_b32 s69, s69, 0x8000
  v_add_f32 v19, v19, v147
  v_cvt_pk_bf16_f32 v201, v146, v147
  s_waitcnt lgkmcnt(4)
  v_mfma_f32_32x32x16_bf16 a[64:79], a[224:227], v[216:219], a[64:79]
  ds_read_b128 a[248:251], v12 offset:14336
  s_xor_b32 s70, s70, 0x8000
  s_xor_b32 s71, s71, 0x8000
  v_exp_f32 v150, v150
  v_exp_f32 v151, v151
  v_mfma_f32_32x32x16_bf16 a[80:95], a[228:231], v[216:219], a[80:95]
  ds_read_b128 a[252:255], v12 offset:15360
  v_add_f32 v18, v18, v148
  v_add_f32 v19, v19, v149
  v_cvt_pk_bf16_f32 v202, v148, v149
  s_waitcnt lgkmcnt(4)
  v_mfma_f32_32x32x16_bf16 a[96:111], a[232:235], v[216:219], a[96:111]
  v_xor_b32 v12, 0x8000, v12
  v_exp_f32 v152, v152
  v_exp_f32 v153, v153
  v_add_f32 v18, v18, v150
  v_mfma_f32_32x32x16_bf16 a[112:127], a[236:239], v[216:219], a[112:127]
  v_xor_b32 v13, 0x8000, v13
  v_add_f32 v19, v19, v151
  v_cvt_pk_bf16_f32 v203, v150, v151
  v_exp_f32 v154, v154
  s_waitcnt lgkmcnt(2)
  v_mfma_f32_32x32x16_bf16 a[64:79], a[240:243], v[220:223], a[64:79]
  v_exp_f32 v155, v155
  v_add_f32 v18, v18, v152
  v_add_f32 v19, v19, v153
  v_cvt_pk_bf16_f32 v204, v152, v153
  v_exp_f32 v156, v156
  v_mfma_f32_32x32x16_bf16 a[80:95], a[244:247], v[220:223], a[80:95]
  v_exp_f32 v157, v157
  v_add_f32 v18, v18, v154
  v_add_f32 v19, v19, v155
  s_waitcnt lgkmcnt(0)
  v_mfma_f32_32x32x16_bf16 a[96:111], a[248:251], v[220:223], a[96:111]
  v_cvt_pk_bf16_f32 v205, v154, v155
  v_exp_f32 v158, v158
  v_exp_f32 v159, v159
  v_add_f32 v18, v18, v156
  v_mfma_f32_32x32x16_bf16 a[112:127], a[252:255], v[220:223], a[112:127]
  v_add_f32 v19, v19, v157
  v_cvt_pk_bf16_f32 v206, v156, v157
  v_add_f32 v18, v18, v158
  v_add_f32 v19, v19, v159
  v_cvt_pk_bf16_f32 v207, v158, v159
  s_lshl_b32 s78, s40, 2
  s_add_u32 s78, s78, s42
  s_lshl_b32 s78, s78, 18
  s_lshl_b32 s79, s41, 13
  s_add_u32 s78, s78, s79
  s_add_u32 s83, s78, 0x3000000
  s_add_u32 s76, s83, 4096
  v_mov_b32 v6, 0
  v_add_f32 v16, v16, v17
  v_mov_b32 v2, v16
  s_nop 1
  v_permlane32_swap_b32 v2, v16
  v_add_f32 v2, v2, v16
  v_mov_b32 v4, 0x71800000
  v_cmp_nle_f32 vcc, v2, v4
  v_rcp_f32 v3, v2
  v_mov_b32 v5, 0x7fc00000
  v_cndmask_b32 v20, v20, v5, vcc
  v_mov_b32 v8, v3
  v_mov_b32 v9, v3
  v_accvgpr_read_b32 v128, a0
  v_accvgpr_read_b32 v129, a1
  v_accvgpr_read_b32 v130, a2
  v_accvgpr_read_b32 v131, a3
  v_accvgpr_read_b32 v132, a4
  v_accvgpr_read_b32 v133, a5
  v_accvgpr_read_b32 v134, a6
  v_accvgpr_read_b32 v135, a7
  v_accvgpr_read_b32 v136, a8
  v_accvgpr_read_b32 v137, a9
  v_accvgpr_read_b32 v138, a10
  v_accvgpr_read_b32 v139, a11
  v_accvgpr_read_b32 v140, a12
  v_accvgpr_read_b32 v141, a13
  v_accvgpr_read_b32 v142, a14
  v_accvgpr_read_b32 v143, a15
  v_pk_mul_f32 v[128:129], v[128:129], v[8:9]
  v_pk_mul_f32 v[130:131], v[130:131], v[8:9]
  v_pk_mul_f32 v[132:133], v[132:133], v[8:9]
  v_pk_mul_f32 v[134:135], v[134:135], v[8:9]
  v_pk_mul_f32 v[136:137], v[136:137], v[8:9]
  v_pk_mul_f32 v[138:139], v[138:139], v[8:9]
  v_pk_mul_f32 v[140:141], v[140:141], v[8:9]
  v_pk_mul_f32 v[142:143], v[142:143], v[8:9]
  v_cvt_pk_bf16_f32 v192, v128, v129
  v_cvt_pk_bf16_f32 v193, v130, v131
  v_cvt_pk_bf16_f32 v194, v132, v133
  v_cvt_pk_bf16_f32 v195, v134, v135
  v_cvt_pk_bf16_f32 v196, v136, v137
  v_cvt_pk_bf16_f32 v197, v138, v139
  v_cvt_pk_bf16_f32 v198, v140, v141
  v_cvt_pk_bf16_f32 v199, v142, v143
  v_dot2_f32_bf16 v20, v192, v6, v20
  v_dot2_f32_bf16 v20, v193, v6, v20
  v_dot2_f32_bf16 v20, v194, v6, v20
  v_dot2_f32_bf16 v20, v195, v6, v20
  v_dot2_f32_bf16 v20, v196, v6, v20
  v_dot2_f32_bf16 v20, v197, v6, v20
  v_dot2_f32_bf16 v20, v198, v6, v20
  v_dot2_f32_bf16 v20, v199, v6, v20
  buffer_store_dwordx4 v[192:195], v21, s[16:19], s83 offen sc1
  buffer_store_dwordx4 v[196:199], v21, s[16:19], s83 offen offset:1024 sc1
  v_accvgpr_read_b32 v128, a16
  v_accvgpr_read_b32 v129, a17
  v_accvgpr_read_b32 v130, a18
  v_accvgpr_read_b32 v131, a19
  v_accvgpr_read_b32 v132, a20
  v_accvgpr_read_b32 v133, a21
  v_accvgpr_read_b32 v134, a22
  v_accvgpr_read_b32 v135, a23
  v_accvgpr_read_b32 v136, a24
  v_accvgpr_read_b32 v137, a25
  v_accvgpr_read_b32 v138, a26
  v_accvgpr_read_b32 v139, a27
  v_accvgpr_read_b32 v140, a28
  v_accvgpr_read_b32 v141, a29
  v_accvgpr_read_b32 v142, a30
  v_accvgpr_read_b32 v143, a31
  v_pk_mul_f32 v[128:129], v[128:129], v[8:9]
  v_pk_mul_f32 v[130:131], v[130:131], v[8:9]
  v_pk_mul_f32 v[132:133], v[132:133], v[8:9]
  v_pk_mul_f32 v[134:135], v[134:135], v[8:9]
  v_pk_mul_f32 v[136:137], v[136:137], v[8:9]
  v_pk_mul_f32 v[138:139], v[138:139], v[8:9]
  v_pk_mul_f32 v[140:141], v[140:141], v[8:9]
  v_pk_mul_f32 v[142:143], v[142:143], v[8:9]
  v_cvt_pk_bf16_f32 v192, v128, v129
  v_cvt_pk_bf16_f32 v193, v130, v131
  v_cvt_pk_bf16_f32 v194, v132, v133
  v_cvt_pk_bf16_f32 v195, v134, v135
  v_cvt_pk_bf16_f32 v196, v136, v137
  v_cvt_pk_bf16_f32 v197, v138, v139
  v_cvt_pk_bf16_f32 v198, v140, v141
  v_cvt_pk_bf16_f32 v199, v142, v143
  v_dot2_f32_bf16 v20, v192, v6, v20
  v_dot2_f32_bf16 v20, v193, v6, v20
  v_dot2_f32_bf16 v20, v194, v6, v20
  v_dot2_f32_bf16 v20, v195, v6, v20
  v_dot2_f32_bf16 v20, v196, v6, v20
  v_dot2_f32_bf16 v20, v197, v6, v20
  v_dot2_f32_bf16 v20, v198, v6, v20
  v_dot2_f32_bf16 v20, v199, v6, v20
  buffer_store_dwordx4 v[192:195], v21, s[16:19], s83 offen offset:2048 sc1
  buffer_store_dwordx4 v[196:199], v21, s[16:19], s83 offen offset:3072 sc1
  v_accvgpr_read_b32 v128, a32
  v_accvgpr_read_b32 v129, a33
  v_accvgpr_read_b32 v130, a34
  v_accvgpr_read_b32 v131, a35
  v_accvgpr_read_b32 v132, a36
  v_accvgpr_read_b32 v133, a37
  v_accvgpr_read_b32 v134, a38
  v_accvgpr_read_b32 v135, a39
  v_accvgpr_read_b32 v136, a40
  v_accvgpr_read_b32 v137, a41
  v_accvgpr_read_b32 v138, a42
  v_accvgpr_read_b32 v139, a43
  v_accvgpr_read_b32 v140, a44
  v_accvgpr_read_b32 v141, a45
  v_accvgpr_read_b32 v142, a46
  v_accvgpr_read_b32 v143, a47
  v_pk_mul_f32 v[128:129], v[128:129], v[8:9]
  v_pk_mul_f32 v[130:131], v[130:131], v[8:9]
  v_pk_mul_f32 v[132:133], v[132:133], v[8:9]
  v_pk_mul_f32 v[134:135], v[134:135], v[8:9]
  v_pk_mul_f32 v[136:137], v[136:137], v[8:9]
  v_pk_mul_f32 v[138:139], v[138:139], v[8:9]
  v_pk_mul_f32 v[140:141], v[140:141], v[8:9]
  v_pk_mul_f32 v[142:143], v[142:143], v[8:9]
  v_cvt_pk_bf16_f32 v192, v128, v129
  v_cvt_pk_bf16_f32 v193, v130, v131
  v_cvt_pk_bf16_f32 v194, v132, v133
  v_cvt_pk_bf16_f32 v195, v134, v135
  v_cvt_pk_bf16_f32 v196, v136, v137
  v_cvt_pk_bf16_f32 v197, v138, v139
  v_cvt_pk_bf16_f32 v198, v140, v141
  v_cvt_pk_bf16_f32 v199, v142, v143
  v_dot2_f32_bf16 v20, v192, v6, v20
  v_dot2_f32_bf16 v20, v193, v6, v20
  v_dot2_f32_bf16 v20, v194, v6, v20
  v_dot2_f32_bf16 v20, v195, v6, v20
  v_dot2_f32_bf16 v20, v196, v6, v20
  v_dot2_f32_bf16 v20, v197, v6, v20
  v_dot2_f32_bf16 v20, v198, v6, v20
  v_dot2_f32_bf16 v20, v199, v6, v20
  buffer_store_dwordx4 v[192:195], v21, s[16:19], s76 offen sc1
  buffer_store_dwordx4 v[196:199], v21, s[16:19], s76 offen offset:1024 sc1
  v_accvgpr_read_b32 v128, a48
  v_accvgpr_read_b32 v129, a49
  v_accvgpr_read_b32 v130, a50
  v_accvgpr_read_b32 v131, a51
  v_accvgpr_read_b32 v132, a52
  v_accvgpr_read_b32 v133, a53
  v_accvgpr_read_b32 v134, a54
  v_accvgpr_read_b32 v135, a55
  v_accvgpr_read_b32 v136, a56
  v_accvgpr_read_b32 v137, a57
  v_accvgpr_read_b32 v138, a58
  v_accvgpr_read_b32 v139, a59
  v_accvgpr_read_b32 v140, a60
  v_accvgpr_read_b32 v141, a61
  v_accvgpr_read_b32 v142, a62
  v_accvgpr_read_b32 v143, a63
  v_pk_mul_f32 v[128:129], v[128:129], v[8:9]
  v_pk_mul_f32 v[130:131], v[130:131], v[8:9]
  v_pk_mul_f32 v[132:133], v[132:133], v[8:9]
  v_pk_mul_f32 v[134:135], v[134:135], v[8:9]
  v_pk_mul_f32 v[136:137], v[136:137], v[8:9]
  v_pk_mul_f32 v[138:139], v[138:139], v[8:9]
  v_pk_mul_f32 v[140:141], v[140:141], v[8:9]
  v_pk_mul_f32 v[142:143], v[142:143], v[8:9]
  v_cvt_pk_bf16_f32 v192, v128, v129
  v_cvt_pk_bf16_f32 v193, v130, v131
  v_cvt_pk_bf16_f32 v194, v132, v133
  v_cvt_pk_bf16_f32 v195, v134, v135
  v_cvt_pk_bf16_f32 v196, v136, v137
  v_cvt_pk_bf16_f32 v197, v138, v139
  v_cvt_pk_bf16_f32 v198, v140, v141
  v_cvt_pk_bf16_f32 v199, v142, v143
  v_dot2_f32_bf16 v20, v192, v6, v20
  v_dot2_f32_bf16 v20, v193, v6, v20
  v_dot2_f32_bf16 v20, v194, v6, v20
  v_dot2_f32_bf16 v20, v195, v6, v20
  v_dot2_f32_bf16 v20, v196, v6, v20
  v_dot2_f32_bf16 v20, v197, v6, v20
  v_dot2_f32_bf16 v20, v198, v6, v20
  v_dot2_f32_bf16 v20, v199, v6, v20
  buffer_store_dwordx4 v[192:195], v21, s[16:19], s76 offen offset:2048 sc1
  buffer_store_dwordx4 v[196:199], v21, s[16:19], s76 offen offset:3072 sc1
L_b_tail:
  s_waitcnt vmcnt(0)
  s_barrier
  s_waitcnt vmcnt(16)
  v_cmp_eq_u32 vcc, s59, v22
  s_nop 3
  s_and_b32 s77, vcc_lo, 0x1ffff
  s_cmp_eq_u32 s77, 0x1ffff
  s_cbranch_scc0 L_p_spin_A
L_p_spinr_A:
  s_lshl_b32 s76, s41, 16
  s_add_u32 s76, s76, 0x4200000
  s_add_u32 s60, s38, s76
  s_addc_u32 s61, s39, 0
  s_and_b32 s61, s61, 0xffff
  s_mov_b32 s62, 0x10000
  s_mov_b32 s63, 0x20000
  s_lshl_b32 s68, s42, 12
  s_lshl_b32 s77, s40, 3
  s_lshl_b32 s78, s42, 1
  s_add_u32 s77, s77, s78
  s_lshl_b32 s76, s41, 6
  s_add_u32 s76, s76, s77
  s_lshl_b32 s76, s76, 10
  s_add_u32 s69, s76, 0x4000000
  s_lshl_b32 s76, s41, 16
  s_add_u32 s76, s76, 0x4400000
  s_add_u32 s64, s38, s76
  s_addc_u32 s65, s39, 0
  s_and_b32 s65, s65, 0xffff
  s_mov_b32 s66, 0x10000
  s_mov_b32 s67, 0x20000
  ds_read_b128 a[224:227], v13 offset:16384
  ds_read_b128 a[228:231], v13 offset:17408
  ds_read_b128 a[232:235], v13 offset:18432
  ds_read_b128 a[236:239], v13 offset:19456
  ds_read_b128 a[240:243], v13 offset:20480
  ds_read_b128 a[244:247], v13 offset:21504
  s_waitcnt lgkmcnt(4)
  v_mfma_f32_32x32x16_bf16 a[64:79], a[224:227], v[200:203], a[64:79]
  ds_read_b128 a[248:251], v13 offset:22528
  v_exp_f32 v176, v176
  v_exp_f32 v177, v177
  v_exp_f32 v178, v178
  v_exp_f32 v179, v179
  v_add_f32 v18, v18, v176
  v_add_f32 v19, v19, v177
  v_cvt_pk_bf16_f32 v216, v176, v177
  v_exp_f32 v180, v180
  v_exp_f32 v181, v181
  v_add_f32 v18, v18, v178
  v_mfma_f32_32x32x16_bf16 a[80:95], a[228:231], v[200:203], a[80:95]
  s_add_u32 m0, s68, 0
  ds_read_b128 a[252:255], v13 offset:23552
  buffer_load_dwordx4 v21, s[60:63], s68 offen sc1 lds
  buffer_load_dwordx4 v21, s[60:63], s68 offen offset:1024 sc1 lds
  buffer_load_dwordx4 v21, s[60:63], s68 offen offset:2048 sc1 lds
  s_waitcnt lgkmcnt(4)
  v_mfma_f32_32x32x16_bf16 a[96:111], a[232:235], v[200:203], a[96:111]
  buffer_load_dwordx4 v21, s[60:63], s68 offen offset:3072 sc1 lds
  s_add_u32 s68, s68, 16384
  buffer_load_dwordx4 a[144:147], v21, s[16:19], s69 offen sc1
  v_mfma_f32_32x32x16_bf16 a[112:127], a[236:239], v[200:203], a[112:127]
  buffer_load_dwordx4 a[148:151], v21, s[16:19], s69 offen offset:1024 sc1
  s_sub_u32 s68, s68, 16384
  s_add_u32 m0, s68, 0x10000
  s_nop 0
  buffer_load_dwordx4 v21, s[64:67], s68 offen sc1 lds
  s_waitcnt lgkmcnt(2)
  v_mfma_f32_32x32x16_bf16 a[64:79], a[240:243], v[204:207], a[64:79]
  buffer_load_dwordx4 v21, s[64:67], s68 offen offset:1024 sc1 lds
  buffer_load_dwordx4 v21, s[64:67], s68 offen offset:2048 sc1 lds
  buffer_load_dwordx4 v21, s[64:67], s68 offen offset:3072 sc1 lds
  v_mfma_f32_32x32x16_bf16 a[80:95], a[244:247], v[204:207], a[80:95]
  s_add_u32 s68, s68, 16384
  s_add_u32 m0, s68, 0
  s_nop 0
  buffer_load_dwordx4 v21, s[60:63], s68 offen sc1 lds
  v_add_f32 v19, v19, v179
  v_cvt_pk_bf16_f32 v217, v178, v179
  s_waitcnt lgkmcnt(0)
  v_mfma_f32_32x32x16_bf16 a[96:111], a[248:251], v[204:207], a[96:111]
  v_exp_f32 v182, v182
  v_exp_f32 v183, v183
  v_add_f32 v18, v18, v180
  v_add_f32 v19, v19, v181
  v_cvt_pk_bf16_f32 v218, v180, v181
  v_exp_f32 v184, v184
  v_exp_f32 v185, v185
  v_add_f32 v18, v18, v182
  v_add_f32 v19, v19, v183
  v_cvt_pk_bf16_f32 v219, v182, v183
  v_exp_f32 v186, v186
  v_exp_f32 v187, v187
  v_add_f32 v18, v18, v184
  v_mfma_f32_32x32x16_bf16 a[112:127], a[252:255], v[204:207], a[112:127]
  v_add_f32 v19, v19, v185
  v_cvt_pk_bf16_f32 v220, v184, v185
  v_exp_f32 v188, v188
  v_exp_f32 v189, v189
  v_add_f32 v18, v18, v186
  v_add_f32 v19, v19, v187
  v_cvt_pk_bf16_f32 v221, v186, v187
  v_exp_f32 v190, v190
  v_exp_f32 v191, v191
  v_add_f32 v18, v18, v188
  v_add_f32 v19, v19, v189
  v_cvt_pk_bf16_f32 v222, v188, v189
  v_add_f32 v18, v18, v190
  v_add_f32 v19, v19, v191
  v_cvt_pk_bf16_f32 v223, v190, v191
  ds_read_b128 a[224:227], v13 offset:24576
  ds_read_b128 a[228:231], v13 offset:25600
  ds_read_b128 a[232:235], v13 offset:26624
  ds_read_b128 a[236:239], v13 offset:27648
  ds_read_b128 a[240:243], v13 offset:28672
  ds_read_b128 a[244:247], v13 offset:29696
  s_waitcnt lgkmcnt(4)
  v_mfma_f32_32x32x16_bf16 a[64:79], a[224:227], v[216:219], a[64:79]
  ds_read_b128 a[248:251], v13 offset:30720
  v_mfma_f32_32x32x16_bf16 a[80:95], a[228:231], v[216:219], a[80:95]
  ds_read_b128 a[252:255], v13 offset:31744
  buffer_load_dwordx4 v21, s[60:63], s68 offen offset:1024 sc1 lds
  buffer_load_dwordx4 v21, s[60:63], s68 offen offset:2048 sc1 lds
  buffer_load_dwordx4 v21, s[60:63], s68 offen offset:3072 sc1 lds
  s_add_u32 s68, s68, 16384
  s_add_u32 m0, s68, 0
  s_waitcnt lgkmcnt(4)
  v_mfma_f32_32x32x16_bf16 a[96:111], a[232:235], v[216:219], a[96:111]
  buffer_load_dwordx4 v21, s[60:63], s68 offen sc1 lds
  buffer_load_dwordx4 v21, s[60:63], s68 offen offset:1024 sc1 lds
  v_mfma_f32_32x32x16_bf16 a[112:127], a[236:239], v[216:219], a[112:127]
  buffer_load_dwordx4 v21, s[60:63], s68 offen offset:2048 sc1 lds
  buffer_load_dwordx4 v21, s[60:63], s68 offen offset:3072 sc1 lds
  s_add_u32 s68, s68, 16384
  s_add_u32 m0, s68, 0
  s_waitcnt lgkmcnt(2)
  v_mfma_f32_32x32x16_bf16 a[64:79], a[240:243], v[220:223], a[64:79]
  buffer_load_dwordx4 v21, s[60:63], s68 offen sc1 lds
  buffer_load_dwordx4 v21, s[60:63], s68 offen offset:1024 sc1 lds
  v_mfma_f32_32x32x16_bf16 a[80:95], a[244:247], v[220:223], a[80:95]
  buffer_load_dwordx4 v21, s[60:63], s68 offen offset:2048 sc1 lds
  buffer_load_dwordx4 v21, s[60:63], s68 offen offset:3072 sc1 lds
  s_add_u32 s68, s68, 16384
  s_waitcnt lgkmcnt(0)
  v_mfma_f32_32x32x16_bf16 a[96:111], a[248:251], v[220:223], a[96:111]
  v_mfma_f32_32x32x16_bf16 a[112:127], a[252:255], v[220:223], a[112:127]
  s_sub_u32 s78, 15, s40
  s_lshl_b32 s78, s78, 2
  s_add_u32 s78, s78, s42
  s_lshl_b32 s78, s78, 18
  s_lshl_b32 s79, s41, 13
  s_add_u32 s78, s78, s79
  s_add_u32 s84, s78, 0x3000000
  s_add_u32 s77, s84, 4096
  v_mov_b32 v6, 0
  v_add_f32 v18, v18, v19
  v_mov_b32 v2, v18
  s_nop 1
  v_permlane32_swap_b32 v2, v18
  v_add_f32 v2, v2, v18
  v_mov_b32 v4, 0x71800000
  v_cmp_nle_f32 vcc, v2, v4
  v_rcp_f32 v3, v2
  v_mov_b32 v5, 0x7fc00000
  v_cndmask_b32 v20, v20, v5, vcc
  v_mov_b32 v8, v3
  v_mov_b32 v9, v3
  v_accvgpr_read_b32 v144, a64
  v_accvgpr_read_b32 v145, a65
  v_accvgpr_read_b32 v146, a66
  v_accvgpr_read_b32 v147, a67
  v_accvgpr_read_b32 v148, a68
  v_accvgpr_read_b32 v149, a69
  v_accvgpr_read_b32 v150, a70
  v_accvgpr_read_b32 v151, a71
  v_accvgpr_read_b32 v152, a72
  v_accvgpr_read_b32 v153, a73
  v_accvgpr_read_b32 v154, a74
  v_accvgpr_read_b32 v155, a75
  v_accvgpr_read_b32 v156, a76
  v_accvgpr_read_b32 v157, a77
  v_accvgpr_read_b32 v158, a78
  v_accvgpr_read_b32 v159, a79
  v_pk_mul_f32 v[144:145], v[144:145], v[8:9]
  v_pk_mul_f32 v[146:147], v[146:147], v[8:9]
  v_pk_mul_f32 v[148:149], v[148:149], v[8:9]
  v_pk_mul_f32 v[150:151], v[150:151], v[8:9]
  v_pk_mul_f32 v[152:153], v[152:153], v[8:9]
  v_pk_mul_f32 v[154:155], v[154:155], v[8:9]
  v_pk_mul_f32 v[156:157], v[156:157], v[8:9]
  v_pk_mul_f32 v[158:159], v[158:159], v[8:9]
  v_cvt_pk_bf16_f32 v200, v144, v145
  v_cvt_pk_bf16_f32 v201, v146, v147
  v_cvt_pk_bf16_f32 v202, v148, v149
  v_cvt_pk_bf16_f32 v203, v150, v151
  v_cvt_pk_bf16_f32 v204, v152, v153
  v_cvt_pk_bf16_f32 v205, v154, v155
  v_cvt_pk_bf16_f32 v206, v156, v157
  v_cvt_pk_bf16_f32 v207, v158, v159
  v_dot2_f32_bf16 v20, v200, v6, v20
  v_dot2_f32_bf16 v20, v201, v6, v20
  v_dot2_f32_bf16 v20, v202, v6, v20
  v_dot2_f32_bf16 v20, v203, v6, v20
  v_dot2_f32_bf16 v20, v204, v6, v20
  v_dot2_f32_bf16 v20, v205, v6, v20
  v_dot2_f32_bf16 v20, v206, v6, v20
  v_dot2_f32_bf16 v20, v207, v6, v20
  buffer_store_dwordx4 v[200:203], v21, s[16:19], s84 offen sc1
  buffer_store_dwordx4 v[204:207], v21, s[16:19], s84 offen offset:1024 sc1
  v_accvgpr_read_b32 v144, a80
  v_accvgpr_read_b32 v145, a81
  v_accvgpr_read_b32 v146, a82
  v_accvgpr_read_b32 v147, a83
  v_accvgpr_read_b32 v148, a84
  v_accvgpr_read_b32 v149, a85
  v_accvgpr_read_b32 v150, a86
  v_accvgpr_read_b32 v151, a87
  v_accvgpr_read_b32 v152, a88
  v_accvgpr_read_b32 v153, a89
  v_accvgpr_read_b32 v154, a90
  v_accvgpr_read_b32 v155, a91
  v_accvgpr_read_b32 v156, a92
  v_accvgpr_read_b32 v157, a93
  v_accvgpr_read_b32 v158, a94
  v_accvgpr_read_b32 v159, a95
  v_pk_mul_f32 v[144:145], v[144:145], v[8:9]
  v_pk_mul_f32 v[146:147], v[146:147], v[8:9]
  v_pk_mul_f32 v[148:149], v[148:149], v[8:9]
  v_pk_mul_f32 v[150:151], v[150:151], v[8:9]
  v_pk_mul_f32 v[152:153], v[152:153], v[8:9]
  v_pk_mul_f32 v[154:155], v[154:155], v[8:9]
  v_pk_mul_f32 v[156:157], v[156:157], v[8:9]
  v_pk_mul_f32 v[158:159], v[158:159], v[8:9]
  v_cvt_pk_bf16_f32 v200, v144, v145
  v_cvt_pk_bf16_f32 v201, v146, v147
  v_cvt_pk_bf16_f32 v202, v148, v149
  v_cvt_pk_bf16_f32 v203, v150, v151
  v_cvt_pk_bf16_f32 v204, v152, v153
  v_cvt_pk_bf16_f32 v205, v154, v155
  v_cvt_pk_bf16_f32 v206, v156, v157
  v_cvt_pk_bf16_f32 v207, v158, v159
  v_dot2_f32_bf16 v20, v200, v6, v20
  v_dot2_f32_bf16 v20, v201, v6, v20
  v_dot2_f32_bf16 v20, v202, v6, v20
  v_dot2_f32_bf16 v20, v203, v6, v20
  v_dot2_f32_bf16 v20, v204, v6, v20
  v_dot2_f32_bf16 v20, v205, v6, v20
  v_dot2_f32_bf16 v20, v206, v6, v20
  v_dot2_f32_bf16 v20, v207, v6, v20
  buffer_store_dwordx4 v[200:203], v21, s[16:19], s84 offen offset:2048 sc1
  buffer_store_dwordx4 v[204:207], v21, s[16:19], s84 offen offset:3072 sc1
  v_accvgpr_read_b32 v144, a96
  v_accvgpr_read_b32 v145, a97
  v_accvgpr_read_b32 v146, a98
  v_accvgpr_read_b32 v147, a99
  v_accvgpr_read_b32 v148, a100
  v_accvgpr_read_b32 v149, a101
  v_accvgpr_read_b32 v150, a102
  v_accvgpr_read_b32 v151, a103
  v_accvgpr_read_b32 v152, a104
  v_accvgpr_read_b32 v153, a105
  v_accvgpr_read_b32 v154, a106
  v_accvgpr_read_b32 v155, a107
  v_accvgpr_read_b32 v156, a108
  v_accvgpr_read_b32 v157, a109
  v_accvgpr_read_b32 v158, a110
  v_accvgpr_read_b32 v159, a111
  v_pk_mul_f32 v[144:145], v[144:145], v[8:9]
  v_pk_mul_f32 v[146:147], v[146:147], v[8:9]
  v_pk_mul_f32 v[148:149], v[148:149], v[8:9]
  v_pk_mul_f32 v[150:151], v[150:151], v[8:9]
  v_pk_mul_f32 v[152:153], v[152:153], v[8:9]
  v_pk_mul_f32 v[154:155], v[154:155], v[8:9]
  v_pk_mul_f32 v[156:157], v[156:157], v[8:9]
  v_pk_mul_f32 v[158:159], v[158:159], v[8:9]
  v_cvt_pk_bf16_f32 v200, v144, v145
  v_cvt_pk_bf16_f32 v201, v146, v147
  v_cvt_pk_bf16_f32 v202, v148, v149
  v_cvt_pk_bf16_f32 v203, v150, v151
  v_cvt_pk_bf16_f32 v204, v152, v153
  v_cvt_pk_bf16_f32 v205, v154, v155
  v_cvt_pk_bf16_f32 v206, v156, v157
  v_cvt_pk_bf16_f32 v207, v158, v159
  v_dot2_f32_bf16 v20, v200, v6, v20
  v_dot2_f32_bf16 v20, v201, v6, v20
  v_dot2_f32_bf16 v20, v202, v6, v20
  v_dot2_f32_bf16 v20, v203, v6, v20
  v_dot2_f32_bf16 v20, v204, v6, v20
  v_dot2_f32_bf16 v20, v205, v6, v20
  v_dot2_f32_bf16 v20, v206, v6, v20
  v_dot2_f32_bf16 v20, v207, v6, v20
  buffer_store_dwordx4 v[200:203], v21, s[16:19], s77 offen sc1
  buffer_store_dwordx4 v[204:207], v21, s[16:19], s77 offen offset:1024 sc1
  v_accvgpr_read_b32 v144, a112
  v_accvgpr_read_b32 v145, a113
  v_accvgpr_read_b32 v146, a114
  v_accvgpr_read_b32 v147, a115
  v_accvgpr_read_b32 v148, a116
  v_accvgpr_read_b32 v149, a117
  v_accvgpr_read_b32 v150, a118
  v_accvgpr_read_b32 v151, a119
  v_accvgpr_read_b32 v152, a120
  v_accvgpr_read_b32 v153, a121
  v_accvgpr_read_b32 v154, a122
  v_accvgpr_read_b32 v155, a123
  v_accvgpr_read_b32 v156, a124
  v_accvgpr_read_b32 v157, a125
  v_accvgpr_read_b32 v158, a126
  v_accvgpr_read_b32 v159, a127
  v_pk_mul_f32 v[144:145], v[144:145], v[8:9]
  v_pk_mul_f32 v[146:147], v[146:147], v[8:9]
  v_pk_mul_f32 v[148:149], v[148:149], v[8:9]
  v_pk_mul_f32 v[150:151], v[150:151], v[8:9]
  v_pk_mul_f32 v[152:153], v[152:153], v[8:9]
  v_pk_mul_f32 v[154:155], v[154:155], v[8:9]
  v_pk_mul_f32 v[156:157], v[156:157], v[8:9]
  v_pk_mul_f32 v[158:159], v[158:159], v[8:9]
  v_cvt_pk_bf16_f32 v200, v144, v145
  v_cvt_pk_bf16_f32 v201, v146, v147
  v_cvt_pk_bf16_f32 v202, v148, v149
  v_cvt_pk_bf16_f32 v203, v150, v151
  v_cvt_pk_bf16_f32 v204, v152, v153
  v_cvt_pk_bf16_f32 v205, v154, v155
  v_cvt_pk_bf16_f32 v206, v156, v157
  v_cvt_pk_bf16_f32 v207, v158, v159
  v_dot2_f32_bf16 v20, v200, v6, v20
  v_dot2_f32_bf16 v20, v201, v6, v20
  v_dot2_f32_bf16 v20, v202, v6, v20
  v_dot2_f32_bf16 v20, v203, v6, v20
  v_dot2_f32_bf16 v20, v204, v6, v20
  v_dot2_f32_bf16 v20, v205, v6, v20
  v_dot2_f32_bf16 v20, v206, v6, v20
  v_dot2_f32_bf16 v20, v207, v6, v20
  buffer_store_dwordx4 v[200:203], v21, s[16:19], s77 offen offset:2048 sc1
  buffer_store_dwordx4 v[204:207], v21, s[16:19], s77 offen offset:3072 sc1
  v_cmp_u_f32 vcc, v20, v20
  v_mov_b32 v3, 0x21000
  v_mov_b32 v2, 1
  s_nop 2
  s_cbranch_vccz L_b_f_32
  ds_write_b32 v3, v2
L_b_f_32:
  s_waitcnt lgkmcnt(0)
  s_barrier
  ds_read_b32 v4, v3
  s_waitcnt lgkmcnt(0)
  v_readfirstlane_b32 s76, v4
  s_nop 3
  s_cmp_eq_u32 s76, 0
  s_cbranch_scc1 L_b_fin
  s_cmp_lg_u32 s82, 0
  s_cbranch_scc1 L_b_fin
L_b_safe:
  s_waitcnt vmcnt(0)
  s_waitcnt lgkmcnt(0)
  s_barrier
  s_mul_i32 s76, s41, 0x80000
  s_add_u32 s76, s76, 0x1000000
  s_add_u32 s60, s38, s76
  s_addc_u32 s61, s39, 0
  s_and_b32 s61, s61, 0xffff
  s_lshl_b32 s62, s85, 13
  s_mov_b32 s63, 0x20000
  s_mul_i32 s76, s41, 0x80000
  s_add_u32 s76, s76, 0x2000000
  s_add_u32 s64, s38, s76
  s_addc_u32 s65, s39, 0
  s_and_b32 s65, s65, 0xffff
  s_lshl_b32 s66, s85, 13
  s_mov_b32 s67, 0x20000
  v_mov_b32 v14, 0xff800000
  v_mov_b32 v15, 0xff800000
  s_mov_b32 s72, 0
  s_mov_b32 s74, 0
  s_lshl_b32 s68, s42, 11
  s_lshl_b32 s80, s42, 11
  v_add_u32 v7, s80, v21
  s_lshl_b32 s78, s40, 2
  s_add_u32 s78, s78, s42
  s_sub_u32 s79, 15, s40
  s_lshl_b32 s79, s79, 2
  s_add_u32 s79, s79, s42
  v_mov_b32 v10, v21
L_b_safe_loop:
  s_mov_b32 m0, s68
  s_nop 0
  buffer_load_dwordx4 v7, s[60:63], s72 offen sc1 lds
  buffer_load_dwordx4 v7, s[60:63], s72 offen offset:1024 sc1 lds
  s_add_u32 s72, s72, 8192
  s_waitcnt vmcnt(0)
  s_barrier
  ds_read_b128 a[192:195], v10
  ds_read_b128 a[196:199], v10 offset:1024
  ds_read_b128 a[200:203], v10 offset:2048
  ds_read_b128 a[204:207], v10 offset:3072
  ds_read_b128 a[208:211], v10 offset:4096
  ds_read_b128 a[212:215], v10 offset:5120
  ds_read_b128 a[216:219], v10 offset:6144
  ds_read_b128 a[220:223], v10 offset:7168
  s_cmp_gt_u32 s74, s78
  s_cbranch_scc1 L_b_s_33
  s_waitcnt lgkmcnt(7)
  v_mfma_f32_32x32x16_bf16 v[128:143], a[192:195], v[32:35], 0
  s_waitcnt lgkmcnt(6)
  v_mfma_f32_32x32x16_bf16 v[128:143], a[196:199], v[36:39], v[128:143]
  s_waitcnt lgkmcnt(5)
  v_mfma_f32_32x32x16_bf16 v[128:143], a[200:203], v[40:43], v[128:143]
  s_waitcnt lgkmcnt(4)
  v_mfma_f32_32x32x16_bf16 v[128:143], a[204:207], v[44:47], v[128:143]
  s_waitcnt lgkmcnt(3)
  v_mfma_f32_32x32x16_bf16 v[128:143], a[208:211], v[48:51], v[128:143]
  s_waitcnt lgkmcnt(2)
  v_mfma_f32_32x32x16_bf16 v[128:143], a[212:215], v[52:55], v[128:143]
  s_waitcnt lgkmcnt(1)
  v_mfma_f32_32x32x16_bf16 v[128:143], a[216:219], v[56:59], v[128:143]
  s_waitcnt lgkmcnt(0)
  v_mfma_f32_32x32x16_bf16 v[128:143], a[220:223], v[60:63], v[128:143]
  s_nop 7
  s_nop 3
  s_cmp_lg_u32 s74, s78
  s_cbranch_scc1 L_b_s_35
  v_accvgpr_read_b32 v8, a128
  v_add_f32 v128, v128, v8
  v_accvgpr_read_b32 v9, a129
  v_add_f32 v129, v129, v9
  v_accvgpr_read_b32 v8, a130
  v_add_f32 v130, v130, v8
  v_accvgpr_read_b32 v9, a131
  v_add_f32 v131, v131, v9
  v_accvgpr_read_b32 v8, a132
  v_add_f32 v132, v132, v8
  v_accvgpr_read_b32 v9, a133
  v_add_f32 v133, v133, v9
  v_accvgpr_read_b32 v8, a134
  v_add_f32 v134, v134, v8
  v_accvgpr_read_b32 v9, a135
  v_add_f32 v135, v135, v9
  v_accvgpr_read_b32 v8, a136
  v_add_f32 v136, v136, v8
  v_accvgpr_read_b32 v9, a137
  v_add_f32 v137, v137, v9
  v_accvgpr_read_b32 v8, a138
  v_add_f32 v138, v138, v8
  v_accvgpr_read_b32 v9, a139
  v_add_f32 v139, v139, v9
  v_accvgpr_read_b32 v8, a140
  v_add_f32 v140, v140, v8
  v_accvgpr_read_b32 v9, a141
  v_add_f32 v141, v141, v9
  v_accvgpr_read_b32 v8, a142
  v_add_f32 v142, v142, v8
  v_accvgpr_read_b32 v9, a143
  v_add_f32 v143, v143, v9
L_b_s_35:
  v_max3_f32 v14, v14, v128, v129
  v_max3_f32 v14, v14, v130, v131
  v_max3_f32 v14, v14, v132, v133
  v_max3_f32 v14, v14, v134, v135
  v_max3_f32 v14, v14, v136, v137
  v_max3_f32 v14, v14, v138, v139
  v_max3_f32 v14, v14, v140, v141
  v_max3_f32 v14, v14, v142, v143
L_b_s_33:
  s_cmp_gt_u32 s74, s79
  s_cbranch_scc1 L_b_s_36
  v_mfma_f32_32x32x16_bf16 v[144:159], a[192:195], v[64:67], 0
  v_mfma_f32_32x32x16_bf16 v[144:159], a[196:199], v[68:71], v[144:159]
  v_mfma_f32_32x32x16_bf16 v[144:159], a[200:203], v[72:75], v[144:159]
  v_mfma_f32_32x32x16_bf16 v[144:159], a[204:207], v[76:79], v[144:159]
  v_mfma_f32_32x32x16_bf16 v[144:159], a[208:211], v[80:83], v[144:159]
  v_mfma_f32_32x32x16_bf16 v[144:159], a[212:215], v[84:87], v[144:159]
  v_mfma_f32_32x32x16_bf16 v[144:159], a[216:219], v[88:91], v[144:159]
  v_mfma_f32_32x32x16_bf16 v[144:159], a[220:223], v[92:95], v[144:159]
  s_nop 7
  s_nop 3
  s_cmp_lg_u32 s74, s79
  s_cbranch_scc1 L_b_s_38
  v_accvgpr_read_b32 v8, a128
  v_add_f32 v144, v144, v8
  v_accvgpr_read_b32 v9, a129
  v_add_f32 v145, v145, v9
  v_accvgpr_read_b32 v8, a130
  v_add_f32 v146, v146, v8
  v_accvgpr_read_b32 v9, a131
  v_add_f32 v147, v147, v9
  v_accvgpr_read_b32 v8, a132
  v_add_f32 v148, v148, v8
  v_accvgpr_read_b32 v9, a133
  v_add_f32 v149, v149, v9
  v_accvgpr_read_b32 v8, a134
  v_add_f32 v150, v150, v8
  v_accvgpr_read_b32 v9, a135
  v_add_f32 v151, v151, v9
  v_accvgpr_read_b32 v8, a136
  v_add_f32 v152, v152, v8
  v_accvgpr_read_b32 v9, a137
  v_add_f32 v153, v153, v9
  v_accvgpr_read_b32 v8, a138
  v_add_f32 v154, v154, v8
  v_accvgpr_read_b32 v9, a139
  v_add_f32 v155, v155, v9
  v_accvgpr_read_b32 v8, a140
  v_add_f32 v156, v156, v8
  v_accvgpr_read_b32 v9, a141
  v_add_f32 v157, v157, v9
  v_accvgpr_read_b32 v8, a142
  v_add_f32 v158, v158, v8
  v_accvgpr_read_b32 v9, a143
  v_add_f32 v159, v159, v9
L_b_s_38:
  v_max3_f32 v15, v15, v144, v145
  v_max3_f32 v15, v15, v146, v147
  v_max3_f32 v15, v15, v148, v149
  v_max3_f32 v15, v15, v150, v151
  v_max3_f32 v15, v15, v152, v153
  v_max3_f32 v15, v15, v154, v155
  v_max3_f32 v15, v15, v156, v157
  v_max3_f32 v15, v15, v158, v159
L_b_s_36:
  s_waitcnt lgkmcnt(0)
  s_barrier
  s_add_u32 s74, s74, 1
  s_cmp_lt_u32 s74, s85
  s_cbranch_scc1 L_b_safe_loop
  v_mov_b32 v2, v14
  s_nop 1
  v_permlane32_swap_b32 v2, v14
  v_max_f32 v14, v14, v2
  v_mov_b32 v3, v15
  s_nop 1
  v_permlane32_swap_b32 v3, v15
  v_max_f32 v15, v15, v3
  s_mov_b32 s82, 1
  s_branch L_b_start
L_b_fin:
  s_branch L_p_start
L_p_start:
  s_load_dwordx2 s[46:47], s[0:1], 72
  v_mov_b32 v1, v27
  v_lshlrev_b32 v2, 4, v1
  s_lshl_b32 s68, s42, 12
  s_add_u32 s68, s68, 16384
  s_add_u32 m0, s68, 0x10000
  s_nop 0
  buffer_load_dwordx4 v2, s[64:67], s68 offen sc1 lds
  buffer_load_dwordx4 v2, s[64:67], s68 offen offset:1024 sc1 lds
  buffer_load_dwordx4 v2, s[64:67], s68 offen offset:2048 sc1 lds
  buffer_load_dwordx4 v2, s[64:67], s68 offen offset:3072 sc1 lds
  s_add_u32 s68, s68, 16384
  s_lshl_b32 s77, s40, 3
  s_lshl_b32 s78, s42, 1
  s_add_u32 s77, s77, s78
  s_lshl_b32 s77, s77, 15
  s_lshl_b32 s78, s41, 10
  s_add_u32 s77, s77, s78
  s_add_u32 s70, s77, 0x4600000
  s_waitcnt vmcnt(29)
  v_accvgpr_read_b32 v20, a144
  v_accvgpr_read_b32 v21, a145
  v_accvgpr_read_b32 v22, a146
  v_accvgpr_read_b32 v23, a147
  s_waitcnt vmcnt(28)
  v_accvgpr_read_b32 v24, a148
  v_accvgpr_read_b32 v25, a149
  v_accvgpr_read_b32 v26, a150
  v_accvgpr_read_b32 v27, a151
  v_add_u32 v54, 0x40000, v2
  s_and_b32 s71, s2, 7
  s_lshl_b32 s71, s71, 2
  s_lshr_b32 s76, s2, 3
  s_and_b32 s76, s76, 3
  s_add_u32 s71, s71, s76
  s_lshr_b32 s72, s2, 5
  s_lshl_b32 s76, s42, 16
  s_lshl_b32 s77, s71, 19
  s_add_u32 s77, s77, s76
  s_add_u32 s83, s77, 0x3000000
  s_add_u32 s84, s83, 0x40000
  s_lshl_b32 s77, s72, 19
  s_add_u32 s77, s77, s76
  s_add_u32 s73, s77, 0x4800000
  s_add_u32 s85, s73, 0x40000
  v_mov_b32 v8, 0x3f803f80
  v_mov_b32 v9, 0x3f803f80
  v_mov_b32 v10, 0x3f803f80
  v_mov_b32 v11, 0x3f803f80
  s_lshl_b32 s76, s42, 10
  s_add_u32 s76, s76, 0x20000
  v_add_u32 v12, s76, v2
  ds_write_b128 v12, v[8:11]
  v_lshrrev_b32 v8, 5, v1
  v_lshlrev_b32 v8, 8, v8
  v_and_b32 v9, 15, v1
  v_lshl_add_u32 v8, v9, 4, v8
  v_add_u32 v8, 0xfc00, v8
  v_add_u32 v10, 4, v9
  v_bfe_u32 v10, v10, 3, 1
  v_lshlrev_b32 v10, 6, v10
  v_add_u32 v10, 0x20000, v10
  v_and_b32 v11, 16, v1
  v_cmp_eq_u32 vcc, 0, v11
  v_mov_b32 v12, 4096
  v_mov_b32 v13, 0
  v_cndmask_b32 v17, v10, v8, vcc
  v_cndmask_b32 v5, v13, v12, vcc
  s_mov_b32 s82, 0
  s_waitcnt vmcnt(12)
  s_waitcnt lgkmcnt(0)
  s_barrier
  v_mov_b32 v13, 0
  v_mov_b32 v14, 0x21000
  ds_write_b32 v14, v13
  s_mov_b32 s48, s46
  s_and_b32 s49, s47, 0xffff
  s_mov_b32 s50, 0x400000
  s_mov_b32 s51, 0x20000
  s_cmp_lg_u32 s82, 0
  s_cbranch_scc1 L_p_m_1
  ds_read_b128 v[28:31], v2
  ds_read_b128 v[32:35], v2 offset:1024
  s_waitcnt lgkmcnt(1)
  v_mfma_f32_32x32x16_bf16 v[128:143], v[28:31], v[20:23], 0
  v_mfma_f32_32x32x16_bf16 v[144:159], v[28:31], v[24:27], 0
  s_waitcnt lgkmcnt(0)
  v_mfma_f32_32x32x16_bf16 v[160:175], v[32:35], v[20:23], 0
  v_mfma_f32_32x32x16_bf16 v[176:191], v[32:35], v[24:27], 0
  s_nop 7
  s_nop 3
  v_max3_f32 v6, v128, v129, v130
  v_max3_f32 v6, v6, v131, v132
  v_max3_f32 v6, v6, v133, v134
  v_max3_f32 v6, v6, v135, v136
  v_max3_f32 v6, v6, v137, v138
  v_max3_f32 v6, v6, v139, v140
  v_max3_f32 v6, v6, v141, v142
  v_max3_f32 v6, v6, v143, v160
  v_max3_f32 v6, v6, v161, v162
  v_max3_f32 v6, v6, v163, v164
  v_max3_f32 v6, v6, v165, v166
  v_max3_f32 v6, v6, v167, v168
  v_max3_f32 v6, v6, v169, v170
  v_max3_f32 v6, v6, v171, v172
  v_max3_f32 v6, v6, v173, v174
  v_max_f32 v6, v6, v175
  v_mov_b32 v8, v6
  s_nop 1
  v_permlane32_swap_b32 v8, v6
  v_max_f32 v6, v6, v8
  v_add_f32 v6, 0x42800000, v6
  v_max3_f32 v7, v144, v145, v146
  v_max3_f32 v7, v7, v147, v148
  v_max3_f32 v7, v7, v149, v150
  v_max3_f32 v7, v7, v151, v152
  v_max3_f32 v7, v7, v153, v154
  v_max3_f32 v7, v7, v155, v156
  v_max3_f32 v7, v7, v157, v158
  v_max3_f32 v7, v7, v159, v176
  v_max3_f32 v7, v7, v177, v178
  v_max3_f32 v7, v7, v179, v180
  v_max3_f32 v7, v7, v181, v182
  v_max3_f32 v7, v7, v183, v184
  v_max3_f32 v7, v7, v185, v186
  v_max3_f32 v7, v7, v187, v188
  v_max3_f32 v7, v7, v189, v190
  v_max_f32 v7, v7, v191
  v_mov_b32 v9, v7
  s_nop 1
  v_permlane32_swap_b32 v9, v7
  v_max_f32 v7, v7, v9
  v_add_f32 v7, 0x42800000, v7
L_p_m_1:
  v_sub_f32 v224, 0, v6
  v_sub_f32 v225, 0, v6
  v_sub_f32 v226, 0, v6
  v_sub_f32 v227, 0, v6
  v_sub_f32 v228, 0, v6
  v_sub_f32 v229, 0, v6
  v_sub_f32 v230, 0, v6
  v_sub_f32 v231, 0, v6
  v_sub_f32 v232, 0, v6
  v_sub_f32 v233, 0, v6
  v_sub_f32 v234, 0, v6
  v_sub_f32 v235, 0, v6
  v_sub_f32 v236, 0, v6
  v_sub_f32 v237, 0, v6
  v_sub_f32 v238, 0, v6
  v_sub_f32 v239, 0, v6
  v_sub_f32 v240, 0, v7
  v_sub_f32 v241, 0, v7
  v_sub_f32 v242, 0, v7
  v_sub_f32 v243, 0, v7
  v_sub_f32 v244, 0, v7
  v_sub_f32 v245, 0, v7
  v_sub_f32 v246, 0, v7
  v_sub_f32 v247, 0, v7
  v_sub_f32 v248, 0, v7
  v_sub_f32 v249, 0, v7
  v_sub_f32 v250, 0, v7
  v_sub_f32 v251, 0, v7
  v_sub_f32 v252, 0, v7
  v_sub_f32 v253, 0, v7
  v_sub_f32 v254, 0, v7
  v_sub_f32 v255, 0, v7
  v_mov_b32 v3, v2
  v_mov_b32 v4, v17
  v_mov_b32 v16, 0
  ds_read_b128 v[28:31], v3
L_p_A0:
  s_waitcnt lgkmcnt(0)
  v_mfma_f32_32x32x16_bf16 v[128:143], v[28:31], v[20:23], v[224:239]
  ds_read_b128 v[32:35], v3 offset:1024
  v_mfma_f32_32x32x16_bf16 v[144:159], v[28:31], v[24:27], v[240:255]
  s_waitcnt lgkmcnt(0)
  v_mfma_f32_32x32x16_bf16 v[160:175], v[32:35], v[20:23], v[224:239]
  ds_read_b128 v[28:31], v3 offset:2048
  ds_read_b128 v[36:39], v4 offset:1024
  ds_read_b128 v[40:43], v4 offset:1536
  s_add_u32 m0, s68, 0x10000
  s_nop 0
  buffer_load_dwordx4 v2, s[64:67], s68 offen sc1 lds
  buffer_load_dwordx4 v2, s[64:67], s68 offen offset:1024 sc1 lds
  s_nop 1
  v_exp_f32 v128, v128
  v_exp_f32 v129, v129
  v_exp_f32 v130, v130
  v_exp_f32 v131, v131
  v_cvt_pk_bf16_f32 v192, v128, v129
  v_exp_f32 v132, v132
  v_exp_f32 v133, v133
  v_cvt_pk_bf16_f32 v193, v130, v131
  v_exp_f32 v134, v134
  v_exp_f32 v135, v135
  v_cvt_pk_bf16_f32 v194, v132, v133
  v_exp_f32 v136, v136
  v_exp_f32 v137, v137
  v_cvt_pk_bf16_f32 v195, v134, v135
  v_exp_f32 v138, v138
  v_exp_f32 v139, v139
  v_cvt_pk_bf16_f32 v196, v136, v137
  v_exp_f32 v140, v140
  v_exp_f32 v141, v141
  v_cvt_pk_bf16_f32 v197, v138, v139
  v_exp_f32 v142, v142
  v_exp_f32 v143, v143
  v_cvt_pk_bf16_f32 v198, v140, v141
  v_cvt_pk_bf16_f32 v199, v142, v143
  v_mfma_f32_32x32x16_bf16 v[176:191], v[32:35], v[24:27], v[240:255]
  buffer_load_dwordx4 v2, s[64:67], s68 offen offset:2048 sc1 lds
  buffer_load_dwordx4 v2, s[64:67], s68 offen offset:3072 sc1 lds
  s_add_u32 s68, s68, 16384
  v_exp_f32 v144, v144
  v_exp_f32 v145, v145
  v_exp_f32 v146, v146
  v_exp_f32 v147, v147
  v_cvt_pk_bf16_f32 v200, v144, v145
  v_exp_f32 v148, v148
  v_exp_f32 v149, v149
  v_cvt_pk_bf16_f32 v201, v146, v147
  v_exp_f32 v150, v150
  v_exp_f32 v151, v151
  v_cvt_pk_bf16_f32 v202, v148, v149
  v_exp_f32 v152, v152
  v_exp_f32 v153, v153
  v_cvt_pk_bf16_f32 v203, v150, v151
  v_exp_f32 v154, v154
  v_exp_f32 v155, v155
  v_cvt_pk_bf16_f32 v204, v152, v153
  v_exp_f32 v156, v156
  v_exp_f32 v157, v157
  v_cvt_pk_bf16_f32 v205, v154, v155
  v_exp_f32 v158, v158
  v_exp_f32 v159, v159
  v_cvt_pk_bf16_f32 v206, v156, v157
  v_cvt_pk_bf16_f32 v207, v158, v159
  s_waitcnt lgkmcnt(0)
  v_mfma_f32_32x32x16_bf16 v[128:143], v[28:31], v[20:23], v[224:239]
  ds_read_b128 v[32:35], v3 offset:3072
  ds_read_b128 v[44:47], v4 offset:2048
  ds_read_b128 v[48:51], v4 offset:2560
  s_add_u32 m0, s68, 0x10000
  v_exp_f32 v160, v160
  v_exp_f32 v161, v161
  v_exp_f32 v162, v162
  v_exp_f32 v163, v163
  v_cvt_pk_bf16_f32 v208, v160, v161
  v_exp_f32 v164, v164
  v_exp_f32 v165, v165
  v_cvt_pk_bf16_f32 v209, v162, v163
  v_mfma_f32_32x32x16_bf16 v[144:159], v[28:31], v[24:27], v[240:255]
  buffer_load_dwordx4 v2, s[64:67], s68 offen sc1 lds
  v_exp_f32 v166, v166
  v_exp_f32 v167, v167
  v_cvt_pk_bf16_f32 v210, v164, v165
  v_exp_f32 v168, v168
  v_exp_f32 v169, v169
  v_cvt_pk_bf16_f32 v211, v166, v167
  v_exp_f32 v170, v170
  v_exp_f32 v171, v171
  v_mfma_f32_32x32x16_bf16 v[64:79], v[36:39], v[192:195], 0
  buffer_load_dwordx4 v2, s[64:67], s68 offen offset:1024 sc1 lds
  v_cvt_pk_bf16_f32 v212, v168, v169
  v_exp_f32 v172, v172
  v_exp_f32 v173, v173
  v_cvt_pk_bf16_f32 v213, v170, v171
  v_exp_f32 v174, v174
  v_exp_f32 v175, v175
  v_cvt_pk_bf16_f32 v214, v172, v173
  v_cvt_pk_bf16_f32 v215, v174, v175
  v_mfma_f32_32x32x16_bf16 v[80:95], v[36:39], v[200:203], 0
  buffer_load_dwordx4 v2, s[64:67], s68 offen offset:2048 sc1 lds
  v_exp_f32 v176, v176
  v_exp_f32 v177, v177
  v_exp_f32 v178, v178
  v_exp_f32 v179, v179
  v_cvt_pk_bf16_f32 v216, v176, v177
  v_exp_f32 v180, v180
  v_exp_f32 v181, v181
  v_cvt_pk_bf16_f32 v217, v178, v179
  v_mfma_f32_32x32x16_bf16 v[64:79], v[40:43], v[196:199], v[64:79]
  buffer_load_dwordx4 v2, s[64:67], s68 offen offset:3072 sc1 lds
  v_exp_f32 v182, v182
  v_exp_f32 v183, v183
  v_cvt_pk_bf16_f32 v218, v180, v181
  v_exp_f32 v184, v184
  v_exp_f32 v185, v185
  v_cvt_pk_bf16_f32 v219, v182, v183
  v_exp_f32 v186, v186
  v_exp_f32 v187, v187
  v_mfma_f32_32x32x16_bf16 v[80:95], v[40:43], v[204:207], v[80:95]
  s_add_u32 s68, s68, 16384
  v_cvt_pk_bf16_f32 v220, v184, v185
  v_exp_f32 v188, v188
  v_exp_f32 v189, v189
  v_cvt_pk_bf16_f32 v221, v186, v187
  v_exp_f32 v190, v190
  v_exp_f32 v191, v191
  v_cvt_pk_bf16_f32 v222, v188, v189
  v_cvt_pk_bf16_f32 v223, v190, v191
  s_waitcnt lgkmcnt(0)
  v_mfma_f32_32x32x16_bf16 v[160:175], v[32:35], v[20:23], v[224:239]
  s_waitcnt vmcnt(8)
  s_barrier
  s_cmp_lg_u32 s42, 0
  s_cbranch_scc1 L_p_sigB
  s_lshl_b32 s76, s40, 7
  s_lshl_b32 s77, s41, 2
  s_add_u32 s76, s76, s77
  s_add_u32 s76, s76, 0x4d04000
  v_mov_b32 v8, 0
  v_mov_b32 v9, s59
  s_mov_b64 exec, 1
  s_nop 1
  buffer_store_dword v9, v8, s[16:19], s76 offen sc1
  s_mov_b64 exec, -1
  s_nop 3
L_p_sigB:
  ds_read_b128 v[28:31], v3 offset:4096
  ds_read_b128 v[36:39], v4 offset:3072
  ds_read_b128 v[40:43], v4 offset:3584
  v_exp_f32 v128, v128
  v_exp_f32 v129, v129
  v_exp_f32 v130, v130
  v_exp_f32 v131, v131
  v_cvt_pk_bf16_f32 v192, v128, v129
  v_exp_f32 v132, v132
  v_exp_f32 v133, v133
  v_cvt_pk_bf16_f32 v193, v130, v131
  v_mfma_f32_32x32x16_bf16 v[176:191], v[32:35], v[24:27], v[240:255]
  v_exp_f32 v134, v134
  v_exp_f32 v135, v135
  v_cvt_pk_bf16_f32 v194, v132, v133
  v_exp_f32 v136, v136
  v_exp_f32 v137, v137
  v_cvt_pk_bf16_f32 v195, v134, v135
  v_exp_f32 v138, v138
  v_exp_f32 v139, v139
  v_mfma_f32_32x32x16_bf16 v[64:79], v[44:47], v[208:211], v[64:79]
  v_cvt_pk_bf16_f32 v196, v136, v137
  v_exp_f32 v140, v140
  v_exp_f32 v141, v141
  v_cvt_pk_bf16_f32 v197, v138, v139
  v_exp_f32 v142, v142
  v_exp_f32 v143, v143
  v_cvt_pk_bf16_f32 v198, v140, v141
  v_cvt_pk_bf16_f32 v199, v142, v143
  v_mfma_f32_32x32x16_bf16 v[80:95], v[44:47], v[216:219], v[80:95]
  v_exp_f32 v144, v144
  v_exp_f32 v145, v145
  v_exp_f32 v146, v146
  v_exp_f32 v147, v147
  v_cvt_pk_bf16_f32 v200, v144, v145
  v_exp_f32 v148, v148
  v_exp_f32 v149, v149
  v_cvt_pk_bf16_f32 v201, v146, v147
  v_mfma_f32_32x32x16_bf16 v[64:79], v[48:51], v[212:215], v[64:79]
  v_exp_f32 v150, v150
  v_exp_f32 v151, v151
  v_cvt_pk_bf16_f32 v202, v148, v149
  v_exp_f32 v152, v152
  v_exp_f32 v153, v153
  v_cvt_pk_bf16_f32 v203, v150, v151
  v_exp_f32 v154, v154
  v_exp_f32 v155, v155
  v_mfma_f32_32x32x16_bf16 v[80:95], v[48:51], v[220:223], v[80:95]
  v_cvt_pk_bf16_f32 v204, v152, v153
  v_exp_f32 v156, v156
  v_exp_f32 v157, v157
  v_cvt_pk_bf16_f32 v205, v154, v155
  v_exp_f32 v158, v158
  v_exp_f32 v159, v159
  v_cvt_pk_bf16_f32 v206, v156, v157
  v_cvt_pk_bf16_f32 v207, v158, v159
  v_add_u32 v3, 4096, v3
  v_add_u32 v4, v4, v5
  s_waitcnt lgkmcnt(0)
  v_mfma_f32_32x32x16_bf16 v[128:143], v[28:31], v[20:23], v[224:239]
  ds_read_b128 v[32:35], v3 offset:1024
  ds_read_b128 v[44:47], v4
  ds_read_b128 v[48:51], v4 offset:512
  v_exp_f32 v160, v160
  v_exp_f32 v161, v161
  v_exp_f32 v162, v162
  v_exp_f32 v163, v163
  v_cvt_pk_bf16_f32 v208, v160, v161
  v_exp_f32 v164, v164
  v_exp_f32 v165, v165
  v_cvt_pk_bf16_f32 v209, v162, v163
  v_mfma_f32_32x32x16_bf16 v[144:159], v[28:31], v[24:27], v[240:255]
  v_exp_f32 v166, v166
  v_exp_f32 v167, v167
  v_cvt_pk_bf16_f32 v210, v164, v165
  v_exp_f32 v168, v168
  v_exp_f32 v169, v169
  v_cvt_pk_bf16_f32 v211, v166, v167
  v_exp_f32 v170, v170
  v_exp_f32 v171, v171
  v_mfma_f32_32x32x16_bf16 v[64:79], v[36:39], v[192:195], v[64:79]
  v_cvt_pk_bf16_f32 v212, v168, v169
  v_exp_f32 v172, v172
  v_exp_f32 v173, v173
  v_cvt_pk_bf16_f32 v213, v170, v171
  v_exp_f32 v174, v174
  v_exp_f32 v175, v175
  v_cvt_pk_bf16_f32 v214, v172, v173
  v_cvt_pk_bf16_f32 v215, v174, v175
  v_mfma_f32_32x32x16_bf16 v[80:95], v[36:39], v[200:203], v[80:95]
  v_exp_f32 v176, v176
  v_exp_f32 v177, v177
  v_exp_f32 v178, v178
  v_exp_f32 v179, v179
  v_cvt_pk_bf16_f32 v216, v176, v177
  v_exp_f32 v180, v180
  v_exp_f32 v181, v181
  v_cvt_pk_bf16_f32 v217, v178, v179
  v_mfma_f32_32x32x16_bf16 v[64:79], v[40:43], v[196:199], v[64:79]
  v_exp_f32 v182, v182
  v_exp_f32 v183, v183
  v_cvt_pk_bf16_f32 v218, v180, v181
  v_exp_f32 v184, v184
  v_exp_f32 v185, v185
  v_cvt_pk_bf16_f32 v219, v182, v183
  v_exp_f32 v186, v186
  v_exp_f32 v187, v187
  v_mfma_f32_32x32x16_bf16 v[80:95], v[40:43], v[204:207], v[80:95]
  v_cvt_pk_bf16_f32 v220, v184, v185
  v_exp_f32 v188, v188
  v_exp_f32 v189, v189
  v_cvt_pk_bf16_f32 v221, v186, v187
  v_exp_f32 v190, v190
  v_exp_f32 v191, v191
  v_cvt_pk_bf16_f32 v222, v188, v189
  v_cvt_pk_bf16_f32 v223, v190, v191
  s_waitcnt lgkmcnt(0)
  v_mfma_f32_32x32x16_bf16 v[160:175], v[32:35], v[20:23], v[224:239]
  ds_read_b128 v[28:31], v3 offset:2048
  ds_read_b128 v[36:39], v4 offset:1024
  ds_read_b128 v[40:43], v4 offset:1536
  v_exp_f32 v128, v128
  v_exp_f32 v129, v129
  v_exp_f32 v130, v130
  v_exp_f32 v131, v131
  v_cvt_pk_bf16_f32 v192, v128, v129
  v_exp_f32 v132, v132
  v_exp_f32 v133, v133
  v_cvt_pk_bf16_f32 v193, v130, v131
  v_mfma_f32_32x32x16_bf16 v[176:191], v[32:35], v[24:27], v[240:255]
  v_exp_f32 v134, v134
  v_exp_f32 v135, v135
  v_cvt_pk_bf16_f32 v194, v132, v133
  v_exp_f32 v136, v136
  v_exp_f32 v137, v137
  v_cvt_pk_bf16_f32 v195, v134, v135
  v_exp_f32 v138, v138
  v_exp_f32 v139, v139
  v_mfma_f32_32x32x16_bf16 v[64:79], v[44:47], v[208:211], v[64:79]
  v_cvt_pk_bf16_f32 v196, v136, v137
  v_exp_f32 v140, v140
  v_exp_f32 v141, v141
  v_cvt_pk_bf16_f32 v197, v138, v139
  v_exp_f32 v142, v142
  v_exp_f32 v143, v143
  v_cvt_pk_bf16_f32 v198, v140, v141
  v_cvt_pk_bf16_f32 v199, v142, v143
  v_mfma_f32_32x32x16_bf16 v[80:95], v[44:47], v[216:219], v[80:95]
  v_exp_f32 v144, v144
  v_exp_f32 v145, v145
  v_exp_f32 v146, v146
  v_exp_f32 v147, v147
  v_cvt_pk_bf16_f32 v200, v144, v145
  v_exp_f32 v148, v148
  v_exp_f32 v149, v149
  v_cvt_pk_bf16_f32 v201, v146, v147
  v_mfma_f32_32x32x16_bf16 v[64:79], v[48:51], v[212:215], v[64:79]
  v_exp_f32 v150, v150
  v_exp_f32 v151, v151
  v_cvt_pk_bf16_f32 v202, v148, v149
  v_exp_f32 v152, v152
  v_exp_f32 v153, v153
  v_cvt_pk_bf16_f32 v203, v150, v151
  v_exp_f32 v154, v154
  v_exp_f32 v155, v155
  v_mfma_f32_32x32x16_bf16 v[80:95], v[48:51], v[220:223], v[80:95]
  v_cvt_pk_bf16_f32 v204, v152, v153
  v_exp_f32 v156, v156
  v_exp_f32 v157, v157
  v_cvt_pk_bf16_f32 v205, v154, v155
  v_exp_f32 v158, v158
  v_exp_f32 v159, v159
  v_cvt_pk_bf16_f32 v206, v156, v157
  v_cvt_pk_bf16_f32 v207, v158, v159
  s_waitcnt lgkmcnt(0)
  v_mfma_f32_32x32x16_bf16 v[128:143], v[28:31], v[20:23], v[224:239]
  ds_read_b128 v[32:35], v3 offset:3072
  ds_read_b128 v[44:47], v4 offset:2048
  ds_read_b128 v[48:51], v4 offset:2560
  v_exp_f32 v160, v160
  v_exp_f32 v161, v161
  v_exp_f32 v162, v162
  v_exp_f32 v163, v163
  v_cvt_pk_bf16_f32 v208, v160, v161
  v_exp_f32 v164, v164
  v_exp_f32 v165, v165
  v_cvt_pk_bf16_f32 v209, v162, v163
  v_mfma_f32_32x32x16_bf16 v[144:159], v[28:31], v[24:27], v[240:255]
  v_exp_f32 v166, v166
  v_exp_f32 v167, v167
  v_cvt_pk_bf16_f32 v210, v164, v165
  v_exp_f32 v168, v168
  v_exp_f32 v169, v169
  v_cvt_pk_bf16_f32 v211, v166, v167
  v_exp_f32 v170, v170
  v_exp_f32 v171, v171
  v_mfma_f32_32x32x16_bf16 v[64:79], v[36:39], v[192:195], v[64:79]
  v_cvt_pk_bf16_f32 v212, v168, v169
  v_exp_f32 v172, v172
  v_exp_f32 v173, v173
  v_cvt_pk_bf16_f32 v213, v170, v171
  v_exp_f32 v174, v174
  v_exp_f32 v175, v175
  v_cvt_pk_bf16_f32 v214, v172, v173
  v_cvt_pk_bf16_f32 v215, v174, v175
  v_mfma_f32_32x32x16_bf16 v[80:95], v[36:39], v[200:203], v[80:95]
  v_exp_f32 v176, v176
  v_exp_f32 v177, v177
  v_exp_f32 v178, v178
  v_exp_f32 v179, v179
  v_cvt_pk_bf16_f32 v216, v176, v177
  v_exp_f32 v180, v180
  v_exp_f32 v181, v181
  v_cvt_pk_bf16_f32 v217, v178, v179
  v_mfma_f32_32x32x16_bf16 v[64:79], v[40:43], v[196:199], v[64:79]
  v_exp_f32 v182, v182
  v_exp_f32 v183, v183
  v_cvt_pk_bf16_f32 v218, v180, v181
  v_exp_f32 v184, v184
  v_exp_f32 v185, v185
  v_cvt_pk_bf16_f32 v219, v182, v183
  v_exp_f32 v186, v186
  v_exp_f32 v187, v187
  v_mfma_f32_32x32x16_bf16 v[80:95], v[40:43], v[204:207], v[80:95]
  v_cvt_pk_bf16_f32 v220, v184, v185
  v_exp_f32 v188, v188
  v_exp_f32 v189, v189
  v_cvt_pk_bf16_f32 v221, v186, v187
  v_exp_f32 v190, v190
  v_exp_f32 v191, v191
  v_cvt_pk_bf16_f32 v222, v188, v189
  v_cvt_pk_bf16_f32 v223, v190, v191
  s_waitcnt lgkmcnt(0)
  v_mfma_f32_32x32x16_bf16 v[160:175], v[32:35], v[20:23], v[224:239]
  ds_read_b128 v[28:31], v3 offset:4096
  ds_read_b128 v[36:39], v4 offset:3072
  ds_read_b128 v[40:43], v4 offset:3584
  v_exp_f32 v128, v128
  v_exp_f32 v129, v129
  v_exp_f32 v130, v130
  v_exp_f32 v131, v131
  v_cvt_pk_bf16_f32 v192, v128, v129
  v_exp_f32 v132, v132
  v_exp_f32 v133, v133
  v_cvt_pk_bf16_f32 v193, v130, v131
  v_mfma_f32_32x32x16_bf16 v[176:191], v[32:35], v[24:27], v[240:255]
  v_exp_f32 v134, v134
  v_exp_f32 v135, v135
  v_cvt_pk_bf16_f32 v194, v132, v133
  v_exp_f32 v136, v136
  v_exp_f32 v137, v137
  v_cvt_pk_bf16_f32 v195, v134, v135
  v_exp_f32 v138, v138
  v_exp_f32 v139, v139
  v_mfma_f32_32x32x16_bf16 v[64:79], v[44:47], v[208:211], v[64:79]
  v_cvt_pk_bf16_f32 v196, v136, v137
  v_exp_f32 v140, v140
  v_exp_f32 v141, v141
  v_cvt_pk_bf16_f32 v197, v138, v139
  v_exp_f32 v142, v142
  v_exp_f32 v143, v143
  v_cvt_pk_bf16_f32 v198, v140, v141
  v_cvt_pk_bf16_f32 v199, v142, v143
  v_mfma_f32_32x32x16_bf16 v[80:95], v[44:47], v[216:219], v[80:95]
  v_exp_f32 v144, v144
  v_exp_f32 v145, v145
  v_exp_f32 v146, v146
  v_exp_f32 v147, v147
  v_cvt_pk_bf16_f32 v200, v144, v145
  v_exp_f32 v148, v148
  v_exp_f32 v149, v149
  v_cvt_pk_bf16_f32 v201, v146, v147
  v_mfma_f32_32x32x16_bf16 v[64:79], v[48:51], v[212:215], v[64:79]
  v_exp_f32 v150, v150
  v_exp_f32 v151, v151
  v_cvt_pk_bf16_f32 v202, v148, v149
  v_exp_f32 v152, v152
  v_exp_f32 v153, v153
  v_cvt_pk_bf16_f32 v203, v150, v151
  v_exp_f32 v154, v154
  v_exp_f32 v155, v155
  v_mfma_f32_32x32x16_bf16 v[80:95], v[48:51], v[220:223], v[80:95]
  v_cvt_pk_bf16_f32 v204, v152, v153
  v_exp_f32 v156, v156
  v_exp_f32 v157, v157
  v_cvt_pk_bf16_f32 v205, v154, v155
  v_exp_f32 v158, v158
  v_exp_f32 v159, v159
  v_cvt_pk_bf16_f32 v206, v156, v157
  v_cvt_pk_bf16_f32 v207, v158, v159
  v_add_u32 v3, 4096, v3
  v_add_u32 v4, v4, v5
  s_waitcnt lgkmcnt(0)
  v_mfma_f32_32x32x16_bf16 v[128:143], v[28:31], v[20:23], v[224:239]
  ds_read_b128 v[32:35], v3 offset:1024
  ds_read_b128 v[44:47], v4
  ds_read_b128 v[48:51], v4 offset:512
  v_exp_f32 v160, v160
  v_exp_f32 v161, v161
  v_exp_f32 v162, v162
  v_exp_f32 v163, v163
  v_cvt_pk_bf16_f32 v208, v160, v161
  v_exp_f32 v164, v164
  v_exp_f32 v165, v165
  v_cvt_pk_bf16_f32 v209, v162, v163
  v_mfma_f32_32x32x16_bf16 v[144:159], v[28:31], v[24:27], v[240:255]
  v_exp_f32 v166, v166
  v_exp_f32 v167, v167
  v_cvt_pk_bf16_f32 v210, v164, v165
  v_exp_f32 v168, v168
  v_exp_f32 v169, v169
  v_cvt_pk_bf16_f32 v211, v166, v167
  v_exp_f32 v170, v170
  v_exp_f32 v171, v171
  v_mfma_f32_32x32x16_bf16 v[64:79], v[36:39], v[192:195], v[64:79]
  v_cvt_pk_bf16_f32 v212, v168, v169
  v_exp_f32 v172, v172
  v_exp_f32 v173, v173
  v_cvt_pk_bf16_f32 v213, v170, v171
  v_exp_f32 v174, v174
  v_exp_f32 v175, v175
  v_cvt_pk_bf16_f32 v214, v172, v173
  v_cvt_pk_bf16_f32 v215, v174, v175
  v_mfma_f32_32x32x16_bf16 v[80:95], v[36:39], v[200:203], v[80:95]
  v_exp_f32 v176, v176
  v_exp_f32 v177, v177
  v_exp_f32 v178, v178
  v_exp_f32 v179, v179
  v_cvt_pk_bf16_f32 v216, v176, v177
  v_exp_f32 v180, v180
  v_exp_f32 v181, v181
  v_cvt_pk_bf16_f32 v217, v178, v179
  v_mfma_f32_32x32x16_bf16 v[64:79], v[40:43], v[196:199], v[64:79]
  v_exp_f32 v182, v182
  v_exp_f32 v183, v183
  v_cvt_pk_bf16_f32 v218, v180, v181
  v_exp_f32 v184, v184
  v_exp_f32 v185, v185
  v_cvt_pk_bf16_f32 v219, v182, v183
  v_exp_f32 v186, v186
  v_exp_f32 v187, v187
  v_mfma_f32_32x32x16_bf16 v[80:95], v[40:43], v[204:207], v[80:95]
  v_cvt_pk_bf16_f32 v220, v184, v185
  v_exp_f32 v188, v188
  v_exp_f32 v189, v189
  v_cvt_pk_bf16_f32 v221, v186, v187
  v_exp_f32 v190, v190
  v_exp_f32 v191, v191
  v_cvt_pk_bf16_f32 v222, v188, v189
  v_cvt_pk_bf16_f32 v223, v190, v191
  s_waitcnt lgkmcnt(0)
  v_mfma_f32_32x32x16_bf16 v[160:175], v[32:35], v[20:23], v[224:239]
  ds_read_b128 v[28:31], v3 offset:2048
  ds_read_b128 v[36:39], v4 offset:1024
  ds_read_b128 v[40:43], v4 offset:1536
  v_exp_f32 v128, v128
  v_exp_f32 v129, v129
  v_exp_f32 v130, v130
  v_exp_f32 v131, v131
  v_cvt_pk_bf16_f32 v192, v128, v129
  v_exp_f32 v132, v132
  v_exp_f32 v133, v133
  v_cvt_pk_bf16_f32 v193, v130, v131
  v_mfma_f32_32x32x16_bf16 v[176:191], v[32:35], v[24:27], v[240:255]
  v_exp_f32 v134, v134
  v_exp_f32 v135, v135
  v_cvt_pk_bf16_f32 v194, v132, v133
  v_exp_f32 v136, v136
  v_exp_f32 v137, v137
  v_cvt_pk_bf16_f32 v195, v134, v135
  v_exp_f32 v138, v138
  v_exp_f32 v139, v139
  v_mfma_f32_32x32x16_bf16 v[64:79], v[44:47], v[208:211], v[64:79]
  v_cvt_pk_bf16_f32 v196, v136, v137
  v_exp_f32 v140, v140
  v_exp_f32 v141, v141
  v_cvt_pk_bf16_f32 v197, v138, v139
  v_exp_f32 v142, v142
  v_exp_f32 v143, v143
  v_cvt_pk_bf16_f32 v198, v140, v141
  v_cvt_pk_bf16_f32 v199, v142, v143
  v_mfma_f32_32x32x16_bf16 v[80:95], v[44:47], v[216:219], v[80:95]
  v_exp_f32 v144, v144
  v_exp_f32 v145, v145
  v_exp_f32 v146, v146
  v_exp_f32 v147, v147
  v_cvt_pk_bf16_f32 v200, v144, v145
  v_exp_f32 v148, v148
  v_exp_f32 v149, v149
  v_cvt_pk_bf16_f32 v201, v146, v147
  v_mfma_f32_32x32x16_bf16 v[64:79], v[48:51], v[212:215], v[64:79]
  v_exp_f32 v150, v150
  v_exp_f32 v151, v151
  v_cvt_pk_bf16_f32 v202, v148, v149
  v_exp_f32 v152, v152
  v_exp_f32 v153, v153
  v_cvt_pk_bf16_f32 v203, v150, v151
  v_exp_f32 v154, v154
  v_exp_f32 v155, v155
  v_mfma_f32_32x32x16_bf16 v[80:95], v[48:51], v[220:223], v[80:95]
  v_cvt_pk_bf16_f32 v204, v152, v153
  v_exp_f32 v156, v156
  v_exp_f32 v157, v157
  v_cvt_pk_bf16_f32 v205, v154, v155
  v_exp_f32 v158, v158
  v_exp_f32 v159, v159
  v_cvt_pk_bf16_f32 v206, v156, v157
  v_cvt_pk_bf16_f32 v207, v158, v159
  s_waitcnt lgkmcnt(0)
  v_mfma_f32_32x32x16_bf16 v[128:143], v[28:31], v[20:23], v[224:239]
  ds_read_b128 v[32:35], v3 offset:3072
  ds_read_b128 v[44:47], v4 offset:2048
  ds_read_b128 v[48:51], v4 offset:2560
  s_lshr_b32 s52, s71, 1
  s_sub_u32 s76, 15, s52
  v_exp_f32 v160, v160
  v_exp_f32 v161, v161
  v_exp_f32 v162, v162
  v_exp_f32 v163, v163
  v_cvt_pk_bf16_f32 v208, v160, v161
  v_exp_f32 v164, v164
  v_exp_f32 v165, v165
  v_cvt_pk_bf16_f32 v209, v162, v163
  v_mfma_f32_32x32x16_bf16 v[144:159], v[28:31], v[24:27], v[240:255]
  s_min_u32 s52, s52, s76
  s_lshl_b32 s52, s52, 7
  v_exp_f32 v166, v166
  v_exp_f32 v167, v167
  v_cvt_pk_bf16_f32 v210, v164, v165
  v_exp_f32 v168, v168
  v_exp_f32 v169, v169
  v_cvt_pk_bf16_f32 v211, v166, v167
  v_exp_f32 v170, v170
  v_exp_f32 v171, v171
  v_mfma_f32_32x32x16_bf16 v[64:79], v[36:39], v[192:195], v[64:79]
  s_add_u32 s52, s52, 0x4d04000
  v_cvt_pk_bf16_f32 v212, v168, v169
  v_exp_f32 v172, v172
  v_exp_f32 v173, v173
  v_cvt_pk_bf16_f32 v213, v170, v171
  v_exp_f32 v174, v174
  v_exp_f32 v175, v175
  v_cvt_pk_bf16_f32 v214, v172, v173
  v_cvt_pk_bf16_f32 v215, v174, v175
  v_mfma_f32_32x32x16_bf16 v[80:95], v[36:39], v[200:203], v[80:95]
  s_mov_b32 s53, 0x4d02c00
  v_exp_f32 v176, v176
  v_exp_f32 v177, v177
  v_exp_f32 v178, v178
  v_exp_f32 v179, v179
  v_cvt_pk_bf16_f32 v216, v176, v177
  v_exp_f32 v180, v180
  v_exp_f32 v181, v181
  v_cvt_pk_bf16_f32 v217, v178, v179
  v_mfma_f32_32x32x16_bf16 v[64:79], v[40:43], v[196:199], v[64:79]
  v_lshlrev_b32 v52, 2, v1
  v_exp_f32 v182, v182
  v_exp_f32 v183, v183
  v_cvt_pk_bf16_f32 v218, v180, v181
  v_exp_f32 v184, v184
  v_exp_f32 v185, v185
  v_cvt_pk_bf16_f32 v219, v182, v183
  v_exp_f32 v186, v186
  v_exp_f32 v187, v187
  v_mfma_f32_32x32x16_bf16 v[80:95], v[40:43], v[204:207], v[80:95]
  buffer_load_dword v18, v52, s[16:19], s52 offen sc1
  v_cvt_pk_bf16_f32 v220, v184, v185
  v_exp_f32 v188, v188
  v_exp_f32 v189, v189
  v_cvt_pk_bf16_f32 v221, v186, v187
  v_exp_f32 v190, v190
  v_exp_f32 v191, v191
  v_cvt_pk_bf16_f32 v222, v188, v189
  v_cvt_pk_bf16_f32 v223, v190, v191
  s_waitcnt lgkmcnt(0)
  v_mfma_f32_32x32x16_bf16 v[160:175], v[32:35], v[20:23], v[224:239]
  ds_read_b128 v[28:31], v3 offset:4096
  ds_read_b128 v[36:39], v4 offset:3072
  ds_read_b128 v[40:43], v4 offset:3584
  v_lshrrev_b32 v19, 3, v1
  v_exp_f32 v128, v128
  v_exp_f32 v129, v129
  v_exp_f32 v130, v130
  v_exp_f32 v131, v131
  v_cvt_pk_bf16_f32 v192, v128, v129
  v_exp_f32 v132, v132
  v_exp_f32 v133, v133
  v_cvt_pk_bf16_f32 v193, v130, v131
  v_mfma_f32_32x32x16_bf16 v[176:191], v[32:35], v[24:27], v[240:255]
  v_lshlrev_b32 v19, 7, v19
  v_exp_f32 v134, v134
  v_exp_f32 v135, v135
  v_cvt_pk_bf16_f32 v194, v132, v133
  v_exp_f32 v136, v136
  v_exp_f32 v137, v137
  v_cvt_pk_bf16_f32 v195, v134, v135
  v_exp_f32 v138, v138
  v_exp_f32 v139, v139
  v_mfma_f32_32x32x16_bf16 v[64:79], v[44:47], v[208:211], v[64:79]
  v_and_b32 v53, 7, v1
  v_cvt_pk_bf16_f32 v196, v136, v137
  v_exp_f32 v140, v140
  v_exp_f32 v141, v141
  v_cvt_pk_bf16_f32 v197, v138, v139
  v_exp_f32 v142, v142
  v_exp_f32 v143, v143
  v_cvt_pk_bf16_f32 v198, v140, v141
  v_cvt_pk_bf16_f32 v199, v142, v143
  v_mfma_f32_32x32x16_bf16 v[80:95], v[44:47], v[216:219], v[80:95]
  v_lshl_add_u32 v53, v53, 2, v19
  v_exp_f32 v144, v144
  v_exp_f32 v145, v145
  v_exp_f32 v146, v146
  v_exp_f32 v147, v147
  v_cvt_pk_bf16_f32 v200, v144, v145
  v_exp_f32 v148, v148
  v_exp_f32 v149, v149
  v_cvt_pk_bf16_f32 v201, v146, v147
  v_mfma_f32_32x32x16_bf16 v[64:79], v[48:51], v[212:215], v[64:79]
  buffer_load_dword v19, v53, s[16:19], s53 offen sc1
  v_exp_f32 v150, v150
  v_exp_f32 v151, v151
  v_cvt_pk_bf16_f32 v202, v148, v149
  v_exp_f32 v152, v152
  v_exp_f32 v153, v153
  v_cvt_pk_bf16_f32 v203, v150, v151
  v_exp_f32 v154, v154
  v_exp_f32 v155, v155
  v_mfma_f32_32x32x16_bf16 v[80:95], v[48:51], v[220:223], v[80:95]
  v_cvt_pk_bf16_f32 v204, v152, v153
  v_exp_f32 v156, v156
  v_exp_f32 v157, v157
  v_cvt_pk_bf16_f32 v205, v154, v155
  v_exp_f32 v158, v158
  v_exp_f32 v159, v159
  v_cvt_pk_bf16_f32 v206, v156, v157
  v_cvt_pk_bf16_f32 v207, v158, v159
  v_add_u32 v3, 4096, v3
  v_add_u32 v4, v4, v5
  s_waitcnt lgkmcnt(0)
  v_mfma_f32_32x32x16_bf16 v[128:143], v[28:31], v[20:23], v[224:239]
  ds_read_b128 v[32:35], v3 offset:1024
  ds_read_b128 v[44:47], v4
  ds_read_b128 v[48:51], v4 offset:512
  v_exp_f32 v160, v160
  v_exp_f32 v161, v161
  v_exp_f32 v162, v162
  v_exp_f32 v163, v163
  v_cvt_pk_bf16_f32 v208, v160, v161
  v_exp_f32 v164, v164
  v_exp_f32 v165, v165
  v_cvt_pk_bf16_f32 v209, v162, v163
  v_mfma_f32_32x32x16_bf16 v[144:159], v[28:31], v[24:27], v[240:255]
  v_exp_f32 v166, v166
  v_exp_f32 v167, v167
  v_cvt_pk_bf16_f32 v210, v164, v165
  v_exp_f32 v168, v168
  v_exp_f32 v169, v169
  v_cvt_pk_bf16_f32 v211, v166, v167
  v_exp_f32 v170, v170
  v_exp_f32 v171, v171
  v_mfma_f32_32x32x16_bf16 v[64:79], v[36:39], v[192:195], v[64:79]
  v_cvt_pk_bf16_f32 v212, v168, v169
  v_exp_f32 v172, v172
  v_exp_f32 v173, v173
  v_cvt_pk_bf16_f32 v213, v170, v171
  v_exp_f32 v174, v174
  v_exp_f32 v175, v175
  v_cvt_pk_bf16_f32 v214, v172, v173
  v_cvt_pk_bf16_f32 v215, v174, v175
  v_mfma_f32_32x32x16_bf16 v[80:95], v[36:39], v[200:203], v[80:95]
  v_exp_f32 v176, v176
  v_exp_f32 v177, v177
  v_exp_f32 v178, v178
  v_exp_f32 v179, v179
  v_cvt_pk_bf16_f32 v216, v176, v177
  v_exp_f32 v180, v180
  v_exp_f32 v181, v181
  v_cvt_pk_bf16_f32 v217, v178, v179
  v_mfma_f32_32x32x16_bf16 v[64:79], v[40:43], v[196:199], v[64:79]
  v_exp_f32 v182, v182
  v_exp_f32 v183, v183
  v_cvt_pk_bf16_f32 v218, v180, v181
  v_exp_f32 v184, v184
  v_exp_f32 v185, v185
  v_cvt_pk_bf16_f32 v219, v182, v183
  v_exp_f32 v186, v186
  v_exp_f32 v187, v187
  v_mfma_f32_32x32x16_bf16 v[80:95], v[40:43], v[204:207], v[80:95]
  v_cvt_pk_bf16_f32 v220, v184, v185
  v_exp_f32 v188, v188
  v_exp_f32 v189, v189
  v_cvt_pk_bf16_f32 v221, v186, v187
  v_exp_f32 v190, v190
  v_exp_f32 v191, v191
  v_cvt_pk_bf16_f32 v222, v188, v189
  v_cvt_pk_bf16_f32 v223, v190, v191
  s_waitcnt lgkmcnt(0)
  v_mfma_f32_32x32x16_bf16 v[160:175], v[32:35], v[20:23], v[224:239]
  ds_read_b128 v[28:31], v3 offset:2048
  ds_read_b128 v[36:39], v4 offset:1024
  ds_read_b128 v[40:43], v4 offset:1536
  v_exp_f32 v128, v128
  v_exp_f32 v129, v129
  v_exp_f32 v130, v130
  v_exp_f32 v131, v131
  v_cvt_pk_bf16_f32 v192, v128, v129
  v_exp_f32 v132, v132
  v_exp_f32 v133, v133
  v_cvt_pk_bf16_f32 v193, v130, v131
  v_mfma_f32_32x32x16_bf16 v[176:191], v[32:35], v[24:27], v[240:255]
  v_exp_f32 v134, v134
  v_exp_f32 v135, v135
  v_cvt_pk_bf16_f32 v194, v132, v133
  v_exp_f32 v136, v136
  v_exp_f32 v137, v137
  v_cvt_pk_bf16_f32 v195, v134, v135
  v_exp_f32 v138, v138
  v_exp_f32 v139, v139
  v_mfma_f32_32x32x16_bf16 v[64:79], v[44:47], v[208:211], v[64:79]
  v_cvt_pk_bf16_f32 v196, v136, v137
  v_exp_f32 v140, v140
  v_exp_f32 v141, v141
  v_cvt_pk_bf16_f32 v197, v138, v139
  v_exp_f32 v142, v142
  v_exp_f32 v143, v143
  v_cvt_pk_bf16_f32 v198, v140, v141
  v_cvt_pk_bf16_f32 v199, v142, v143
  v_mfma_f32_32x32x16_bf16 v[80:95], v[44:47], v[216:219], v[80:95]
  v_exp_f32 v144, v144
  v_exp_f32 v145, v145
  v_exp_f32 v146, v146
  v_exp_f32 v147, v147
  v_cvt_pk_bf16_f32 v200, v144, v145
  v_exp_f32 v148, v148
  v_exp_f32 v149, v149
  v_cvt_pk_bf16_f32 v201, v146, v147
  v_mfma_f32_32x32x16_bf16 v[64:79], v[48:51], v[212:215], v[64:79]
  v_exp_f32 v150, v150
  v_exp_f32 v151, v151
  v_cvt_pk_bf16_f32 v202, v148, v149
  v_exp_f32 v152, v152
  v_exp_f32 v153, v153
  v_cvt_pk_bf16_f32 v203, v150, v151
  v_exp_f32 v154, v154
  v_exp_f32 v155, v155
  v_mfma_f32_32x32x16_bf16 v[80:95], v[48:51], v[220:223], v[80:95]
  v_cvt_pk_bf16_f32 v204, v152, v153
  v_exp_f32 v156, v156
  v_exp_f32 v157, v157
  v_cvt_pk_bf16_f32 v205, v154, v155
  v_exp_f32 v158, v158
  v_exp_f32 v159, v159
  v_cvt_pk_bf16_f32 v206, v156, v157
  v_cvt_pk_bf16_f32 v207, v158, v159
  s_waitcnt lgkmcnt(0)
  v_mfma_f32_32x32x16_bf16 v[128:143], v[28:31], v[20:23], v[224:239]
  ds_read_b128 v[32:35], v3 offset:3072
  ds_read_b128 v[44:47], v4 offset:2048
  ds_read_b128 v[48:51], v4 offset:2560
  v_exp_f32 v160, v160
  v_exp_f32 v161, v161
  v_exp_f32 v162, v162
  v_exp_f32 v163, v163
  v_cvt_pk_bf16_f32 v208, v160, v161
  v_exp_f32 v164, v164
  v_exp_f32 v165, v165
  v_cvt_pk_bf16_f32 v209, v162, v163
  v_mfma_f32_32x32x16_bf16 v[144:159], v[28:31], v[24:27], v[240:255]
  v_exp_f32 v166, v166
  v_exp_f32 v167, v167
  v_cvt_pk_bf16_f32 v210, v164, v165
  v_exp_f32 v168, v168
  v_exp_f32 v169, v169
  v_cvt_pk_bf16_f32 v211, v166, v167
  v_exp_f32 v170, v170
  v_exp_f32 v171, v171
  v_mfma_f32_32x32x16_bf16 v[64:79], v[36:39], v[192:195], v[64:79]
  v_cvt_pk_bf16_f32 v212, v168, v169
  v_exp_f32 v172, v172
  v_exp_f32 v173, v173
  v_cvt_pk_bf16_f32 v213, v170, v171
  v_exp_f32 v174, v174
  v_exp_f32 v175, v175
  v_cvt_pk_bf16_f32 v214, v172, v173
  v_cvt_pk_bf16_f32 v215, v174, v175
  v_mfma_f32_32x32x16_bf16 v[80:95], v[36:39], v[200:203], v[80:95]
  v_exp_f32 v176, v176
  v_exp_f32 v177, v177
  v_exp_f32 v178, v178
  v_exp_f32 v179, v179
  v_cvt_pk_bf16_f32 v216, v176, v177
  v_exp_f32 v180, v180
  v_exp_f32 v181, v181
  v_cvt_pk_bf16_f32 v217, v178, v179
  v_mfma_f32_32x32x16_bf16 v[64:79], v[40:43], v[196:199], v[64:79]
  v_exp_f32 v182, v182
  v_exp_f32 v183, v183
  v_cvt_pk_bf16_f32 v218, v180, v181
  v_exp_f32 v184, v184
  v_exp_f32 v185, v185
  v_cvt_pk_bf16_f32 v219, v182, v183
  v_exp_f32 v186, v186
  v_exp_f32 v187, v187
  v_mfma_f32_32x32x16_bf16 v[80:95], v[40:43], v[204:207], v[80:95]
  v_cvt_pk_bf16_f32 v220, v184, v185
  v_exp_f32 v188, v188
  v_exp_f32 v189, v189
  v_cvt_pk_bf16_f32 v221, v186, v187
  v_exp_f32 v190, v190
  v_exp_f32 v191, v191
  v_cvt_pk_bf16_f32 v222, v188, v189
  v_cvt_pk_bf16_f32 v223, v190, v191
  s_waitcnt lgkmcnt(0)
  v_mfma_f32_32x32x16_bf16 v[160:175], v[32:35], v[20:23], v[224:239]
  s_waitcnt vmcnt(2)
  s_barrier
  ds_read_b128 v[28:31], v3 offset:4096
  ds_read_b128 v[36:39], v4 offset:3072
  ds_read_b128 v[40:43], v4 offset:3584
  s_waitcnt vmcnt(0)
  v_cmp_eq_u32 vcc, s59, v18
  s_nop 3
  s_and_b32 s77, vcc_lo, 0xffffffff
  s_cmp_eq_u32 s77, 0xffffffff
  s_cbranch_scc0 L_p_spin_B
  v_cmp_eq_u32 vcc, s59, v19
  s_nop 3
  s_and_b32 s77, vcc_lo, 0xffffffff
  s_and_b32 s81, vcc_hi, 0xffffffff
  s_and_b32 s77, s77, s81
  s_cmp_eq_u32 s77, 0xffffffff
  s_cbranch_scc0 L_p_spin_B
L_p_spinr_B:
  v_exp_f32 v128, v128
  v_exp_f32 v129, v129
  v_exp_f32 v130, v130
  v_exp_f32 v131, v131
  v_cvt_pk_bf16_f32 v192, v128, v129
  v_exp_f32 v132, v132
  v_exp_f32 v133, v133
  v_cvt_pk_bf16_f32 v193, v130, v131
  v_mfma_f32_32x32x16_bf16 v[176:191], v[32:35], v[24:27], v[240:255]
  v_exp_f32 v134, v134
  v_exp_f32 v135, v135
  v_cvt_pk_bf16_f32 v194, v132, v133
  v_exp_f32 v136, v136
  v_exp_f32 v137, v137
  v_cvt_pk_bf16_f32 v195, v134, v135
  v_exp_f32 v138, v138
  v_exp_f32 v139, v139
  v_mfma_f32_32x32x16_bf16 v[64:79], v[44:47], v[208:211], v[64:79]
  v_cvt_pk_bf16_f32 v196, v136, v137
  v_exp_f32 v140, v140
  v_exp_f32 v141, v141
  v_cvt_pk_bf16_f32 v197, v138, v139
  v_exp_f32 v142, v142
  v_exp_f32 v143, v143
  v_cvt_pk_bf16_f32 v198, v140, v141
  v_cvt_pk_bf16_f32 v199, v142, v143
  v_mfma_f32_32x32x16_bf16 v[80:95], v[44:47], v[216:219], v[80:95]
  v_exp_f32 v144, v144
  v_exp_f32 v145, v145
  v_exp_f32 v146, v146
  v_exp_f32 v147, v147
  v_cvt_pk_bf16_f32 v200, v144, v145
  v_exp_f32 v148, v148
  v_exp_f32 v149, v149
  v_cvt_pk_bf16_f32 v201, v146, v147
  v_mfma_f32_32x32x16_bf16 v[64:79], v[48:51], v[212:215], v[64:79]
  v_exp_f32 v150, v150
  v_exp_f32 v151, v151
  v_cvt_pk_bf16_f32 v202, v148, v149
  v_exp_f32 v152, v152
  v_exp_f32 v153, v153
  v_cvt_pk_bf16_f32 v203, v150, v151
  v_exp_f32 v154, v154
  v_exp_f32 v155, v155
  v_mfma_f32_32x32x16_bf16 v[80:95], v[48:51], v[220:223], v[80:95]
  v_cvt_pk_bf16_f32 v204, v152, v153
  v_exp_f32 v156, v156
  v_exp_f32 v157, v157
  v_cvt_pk_bf16_f32 v205, v154, v155
  v_exp_f32 v158, v158
  v_exp_f32 v159, v159
  v_cvt_pk_bf16_f32 v206, v156, v157
  v_cvt_pk_bf16_f32 v207, v158, v159
  v_add_u32 v3, 4096, v3
  v_add_u32 v4, v4, v5
  s_waitcnt lgkmcnt(0)
  v_mfma_f32_32x32x16_bf16 v[128:143], v[28:31], v[20:23], v[224:239]
  ds_read_b128 v[32:35], v3 offset:1024
  ds_read_b128 v[44:47], v4
  ds_read_b128 v[48:51], v4 offset:512
  buffer_load_dwordx4 a[64:67], v2, s[16:19], s83 offen sc1
  buffer_load_dwordx4 a[72:75], v2, s[16:19], s73 offen sc1
  v_exp_f32 v160, v160
  v_exp_f32 v161, v161
  v_exp_f32 v162, v162
  v_exp_f32 v163, v163
  v_cvt_pk_bf16_f32 v208, v160, v161
  v_exp_f32 v164, v164
  v_exp_f32 v165, v165
  v_cvt_pk_bf16_f32 v209, v162, v163
  v_mfma_f32_32x32x16_bf16 v[144:159], v[28:31], v[24:27], v[240:255]
  buffer_load_dwordx4 a[68:71], v54, s[16:19], s83 offen sc1
  buffer_load_dwordx4 a[76:79], v54, s[16:19], s73 offen sc1
  v_exp_f32 v166, v166
  v_exp_f32 v167, v167
  v_cvt_pk_bf16_f32 v210, v164, v165
  v_exp_f32 v168, v168
  v_exp_f32 v169, v169
  v_cvt_pk_bf16_f32 v211, v166, v167
  v_exp_f32 v170, v170
  v_exp_f32 v171, v171
  v_mfma_f32_32x32x16_bf16 v[64:79], v[36:39], v[192:195], v[64:79]
  buffer_load_dwordx4 a[80:83], v2, s[16:19], s83 offen offset:1024 sc1
  buffer_load_dwordx4 a[88:91], v2, s[16:19], s73 offen offset:1024 sc1
  v_cvt_pk_bf16_f32 v212, v168, v169
  v_exp_f32 v172, v172
  v_exp_f32 v173, v173
  v_cvt_pk_bf16_f32 v213, v170, v171
  v_exp_f32 v174, v174
  v_exp_f32 v175, v175
  v_cvt_pk_bf16_f32 v214, v172, v173
  v_cvt_pk_bf16_f32 v215, v174, v175
  v_mfma_f32_32x32x16_bf16 v[80:95], v[36:39], v[200:203], v[80:95]
  buffer_load_dwordx4 a[84:87], v54, s[16:19], s83 offen offset:1024 sc1
  v_exp_f32 v176, v176
  v_exp_f32 v177, v177
  v_exp_f32 v178, v178
  v_exp_f32 v179, v179
  v_cvt_pk_bf16_f32 v216, v176, v177
  v_exp_f32 v180, v180
  v_exp_f32 v181, v181
  v_cvt_pk_bf16_f32 v217, v178, v179
  v_mfma_f32_32x32x16_bf16 v[64:79], v[40:43], v[196:199], v[64:79]
  buffer_load_dwordx4 a[92:95], v54, s[16:19], s73 offen offset:1024 sc1
  v_exp_f32 v182, v182
  v_exp_f32 v183, v183
  v_cvt_pk_bf16_f32 v218, v180, v181
  v_exp_f32 v184, v184
  v_exp_f32 v185, v185
  v_cvt_pk_bf16_f32 v219, v182, v183
  v_exp_f32 v186, v186
  v_exp_f32 v187, v187
  v_mfma_f32_32x32x16_bf16 v[80:95], v[40:43], v[204:207], v[80:95]
  buffer_load_dwordx4 a[96:99], v2, s[16:19], s83 offen offset:2048 sc1
  v_cvt_pk_bf16_f32 v220, v184, v185
  v_exp_f32 v188, v188
  v_exp_f32 v189, v189
  v_cvt_pk_bf16_f32 v221, v186, v187
  v_exp_f32 v190, v190
  v_exp_f32 v191, v191
  v_cvt_pk_bf16_f32 v222, v188, v189
  v_cvt_pk_bf16_f32 v223, v190, v191
  s_waitcnt lgkmcnt(0)
  v_mfma_f32_32x32x16_bf16 v[160:175], v[32:35], v[20:23], v[224:239]
  ds_read_b128 v[28:31], v3 offset:2048
  ds_read_b128 v[36:39], v4 offset:1024
  ds_read_b128 v[40:43], v4 offset:1536
  buffer_load_dwordx4 a[104:107], v2, s[16:19], s73 offen offset:2048 sc1
  buffer_load_dwordx4 a[100:103], v54, s[16:19], s83 offen offset:2048 sc1
  v_exp_f32 v128, v128
  v_exp_f32 v129, v129
  v_exp_f32 v130, v130
  v_exp_f32 v131, v131
  v_cvt_pk_bf16_f32 v192, v128, v129
  v_exp_f32 v132, v132
  v_exp_f32 v133, v133
  v_cvt_pk_bf16_f32 v193, v130, v131
  v_mfma_f32_32x32x16_bf16 v[176:191], v[32:35], v[24:27], v[240:255]
  buffer_load_dwordx4 a[108:111], v54, s[16:19], s73 offen offset:2048 sc1
  buffer_load_dwordx4 a[112:115], v2, s[16:19], s83 offen offset:3072 sc1
  v_exp_f32 v134, v134
  v_exp_f32 v135, v135
  v_cvt_pk_bf16_f32 v194, v132, v133
  v_exp_f32 v136, v136
  v_exp_f32 v137, v137
  v_cvt_pk_bf16_f32 v195, v134, v135
  v_exp_f32 v138, v138
  v_exp_f32 v139, v139
  v_mfma_f32_32x32x16_bf16 v[64:79], v[44:47], v[208:211], v[64:79]
  buffer_load_dwordx4 a[120:123], v2, s[16:19], s73 offen offset:3072 sc1
  buffer_load_dwordx4 a[116:119], v54, s[16:19], s83 offen offset:3072 sc1
  v_cvt_pk_bf16_f32 v196, v136, v137
  v_exp_f32 v140, v140
  v_exp_f32 v141, v141
  v_cvt_pk_bf16_f32 v197, v138, v139
  v_exp_f32 v142, v142
  v_exp_f32 v143, v143
  v_cvt_pk_bf16_f32 v198, v140, v141
  v_cvt_pk_bf16_f32 v199, v142, v143
  v_mfma_f32_32x32x16_bf16 v[80:95], v[44:47], v[216:219], v[80:95]
  buffer_load_dwordx4 a[124:127], v54, s[16:19], s73 offen offset:3072 sc1
  v_exp_f32 v144, v144
  v_exp_f32 v145, v145
  v_exp_f32 v146, v146
  v_exp_f32 v147, v147
  v_cvt_pk_bf16_f32 v200, v144, v145
  v_exp_f32 v148, v148
  v_exp_f32 v149, v149
  v_cvt_pk_bf16_f32 v201, v146, v147
  v_mfma_f32_32x32x16_bf16 v[64:79], v[48:51], v[212:215], v[64:79]
  s_add_u32 s83, s83, 4096
  v_exp_f32 v150, v150
  v_exp_f32 v151, v151
  v_cvt_pk_bf16_f32 v202, v148, v149
  v_exp_f32 v152, v152
  v_exp_f32 v153, v153
  v_cvt_pk_bf16_f32 v203, v150, v151
  v_exp_f32 v154, v154
  v_exp_f32 v155, v155
  v_mfma_f32_32x32x16_bf16 v[80:95], v[48:51], v[220:223], v[80:95]
  s_add_u32 s73, s73, 4096
  v_cvt_pk_bf16_f32 v204, v152, v153
  v_exp_f32 v156, v156
  v_exp_f32 v157, v157
  v_cvt_pk_bf16_f32 v205, v154, v155
  v_exp_f32 v158, v158
  v_exp_f32 v159, v159
  v_cvt_pk_bf16_f32 v206, v156, v157
  v_cvt_pk_bf16_f32 v207, v158, v159
  s_waitcnt lgkmcnt(0)
  v_mfma_f32_32x32x16_bf16 v[128:143], v[28:31], v[20:23], v[224:239]
  ds_read_b128 v[32:35], v3 offset:3072
  ds_read_b128 v[44:47], v4 offset:2048
  ds_read_b128 v[48:51], v4 offset:2560
  buffer_load_dwordx4 a[128:131], v2, s[16:19], s83 offen sc1
  buffer_load_dwordx4 a[136:139], v2, s[16:19], s73 offen sc1
  v_exp_f32 v160, v160
  v_exp_f32 v161, v161
  v_exp_f32 v162, v162
  v_exp_f32 v163, v163
  v_cvt_pk_bf16_f32 v208, v160, v161
  v_exp_f32 v164, v164
  v_exp_f32 v165, v165
  v_cvt_pk_bf16_f32 v209, v162, v163
  v_mfma_f32_32x32x16_bf16 v[144:159], v[28:31], v[24:27], v[240:255]
  buffer_load_dwordx4 a[132:135], v54, s[16:19], s83 offen sc1
  buffer_load_dwordx4 a[140:143], v54, s[16:19], s73 offen sc1
  v_exp_f32 v166, v166
  v_exp_f32 v167, v167
  v_cvt_pk_bf16_f32 v210, v164, v165
  v_exp_f32 v168, v168
  v_exp_f32 v169, v169
  v_cvt_pk_bf16_f32 v211, v166, v167
  v_exp_f32 v170, v170
  v_exp_f32 v171, v171
  v_mfma_f32_32x32x16_bf16 v[64:79], v[36:39], v[192:195], v[64:79]
  buffer_load_dwordx4 a[144:147], v2, s[16:19], s83 offen offset:1024 sc1
  buffer_load_dwordx4 a[152:155], v2, s[16:19], s73 offen offset:1024 sc1
  v_cvt_pk_bf16_f32 v212, v168, v169
  v_exp_f32 v172, v172
  v_exp_f32 v173, v173
  v_cvt_pk_bf16_f32 v213, v170, v171
  v_exp_f32 v174, v174
  v_exp_f32 v175, v175
  v_cvt_pk_bf16_f32 v214, v172, v173
  v_cvt_pk_bf16_f32 v215, v174, v175
  v_mfma_f32_32x32x16_bf16 v[80:95], v[36:39], v[200:203], v[80:95]
  buffer_load_dwordx4 a[148:151], v54, s[16:19], s83 offen offset:1024 sc1
  v_exp_f32 v176, v176
  v_exp_f32 v177, v177
  v_exp_f32 v178, v178
  v_exp_f32 v179, v179
  v_cvt_pk_bf16_f32 v216, v176, v177
  v_exp_f32 v180, v180
  v_exp_f32 v181, v181
  v_cvt_pk_bf16_f32 v217, v178, v179
  v_mfma_f32_32x32x16_bf16 v[64:79], v[40:43], v[196:199], v[64:79]
  buffer_load_dwordx4 a[156:159], v54, s[16:19], s73 offen offset:1024 sc1
  v_exp_f32 v182, v182
  v_exp_f32 v183, v183
  v_cvt_pk_bf16_f32 v218, v180, v181
  v_exp_f32 v184, v184
  v_exp_f32 v185, v185
  v_cvt_pk_bf16_f32 v219, v182, v183
  v_exp_f32 v186, v186
  v_exp_f32 v187, v187
  v_mfma_f32_32x32x16_bf16 v[80:95], v[40:43], v[204:207], v[80:95]
  buffer_load_dwordx4 a[160:163], v2, s[16:19], s83 offen offset:2048 sc1
  v_cvt_pk_bf16_f32 v220, v184, v185
  v_exp_f32 v188, v188
  v_exp_f32 v189, v189
  v_cvt_pk_bf16_f32 v221, v186, v187
  v_exp_f32 v190, v190
  v_exp_f32 v191, v191
  v_cvt_pk_bf16_f32 v222, v188, v189
  v_cvt_pk_bf16_f32 v223, v190, v191
  s_waitcnt lgkmcnt(0)
  v_mfma_f32_32x32x16_bf16 v[160:175], v[32:35], v[20:23], v[224:239]
  ds_read_b128 v[28:31], v3 offset:4096
  ds_read_b128 v[36:39], v4 offset:3072
  ds_read_b128 v[40:43], v4 offset:3584
  buffer_load_dwordx4 a[168:171], v2, s[16:19], s73 offen offset:2048 sc1
  buffer_load_dwordx4 a[164:167], v54, s[16:19], s83 offen offset:2048 sc1
  v_exp_f32 v128, v128
  v_exp_f32 v129, v129
  v_exp_f32 v130, v130
  v_exp_f32 v131, v131
  v_cvt_pk_bf16_f32 v192, v128, v129
  v_exp_f32 v132, v132
  v_exp_f32 v133, v133
  v_cvt_pk_bf16_f32 v193, v130, v131
  v_mfma_f32_32x32x16_bf16 v[176:191], v[32:35], v[24:27], v[240:255]
  buffer_load_dwordx4 a[172:175], v54, s[16:19], s73 offen offset:2048 sc1
  buffer_load_dwordx4 a[176:179], v2, s[16:19], s83 offen offset:3072 sc1
  v_exp_f32 v134, v134
  v_exp_f32 v135, v135
  v_cvt_pk_bf16_f32 v194, v132, v133
  v_exp_f32 v136, v136
  v_exp_f32 v137, v137
  v_cvt_pk_bf16_f32 v195, v134, v135
  v_exp_f32 v138, v138
  v_exp_f32 v139, v139
  v_mfma_f32_32x32x16_bf16 v[64:79], v[44:47], v[208:211], v[64:79]
  buffer_load_dwordx4 a[184:187], v2, s[16:19], s73 offen offset:3072 sc1
  buffer_load_dwordx4 a[180:183], v54, s[16:19], s83 offen offset:3072 sc1
  v_cvt_pk_bf16_f32 v196, v136, v137
  v_exp_f32 v140, v140
  v_exp_f32 v141, v141
  v_cvt_pk_bf16_f32 v197, v138, v139
  v_exp_f32 v142, v142
  v_exp_f32 v143, v143
  v_cvt_pk_bf16_f32 v198, v140, v141
  v_cvt_pk_bf16_f32 v199, v142, v143
  v_mfma_f32_32x32x16_bf16 v[80:95], v[44:47], v[216:219], v[80:95]
  buffer_load_dwordx4 a[188:191], v54, s[16:19], s73 offen offset:3072 sc1
  v_exp_f32 v144, v144
  v_exp_f32 v145, v145
  v_exp_f32 v146, v146
  v_exp_f32 v147, v147
  v_cvt_pk_bf16_f32 v200, v144, v145
  v_exp_f32 v148, v148
  v_exp_f32 v149, v149
  v_cvt_pk_bf16_f32 v201, v146, v147
  v_mfma_f32_32x32x16_bf16 v[64:79], v[48:51], v[212:215], v[64:79]
  s_add_u32 s83, s83, 4096
  v_exp_f32 v150, v150
  v_exp_f32 v151, v151
  v_cvt_pk_bf16_f32 v202, v148, v149
  v_exp_f32 v152, v152
  v_exp_f32 v153, v153
  v_cvt_pk_bf16_f32 v203, v150, v151
  v_exp_f32 v154, v154
  v_exp_f32 v155, v155
  v_mfma_f32_32x32x16_bf16 v[80:95], v[48:51], v[220:223], v[80:95]
  s_add_u32 s73, s73, 4096
  v_cvt_pk_bf16_f32 v204, v152, v153
  v_exp_f32 v156, v156
  v_exp_f32 v157, v157
  v_cvt_pk_bf16_f32 v205, v154, v155
  v_exp_f32 v158, v158
  v_exp_f32 v159, v159
  v_cvt_pk_bf16_f32 v206, v156, v157
  v_cvt_pk_bf16_f32 v207, v158, v159
  v_add_u32 v3, 4096, v3
  v_add_u32 v4, v4, v5
  s_waitcnt lgkmcnt(0)
  v_mfma_f32_32x32x16_bf16 v[128:143], v[28:31], v[20:23], v[224:239]
  ds_read_b128 v[32:35], v3 offset:1024
  ds_read_b128 v[44:47], v4
  ds_read_b128 v[48:51], v4 offset:512
  v_exp_f32 v160, v160
  v_exp_f32 v161, v161
  v_exp_f32 v162, v162
  v_exp_f32 v163, v163
  v_cvt_pk_bf16_f32 v208, v160, v161
  s_waitcnt vmcnt(28)
  v_mfma_f32_32x32x16_bf16 a[0:15], a[72:75], a[64:67], 0
  v_exp_f32 v164, v164
  v_exp_f32 v165, v165
  v_cvt_pk_bf16_f32 v209, v162, v163
  v_exp_f32 v166, v166
  v_exp_f32 v167, v167
  v_mfma_f32_32x32x16_bf16 v[144:159], v[28:31], v[24:27], v[240:255]
  v_cvt_pk_bf16_f32 v210, v164, v165
  v_exp_f32 v168, v168
  v_exp_f32 v169, v169
  v_cvt_pk_bf16_f32 v211, v166, v167
  v_mfma_f32_32x32x16_bf16 a[16:31], a[72:75], a[68:71], 0
  v_exp_f32 v170, v170
  v_exp_f32 v171, v171
  v_cvt_pk_bf16_f32 v212, v168, v169
  v_exp_f32 v172, v172
  v_exp_f32 v173, v173
  v_mfma_f32_32x32x16_bf16 v[64:79], v[36:39], v[192:195], v[64:79]
  v_cvt_pk_bf16_f32 v213, v170, v171
  v_exp_f32 v174, v174
  v_exp_f32 v175, v175
  v_cvt_pk_bf16_f32 v214, v172, v173
  v_cvt_pk_bf16_f32 v215, v174, v175
  v_mfma_f32_32x32x16_bf16 a[32:47], a[76:79], a[64:67], 0
  v_exp_f32 v176, v176
  v_exp_f32 v177, v177
  v_exp_f32 v178, v178
  v_exp_f32 v179, v179
  v_cvt_pk_bf16_f32 v216, v176, v177
  v_mfma_f32_32x32x16_bf16 v[80:95], v[36:39], v[200:203], v[80:95]
  v_exp_f32 v180, v180
  v_exp_f32 v181, v181
  v_cvt_pk_bf16_f32 v217, v178, v179
  v_exp_f32 v182, v182
  v_exp_f32 v183, v183
  v_mfma_f32_32x32x16_bf16 v[64:79], v[40:43], v[196:199], v[64:79]
  v_cvt_pk_bf16_f32 v218, v180, v181
  v_exp_f32 v184, v184
  v_exp_f32 v185, v185
  v_cvt_pk_bf16_f32 v219, v182, v183
  v_mfma_f32_32x32x16_bf16 a[48:63], a[76:79], a[68:71], 0
  buffer_load_dwordx4 a[64:67], v2, s[16:19], s83 offen sc1
  buffer_load_dwordx4 a[72:75], v2, s[16:19], s73 offen sc1
  v_exp_f32 v186, v186
  v_exp_f32 v187, v187
  v_cvt_pk_bf16_f32 v220, v184, v185
  v_exp_f32 v188, v188
  v_exp_f32 v189, v189
  v_mfma_f32_32x32x16_bf16 v[80:95], v[40:43], v[204:207], v[80:95]
  buffer_load_dwordx4 a[68:71], v54, s[16:19], s83 offen sc1
  buffer_load_dwordx4 a[76:79], v54, s[16:19], s73 offen sc1
  v_cvt_pk_bf16_f32 v221, v186, v187
  v_exp_f32 v190, v190
  v_exp_f32 v191, v191
  v_cvt_pk_bf16_f32 v222, v188, v189
  v_cvt_pk_bf16_f32 v223, v190, v191
  s_waitcnt lgkmcnt(0)
  v_mfma_f32_32x32x16_bf16 v[160:175], v[32:35], v[20:23], v[224:239]
  ds_read_b128 v[28:31], v3 offset:2048
  ds_read_b128 v[36:39], v4 offset:1024
  ds_read_b128 v[40:43], v4 offset:1536
  v_exp_f32 v128, v128
  v_exp_f32 v129, v129
  v_exp_f32 v130, v130
  v_exp_f32 v131, v131
  v_cvt_pk_bf16_f32 v192, v128, v129
  s_waitcnt vmcnt(28)
  v_mfma_f32_32x32x16_bf16 a[0:15], a[88:91], a[80:83], a[0:15]
  v_exp_f32 v132, v132
  v_exp_f32 v133, v133
  v_cvt_pk_bf16_f32 v193, v130, v131
  v_exp_f32 v134, v134
  v_exp_f32 v135, v135
  v_mfma_f32_32x32x16_bf16 v[176:191], v[32:35], v[24:27], v[240:255]
  v_cvt_pk_bf16_f32 v194, v132, v133
  v_exp_f32 v136, v136
  v_exp_f32 v137, v137
  v_cvt_pk_bf16_f32 v195, v134, v135
  v_mfma_f32_32x32x16_bf16 a[16:31], a[88:91], a[84:87], a[16:31]
  v_exp_f32 v138, v138
  v_exp_f32 v139, v139
  v_cvt_pk_bf16_f32 v196, v136, v137
  v_exp_f32 v140, v140
  v_exp_f32 v141, v141
  v_mfma_f32_32x32x16_bf16 v[64:79], v[44:47], v[208:211], v[64:79]
  v_cvt_pk_bf16_f32 v197, v138, v139
  v_exp_f32 v142, v142
  v_exp_f32 v143, v143
  v_cvt_pk_bf16_f32 v198, v140, v141
  v_cvt_pk_bf16_f32 v199, v142, v143
  v_mfma_f32_32x32x16_bf16 a[32:47], a[92:95], a[80:83], a[32:47]
  v_exp_f32 v144, v144
  v_exp_f32 v145, v145
  v_exp_f32 v146, v146
  v_exp_f32 v147, v147
  v_cvt_pk_bf16_f32 v200, v144, v145
  v_mfma_f32_32x32x16_bf16 v[80:95], v[44:47], v[216:219], v[80:95]
  v_exp_f32 v148, v148
  v_exp_f32 v149, v149
  v_cvt_pk_bf16_f32 v201, v146, v147
  v_exp_f32 v150, v150
  v_exp_f32 v151, v151
  v_mfma_f32_32x32x16_bf16 v[64:79], v[48:51], v[212:215], v[64:79]
  v_cvt_pk_bf16_f32 v202, v148, v149
  v_exp_f32 v152, v152
  v_exp_f32 v153, v153
  v_cvt_pk_bf16_f32 v203, v150, v151
  v_mfma_f32_32x32x16_bf16 a[48:63], a[92:95], a[84:87], a[48:63]
  buffer_load_dwordx4 a[80:83], v2, s[16:19], s83 offen offset:1024 sc1
  buffer_load_dwordx4 a[88:91], v2, s[16:19], s73 offen offset:1024 sc1
  v_exp_f32 v154, v154
  v_exp_f32 v155, v155
  v_cvt_pk_bf16_f32 v204, v152, v153
  v_exp_f32 v156, v156
  v_exp_f32 v157, v157
  v_mfma_f32_32x32x16_bf16 v[80:95], v[48:51], v[220:223], v[80:95]
  buffer_load_dwordx4 a[84:87], v54, s[16:19], s83 offen offset:1024 sc1
  buffer_load_dwordx4 a[92:95], v54, s[16:19], s73 offen offset:1024 sc1
  v_cvt_pk_bf16_f32 v205, v154, v155
  v_exp_f32 v158, v158
  v_exp_f32 v159, v159
  v_cvt_pk_bf16_f32 v206, v156, v157
  v_cvt_pk_bf16_f32 v207, v158, v159
  s_waitcnt lgkmcnt(0)
  v_mfma_f32_32x32x16_bf16 v[128:143], v[28:31], v[20:23], v[224:239]
  ds_read_b128 v[32:35], v3 offset:3072
  ds_read_b128 v[44:47], v4 offset:2048
  ds_read_b128 v[48:51], v4 offset:2560
  v_exp_f32 v160, v160
  v_exp_f32 v161, v161
  v_exp_f32 v162, v162
  s_waitcnt vmcnt(28)
  v_mfma_f32_32x32x16_bf16 a[0:15], a[104:107], a[96:99], a[0:15]
  v_exp_f32 v163, v163
  v_cvt_pk_bf16_f32 v208, v160, v161
  v_exp_f32 v164, v164
  v_exp_f32 v165, v165
  v_mfma_f32_32x32x16_bf16 a[16:31], a[104:107], a[100:103], a[16:31]
  v_cvt_pk_bf16_f32 v209, v162, v163
  v_exp_f32 v166, v166
  v_exp_f32 v167, v167
  v_mfma_f32_32x32x16_bf16 v[144:159], v[28:31], v[24:27], v[240:255]
  v_cvt_pk_bf16_f32 v210, v164, v165
  v_exp_f32 v168, v168
  v_exp_f32 v169, v169
  v_cvt_pk_bf16_f32 v211, v166, v167
  v_mfma_f32_32x32x16_bf16 a[32:47], a[108:111], a[96:99], a[32:47]
  v_exp_f32 v170, v170
  v_exp_f32 v171, v171
  v_cvt_pk_bf16_f32 v212, v168, v169
  v_mfma_f32_32x32x16_bf16 v[64:79], v[36:39], v[192:195], v[64:79]
  v_exp_f32 v172, v172
  v_exp_f32 v173, v173
  v_cvt_pk_bf16_f32 v213, v170, v171
  v_exp_f32 v174, v174
  v_mfma_f32_32x32x16_bf16 a[48:63], a[108:111], a[100:103], a[48:63]
  buffer_load_dwordx4 a[96:99], v2, s[16:19], s83 offen offset:2048 sc1
  v_exp_f32 v175, v175
  v_cvt_pk_bf16_f32 v214, v172, v173
  v_cvt_pk_bf16_f32 v215, v174, v175
  s_waitcnt vmcnt(25)
  v_mfma_f32_32x32x16_bf16 a[0:15], a[120:123], a[112:115], a[0:15]
  buffer_load_dwordx4 a[104:107], v2, s[16:19], s73 offen offset:2048 sc1
  v_exp_f32 v176, v176
  v_exp_f32 v177, v177
  v_exp_f32 v178, v178
  v_mfma_f32_32x32x16_bf16 v[80:95], v[36:39], v[200:203], v[80:95]
  buffer_load_dwordx4 a[100:103], v54, s[16:19], s83 offen offset:2048 sc1
  v_exp_f32 v179, v179
  v_cvt_pk_bf16_f32 v216, v176, v177
  v_exp_f32 v180, v180
  v_exp_f32 v181, v181
  v_mfma_f32_32x32x16_bf16 a[16:31], a[120:123], a[116:119], a[16:31]
  buffer_load_dwordx4 a[108:111], v54, s[16:19], s73 offen offset:2048 sc1
  v_cvt_pk_bf16_f32 v217, v178, v179
  v_exp_f32 v182, v182
  v_exp_f32 v183, v183
  v_mfma_f32_32x32x16_bf16 v[64:79], v[40:43], v[196:199], v[64:79]
  v_cvt_pk_bf16_f32 v218, v180, v181
  v_exp_f32 v184, v184
  v_exp_f32 v185, v185
  v_cvt_pk_bf16_f32 v219, v182, v183
  v_mfma_f32_32x32x16_bf16 a[32:47], a[124:127], a[112:115], a[32:47]
  v_exp_f32 v186, v186
  v_exp_f32 v187, v187
  v_cvt_pk_bf16_f32 v220, v184, v185
  v_mfma_f32_32x32x16_bf16 v[80:95], v[40:43], v[204:207], v[80:95]
  v_exp_f32 v188, v188
  v_exp_f32 v189, v189
  v_cvt_pk_bf16_f32 v221, v186, v187
  v_exp_f32 v190, v190
  v_mfma_f32_32x32x16_bf16 a[48:63], a[124:127], a[116:119], a[48:63]
  buffer_load_dwordx4 a[112:115], v2, s[16:19], s83 offen offset:3072 sc1
  buffer_load_dwordx4 a[120:123], v2, s[16:19], s73 offen offset:3072 sc1
  buffer_load_dwordx4 a[116:119], v54, s[16:19], s83 offen offset:3072 sc1
  buffer_load_dwordx4 a[124:127], v54, s[16:19], s73 offen offset:3072 sc1
  s_add_u32 s83, s83, 4096
  s_add_u32 s73, s73, 4096
  v_exp_f32 v191, v191
  v_cvt_pk_bf16_f32 v222, v188, v189
  v_cvt_pk_bf16_f32 v223, v190, v191
  s_waitcnt lgkmcnt(0)
  v_mfma_f32_32x32x16_bf16 v[160:175], v[32:35], v[20:23], v[224:239]
  ds_read_b128 v[28:31], v3 offset:4096
  ds_read_b128 v[36:39], v4 offset:3072
  ds_read_b128 v[40:43], v4 offset:3584
  v_exp_f32 v128, v128
  v_exp_f32 v129, v129
  v_exp_f32 v130, v130
  v_exp_f32 v131, v131
  v_cvt_pk_bf16_f32 v192, v128, v129
  s_waitcnt vmcnt(28)
  v_mfma_f32_32x32x16_bf16 a[0:15], a[136:139], a[128:131], a[0:15]
  v_exp_f32 v132, v132
  v_exp_f32 v133, v133
  v_cvt_pk_bf16_f32 v193, v130, v131
  v_exp_f32 v134, v134
  v_exp_f32 v135, v135
  v_mfma_f32_32x32x16_bf16 v[176:191], v[32:35], v[24:27], v[240:255]
  v_cvt_pk_bf16_f32 v194, v132, v133
  v_exp_f32 v136, v136
  v_exp_f32 v137, v137
  v_cvt_pk_bf16_f32 v195, v134, v135
  v_mfma_f32_32x32x16_bf16 a[16:31], a[136:139], a[132:135], a[16:31]
  v_exp_f32 v138, v138
  v_exp_f32 v139, v139
  v_cvt_pk_bf16_f32 v196, v136, v137
  v_exp_f32 v140, v140
  v_exp_f32 v141, v141
  v_mfma_f32_32x32x16_bf16 v[64:79], v[44:47], v[208:211], v[64:79]
  v_cvt_pk_bf16_f32 v197, v138, v139
  v_exp_f32 v142, v142
  v_exp_f32 v143, v143
  v_cvt_pk_bf16_f32 v198, v140, v141
  v_cvt_pk_bf16_f32 v199, v142, v143
  v_mfma_f32_32x32x16_bf16 a[32:47], a[140:143], a[128:131], a[32:47]
  v_exp_f32 v144, v144
  v_exp_f32 v145, v145
  v_exp_f32 v146, v146
  v_exp_f32 v147, v147
  v_cvt_pk_bf16_f32 v200, v144, v145
  v_mfma_f32_32x32x16_bf16 v[80:95], v[44:47], v[216:219], v[80:95]
  v_exp_f32 v148, v148
  v_exp_f32 v149, v149
  v_cvt_pk_bf16_f32 v201, v146, v147
  v_exp_f32 v150, v150
  v_exp_f32 v151, v151
  v_mfma_f32_32x32x16_bf16 v[64:79], v[48:51], v[212:215], v[64:79]
  v_cvt_pk_bf16_f32 v202, v148, v149
  v_exp_f32 v152, v152
  v_exp_f32 v153, v153
  v_cvt_pk_bf16_f32 v203, v150, v151
  v_mfma_f32_32x32x16_bf16 a[48:63], a[140:143], a[132:135], a[48:63]
  buffer_load_dwordx4 a[128:131], v2, s[16:19], s83 offen sc1
  buffer_load_dwordx4 a[136:139], v2, s[16:19], s73 offen sc1
  v_exp_f32 v154, v154
  v_exp_f32 v155, v155
  v_cvt_pk_bf16_f32 v204, v152, v153
  v_exp_f32 v156, v156
  v_exp_f32 v157, v157
  v_mfma_f32_32x32x16_bf16 v[80:95], v[48:51], v[220:223], v[80:95]
  buffer_load_dwordx4 a[132:135], v54, s[16:19], s83 offen sc1
  buffer_load_dwordx4 a[140:143], v54, s[16:19], s73 offen sc1
  v_cvt_pk_bf16_f32 v205, v154, v155
  v_exp_f32 v158, v158
  v_exp_f32 v159, v159
  v_cvt_pk_bf16_f32 v206, v156, v157
  v_cvt_pk_bf16_f32 v207, v158, v159
  v_add_u32 v3, 4096, v3
  v_add_u32 v4, v4, v5
  s_waitcnt lgkmcnt(0)
  v_mfma_f32_32x32x16_bf16 v[128:143], v[28:31], v[20:23], v[224:239]
  ds_read_b128 v[32:35], v3 offset:1024
  ds_read_b128 v[44:47], v4
  ds_read_b128 v[48:51], v4 offset:512
  v_exp_f32 v160, v160
  v_exp_f32 v161, v161
  v_exp_f32 v162, v162
  s_waitcnt vmcnt(28)
  v_mfma_f32_32x32x16_bf16 a[0:15], a[152:155], a[144:147], a[0:15]
  v_exp_f32 v163, v163
  v_cvt_pk_bf16_f32 v208, v160, v161
  v_exp_f32 v164, v164
  v_exp_f32 v165, v165
  v_mfma_f32_32x32x16_bf16 a[16:31], a[152:155], a[148:151], a[16:31]
  v_cvt_pk_bf16_f32 v209, v162, v163
  v_exp_f32 v166, v166
  v_exp_f32 v167, v167
  v_mfma_f32_32x32x16_bf16 v[144:159], v[28:31], v[24:27], v[240:255]
  v_cvt_pk_bf16_f32 v210, v164, v165
  v_exp_f32 v168, v168
  v_exp_f32 v169, v169
  v_cvt_pk_bf16_f32 v211, v166, v167
  v_mfma_f32_32x32x16_bf16 a[32:47], a[156:159], a[144:147], a[32:47]
  v_exp_f32 v170, v170
  v_exp_f32 v171, v171
  v_cvt_pk_bf16_f32 v212, v168, v169
  v_mfma_f32_32x32x16_bf16 v[64:79], v[36:39], v[192:195], v[64:79]
  v_exp_f32 v172, v172
  v_exp_f32 v173, v173
  v_cvt_pk_bf16_f32 v213, v170, v171
  v_exp_f32 v174, v174
  v_mfma_f32_32x32x16_bf16 a[48:63], a[156:159], a[148:151], a[48:63]
  buffer_load_dwordx4 a[144:147], v2, s[16:19], s83 offen offset:1024 sc1
  v_exp_f32 v175, v175
  v_cvt_pk_bf16_f32 v214, v172, v173
  v_cvt_pk_bf16_f32 v215, v174, v175
  s_waitcnt vmcnt(25)
  v_mfma_f32_32x32x16_bf16 a[0:15], a[168:171], a[160:163], a[0:15]
  buffer_load_dwordx4 a[152:155], v2, s[16:19], s73 offen offset:1024 sc1
  v_exp_f32 v176, v176
  v_exp_f32 v177, v177
  v_exp_f32 v178, v178
  v_mfma_f32_32x32x16_bf16 v[80:95], v[36:39], v[200:203], v[80:95]
  buffer_load_dwordx4 a[148:151], v54, s[16:19], s83 offen offset:1024 sc1
  v_exp_f32 v179, v179
  v_cvt_pk_bf16_f32 v216, v176, v177
  v_exp_f32 v180, v180
  v_exp_f32 v181, v181
  v_mfma_f32_32x32x16_bf16 a[16:31], a[168:171], a[164:167], a[16:31]
  buffer_load_dwordx4 a[156:159], v54, s[16:19], s73 offen offset:1024 sc1
  v_cvt_pk_bf16_f32 v217, v178, v179
  v_exp_f32 v182, v182
  v_exp_f32 v183, v183
  v_mfma_f32_32x32x16_bf16 v[64:79], v[40:43], v[196:199], v[64:79]
  v_cvt_pk_bf16_f32 v218, v180, v181
  v_exp_f32 v184, v184
  v_exp_f32 v185, v185
  v_cvt_pk_bf16_f32 v219, v182, v183
  v_mfma_f32_32x32x16_bf16 a[32:47], a[172:175], a[160:163], a[32:47]
  v_exp_f32 v186, v186
  v_exp_f32 v187, v187
  v_cvt_pk_bf16_f32 v220, v184, v185
  v_mfma_f32_32x32x16_bf16 v[80:95], v[40:43], v[204:207], v[80:95]
  v_exp_f32 v188, v188
  v_exp_f32 v189, v189
  v_cvt_pk_bf16_f32 v221, v186, v187
  v_exp_f32 v190, v190
  v_mfma_f32_32x32x16_bf16 a[48:63], a[172:175], a[164:167], a[48:63]
  buffer_load_dwordx4 a[160:163], v2, s[16:19], s83 offen offset:2048 sc1
  buffer_load_dwordx4 a[168:171], v2, s[16:19], s73 offen offset:2048 sc1
  buffer_load_dwordx4 a[164:167], v54, s[16:19], s83 offen offset:2048 sc1
  buffer_load_dwordx4 a[172:175], v54, s[16:19], s73 offen offset:2048 sc1
  v_exp_f32 v191, v191
  v_cvt_pk_bf16_f32 v222, v188, v189
  v_cvt_pk_bf16_f32 v223, v190, v191
  s_waitcnt lgkmcnt(0)
  v_mfma_f32_32x32x16_bf16 v[160:175], v[32:35], v[20:23], v[224:239]
  ds_read_b128 v[28:31], v3 offset:2048
  ds_read_b128 v[36:39], v4 offset:1024
  ds_read_b128 v[40:43], v4 offset:1536
  v_exp_f32 v128, v128
  v_exp_f32 v129, v129
  v_exp_f32 v130, v130
  v_exp_f32 v131, v131
  v_cvt_pk_bf16_f32 v192, v128, v129
  s_waitcnt vmcnt(28)
  v_mfma_f32_32x32x16_bf16 a[0:15], a[184:187], a[176:179], a[0:15]
  v_exp_f32 v132, v132
  v_exp_f32 v133, v133
  v_cvt_pk_bf16_f32 v193, v130, v131
  v_exp_f32 v134, v134
  v_exp_f32 v135, v135
  v_mfma_f32_32x32x16_bf16 v[176:191], v[32:35], v[24:27], v[240:255]
  v_cvt_pk_bf16_f32 v194, v132, v133
  v_exp_f32 v136, v136
  v_exp_f32 v137, v137
  v_cvt_pk_bf16_f32 v195, v134, v135
  v_mfma_f32_32x32x16_bf16 a[16:31], a[184:187], a[180:183], a[16:31]
  v_exp_f32 v138, v138
  v_exp_f32 v139, v139
  v_cvt_pk_bf16_f32 v196, v136, v137
  v_exp_f32 v140, v140
  v_exp_f32 v141, v141
  v_mfma_f32_32x32x16_bf16 v[64:79], v[44:47], v[208:211], v[64:79]
  v_cvt_pk_bf16_f32 v197, v138, v139
  v_exp_f32 v142, v142
  v_exp_f32 v143, v143
  v_cvt_pk_bf16_f32 v198, v140, v141
  v_cvt_pk_bf16_f32 v199, v142, v143
  v_mfma_f32_32x32x16_bf16 a[32:47], a[188:191], a[176:179], a[32:47]
  v_exp_f32 v144, v144
  v_exp_f32 v145, v145
  v_exp_f32 v146, v146
  v_exp_f32 v147, v147
  v_cvt_pk_bf16_f32 v200, v144, v145
  v_mfma_f32_32x32x16_bf16 v[80:95], v[44:47], v[216:219], v[80:95]
  v_exp_f32 v148, v148
  v_exp_f32 v149, v149
  v_cvt_pk_bf16_f32 v201, v146, v147
  v_exp_f32 v150, v150
  v_exp_f32 v151, v151
  v_mfma_f32_32x32x16_bf16 v[64:79], v[48:51], v[212:215], v[64:79]
  v_cvt_pk_bf16_f32 v202, v148, v149
  v_exp_f32 v152, v152
  v_exp_f32 v153, v153
  v_cvt_pk_bf16_f32 v203, v150, v151
  v_mfma_f32_32x32x16_bf16 a[48:63], a[188:191], a[180:183], a[48:63]
  buffer_load_dwordx4 a[176:179], v2, s[16:19], s83 offen offset:3072 sc1
  buffer_load_dwordx4 a[184:187], v2, s[16:19], s73 offen offset:3072 sc1
  buffer_load_dwordx4 a[180:183], v54, s[16:19], s83 offen offset:3072 sc1
  v_exp_f32 v154, v154
  v_exp_f32 v155, v155
  v_cvt_pk_bf16_f32 v204, v152, v153
  v_exp_f32 v156, v156
  v_exp_f32 v157, v157
  v_mfma_f32_32x32x16_bf16 v[80:95], v[48:51], v[220:223], v[80:95]
  buffer_load_dwordx4 a[188:191], v54, s[16:19], s73 offen offset:3072 sc1
  s_add_u32 s83, s83, 4096
  s_add_u32 s73, s73, 4096
  v_cvt_pk_bf16_f32 v205, v154, v155
  v_exp_f32 v158, v158
  v_exp_f32 v159, v159
  v_cvt_pk_bf16_f32 v206, v156, v157
  v_cvt_pk_bf16_f32 v207, v158, v159
  s_waitcnt lgkmcnt(0)
  v_mfma_f32_32x32x16_bf16 v[128:143], v[28:31], v[20:23], v[224:239]
  ds_read_b128 v[32:35], v3 offset:3072
  ds_read_b128 v[44:47], v4 offset:2048
  ds_read_b128 v[48:51], v4 offset:2560
  v_exp_f32 v160, v160
  v_exp_f32 v161, v161
  v_exp_f32 v162, v162
  s_waitcnt vmcnt(28)
  v_mfma_f32_32x32x16_bf16 a[0:15], a[72:75], a[64:67], a[0:15]
  v_exp_f32 v163, v163
  v_cvt_pk_bf16_f32 v208, v160, v161
  v_exp_f32 v164, v164
  v_exp_f32 v165, v165
  v_mfma_f32_32x32x16_bf16 a[16:31], a[72:75], a[68:71], a[16:31]
  v_cvt_pk_bf16_f32 v209, v162, v163
  v_exp_f32 v166, v166
  v_exp_f32 v167, v167
  v_mfma_f32_32x32x16_bf16 v[144:159], v[28:31], v[24:27], v[240:255]
  v_cvt_pk_bf16_f32 v210, v164, v165
  v_exp_f32 v168, v168
  v_exp_f32 v169, v169
  v_cvt_pk_bf16_f32 v211, v166, v167
  v_mfma_f32_32x32x16_bf16 a[32:47], a[76:79], a[64:67], a[32:47]
  v_exp_f32 v170, v170
  v_exp_f32 v171, v171
  v_cvt_pk_bf16_f32 v212, v168, v169
  v_mfma_f32_32x32x16_bf16 v[64:79], v[36:39], v[192:195], v[64:79]
  v_exp_f32 v172, v172
  v_exp_f32 v173, v173
  v_cvt_pk_bf16_f32 v213, v170, v171
  v_exp_f32 v174, v174
  v_mfma_f32_32x32x16_bf16 a[48:63], a[76:79], a[68:71], a[48:63]
  buffer_load_dwordx4 a[64:67], v2, s[16:19], s83 offen sc1
  v_exp_f32 v175, v175
  v_cvt_pk_bf16_f32 v214, v172, v173
  v_cvt_pk_bf16_f32 v215, v174, v175
  s_waitcnt vmcnt(25)
  v_mfma_f32_32x32x16_bf16 a[0:15], a[88:91], a[80:83], a[0:15]
  buffer_load_dwordx4 a[72:75], v2, s[16:19], s73 offen sc1
  v_exp_f32 v176, v176
  v_exp_f32 v177, v177
  v_exp_f32 v178, v178
  v_mfma_f32_32x32x16_bf16 v[80:95], v[36:39], v[200:203], v[80:95]
  buffer_load_dwordx4 a[68:71], v54, s[16:19], s83 offen sc1
  v_exp_f32 v179, v179
  v_cvt_pk_bf16_f32 v216, v176, v177
  v_exp_f32 v180, v180
  v_exp_f32 v181, v181
  v_mfma_f32_32x32x16_bf16 a[16:31], a[88:91], a[84:87], a[16:31]
  buffer_load_dwordx4 a[76:79], v54, s[16:19], s73 offen sc1
  v_cvt_pk_bf16_f32 v217, v178, v179
  v_exp_f32 v182, v182
  v_exp_f32 v183, v183
  v_mfma_f32_32x32x16_bf16 v[64:79], v[40:43], v[196:199], v[64:79]
  v_cvt_pk_bf16_f32 v218, v180, v181
  v_exp_f32 v184, v184
  v_exp_f32 v185, v185
  v_cvt_pk_bf16_f32 v219, v182, v183
  v_mfma_f32_32x32x16_bf16 a[32:47], a[92:95], a[80:83], a[32:47]
  v_exp_f32 v186, v186
  v_exp_f32 v187, v187
  v_cvt_pk_bf16_f32 v220, v184, v185
  v_mfma_f32_32x32x16_bf16 v[80:95], v[40:43], v[204:207], v[80:95]
  v_exp_f32 v188, v188
  v_exp_f32 v189, v189
  v_cvt_pk_bf16_f32 v221, v186, v187
  v_exp_f32 v190, v190
  v_mfma_f32_32x32x16_bf16 a[48:63], a[92:95], a[84:87], a[48:63]
  buffer_load_dwordx4 a[80:83], v2, s[16:19], s83 offen offset:1024 sc1
  buffer_load_dwordx4 a[88:91], v2, s[16:19], s73 offen offset:1024 sc1
  buffer_load_dwordx4 a[84:87], v54, s[16:19], s83 offen offset:1024 sc1
  buffer_load_dwordx4 a[92:95], v54, s[16:19], s73 offen offset:1024 sc1
  v_exp_f32 v191, v191
  v_cvt_pk_bf16_f32 v222, v188, v189
  v_cvt_pk_bf16_f32 v223, v190, v191
  s_waitcnt lgkmcnt(0)
  v_mfma_f32_32x32x16_bf16 v[160:175], v[32:35], v[20:23], v[224:239]
  ds_read_b128 v[28:31], v3 offset:4096
  ds_read_b128 v[36:39], v4 offset:3072
  ds_read_b128 v[40:43], v4 offset:3584
  v_exp_f32 v128, v128
  v_exp_f32 v129, v129
  v_exp_f32 v130, v130
  v_exp_f32 v131, v131
  v_cvt_pk_bf16_f32 v192, v128, v129
  s_waitcnt vmcnt(28)
  v_mfma_f32_32x32x16_bf16 a[0:15], a[104:107], a[96:99], a[0:15]
  v_exp_f32 v132, v132
  v_exp_f32 v133, v133
  v_cvt_pk_bf16_f32 v193, v130, v131
  v_exp_f32 v134, v134
  v_exp_f32 v135, v135
  v_mfma_f32_32x32x16_bf16 v[176:191], v[32:35], v[24:27], v[240:255]
  v_cvt_pk_bf16_f32 v194, v132, v133
  v_exp_f32 v136, v136
  v_exp_f32 v137, v137
  v_cvt_pk_bf16_f32 v195, v134, v135
  v_mfma_f32_32x32x16_bf16 a[16:31], a[104:107], a[100:103], a[16:31]
  v_exp_f32 v138, v138
  v_exp_f32 v139, v139
  v_cvt_pk_bf16_f32 v196, v136, v137
  v_exp_f32 v140, v140
  v_exp_f32 v141, v141
  v_mfma_f32_32x32x16_bf16 v[64:79], v[44:47], v[208:211], v[64:79]
  v_cvt_pk_bf16_f32 v197, v138, v139
  v_exp_f32 v142, v142
  v_exp_f32 v143, v143
  v_cvt_pk_bf16_f32 v198, v140, v141
  v_cvt_pk_bf16_f32 v199, v142, v143
  v_mfma_f32_32x32x16_bf16 a[32:47], a[108:111], a[96:99], a[32:47]
  v_exp_f32 v144, v144
  v_exp_f32 v145, v145
  v_exp_f32 v146, v146
  v_exp_f32 v147, v147
  v_cvt_pk_bf16_f32 v200, v144, v145
  v_mfma_f32_32x32x16_bf16 v[80:95], v[44:47], v[216:219], v[80:95]
  v_exp_f32 v148, v148
  v_exp_f32 v149, v149
  v_cvt_pk_bf16_f32 v201, v146, v147
  v_exp_f32 v150, v150
  v_exp_f32 v151, v151
  v_mfma_f32_32x32x16_bf16 v[64:79], v[48:51], v[212:215], v[64:79]
  v_cvt_pk_bf16_f32 v202, v148, v149
  v_exp_f32 v152, v152
  v_exp_f32 v153, v153
  v_cvt_pk_bf16_f32 v203, v150, v151
  v_mfma_f32_32x32x16_bf16 a[48:63], a[108:111], a[100:103], a[48:63]
  buffer_load_dwordx4 a[96:99], v2, s[16:19], s83 offen offset:2048 sc1
  buffer_load_dwordx4 a[104:107], v2, s[16:19], s73 offen offset:2048 sc1
  v_exp_f32 v154, v154
  v_exp_f32 v155, v155
  v_cvt_pk_bf16_f32 v204, v152, v153
  v_exp_f32 v156, v156
  v_exp_f32 v157, v157
  v_mfma_f32_32x32x16_bf16 v[80:95], v[48:51], v[220:223], v[80:95]
  buffer_load_dwordx4 a[100:103], v54, s[16:19], s83 offen offset:2048 sc1
  buffer_load_dwordx4 a[108:111], v54, s[16:19], s73 offen offset:2048 sc1
  v_cvt_pk_bf16_f32 v205, v154, v155
  v_exp_f32 v158, v158
  v_exp_f32 v159, v159
  v_cvt_pk_bf16_f32 v206, v156, v157
  v_cvt_pk_bf16_f32 v207, v158, v159
  v_add_u32 v3, 4096, v3
  v_add_u32 v4, v4, v5
  s_waitcnt lgkmcnt(0)
  v_mfma_f32_32x32x16_bf16 v[128:143], v[28:31], v[20:23], v[224:239]
  ds_read_b128 v[32:35], v3 offset:1024
  ds_read_b128 v[44:47], v4
  ds_read_b128 v[48:51], v4 offset:512
  v_exp_f32 v160, v160
  v_exp_f32 v161, v161
  v_exp_f32 v162, v162
  s_waitcnt vmcnt(28)
  v_mfma_f32_32x32x16_bf16 a[0:15], a[120:123], a[112:115], a[0:15]
  v_exp_f32 v163, v163
  v_cvt_pk_bf16_f32 v208, v160, v161
  v_exp_f32 v164, v164
  v_exp_f32 v165, v165
  v_mfma_f32_32x32x16_bf16 a[16:31], a[120:123], a[116:119], a[16:31]
  v_cvt_pk_bf16_f32 v209, v162, v163
  v_exp_f32 v166, v166
  v_exp_f32 v167, v167
  v_mfma_f32_32x32x16_bf16 v[144:159], v[28:31], v[24:27], v[240:255]
  v_cvt_pk_bf16_f32 v210, v164, v165
  v_exp_f32 v168, v168
  v_exp_f32 v169, v169
  v_cvt_pk_bf16_f32 v211, v166, v167
  v_mfma_f32_32x32x16_bf16 a[32:47], a[124:127], a[112:115], a[32:47]
  v_exp_f32 v170, v170
  v_exp_f32 v171, v171
  v_cvt_pk_bf16_f32 v212, v168, v169
  v_mfma_f32_32x32x16_bf16 v[64:79], v[36:39], v[192:195], v[64:79]
  v_exp_f32 v172, v172
  v_exp_f32 v173, v173
  v_cvt_pk_bf16_f32 v213, v170, v171
  v_exp_f32 v174, v174
  v_mfma_f32_32x32x16_bf16 a[48:63], a[124:127], a[116:119], a[48:63]
  buffer_load_dwordx4 a[112:115], v2, s[16:19], s83 offen offset:3072 sc1
  v_exp_f32 v175, v175
  v_cvt_pk_bf16_f32 v214, v172, v173
  v_cvt_pk_bf16_f32 v215, v174, v175
  s_waitcnt vmcnt(25)
  v_mfma_f32_32x32x16_bf16 a[0:15], a[136:139], a[128:131], a[0:15]
  buffer_load_dwordx4 a[120:123], v2, s[16:19], s73 offen offset:3072 sc1
  v_exp_f32 v176, v176
  v_exp_f32 v177, v177
  v_exp_f32 v178, v178
  v_mfma_f32_32x32x16_bf16 v[80:95], v[36:39], v[200:203], v[80:95]
  buffer_load_dwordx4 a[116:119], v54, s[16:19], s83 offen offset:3072 sc1
  v_exp_f32 v179, v179
  v_cvt_pk_bf16_f32 v216, v176, v177
  v_exp_f32 v180, v180
  v_exp_f32 v181, v181
  v_mfma_f32_32x32x16_bf16 a[16:31], a[136:139], a[132:135], a[16:31]
  buffer_load_dwordx4 a[124:127], v54, s[16:19], s73 offen offset:3072 sc1
  v_cvt_pk_bf16_f32 v217, v178, v179
  v_exp_f32 v182, v182
  v_exp_f32 v183, v183
  v_mfma_f32_32x32x16_bf16 v[64:79], v[40:43], v[196:199], v[64:79]
  s_add_u32 s83, s83, 4096
  v_cvt_pk_bf16_f32 v218, v180, v181
  v_exp_f32 v184, v184
  v_exp_f32 v185, v185
  v_cvt_pk_bf16_f32 v219, v182, v183
  v_mfma_f32_32x32x16_bf16 a[32:47], a[140:143], a[128:131], a[32:47]
  s_add_u32 s73, s73, 4096
  v_exp_f32 v186, v186
  v_exp_f32 v187, v187
  v_cvt_pk_bf16_f32 v220, v184, v185
  v_mfma_f32_32x32x16_bf16 v[80:95], v[40:43], v[204:207], v[80:95]
  v_exp_f32 v188, v188
  v_exp_f32 v189, v189
  v_cvt_pk_bf16_f32 v221, v186, v187
  v_exp_f32 v190, v190
  v_mfma_f32_32x32x16_bf16 a[48:63], a[140:143], a[132:135], a[48:63]
  buffer_load_dwordx4 a[128:131], v2, s[16:19], s83 offen sc1
  buffer_load_dwordx4 a[136:139], v2, s[16:19], s73 offen sc1
  buffer_load_dwordx4 a[132:135], v54, s[16:19], s83 offen sc1
  buffer_load_dwordx4 a[140:143], v54, s[16:19], s73 offen sc1
  v_exp_f32 v191, v191
  v_cvt_pk_bf16_f32 v222, v188, v189
  v_cvt_pk_bf16_f32 v223, v190, v191
  s_waitcnt lgkmcnt(0)
  v_mfma_f32_32x32x16_bf16 v[160:175], v[32:35], v[20:23], v[224:239]
  ds_read_b128 v[28:31], v3 offset:2048
  ds_read_b128 v[36:39], v4 offset:1024
  ds_read_b128 v[40:43], v4 offset:1536
  v_exp_f32 v128, v128
  v_exp_f32 v129, v129
  v_exp_f32 v130, v130
  v_exp_f32 v131, v131
  v_cvt_pk_bf16_f32 v192, v128, v129
  s_waitcnt vmcnt(28)
  v_mfma_f32_32x32x16_bf16 a[0:15], a[152:155], a[144:147], a[0:15]
  v_exp_f32 v132, v132
  v_exp_f32 v133, v133
  v_cvt_pk_bf16_f32 v193, v130, v131
  v_exp_f32 v134, v134
  v_exp_f32 v135, v135
  v_mfma_f32_32x32x16_bf16 v[176:191], v[32:35], v[24:27], v[240:255]
  v_cvt_pk_bf16_f32 v194, v132, v133
  v_exp_f32 v136, v136
  v_exp_f32 v137, v137
  v_cvt_pk_bf16_f32 v195, v134, v135
  v_mfma_f32_32x32x16_bf16 a[16:31], a[152:155], a[148:151], a[16:31]
  v_exp_f32 v138, v138
  v_exp_f32 v139, v139
  v_cvt_pk_bf16_f32 v196, v136, v137
  v_exp_f32 v140, v140
  v_exp_f32 v141, v141
  v_mfma_f32_32x32x16_bf16 v[64:79], v[44:47], v[208:211], v[64:79]
  v_cvt_pk_bf16_f32 v197, v138, v139
  v_exp_f32 v142, v142
  v_exp_f32 v143, v143
  v_cvt_pk_bf16_f32 v198, v140, v141
  v_cvt_pk_bf16_f32 v199, v142, v143
  v_mfma_f32_32x32x16_bf16 a[32:47], a[156:159], a[144:147], a[32:47]
  v_exp_f32 v144, v144
  v_exp_f32 v145, v145
  v_exp_f32 v146, v146
  v_exp_f32 v147, v147
  v_cvt_pk_bf16_f32 v200, v144, v145
  v_mfma_f32_32x32x16_bf16 v[80:95], v[44:47], v[216:219], v[80:95]
  v_exp_f32 v148, v148
  v_exp_f32 v149, v149
  v_cvt_pk_bf16_f32 v201, v146, v147
  v_exp_f32 v150, v150
  v_exp_f32 v151, v151
  v_mfma_f32_32x32x16_bf16 v[64:79], v[48:51], v[212:215], v[64:79]
  v_cvt_pk_bf16_f32 v202, v148, v149
  v_exp_f32 v152, v152
  v_exp_f32 v153, v153
  v_cvt_pk_bf16_f32 v203, v150, v151
  v_mfma_f32_32x32x16_bf16 a[48:63], a[156:159], a[148:151], a[48:63]
  buffer_load_dwordx4 a[144:147], v2, s[16:19], s83 offen offset:1024 sc1
  buffer_load_dwordx4 a[152:155], v2, s[16:19], s73 offen offset:1024 sc1
  v_exp_f32 v154, v154
  v_exp_f32 v155, v155
  v_cvt_pk_bf16_f32 v204, v152, v153
  v_exp_f32 v156, v156
  v_exp_f32 v157, v157
  v_mfma_f32_32x32x16_bf16 v[80:95], v[48:51], v[220:223], v[80:95]
  buffer_load_dwordx4 a[148:151], v54, s[16:19], s83 offen offset:1024 sc1
  buffer_load_dwordx4 a[156:159], v54, s[16:19], s73 offen offset:1024 sc1
  v_cvt_pk_bf16_f32 v205, v154, v155
  v_exp_f32 v158, v158
  v_exp_f32 v159, v159
  v_cvt_pk_bf16_f32 v206, v156, v157
  v_cvt_pk_bf16_f32 v207, v158, v159
  s_waitcnt lgkmcnt(0)
  v_mfma_f32_32x32x16_bf16 v[128:143], v[28:31], v[20:23], v[224:239]
  ds_read_b128 v[32:35], v3 offset:3072
  ds_read_b128 v[44:47], v4 offset:2048
  ds_read_b128 v[48:51], v4 offset:2560
  v_exp_f32 v160, v160
  v_exp_f32 v161, v161
  v_exp_f32 v162, v162
  s_waitcnt vmcnt(28)
  v_mfma_f32_32x32x16_bf16 a[0:15], a[168:171], a[160:163], a[0:15]
  v_exp_f32 v163, v163
  v_cvt_pk_bf16_f32 v208, v160, v161
  v_exp_f32 v164, v164
  v_exp_f32 v165, v165
  v_mfma_f32_32x32x16_bf16 a[16:31], a[168:171], a[164:167], a[16:31]
  v_cvt_pk_bf16_f32 v209, v162, v163
  v_exp_f32 v166, v166
  v_exp_f32 v167, v167
  v_mfma_f32_32x32x16_bf16 v[144:159], v[28:31], v[24:27], v[240:255]
  v_cvt_pk_bf16_f32 v210, v164, v165
  v_exp_f32 v168, v168
  v_exp_f32 v169, v169
  v_cvt_pk_bf16_f32 v211, v166, v167
  v_mfma_f32_32x32x16_bf16 a[32:47], a[172:175], a[160:163], a[32:47]
  v_exp_f32 v170, v170
  v_exp_f32 v171, v171
  v_cvt_pk_bf16_f32 v212, v168, v169
  v_mfma_f32_32x32x16_bf16 v[64:79], v[36:39], v[192:195], v[64:79]
  v_exp_f32 v172, v172
  v_exp_f32 v173, v173
  v_cvt_pk_bf16_f32 v213, v170, v171
  v_exp_f32 v174, v174
  v_mfma_f32_32x32x16_bf16 a[48:63], a[172:175], a[164:167], a[48:63]
  buffer_load_dwordx4 a[160:163], v2, s[16:19], s83 offen offset:2048 sc1
  v_exp_f32 v175, v175
  v_cvt_pk_bf16_f32 v214, v172, v173
  v_cvt_pk_bf16_f32 v215, v174, v175
  s_waitcnt vmcnt(25)
  v_mfma_f32_32x32x16_bf16 a[0:15], a[184:187], a[176:179], a[0:15]
  buffer_load_dwordx4 a[168:171], v2, s[16:19], s73 offen offset:2048 sc1
  v_exp_f32 v176, v176
  v_exp_f32 v177, v177
  v_exp_f32 v178, v178
  v_mfma_f32_32x32x16_bf16 v[80:95], v[36:39], v[200:203], v[80:95]
  buffer_load_dwordx4 a[164:167], v54, s[16:19], s83 offen offset:2048 sc1
  v_exp_f32 v179, v179
  v_cvt_pk_bf16_f32 v216, v176, v177
  v_exp_f32 v180, v180
  v_exp_f32 v181, v181
  v_mfma_f32_32x32x16_bf16 a[16:31], a[184:187], a[180:183], a[16:31]
  buffer_load_dwordx4 a[172:175], v54, s[16:19], s73 offen offset:2048 sc1
  v_cvt_pk_bf16_f32 v217, v178, v179
  v_exp_f32 v182, v182
  v_exp_f32 v183, v183
  v_mfma_f32_32x32x16_bf16 v[64:79], v[40:43], v[196:199], v[64:79]
  v_cvt_pk_bf16_f32 v218, v180, v181
  v_exp_f32 v184, v184
  v_exp_f32 v185, v185
  v_cvt_pk_bf16_f32 v219, v182, v183
  v_mfma_f32_32x32x16_bf16 a[32:47], a[188:191], a[176:179], a[32:47]
  v_exp_f32 v186, v186
  v_exp_f32 v187, v187
  v_cvt_pk_bf16_f32 v220, v184, v185
  v_mfma_f32_32x32x16_bf16 v[80:95], v[40:43], v[204:207], v[80:95]
  v_exp_f32 v188, v188
  v_exp_f32 v189, v189
  v_cvt_pk_bf16_f32 v221, v186, v187
  v_exp_f32 v190, v190
  v_mfma_f32_32x32x16_bf16 a[48:63], a[188:191], a[180:183], a[48:63]
  buffer_load_dwordx4 a[176:179], v2, s[16:19], s83 offen offset:3072 sc1
  buffer_load_dwordx4 a[184:187], v2, s[16:19], s73 offen offset:3072 sc1
  buffer_load_dwordx4 a[180:183], v54, s[16:19], s83 offen offset:3072 sc1
  buffer_load_dwordx4 a[188:191], v54, s[16:19], s73 offen offset:3072 sc1
  s_add_u32 s83, s83, 4096
  s_add_u32 s73, s73, 4096
  v_exp_f32 v191, v191
  v_cvt_pk_bf16_f32 v222, v188, v189
  v_cvt_pk_bf16_f32 v223, v190, v191
  s_waitcnt lgkmcnt(0)
  v_mfma_f32_32x32x16_bf16 v[160:175], v[32:35], v[20:23], v[224:239]
  ds_read_b128 v[28:31], v3 offset:4096
  ds_read_b128 v[36:39], v4 offset:3072
  ds_read_b128 v[40:43], v4 offset:3584
  v_exp_f32 v128, v128
  v_exp_f32 v129, v129
  v_exp_f32 v130, v130
  v_exp_f32 v131, v131
  v_cvt_pk_bf16_f32 v192, v128, v129
  s_waitcnt vmcnt(28)
  v_mfma_f32_32x32x16_bf16 a[0:15], a[72:75], a[64:67], a[0:15]
  v_exp_f32 v132, v132
  v_exp_f32 v133, v133
  v_cvt_pk_bf16_f32 v193, v130, v131
  v_exp_f32 v134, v134
  v_exp_f32 v135, v135
  v_mfma_f32_32x32x16_bf16 v[176:191], v[32:35], v[24:27], v[240:255]
  v_cvt_pk_bf16_f32 v194, v132, v133
  v_exp_f32 v136, v136
  v_exp_f32 v137, v137
  v_cvt_pk_bf16_f32 v195, v134, v135
  v_mfma_f32_32x32x16_bf16 a[16:31], a[72:75], a[68:71], a[16:31]
  v_exp_f32 v138, v138
  v_exp_f32 v139, v139
  v_cvt_pk_bf16_f32 v196, v136, v137
  v_exp_f32 v140, v140
  v_exp_f32 v141, v141
  v_mfma_f32_32x32x16_bf16 v[64:79], v[44:47], v[208:211], v[64:79]
  v_cvt_pk_bf16_f32 v197, v138, v139
  v_exp_f32 v142, v142
  v_exp_f32 v143, v143
  v_cvt_pk_bf16_f32 v198, v140, v141
  v_cvt_pk_bf16_f32 v199, v142, v143
  v_mfma_f32_32x32x16_bf16 a[32:47], a[76:79], a[64:67], a[32:47]
  v_exp_f32 v144, v144
  v_exp_f32 v145, v145
  v_exp_f32 v146, v146
  v_exp_f32 v147, v147
  v_cvt_pk_bf16_f32 v200, v144, v145
  v_mfma_f32_32x32x16_bf16 v[80:95], v[44:47], v[216:219], v[80:95]
  v_exp_f32 v148, v148
  v_exp_f32 v149, v149
  v_cvt_pk_bf16_f32 v201, v146, v147
  v_exp_f32 v150, v150
  v_exp_f32 v151, v151
  v_mfma_f32_32x32x16_bf16 v[64:79], v[48:51], v[212:215], v[64:79]
  v_cvt_pk_bf16_f32 v202, v148, v149
  v_exp_f32 v152, v152
  v_exp_f32 v153, v153
  v_cvt_pk_bf16_f32 v203, v150, v151
  v_mfma_f32_32x32x16_bf16 a[48:63], a[76:79], a[68:71], a[48:63]
  buffer_load_dwordx4 a[64:67], v2, s[16:19], s83 offen sc1
  buffer_load_dwordx4 a[72:75], v2, s[16:19], s73 offen sc1
  v_exp_f32 v154, v154
  v_exp_f32 v155, v155
  v_cvt_pk_bf16_f32 v204, v152, v153
  v_exp_f32 v156, v156
  v_exp_f32 v157, v157
  v_mfma_f32_32x32x16_bf16 v[80:95], v[48:51], v[220:223], v[80:95]
  buffer_load_dwordx4 a[68:71], v54, s[16:19], s83 offen sc1
  buffer_load_dwordx4 a[76:79], v54, s[16:19], s73 offen sc1
  v_cvt_pk_bf16_f32 v205, v154, v155
  v_exp_f32 v158, v158
  v_exp_f32 v159, v159
  v_cvt_pk_bf16_f32 v206, v156, v157
  v_cvt_pk_bf16_f32 v207, v158, v159
  v_add_u32 v3, 4096, v3
  v_add_u32 v4, v4, v5
  s_waitcnt lgkmcnt(0)
  v_mfma_f32_32x32x16_bf16 v[128:143], v[28:31], v[20:23], v[224:239]
  ds_read_b128 v[32:35], v3 offset:1024
  ds_read_b128 v[44:47], v4
  ds_read_b128 v[48:51], v4 offset:512
  v_exp_f32 v160, v160
  v_exp_f32 v161, v161
  v_exp_f32 v162, v162
  v_exp_f32 v163, v163
  v_cvt_pk_bf16_f32 v208, v160, v161
  s_waitcnt vmcnt(28)
  v_mfma_f32_32x32x16_bf16 a[0:15], a[88:91], a[80:83], a[0:15]
  v_exp_f32 v164, v164
  v_exp_f32 v165, v165
  v_cvt_pk_bf16_f32 v209, v162, v163
  v_exp_f32 v166, v166
  v_exp_f32 v167, v167
  v_mfma_f32_32x32x16_bf16 v[144:159], v[28:31], v[24:27], v[240:255]
  v_cvt_pk_bf16_f32 v210, v164, v165
  v_exp_f32 v168, v168
  v_exp_f32 v169, v169
  v_cvt_pk_bf16_f32 v211, v166, v167
  v_mfma_f32_32x32x16_bf16 a[16:31], a[88:91], a[84:87], a[16:31]
  v_exp_f32 v170, v170
  v_exp_f32 v171, v171
  v_cvt_pk_bf16_f32 v212, v168, v169
  v_exp_f32 v172, v172
  v_exp_f32 v173, v173
  v_mfma_f32_32x32x16_bf16 v[64:79], v[36:39], v[192:195], v[64:79]
  v_cvt_pk_bf16_f32 v213, v170, v171
  v_exp_f32 v174, v174
  v_exp_f32 v175, v175
  v_cvt_pk_bf16_f32 v214, v172, v173
  v_cvt_pk_bf16_f32 v215, v174, v175
  v_mfma_f32_32x32x16_bf16 a[32:47], a[92:95], a[80:83], a[32:47]
  v_exp_f32 v176, v176
  v_exp_f32 v177, v177
  v_exp_f32 v178, v178
  v_exp_f32 v179, v179
  v_cvt_pk_bf16_f32 v216, v176, v177
  v_mfma_f32_32x32x16_bf16 v[80:95], v[36:39], v[200:203], v[80:95]
  v_exp_f32 v180, v180
  v_exp_f32 v181, v181
  v_cvt_pk_bf16_f32 v217, v178, v179
  v_exp_f32 v182, v182
  v_exp_f32 v183, v183
  v_mfma_f32_32x32x16_bf16 v[64:79], v[40:43], v[196:199], v[64:79]
  v_cvt_pk_bf16_f32 v218, v180, v181
  v_exp_f32 v184, v184
  v_exp_f32 v185, v185
  v_cvt_pk_bf16_f32 v219, v182, v183
  v_mfma_f32_32x32x16_bf16 a[48:63], a[92:95], a[84:87], a[48:63]
  buffer_load_dwordx4 a[80:83], v2, s[16:19], s83 offen offset:1024 sc1
  buffer_load_dwordx4 a[88:91], v2, s[16:19], s73 offen offset:1024 sc1
  v_exp_f32 v186, v186
  v_exp_f32 v187, v187
  v_cvt_pk_bf16_f32 v220, v184, v185
  v_exp_f32 v188, v188
  v_exp_f32 v189, v189
  v_mfma_f32_32x32x16_bf16 v[80:95], v[40:43], v[204:207], v[80:95]
  buffer_load_dwordx4 a[84:87], v54, s[16:19], s83 offen offset:1024 sc1
  buffer_load_dwordx4 a[92:95], v54, s[16:19], s73 offen offset:1024 sc1
  v_cvt_pk_bf16_f32 v221, v186, v187
  v_exp_f32 v190, v190
  v_exp_f32 v191, v191
  v_cvt_pk_bf16_f32 v222, v188, v189
  v_cvt_pk_bf16_f32 v223, v190, v191
  s_waitcnt lgkmcnt(0)
  v_mfma_f32_32x32x16_bf16 v[160:175], v[32:35], v[20:23], v[224:239]
  ds_read_b128 v[28:31], v3 offset:2048
  ds_read_b128 v[36:39], v4 offset:1024
  ds_read_b128 v[40:43], v4 offset:1536
  v_exp_f32 v128, v128
  v_exp_f32 v129, v129
  v_exp_f32 v130, v130
  s_waitcnt vmcnt(28)
  v_mfma_f32_32x32x16_bf16 a[0:15], a[104:107], a[96:99], a[0:15]
  v_exp_f32 v131, v131
  v_cvt_pk_bf16_f32 v192, v128, v129
  v_exp_f32 v132, v132
  v_exp_f32 v133, v133
  v_mfma_f32_32x32x16_bf16 a[16:31], a[104:107], a[100:103], a[16:31]
  v_cvt_pk_bf16_f32 v193, v130, v131
  v_exp_f32 v134, v134
  v_exp_f32 v135, v135
  v_mfma_f32_32x32x16_bf16 v[176:191], v[32:35], v[24:27], v[240:255]
  v_cvt_pk_bf16_f32 v194, v132, v133
  v_exp_f32 v136, v136
  v_exp_f32 v137, v137
  v_cvt_pk_bf16_f32 v195, v134, v135
  v_mfma_f32_32x32x16_bf16 a[32:47], a[108:111], a[96:99], a[32:47]
  v_exp_f32 v138, v138
  v_exp_f32 v139, v139
  v_cvt_pk_bf16_f32 v196, v136, v137
  v_mfma_f32_32x32x16_bf16 v[64:79], v[44:47], v[208:211], v[64:79]
  v_exp_f32 v140, v140
  v_exp_f32 v141, v141
  v_cvt_pk_bf16_f32 v197, v138, v139
  v_exp_f32 v142, v142
  v_mfma_f32_32x32x16_bf16 a[48:63], a[108:111], a[100:103], a[48:63]
  buffer_load_dwordx4 a[96:99], v2, s[16:19], s83 offen offset:2048 sc1
  v_exp_f32 v143, v143
  v_cvt_pk_bf16_f32 v198, v140, v141
  v_cvt_pk_bf16_f32 v199, v142, v143
  s_waitcnt vmcnt(25)
  v_mfma_f32_32x32x16_bf16 a[0:15], a[120:123], a[112:115], a[0:15]
  buffer_load_dwordx4 a[104:107], v2, s[16:19], s73 offen offset:2048 sc1
  v_exp_f32 v144, v144
  v_exp_f32 v145, v145
  v_exp_f32 v146, v146
  v_mfma_f32_32x32x16_bf16 v[80:95], v[44:47], v[216:219], v[80:95]
  buffer_load_dwordx4 a[100:103], v54, s[16:19], s83 offen offset:2048 sc1
  v_exp_f32 v147, v147
  v_cvt_pk_bf16_f32 v200, v144, v145
  v_exp_f32 v148, v148
  v_exp_f32 v149, v149
  v_mfma_f32_32x32x16_bf16 a[16:31], a[120:123], a[116:119], a[16:31]
  buffer_load_dwordx4 a[108:111], v54, s[16:19], s73 offen offset:2048 sc1
  v_cvt_pk_bf16_f32 v201, v146, v147
  v_exp_f32 v150, v150
  v_exp_f32 v151, v151
  v_mfma_f32_32x32x16_bf16 v[64:79], v[48:51], v[212:215], v[64:79]
  v_cvt_pk_bf16_f32 v202, v148, v149
  v_exp_f32 v152, v152
  v_exp_f32 v153, v153
  v_cvt_pk_bf16_f32 v203, v150, v151
  v_mfma_f32_32x32x16_bf16 a[32:47], a[124:127], a[112:115], a[32:47]
  v_exp_f32 v154, v154
  v_exp_f32 v155, v155
  v_cvt_pk_bf16_f32 v204, v152, v153
  v_mfma_f32_32x32x16_bf16 v[80:95], v[48:51], v[220:223], v[80:95]
  v_exp_f32 v156, v156
  v_exp_f32 v157, v157
  v_cvt_pk_bf16_f32 v205, v154, v155
  v_exp_f32 v158, v158
  v_mfma_f32_32x32x16_bf16 a[48:63], a[124:127], a[116:119], a[48:63]
  buffer_load_dwordx4 a[112:115], v2, s[16:19], s83 offen offset:3072 sc1
  buffer_load_dwordx4 a[120:123], v2, s[16:19], s73 offen offset:3072 sc1
  buffer_load_dwordx4 a[116:119], v54, s[16:19], s83 offen offset:3072 sc1
  buffer_load_dwordx4 a[124:127], v54, s[16:19], s73 offen offset:3072 sc1
  s_add_u32 s83, s83, 4096
  s_add_u32 s73, s73, 4096
  v_exp_f32 v159, v159
  v_cvt_pk_bf16_f32 v206, v156, v157
  v_cvt_pk_bf16_f32 v207, v158, v159
  s_waitcnt lgkmcnt(0)
  v_mfma_f32_32x32x16_bf16 v[128:143], v[28:31], v[20:23], v[224:239]
  ds_read_b128 v[32:35], v3 offset:3072
  ds_read_b128 v[44:47], v4 offset:2048
  ds_read_b128 v[48:51], v4 offset:2560
  v_exp_f32 v160, v160
  v_exp_f32 v161, v161
  v_exp_f32 v162, v162
  v_exp_f32 v163, v163
  v_cvt_pk_bf16_f32 v208, v160, v161
  s_waitcnt vmcnt(28)
  v_mfma_f32_32x32x16_bf16 a[0:15], a[136:139], a[128:131], a[0:15]
  v_exp_f32 v164, v164
  v_exp_f32 v165, v165
  v_cvt_pk_bf16_f32 v209, v162, v163
  v_exp_f32 v166, v166
  v_exp_f32 v167, v167
  v_mfma_f32_32x32x16_bf16 v[144:159], v[28:31], v[24:27], v[240:255]
  v_cvt_pk_bf16_f32 v210, v164, v165
  v_exp_f32 v168, v168
  v_exp_f32 v169, v169
  v_cvt_pk_bf16_f32 v211, v166, v167
  v_mfma_f32_32x32x16_bf16 a[16:31], a[136:139], a[132:135], a[16:31]
  v_exp_f32 v170, v170
  v_exp_f32 v171, v171
  v_cvt_pk_bf16_f32 v212, v168, v169
  v_exp_f32 v172, v172
  v_exp_f32 v173, v173
  v_mfma_f32_32x32x16_bf16 v[64:79], v[36:39], v[192:195], v[64:79]
  v_cvt_pk_bf16_f32 v213, v170, v171
  v_exp_f32 v174, v174
  v_exp_f32 v175, v175
  v_cvt_pk_bf16_f32 v214, v172, v173
  v_cvt_pk_bf16_f32 v215, v174, v175
  v_mfma_f32_32x32x16_bf16 a[32:47], a[140:143], a[128:131], a[32:47]
  v_exp_f32 v176, v176
  v_exp_f32 v177, v177
  v_exp_f32 v178, v178
  v_exp_f32 v179, v179
  v_cvt_pk_bf16_f32 v216, v176, v177
  v_mfma_f32_32x32x16_bf16 v[80:95], v[36:39], v[200:203], v[80:95]
  v_exp_f32 v180, v180
  v_exp_f32 v181, v181
  v_cvt_pk_bf16_f32 v217, v178, v179
  v_exp_f32 v182, v182
  v_exp_f32 v183, v183
  v_mfma_f32_32x32x16_bf16 v[64:79], v[40:43], v[196:199], v[64:79]
  v_cvt_pk_bf16_f32 v218, v180, v181
  v_exp_f32 v184, v184
  v_exp_f32 v185, v185
  v_cvt_pk_bf16_f32 v219, v182, v183
  v_mfma_f32_32x32x16_bf16 a[48:63], a[140:143], a[132:135], a[48:63]
  buffer_load_dwordx4 a[128:131], v2, s[16:19], s83 offen sc1
  buffer_load_dwordx4 a[136:139], v2, s[16:19], s73 offen sc1
  v_exp_f32 v186, v186
  v_exp_f32 v187, v187
  v_cvt_pk_bf16_f32 v220, v184, v185
  v_exp_f32 v188, v188
  v_exp_f32 v189, v189
  v_mfma_f32_32x32x16_bf16 v[80:95], v[40:43], v[204:207], v[80:95]
  buffer_load_dwordx4 a[132:135], v54, s[16:19], s83 offen sc1
  buffer_load_dwordx4 a[140:143], v54, s[16:19], s73 offen sc1
  v_cvt_pk_bf16_f32 v221, v186, v187
  v_exp_f32 v190, v190
  v_exp_f32 v191, v191
  v_cvt_pk_bf16_f32 v222, v188, v189
  v_cvt_pk_bf16_f32 v223, v190, v191
  s_waitcnt lgkmcnt(0)
  v_mfma_f32_32x32x16_bf16 v[160:175], v[32:35], v[20:23], v[224:239]
  ds_read_b128 v[28:31], v3 offset:4096
  ds_read_b128 v[36:39], v4 offset:3072
  ds_read_b128 v[40:43], v4 offset:3584
  v_exp_f32 v128, v128
  v_exp_f32 v129, v129
  v_exp_f32 v130, v130
  s_waitcnt vmcnt(28)
  v_mfma_f32_32x32x16_bf16 a[0:15], a[152:155], a[144:147], a[0:15]
  v_exp_f32 v131, v131
  v_cvt_pk_bf16_f32 v192, v128, v129
  v_exp_f32 v132, v132
  v_exp_f32 v133, v133
  v_mfma_f32_32x32x16_bf16 a[16:31], a[152:155], a[148:151], a[16:31]
  v_cvt_pk_bf16_f32 v193, v130, v131
  v_exp_f32 v134, v134
  v_exp_f32 v135, v135
  v_mfma_f32_32x32x16_bf16 v[176:191], v[32:35], v[24:27], v[240:255]
  v_cvt_pk_bf16_f32 v194, v132, v133
  v_exp_f32 v136, v136
  v_exp_f32 v137, v137
  v_cvt_pk_bf16_f32 v195, v134, v135
  v_mfma_f32_32x32x16_bf16 a[32:47], a[156:159], a[144:147], a[32:47]
  v_exp_f32 v138, v138
  v_exp_f32 v139, v139
  v_cvt_pk_bf16_f32 v196, v136, v137
  v_mfma_f32_32x32x16_bf16 v[64:79], v[44:47], v[208:211], v[64:79]
  v_exp_f32 v140, v140
  v_exp_f32 v141, v141
  v_cvt_pk_bf16_f32 v197, v138, v139
  v_exp_f32 v142, v142
  v_mfma_f32_32x32x16_bf16 a[48:63], a[156:159], a[148:151], a[48:63]
  buffer_load_dwordx4 a[144:147], v2, s[16:19], s83 offen offset:1024 sc1
  v_exp_f32 v143, v143
  v_cvt_pk_bf16_f32 v198, v140, v141
  v_cvt_pk_bf16_f32 v199, v142, v143
  s_waitcnt vmcnt(25)
  v_mfma_f32_32x32x16_bf16 a[0:15], a[168:171], a[160:163], a[0:15]
  buffer_load_dwordx4 a[152:155], v2, s[16:19], s73 offen offset:1024 sc1
  v_exp_f32 v144, v144
  v_exp_f32 v145, v145
  v_exp_f32 v146, v146
  v_mfma_f32_32x32x16_bf16 v[80:95], v[44:47], v[216:219], v[80:95]
  buffer_load_dwordx4 a[148:151], v54, s[16:19], s83 offen offset:1024 sc1
  v_exp_f32 v147, v147
  v_cvt_pk_bf16_f32 v200, v144, v145
  v_exp_f32 v148, v148
  v_exp_f32 v149, v149
  v_mfma_f32_32x32x16_bf16 a[16:31], a[168:171], a[164:167], a[16:31]
  buffer_load_dwordx4 a[156:159], v54, s[16:19], s73 offen offset:1024 sc1
  v_cvt_pk_bf16_f32 v201, v146, v147
  v_exp_f32 v150, v150
  v_exp_f32 v151, v151
  v_mfma_f32_32x32x16_bf16 v[64:79], v[48:51], v[212:215], v[64:79]
  v_cvt_pk_bf16_f32 v202, v148, v149
  v_exp_f32 v152, v152
  v_exp_f32 v153, v153
  v_cvt_pk_bf16_f32 v203, v150, v151
  v_mfma_f32_32x32x16_bf16 a[32:47], a[172:175], a[160:163], a[32:47]
  v_exp_f32 v154, v154
  v_exp_f32 v155, v155
  v_cvt_pk_bf16_f32 v204, v152, v153
  v_mfma_f32_32x32x16_bf16 v[80:95], v[48:51], v[220:223], v[80:95]
  v_exp_f32 v156, v156
  v_exp_f32 v157, v157
  v_cvt_pk_bf16_f32 v205, v154, v155
  v_exp_f32 v158, v158
  v_mfma_f32_32x32x16_bf16 a[48:63], a[172:175], a[164:167], a[48:63]
  buffer_load_dwordx4 a[160:163], v2, s[16:19], s83 offen offset:2048 sc1
  buffer_load_dwordx4 a[168:171], v2, s[16:19], s73 offen offset:2048 sc1
  buffer_load_dwordx4 a[164:167], v54, s[16:19], s83 offen offset:2048 sc1
  buffer_load_dwordx4 a[172:175], v54, s[16:19], s73 offen offset:2048 sc1
  v_exp_f32 v159, v159
  v_cvt_pk_bf16_f32 v206, v156, v157
  v_cvt_pk_bf16_f32 v207, v158, v159
  v_add_u32 v3, 4096, v3
  v_add_u32 v4, v4, v5
  s_waitcnt lgkmcnt(0)
  v_mfma_f32_32x32x16_bf16 v[128:143], v[28:31], v[20:23], v[224:239]
  ds_read_b128 v[32:35], v3 offset:1024
  ds_read_b128 v[44:47], v4
  ds_read_b128 v[48:51], v4 offset:512
  v_exp_f32 v160, v160
  v_exp_f32 v161, v161
  v_exp_f32 v162, v162
  v_exp_f32 v163, v163
  v_cvt_pk_bf16_f32 v208, v160, v161
  s_waitcnt vmcnt(28)
  v_mfma_f32_32x32x16_bf16 a[0:15], a[184:187], a[176:179], a[0:15]
  v_exp_f32 v164, v164
  v_exp_f32 v165, v165
  v_cvt_pk_bf16_f32 v209, v162, v163
  v_exp_f32 v166, v166
  v_exp_f32 v167, v167
  v_mfma_f32_32x32x16_bf16 v[144:159], v[28:31], v[24:27], v[240:255]
  v_cvt_pk_bf16_f32 v210, v164, v165
  v_exp_f32 v168, v168
  v_exp_f32 v169, v169
  v_cvt_pk_bf16_f32 v211, v166, v167
  v_mfma_f32_32x32x16_bf16 a[16:31], a[184:187], a[180:183], a[16:31]
  v_exp_f32 v170, v170
  v_exp_f32 v171, v171
  v_cvt_pk_bf16_f32 v212, v168, v169
  v_exp_f32 v172, v172
  v_exp_f32 v173, v173
  v_mfma_f32_32x32x16_bf16 v[64:79], v[36:39], v[192:195], v[64:79]
  v_cvt_pk_bf16_f32 v213, v170, v171
  v_exp_f32 v174, v174
  v_exp_f32 v175, v175
  v_cvt_pk_bf16_f32 v214, v172, v173
  v_cvt_pk_bf16_f32 v215, v174, v175
  v_mfma_f32_32x32x16_bf16 a[32:47], a[188:191], a[176:179], a[32:47]
  v_exp_f32 v176, v176
  v_exp_f32 v177, v177
  v_exp_f32 v178, v178
  v_exp_f32 v179, v179
  v_cvt_pk_bf16_f32 v216, v176, v177
  v_mfma_f32_32x32x16_bf16 v[80:95], v[36:39], v[200:203], v[80:95]
  v_exp_f32 v180, v180
  v_exp_f32 v181, v181
  v_cvt_pk_bf16_f32 v217, v178, v179
  v_exp_f32 v182, v182
  v_exp_f32 v183, v183
  v_mfma_f32_32x32x16_bf16 v[64:79], v[40:43], v[196:199], v[64:79]
  v_cvt_pk_bf16_f32 v218, v180, v181
  v_exp_f32 v184, v184
  v_exp_f32 v185, v185
  v_cvt_pk_bf16_f32 v219, v182, v183
  v_mfma_f32_32x32x16_bf16 a[48:63], a[188:191], a[180:183], a[48:63]
  buffer_load_dwordx4 a[176:179], v2, s[16:19], s83 offen offset:3072 sc1
  buffer_load_dwordx4 a[184:187], v2, s[16:19], s73 offen offset:3072 sc1
  buffer_load_dwordx4 a[180:183], v54, s[16:19], s83 offen offset:3072 sc1
  v_exp_f32 v186, v186
  v_exp_f32 v187, v187
  v_cvt_pk_bf16_f32 v220, v184, v185
  v_exp_f32 v188, v188
  v_exp_f32 v189, v189
  v_mfma_f32_32x32x16_bf16 v[80:95], v[40:43], v[204:207], v[80:95]
  buffer_load_dwordx4 a[188:191], v54, s[16:19], s73 offen offset:3072 sc1
  s_add_u32 s83, s83, 4096
  s_add_u32 s73, s73, 4096
  v_cvt_pk_bf16_f32 v221, v186, v187
  v_exp_f32 v190, v190
  v_exp_f32 v191, v191
  v_cvt_pk_bf16_f32 v222, v188, v189
  v_cvt_pk_bf16_f32 v223, v190, v191
  s_waitcnt lgkmcnt(0)
  v_mfma_f32_32x32x16_bf16 v[160:175], v[32:35], v[20:23], v[224:239]
  ds_read_b128 v[28:31], v3 offset:2048
  ds_read_b128 v[36:39], v4 offset:1024
  ds_read_b128 v[40:43], v4 offset:1536
  v_exp_f32 v128, v128
  v_exp_f32 v129, v129
  v_exp_f32 v130, v130
  s_waitcnt vmcnt(28)
  v_mfma_f32_32x32x16_bf16 a[0:15], a[72:75], a[64:67], a[0:15]
  v_exp_f32 v131, v131
  v_cvt_pk_bf16_f32 v192, v128, v129
  v_exp_f32 v132, v132
  v_exp_f32 v133, v133
  v_mfma_f32_32x32x16_bf16 a[16:31], a[72:75], a[68:71], a[16:31]
  v_cvt_pk_bf16_f32 v193, v130, v131
  v_exp_f32 v134, v134
  v_exp_f32 v135, v135
  v_mfma_f32_32x32x16_bf16 v[176:191], v[32:35], v[24:27], v[240:255]
  v_cvt_pk_bf16_f32 v194, v132, v133
  v_exp_f32 v136, v136
  v_exp_f32 v137, v137
  v_cvt_pk_bf16_f32 v195, v134, v135
  v_mfma_f32_32x32x16_bf16 a[32:47], a[76:79], a[64:67], a[32:47]
  v_exp_f32 v138, v138
  v_exp_f32 v139, v139
  v_cvt_pk_bf16_f32 v196, v136, v137
  v_mfma_f32_32x32x16_bf16 v[64:79], v[44:47], v[208:211], v[64:79]
  v_exp_f32 v140, v140
  v_exp_f32 v141, v141
  v_cvt_pk_bf16_f32 v197, v138, v139
  v_exp_f32 v142, v142
  v_mfma_f32_32x32x16_bf16 a[48:63], a[76:79], a[68:71], a[48:63]
  buffer_load_dwordx4 a[64:67], v2, s[16:19], s83 offen sc1
  v_exp_f32 v143, v143
  v_cvt_pk_bf16_f32 v198, v140, v141
  v_cvt_pk_bf16_f32 v199, v142, v143
  s_waitcnt vmcnt(25)
  v_mfma_f32_32x32x16_bf16 a[0:15], a[88:91], a[80:83], a[0:15]
  buffer_load_dwordx4 a[72:75], v2, s[16:19], s73 offen sc1
  v_exp_f32 v144, v144
  v_exp_f32 v145, v145
  v_exp_f32 v146, v146
  v_mfma_f32_32x32x16_bf16 v[80:95], v[44:47], v[216:219], v[80:95]
  buffer_load_dwordx4 a[68:71], v54, s[16:19], s83 offen sc1
  v_exp_f32 v147, v147
  v_cvt_pk_bf16_f32 v200, v144, v145
  v_exp_f32 v148, v148
  v_exp_f32 v149, v149
  v_mfma_f32_32x32x16_bf16 a[16:31], a[88:91], a[84:87], a[16:31]
  buffer_load_dwordx4 a[76:79], v54, s[16:19], s73 offen sc1
  v_cvt_pk_bf16_f32 v201, v146, v147
  v_exp_f32 v150, v150
  v_exp_f32 v151, v151
  v_mfma_f32_32x32x16_bf16 v[64:79], v[48:51], v[212:215], v[64:79]
  v_cvt_pk_bf16_f32 v202, v148, v149
  v_exp_f32 v152, v152
  v_exp_f32 v153, v153
  v_cvt_pk_bf16_f32 v203, v150, v151
  v_mfma_f32_32x32x16_bf16 a[32:47], a[92:95], a[80:83], a[32:47]
  v_exp_f32 v154, v154
  v_exp_f32 v155, v155
  v_cvt_pk_bf16_f32 v204, v152, v153
  v_mfma_f32_32x32x16_bf16 v[80:95], v[48:51], v[220:223], v[80:95]
  v_exp_f32 v156, v156
  v_exp_f32 v157, v157
  v_cvt_pk_bf16_f32 v205, v154, v155
  v_exp_f32 v158, v158
  v_mfma_f32_32x32x16_bf16 a[48:63], a[92:95], a[84:87], a[48:63]
  buffer_load_dwordx4 a[80:83], v2, s[16:19], s83 offen offset:1024 sc1
  buffer_load_dwordx4 a[88:91], v2, s[16:19], s73 offen offset:1024 sc1
  buffer_load_dwordx4 a[84:87], v54, s[16:19], s83 offen offset:1024 sc1
  buffer_load_dwordx4 a[92:95], v54, s[16:19], s73 offen offset:1024 sc1
  v_exp_f32 v159, v159
  v_cvt_pk_bf16_f32 v206, v156, v157
  v_cvt_pk_bf16_f32 v207, v158, v159
  s_waitcnt lgkmcnt(0)
  v_mfma_f32_32x32x16_bf16 v[128:143], v[28:31], v[20:23], v[224:239]
  ds_read_b128 v[32:35], v3 offset:3072
  ds_read_b128 v[44:47], v4 offset:2048
  ds_read_b128 v[48:51], v4 offset:2560
  v_exp_f32 v160, v160
  v_exp_f32 v161, v161
  v_exp_f32 v162, v162
  v_exp_f32 v163, v163
  v_cvt_pk_bf16_f32 v208, v160, v161
  s_waitcnt vmcnt(28)
  v_mfma_f32_32x32x16_bf16 a[0:15], a[104:107], a[96:99], a[0:15]
  v_exp_f32 v164, v164
  v_exp_f32 v165, v165
  v_cvt_pk_bf16_f32 v209, v162, v163
  v_exp_f32 v166, v166
  v_exp_f32 v167, v167
  v_mfma_f32_32x32x16_bf16 v[144:159], v[28:31], v[24:27], v[240:255]
  v_cvt_pk_bf16_f32 v210, v164, v165
  v_exp_f32 v168, v168
  v_exp_f32 v169, v169
  v_cvt_pk_bf16_f32 v211, v166, v167
  v_mfma_f32_32x32x16_bf16 a[16:31], a[104:107], a[100:103], a[16:31]
  v_exp_f32 v170, v170
  v_exp_f32 v171, v171
  v_cvt_pk_bf16_f32 v212, v168, v169
  v_exp_f32 v172, v172
  v_exp_f32 v173, v173
  v_mfma_f32_32x32x16_bf16 v[64:79], v[36:39], v[192:195], v[64:79]
  v_cvt_pk_bf16_f32 v213, v170, v171
  v_exp_f32 v174, v174
  v_exp_f32 v175, v175
  v_cvt_pk_bf16_f32 v214, v172, v173
  v_cvt_pk_bf16_f32 v215, v174, v175
  v_mfma_f32_32x32x16_bf16 a[32:47], a[108:111], a[96:99], a[32:47]
  v_exp_f32 v176, v176
  v_exp_f32 v177, v177
  v_exp_f32 v178, v178
  v_exp_f32 v179, v179
  v_cvt_pk_bf16_f32 v216, v176, v177
  v_mfma_f32_32x32x16_bf16 v[80:95], v[36:39], v[200:203], v[80:95]
  v_exp_f32 v180, v180
  v_exp_f32 v181, v181
  v_cvt_pk_bf16_f32 v217, v178, v179
  v_exp_f32 v182, v182
  v_exp_f32 v183, v183
  v_mfma_f32_32x32x16_bf16 v[64:79], v[40:43], v[196:199], v[64:79]
  v_cvt_pk_bf16_f32 v218, v180, v181
  v_exp_f32 v184, v184
  v_exp_f32 v185, v185
  v_cvt_pk_bf16_f32 v219, v182, v183
  v_mfma_f32_32x32x16_bf16 a[48:63], a[108:111], a[100:103], a[48:63]
  buffer_load_dwordx4 a[96:99], v2, s[16:19], s83 offen offset:2048 sc1
  buffer_load_dwordx4 a[104:107], v2, s[16:19], s73 offen offset:2048 sc1
  v_exp_f32 v186, v186
  v_exp_f32 v187, v187
  v_cvt_pk_bf16_f32 v220, v184, v185
  v_exp_f32 v188, v188
  v_exp_f32 v189, v189
  v_mfma_f32_32x32x16_bf16 v[80:95], v[40:43], v[204:207], v[80:95]
  buffer_load_dwordx4 a[100:103], v54, s[16:19], s83 offen offset:2048 sc1
  buffer_load_dwordx4 a[108:111], v54, s[16:19], s73 offen offset:2048 sc1
  v_cvt_pk_bf16_f32 v221, v186, v187
  v_exp_f32 v190, v190
  v_exp_f32 v191, v191
  v_cvt_pk_bf16_f32 v222, v188, v189
  v_cvt_pk_bf16_f32 v223, v190, v191
  s_waitcnt lgkmcnt(0)
  v_mfma_f32_32x32x16_bf16 v[160:175], v[32:35], v[20:23], v[224:239]
  ds_read_b128 v[28:31], v3 offset:4096
  ds_read_b128 v[36:39], v4 offset:3072
  ds_read_b128 v[40:43], v4 offset:3584
  v_exp_f32 v128, v128
  v_exp_f32 v129, v129
  v_exp_f32 v130, v130
  s_waitcnt vmcnt(28)
  v_mfma_f32_32x32x16_bf16 a[0:15], a[120:123], a[112:115], a[0:15]
  v_exp_f32 v131, v131
  v_cvt_pk_bf16_f32 v192, v128, v129
  v_exp_f32 v132, v132
  v_exp_f32 v133, v133
  v_mfma_f32_32x32x16_bf16 a[16:31], a[120:123], a[116:119], a[16:31]
  v_cvt_pk_bf16_f32 v193, v130, v131
  v_exp_f32 v134, v134
  v_exp_f32 v135, v135
  v_mfma_f32_32x32x16_bf16 v[176:191], v[32:35], v[24:27], v[240:255]
  v_cvt_pk_bf16_f32 v194, v132, v133
  v_exp_f32 v136, v136
  v_exp_f32 v137, v137
  v_cvt_pk_bf16_f32 v195, v134, v135
  v_mfma_f32_32x32x16_bf16 a[32:47], a[124:127], a[112:115], a[32:47]
  v_exp_f32 v138, v138
  v_exp_f32 v139, v139
  v_cvt_pk_bf16_f32 v196, v136, v137
  v_mfma_f32_32x32x16_bf16 v[64:79], v[44:47], v[208:211], v[64:79]
  v_exp_f32 v140, v140
  v_exp_f32 v141, v141
  v_cvt_pk_bf16_f32 v197, v138, v139
  v_exp_f32 v142, v142
  v_mfma_f32_32x32x16_bf16 a[48:63], a[124:127], a[116:119], a[48:63]
  buffer_load_dwordx4 a[112:115], v2, s[16:19], s83 offen offset:3072 sc1
  v_exp_f32 v143, v143
  v_cvt_pk_bf16_f32 v198, v140, v141
  v_cvt_pk_bf16_f32 v199, v142, v143
  s_waitcnt vmcnt(25)
  v_mfma_f32_32x32x16_bf16 a[0:15], a[136:139], a[128:131], a[0:15]
  buffer_load_dwordx4 a[120:123], v2, s[16:19], s73 offen offset:3072 sc1
  v_exp_f32 v144, v144
  v_exp_f32 v145, v145
  v_exp_f32 v146, v146
  v_mfma_f32_32x32x16_bf16 v[80:95], v[44:47], v[216:219], v[80:95]
  buffer_load_dwordx4 a[116:119], v54, s[16:19], s83 offen offset:3072 sc1
  v_exp_f32 v147, v147
  v_cvt_pk_bf16_f32 v200, v144, v145
  v_exp_f32 v148, v148
  v_exp_f32 v149, v149
  v_mfma_f32_32x32x16_bf16 a[16:31], a[136:139], a[132:135], a[16:31]
  buffer_load_dwordx4 a[124:127], v54, s[16:19], s73 offen offset:3072 sc1
  v_cvt_pk_bf16_f32 v201, v146, v147
  v_exp_f32 v150, v150
  v_exp_f32 v151, v151
  v_mfma_f32_32x32x16_bf16 v[64:79], v[48:51], v[212:215], v[64:79]
  s_add_u32 s83, s83, 4096
  v_cvt_pk_bf16_f32 v202, v148, v149
  v_exp_f32 v152, v152
  v_exp_f32 v153, v153
  v_cvt_pk_bf16_f32 v203, v150, v151
  v_mfma_f32_32x32x16_bf16 a[32:47], a[140:143], a[128:131], a[32:47]
  s_add_u32 s73, s73, 4096
  v_exp_f32 v154, v154
  v_exp_f32 v155, v155
  v_cvt_pk_bf16_f32 v204, v152, v153
  v_mfma_f32_32x32x16_bf16 v[80:95], v[48:51], v[220:223], v[80:95]
  v_exp_f32 v156, v156
  v_exp_f32 v157, v157
  v_cvt_pk_bf16_f32 v205, v154, v155
  v_exp_f32 v158, v158
  v_mfma_f32_32x32x16_bf16 a[48:63], a[140:143], a[132:135], a[48:63]
  buffer_load_dwordx4 a[128:131], v2, s[16:19], s83 offen sc1
  buffer_load_dwordx4 a[136:139], v2, s[16:19], s73 offen sc1
  buffer_load_dwordx4 a[132:135], v54, s[16:19], s83 offen sc1
  buffer_load_dwordx4 a[140:143], v54, s[16:19], s73 offen sc1
  v_exp_f32 v159, v159
  v_cvt_pk_bf16_f32 v206, v156, v157
  v_cvt_pk_bf16_f32 v207, v158, v159
  v_add_u32 v3, 4096, v3
  v_add_u32 v4, v4, v5
  s_waitcnt lgkmcnt(0)
  v_mfma_f32_32x32x16_bf16 v[128:143], v[28:31], v[20:23], v[224:239]
  ds_read_b128 v[32:35], v3 offset:1024
  ds_read_b128 v[44:47], v4
  ds_read_b128 v[48:51], v4 offset:512
  v_exp_f32 v160, v160
  v_exp_f32 v161, v161
  v_exp_f32 v162, v162
  v_exp_f32 v163, v163
  v_cvt_pk_bf16_f32 v208, v160, v161
  s_waitcnt vmcnt(28)
  v_mfma_f32_32x32x16_bf16 a[0:15], a[152:155], a[144:147], a[0:15]
  v_exp_f32 v164, v164
  v_exp_f32 v165, v165
  v_cvt_pk_bf16_f32 v209, v162, v163
  v_exp_f32 v166, v166
  v_exp_f32 v167, v167
  v_mfma_f32_32x32x16_bf16 v[144:159], v[28:31], v[24:27], v[240:255]
  v_cvt_pk_bf16_f32 v210, v164, v165
  v_exp_f32 v168, v168
  v_exp_f32 v169, v169
  v_cvt_pk_bf16_f32 v211, v166, v167
  v_mfma_f32_32x32x16_bf16 a[16:31], a[152:155], a[148:151], a[16:31]
  v_exp_f32 v170, v170
  v_exp_f32 v171, v171
  v_cvt_pk_bf16_f32 v212, v168, v169
  v_exp_f32 v172, v172
  v_exp_f32 v173, v173
  v_mfma_f32_32x32x16_bf16 v[64:79], v[36:39], v[192:195], v[64:79]
  v_cvt_pk_bf16_f32 v213, v170, v171
  v_exp_f32 v174, v174
  v_exp_f32 v175, v175
  v_cvt_pk_bf16_f32 v214, v172, v173
  v_cvt_pk_bf16_f32 v215, v174, v175
  v_mfma_f32_32x32x16_bf16 a[32:47], a[156:159], a[144:147], a[32:47]
  v_exp_f32 v176, v176
  v_exp_f32 v177, v177
  v_exp_f32 v178, v178
  v_exp_f32 v179, v179
  v_cvt_pk_bf16_f32 v216, v176, v177
  v_mfma_f32_32x32x16_bf16 v[80:95], v[36:39], v[200:203], v[80:95]
  v_exp_f32 v180, v180
  v_exp_f32 v181, v181
  v_cvt_pk_bf16_f32 v217, v178, v179
  v_exp_f32 v182, v182
  v_exp_f32 v183, v183
  v_mfma_f32_32x32x16_bf16 v[64:79], v[40:43], v[196:199], v[64:79]
  v_cvt_pk_bf16_f32 v218, v180, v181
  v_exp_f32 v184, v184
  v_exp_f32 v185, v185
  v_cvt_pk_bf16_f32 v219, v182, v183
  v_mfma_f32_32x32x16_bf16 a[48:63], a[156:159], a[148:151], a[48:63]
  buffer_load_dwordx4 a[144:147], v2, s[16:19], s83 offen offset:1024 sc1
  buffer_load_dwordx4 a[152:155], v2, s[16:19], s73 offen offset:1024 sc1
  v_exp_f32 v186, v186
  v_exp_f32 v187, v187
  v_cvt_pk_bf16_f32 v220, v184, v185
  v_exp_f32 v188, v188
  v_exp_f32 v189, v189
  v_mfma_f32_32x32x16_bf16 v[80:95], v[40:43], v[204:207], v[80:95]
  buffer_load_dwordx4 a[148:151], v54, s[16:19], s83 offen offset:1024 sc1
  buffer_load_dwordx4 a[156:159], v54, s[16:19], s73 offen offset:1024 sc1
  v_cvt_pk_bf16_f32 v221, v186, v187
  v_exp_f32 v190, v190
  v_exp_f32 v191, v191
  v_cvt_pk_bf16_f32 v222, v188, v189
  v_cvt_pk_bf16_f32 v223, v190, v191
  s_waitcnt lgkmcnt(0)
  v_mfma_f32_32x32x16_bf16 v[160:175], v[32:35], v[20:23], v[224:239]
  ds_read_b128 v[28:31], v3 offset:2048
  ds_read_b128 v[36:39], v4 offset:1024
  ds_read_b128 v[40:43], v4 offset:1536
  v_exp_f32 v128, v128
  v_exp_f32 v129, v129
  v_exp_f32 v130, v130
  s_waitcnt vmcnt(28)
  v_mfma_f32_32x32x16_bf16 a[0:15], a[168:171], a[160:163], a[0:15]
  v_exp_f32 v131, v131
  v_cvt_pk_bf16_f32 v192, v128, v129
  v_exp_f32 v132, v132
  v_exp_f32 v133, v133
  v_mfma_f32_32x32x16_bf16 a[16:31], a[168:171], a[164:167], a[16:31]
  v_cvt_pk_bf16_f32 v193, v130, v131
  v_exp_f32 v134, v134
  v_exp_f32 v135, v135
  v_mfma_f32_32x32x16_bf16 v[176:191], v[32:35], v[24:27], v[240:255]
  v_cvt_pk_bf16_f32 v194, v132, v133
  v_exp_f32 v136, v136
  v_exp_f32 v137, v137
  v_cvt_pk_bf16_f32 v195, v134, v135
  v_mfma_f32_32x32x16_bf16 a[32:47], a[172:175], a[160:163], a[32:47]
  v_exp_f32 v138, v138
  v_exp_f32 v139, v139
  v_cvt_pk_bf16_f32 v196, v136, v137
  v_mfma_f32_32x32x16_bf16 v[64:79], v[44:47], v[208:211], v[64:79]
  v_exp_f32 v140, v140
  v_exp_f32 v141, v141
  v_cvt_pk_bf16_f32 v197, v138, v139
  v_exp_f32 v142, v142
  v_mfma_f32_32x32x16_bf16 a[48:63], a[172:175], a[164:167], a[48:63]
  buffer_load_dwordx4 a[160:163], v2, s[16:19], s83 offen offset:2048 sc1
  v_exp_f32 v143, v143
  v_cvt_pk_bf16_f32 v198, v140, v141
  v_cvt_pk_bf16_f32 v199, v142, v143
  s_waitcnt vmcnt(25)
  v_mfma_f32_32x32x16_bf16 a[0:15], a[184:187], a[176:179], a[0:15]
  buffer_load_dwordx4 a[168:171], v2, s[16:19], s73 offen offset:2048 sc1
  v_exp_f32 v144, v144
  v_exp_f32 v145, v145
  v_exp_f32 v146, v146
  v_mfma_f32_32x32x16_bf16 v[80:95], v[44:47], v[216:219], v[80:95]
  buffer_load_dwordx4 a[164:167], v54, s[16:19], s83 offen offset:2048 sc1
  v_exp_f32 v147, v147
  v_cvt_pk_bf16_f32 v200, v144, v145
  v_exp_f32 v148, v148
  v_exp_f32 v149, v149
  v_mfma_f32_32x32x16_bf16 a[16:31], a[184:187], a[180:183], a[16:31]
  buffer_load_dwordx4 a[172:175], v54, s[16:19], s73 offen offset:2048 sc1
  v_cvt_pk_bf16_f32 v201, v146, v147
  v_exp_f32 v150, v150
  v_exp_f32 v151, v151
  v_mfma_f32_32x32x16_bf16 v[64:79], v[48:51], v[212:215], v[64:79]
  v_cvt_pk_bf16_f32 v202, v148, v149
  v_exp_f32 v152, v152
  v_exp_f32 v153, v153
  v_cvt_pk_bf16_f32 v203, v150, v151
  v_mfma_f32_32x32x16_bf16 a[32:47], a[188:191], a[176:179], a[32:47]
  v_exp_f32 v154, v154
  v_exp_f32 v155, v155
  v_cvt_pk_bf16_f32 v204, v152, v153
  v_mfma_f32_32x32x16_bf16 v[80:95], v[48:51], v[220:223], v[80:95]
  v_exp_f32 v156, v156
  v_exp_f32 v157, v157
  v_cvt_pk_bf16_f32 v205, v154, v155
  v_exp_f32 v158, v158
  v_mfma_f32_32x32x16_bf16 a[48:63], a[188:191], a[180:183], a[48:63]
  buffer_load_dwordx4 a[176:179], v2, s[16:19], s83 offen offset:3072 sc1
  buffer_load_dwordx4 a[184:187], v2, s[16:19], s73 offen offset:3072 sc1
  buffer_load_dwordx4 a[180:183], v54, s[16:19], s83 offen offset:3072 sc1
  buffer_load_dwordx4 a[188:191], v54, s[16:19], s73 offen offset:3072 sc1
  s_add_u32 s83, s83, 4096
  s_add_u32 s73, s73, 4096
  v_exp_f32 v159, v159
  v_cvt_pk_bf16_f32 v206, v156, v157
  v_cvt_pk_bf16_f32 v207, v158, v159
  s_waitcnt lgkmcnt(0)
  v_mfma_f32_32x32x16_bf16 v[128:143], v[28:31], v[20:23], v[224:239]
  ds_read_b128 v[32:35], v3 offset:3072
  ds_read_b128 v[44:47], v4 offset:2048
  ds_read_b128 v[48:51], v4 offset:2560
  v_exp_f32 v160, v160
  v_exp_f32 v161, v161
  v_exp_f32 v162, v162
  v_exp_f32 v163, v163
  v_cvt_pk_bf16_f32 v208, v160, v161
  s_waitcnt vmcnt(28)
  v_mfma_f32_32x32x16_bf16 a[0:15], a[72:75], a[64:67], a[0:15]
  v_exp_f32 v164, v164
  v_exp_f32 v165, v165
  v_cvt_pk_bf16_f32 v209, v162, v163
  v_exp_f32 v166, v166
  v_exp_f32 v167, v167
  v_mfma_f32_32x32x16_bf16 v[144:159], v[28:31], v[24:27], v[240:255]
  v_cvt_pk_bf16_f32 v210, v164, v165
  v_exp_f32 v168, v168
  v_exp_f32 v169, v169
  v_cvt_pk_bf16_f32 v211, v166, v167
  v_mfma_f32_32x32x16_bf16 a[16:31], a[72:75], a[68:71], a[16:31]
  v_exp_f32 v170, v170
  v_exp_f32 v171, v171
  v_cvt_pk_bf16_f32 v212, v168, v169
  v_exp_f32 v172, v172
  v_exp_f32 v173, v173
  v_mfma_f32_32x32x16_bf16 v[64:79], v[36:39], v[192:195], v[64:79]
  v_cvt_pk_bf16_f32 v213, v170, v171
  v_exp_f32 v174, v174
  v_exp_f32 v175, v175
  v_cvt_pk_bf16_f32 v214, v172, v173
  v_cvt_pk_bf16_f32 v215, v174, v175
  v_mfma_f32_32x32x16_bf16 a[32:47], a[76:79], a[64:67], a[32:47]
  v_exp_f32 v176, v176
  v_exp_f32 v177, v177
  v_exp_f32 v178, v178
  v_exp_f32 v179, v179
  v_cvt_pk_bf16_f32 v216, v176, v177
  v_mfma_f32_32x32x16_bf16 v[80:95], v[36:39], v[200:203], v[80:95]
  v_exp_f32 v180, v180
  v_exp_f32 v181, v181
  v_cvt_pk_bf16_f32 v217, v178, v179
  v_exp_f32 v182, v182
  v_exp_f32 v183, v183
  v_mfma_f32_32x32x16_bf16 v[64:79], v[40:43], v[196:199], v[64:79]
  v_cvt_pk_bf16_f32 v218, v180, v181
  v_exp_f32 v184, v184
  v_exp_f32 v185, v185
  v_cvt_pk_bf16_f32 v219, v182, v183
  v_mfma_f32_32x32x16_bf16 a[48:63], a[76:79], a[68:71], a[48:63]
  buffer_load_dwordx4 a[64:67], v2, s[16:19], s83 offen sc1
  buffer_load_dwordx4 a[72:75], v2, s[16:19], s73 offen sc1
  v_exp_f32 v186, v186
  v_exp_f32 v187, v187
  v_cvt_pk_bf16_f32 v220, v184, v185
  v_exp_f32 v188, v188
  v_exp_f32 v189, v189
  v_mfma_f32_32x32x16_bf16 v[80:95], v[40:43], v[204:207], v[80:95]
  buffer_load_dwordx4 a[68:71], v54, s[16:19], s83 offen sc1
  buffer_load_dwordx4 a[76:79], v54, s[16:19], s73 offen sc1
  v_cvt_pk_bf16_f32 v221, v186, v187
  v_exp_f32 v190, v190
  v_exp_f32 v191, v191
  v_cvt_pk_bf16_f32 v222, v188, v189
  v_cvt_pk_bf16_f32 v223, v190, v191
  s_waitcnt lgkmcnt(0)
  v_mfma_f32_32x32x16_bf16 v[160:175], v[32:35], v[20:23], v[224:239]
  ds_read_b128 v[28:31], v3 offset:4096
  ds_read_b128 v[36:39], v4 offset:3072
  ds_read_b128 v[40:43], v4 offset:3584
  v_exp_f32 v128, v128
  v_exp_f32 v129, v129
  v_exp_f32 v130, v130
  v_exp_f32 v131, v131
  v_cvt_pk_bf16_f32 v192, v128, v129
  s_waitcnt vmcnt(28)
  v_mfma_f32_32x32x16_bf16 a[0:15], a[88:91], a[80:83], a[0:15]
  v_exp_f32 v132, v132
  v_exp_f32 v133, v133
  v_cvt_pk_bf16_f32 v193, v130, v131
  v_exp_f32 v134, v134
  v_exp_f32 v135, v135
  v_mfma_f32_32x32x16_bf16 v[176:191], v[32:35], v[24:27], v[240:255]
  v_cvt_pk_bf16_f32 v194, v132, v133
  v_exp_f32 v136, v136
  v_exp_f32 v137, v137
  v_cvt_pk_bf16_f32 v195, v134, v135
  v_mfma_f32_32x32x16_bf16 a[16:31], a[88:91], a[84:87], a[16:31]
  v_exp_f32 v138, v138
  v_exp_f32 v139, v139
  v_cvt_pk_bf16_f32 v196, v136, v137
  v_exp_f32 v140, v140
  v_exp_f32 v141, v141
  v_mfma_f32_32x32x16_bf16 v[64:79], v[44:47], v[208:211], v[64:79]
  v_cvt_pk_bf16_f32 v197, v138, v139
  v_exp_f32 v142, v142
  v_exp_f32 v143, v143
  v_cvt_pk_bf16_f32 v198, v140, v141
  v_cvt_pk_bf16_f32 v199, v142, v143
  v_mfma_f32_32x32x16_bf16 a[32:47], a[92:95], a[80:83], a[32:47]
  v_exp_f32 v144, v144
  v_exp_f32 v145, v145
  v_exp_f32 v146, v146
  v_exp_f32 v147, v147
  v_cvt_pk_bf16_f32 v200, v144, v145
  v_mfma_f32_32x32x16_bf16 v[80:95], v[44:47], v[216:219], v[80:95]
  v_exp_f32 v148, v148
  v_exp_f32 v149, v149
  v_cvt_pk_bf16_f32 v201, v146, v147
  v_exp_f32 v150, v150
  v_exp_f32 v151, v151
  v_mfma_f32_32x32x16_bf16 v[64:79], v[48:51], v[212:215], v[64:79]
  v_cvt_pk_bf16_f32 v202, v148, v149
  v_exp_f32 v152, v152
  v_exp_f32 v153, v153
  v_cvt_pk_bf16_f32 v203, v150, v151
  v_mfma_f32_32x32x16_bf16 a[48:63], a[92:95], a[84:87], a[48:63]
  buffer_load_dwordx4 a[80:83], v2, s[16:19], s83 offen offset:1024 sc1
  buffer_load_dwordx4 a[88:91], v2, s[16:19], s73 offen offset:1024 sc1
  v_exp_f32 v154, v154
  v_exp_f32 v155, v155
  v_cvt_pk_bf16_f32 v204, v152, v153
  v_exp_f32 v156, v156
  v_exp_f32 v157, v157
  v_mfma_f32_32x32x16_bf16 v[80:95], v[48:51], v[220:223], v[80:95]
  buffer_load_dwordx4 a[84:87], v54, s[16:19], s83 offen offset:1024 sc1
  buffer_load_dwordx4 a[92:95], v54, s[16:19], s73 offen offset:1024 sc1
  v_cvt_pk_bf16_f32 v205, v154, v155
  v_exp_f32 v158, v158
  v_exp_f32 v159, v159
  v_cvt_pk_bf16_f32 v206, v156, v157
  v_cvt_pk_bf16_f32 v207, v158, v159
  v_add_u32 v3, 4096, v3
  v_add_u32 v4, v4, v5
  s_waitcnt lgkmcnt(0)
  v_mfma_f32_32x32x16_bf16 v[128:143], v[28:31], v[20:23], v[224:239]
  ds_read_b128 v[32:35], v3 offset:1024
  ds_read_b128 v[44:47], v4
  ds_read_b128 v[48:51], v4 offset:512
  v_exp_f32 v160, v160
  v_exp_f32 v161, v161
  v_exp_f32 v162, v162
  s_waitcnt vmcnt(28)
  v_mfma_f32_32x32x16_bf16 a[0:15], a[104:107], a[96:99], a[0:15]
  v_exp_f32 v163, v163
  v_cvt_pk_bf16_f32 v208, v160, v161
  v_exp_f32 v164, v164
  v_exp_f32 v165, v165
  v_mfma_f32_32x32x16_bf16 a[16:31], a[104:107], a[100:103], a[16:31]
  v_cvt_pk_bf16_f32 v209, v162, v163
  v_exp_f32 v166, v166
  v_exp_f32 v167, v167
  v_mfma_f32_32x32x16_bf16 v[144:159], v[28:31], v[24:27], v[240:255]
  v_cvt_pk_bf16_f32 v210, v164, v165
  v_exp_f32 v168, v168
  v_exp_f32 v169, v169
  v_cvt_pk_bf16_f32 v211, v166, v167
  v_mfma_f32_32x32x16_bf16 a[32:47], a[108:111], a[96:99], a[32:47]
  v_exp_f32 v170, v170
  v_exp_f32 v171, v171
  v_cvt_pk_bf16_f32 v212, v168, v169
  v_mfma_f32_32x32x16_bf16 v[64:79], v[36:39], v[192:195], v[64:79]
  v_exp_f32 v172, v172
  v_exp_f32 v173, v173
  v_cvt_pk_bf16_f32 v213, v170, v171
  v_exp_f32 v174, v174
  v_mfma_f32_32x32x16_bf16 a[48:63], a[108:111], a[100:103], a[48:63]
  buffer_load_dwordx4 a[96:99], v2, s[16:19], s83 offen offset:2048 sc1
  v_exp_f32 v175, v175
  v_cvt_pk_bf16_f32 v214, v172, v173
  v_cvt_pk_bf16_f32 v215, v174, v175
  s_waitcnt vmcnt(25)
  v_mfma_f32_32x32x16_bf16 a[0:15], a[120:123], a[112:115], a[0:15]
  buffer_load_dwordx4 a[104:107], v2, s[16:19], s73 offen offset:2048 sc1
  v_exp_f32 v176, v176
  v_exp_f32 v177, v177
  v_exp_f32 v178, v178
  v_mfma_f32_32x32x16_bf16 v[80:95], v[36:39], v[200:203], v[80:95]
  buffer_load_dwordx4 a[100:103], v54, s[16:19], s83 offen offset:2048 sc1
  v_exp_f32 v179, v179
  v_cvt_pk_bf16_f32 v216, v176, v177
  v_exp_f32 v180, v180
  v_exp_f32 v181, v181
  v_mfma_f32_32x32x16_bf16 a[16:31], a[120:123], a[116:119], a[16:31]
  buffer_load_dwordx4 a[108:111], v54, s[16:19], s73 offen offset:2048 sc1
  v_cvt_pk_bf16_f32 v217, v178, v179
  v_exp_f32 v182, v182
  v_exp_f32 v183, v183
  v_mfma_f32_32x32x16_bf16 v[64:79], v[40:43], v[196:199], v[64:79]
  v_cvt_pk_bf16_f32 v218, v180, v181
  v_exp_f32 v184, v184
  v_exp_f32 v185, v185
  v_cvt_pk_bf16_f32 v219, v182, v183
  v_mfma_f32_32x32x16_bf16 a[32:47], a[124:127], a[112:115], a[32:47]
  v_exp_f32 v186, v186
  v_exp_f32 v187, v187
  v_cvt_pk_bf16_f32 v220, v184, v185
  v_mfma_f32_32x32x16_bf16 v[80:95], v[40:43], v[204:207], v[80:95]
  v_exp_f32 v188, v188
  v_exp_f32 v189, v189
  v_cvt_pk_bf16_f32 v221, v186, v187
  v_exp_f32 v190, v190
  v_mfma_f32_32x32x16_bf16 a[48:63], a[124:127], a[116:119], a[48:63]
  buffer_load_dwordx4 a[112:115], v2, s[16:19], s83 offen offset:3072 sc1
  buffer_load_dwordx4 a[120:123], v2, s[16:19], s73 offen offset:3072 sc1
  buffer_load_dwordx4 a[116:119], v54, s[16:19], s83 offen offset:3072 sc1
  buffer_load_dwordx4 a[124:127], v54, s[16:19], s73 offen offset:3072 sc1
  s_add_u32 s83, s83, 4096
  s_add_u32 s73, s73, 4096
  v_exp_f32 v191, v191
  v_cvt_pk_bf16_f32 v222, v188, v189
  v_cvt_pk_bf16_f32 v223, v190, v191
  s_waitcnt lgkmcnt(0)
  v_mfma_f32_32x32x16_bf16 v[160:175], v[32:35], v[20:23], v[224:239]
  ds_read_b128 v[28:31], v3 offset:2048
  ds_read_b128 v[36:39], v4 offset:1024
  ds_read_b128 v[40:43], v4 offset:1536
  v_exp_f32 v128, v128
  v_exp_f32 v129, v129
  v_exp_f32 v130, v130
  v_exp_f32 v131, v131
  v_cvt_pk_bf16_f32 v192, v128, v129
  s_waitcnt vmcnt(28)
  v_mfma_f32_32x32x16_bf16 a[0:15], a[136:139], a[128:131], a[0:15]
  v_exp_f32 v132, v132
  v_exp_f32 v133, v133
  v_cvt_pk_bf16_f32 v193, v130, v131
  v_exp_f32 v134, v134
  v_exp_f32 v135, v135
  v_mfma_f32_32x32x16_bf16 v[176:191], v[32:35], v[24:27], v[240:255]
  v_cvt_pk_bf16_f32 v194, v132, v133
  v_exp_f32 v136, v136
  v_exp_f32 v137, v137
  v_cvt_pk_bf16_f32 v195, v134, v135
  v_mfma_f32_32x32x16_bf16 a[16:31], a[136:139], a[132:135], a[16:31]
  v_exp_f32 v138, v138
  v_exp_f32 v139, v139
  v_cvt_pk_bf16_f32 v196, v136, v137
  v_exp_f32 v140, v140
  v_exp_f32 v141, v141
  v_mfma_f32_32x32x16_bf16 v[64:79], v[44:47], v[208:211], v[64:79]
  v_cvt_pk_bf16_f32 v197, v138, v139
  v_exp_f32 v142, v142
  v_exp_f32 v143, v143
  v_cvt_pk_bf16_f32 v198, v140, v141
  v_cvt_pk_bf16_f32 v199, v142, v143
  v_mfma_f32_32x32x16_bf16 a[32:47], a[140:143], a[128:131], a[32:47]
  v_exp_f32 v144, v144
  v_exp_f32 v145, v145
  v_exp_f32 v146, v146
  v_exp_f32 v147, v147
  v_cvt_pk_bf16_f32 v200, v144, v145
  v_mfma_f32_32x32x16_bf16 v[80:95], v[44:47], v[216:219], v[80:95]
  v_exp_f32 v148, v148
  v_exp_f32 v149, v149
  v_cvt_pk_bf16_f32 v201, v146, v147
  v_exp_f32 v150, v150
  v_exp_f32 v151, v151
  v_mfma_f32_32x32x16_bf16 v[64:79], v[48:51], v[212:215], v[64:79]
  v_cvt_pk_bf16_f32 v202, v148, v149
  v_exp_f32 v152, v152
  v_exp_f32 v153, v153
  v_cvt_pk_bf16_f32 v203, v150, v151
  v_mfma_f32_32x32x16_bf16 a[48:63], a[140:143], a[132:135], a[48:63]
  buffer_load_dwordx4 a[128:131], v2, s[16:19], s83 offen sc1
  buffer_load_dwordx4 a[136:139], v2, s[16:19], s73 offen sc1
  v_exp_f32 v154, v154
  v_exp_f32 v155, v155
  v_cvt_pk_bf16_f32 v204, v152, v153
  v_exp_f32 v156, v156
  v_exp_f32 v157, v157
  v_mfma_f32_32x32x16_bf16 v[80:95], v[48:51], v[220:223], v[80:95]
  buffer_load_dwordx4 a[132:135], v54, s[16:19], s83 offen sc1
  buffer_load_dwordx4 a[140:143], v54, s[16:19], s73 offen sc1
  v_cvt_pk_bf16_f32 v205, v154, v155
  v_exp_f32 v158, v158
  v_exp_f32 v159, v159
  v_cvt_pk_bf16_f32 v206, v156, v157
  v_cvt_pk_bf16_f32 v207, v158, v159
  s_waitcnt lgkmcnt(0)
  v_mfma_f32_32x32x16_bf16 v[128:143], v[28:31], v[20:23], v[224:239]
  ds_read_b128 v[32:35], v3 offset:3072
  ds_read_b128 v[44:47], v4 offset:2048
  ds_read_b128 v[48:51], v4 offset:2560
  v_exp_f32 v160, v160
  v_exp_f32 v161, v161
  v_exp_f32 v162, v162
  s_waitcnt vmcnt(28)
  v_mfma_f32_32x32x16_bf16 a[0:15], a[152:155], a[144:147], a[0:15]
  v_exp_f32 v163, v163
  v_cvt_pk_bf16_f32 v208, v160, v161
  v_exp_f32 v164, v164
  v_exp_f32 v165, v165
  v_mfma_f32_32x32x16_bf16 a[16:31], a[152:155], a[148:151], a[16:31]
  v_cvt_pk_bf16_f32 v209, v162, v163
  v_exp_f32 v166, v166
  v_exp_f32 v167, v167
  v_mfma_f32_32x32x16_bf16 v[144:159], v[28:31], v[24:27], v[240:255]
  v_cvt_pk_bf16_f32 v210, v164, v165
  v_exp_f32 v168, v168
  v_exp_f32 v169, v169
  v_cvt_pk_bf16_f32 v211, v166, v167
  v_mfma_f32_32x32x16_bf16 a[32:47], a[156:159], a[144:147], a[32:47]
  v_exp_f32 v170, v170
  v_exp_f32 v171, v171
  v_cvt_pk_bf16_f32 v212, v168, v169
  v_mfma_f32_32x32x16_bf16 v[64:79], v[36:39], v[192:195], v[64:79]
  v_exp_f32 v172, v172
  v_exp_f32 v173, v173
  v_cvt_pk_bf16_f32 v213, v170, v171
  v_exp_f32 v174, v174
  v_mfma_f32_32x32x16_bf16 a[48:63], a[156:159], a[148:151], a[48:63]
  buffer_load_dwordx4 a[144:147], v2, s[16:19], s83 offen offset:1024 sc1
  v_exp_f32 v175, v175
  v_cvt_pk_bf16_f32 v214, v172, v173
  v_cvt_pk_bf16_f32 v215, v174, v175
  s_waitcnt vmcnt(25)
  v_mfma_f32_32x32x16_bf16 a[0:15], a[168:171], a[160:163], a[0:15]
  buffer_load_dwordx4 a[152:155], v2, s[16:19], s73 offen offset:1024 sc1
  v_exp_f32 v176, v176
  v_exp_f32 v177, v177
  v_exp_f32 v178, v178
  v_mfma_f32_32x32x16_bf16 v[80:95], v[36:39], v[200:203], v[80:95]
  buffer_load_dwordx4 a[148:151], v54, s[16:19], s83 offen offset:1024 sc1
  v_exp_f32 v179, v179
  v_cvt_pk_bf16_f32 v216, v176, v177
  v_exp_f32 v180, v180
  v_exp_f32 v181, v181
  v_mfma_f32_32x32x16_bf16 a[16:31], a[168:171], a[164:167], a[16:31]
  buffer_load_dwordx4 a[156:159], v54, s[16:19], s73 offen offset:1024 sc1
  v_cvt_pk_bf16_f32 v217, v178, v179
  v_exp_f32 v182, v182
  v_exp_f32 v183, v183
  v_mfma_f32_32x32x16_bf16 v[64:79], v[40:43], v[196:199], v[64:79]
  v_cvt_pk_bf16_f32 v218, v180, v181
  v_exp_f32 v184, v184
  v_exp_f32 v185, v185
  v_cvt_pk_bf16_f32 v219, v182, v183
  v_mfma_f32_32x32x16_bf16 a[32:47], a[172:175], a[160:163], a[32:47]
  v_exp_f32 v186, v186
  v_exp_f32 v187, v187
  v_cvt_pk_bf16_f32 v220, v184, v185
  v_mfma_f32_32x32x16_bf16 v[80:95], v[40:43], v[204:207], v[80:95]
  v_exp_f32 v188, v188
  v_exp_f32 v189, v189
  v_cvt_pk_bf16_f32 v221, v186, v187
  v_exp_f32 v190, v190
  v_mfma_f32_32x32x16_bf16 a[48:63], a[172:175], a[164:167], a[48:63]
  buffer_load_dwordx4 a[160:163], v2, s[16:19], s83 offen offset:2048 sc1
  buffer_load_dwordx4 a[168:171], v2, s[16:19], s73 offen offset:2048 sc1
  buffer_load_dwordx4 a[164:167], v54, s[16:19], s83 offen offset:2048 sc1
  buffer_load_dwordx4 a[172:175], v54, s[16:19], s73 offen offset:2048 sc1
  v_exp_f32 v191, v191
  v_cvt_pk_bf16_f32 v222, v188, v189
  v_cvt_pk_bf16_f32 v223, v190, v191
  s_waitcnt lgkmcnt(0)
  v_mfma_f32_32x32x16_bf16 v[160:175], v[32:35], v[20:23], v[224:239]
  ds_read_b128 v[28:31], v3 offset:4096
  ds_read_b128 v[36:39], v4 offset:3072
  ds_read_b128 v[40:43], v4 offset:3584
  v_exp_f32 v128, v128
  v_exp_f32 v129, v129
  v_exp_f32 v130, v130
  v_exp_f32 v131, v131
  v_cvt_pk_bf16_f32 v192, v128, v129
  s_waitcnt vmcnt(28)
  v_mfma_f32_32x32x16_bf16 a[0:15], a[184:187], a[176:179], a[0:15]
  v_exp_f32 v132, v132
  v_exp_f32 v133, v133
  v_cvt_pk_bf16_f32 v193, v130, v131
  v_exp_f32 v134, v134
  v_exp_f32 v135, v135
  v_mfma_f32_32x32x16_bf16 v[176:191], v[32:35], v[24:27], v[240:255]
  v_cvt_pk_bf16_f32 v194, v132, v133
  v_exp_f32 v136, v136
  v_exp_f32 v137, v137
  v_cvt_pk_bf16_f32 v195, v134, v135
  v_mfma_f32_32x32x16_bf16 a[16:31], a[184:187], a[180:183], a[16:31]
  v_exp_f32 v138, v138
  v_exp_f32 v139, v139
  v_cvt_pk_bf16_f32 v196, v136, v137
  v_exp_f32 v140, v140
  v_exp_f32 v141, v141
  v_mfma_f32_32x32x16_bf16 v[64:79], v[44:47], v[208:211], v[64:79]
  v_cvt_pk_bf16_f32 v197, v138, v139
  v_exp_f32 v142, v142
  v_exp_f32 v143, v143
  v_cvt_pk_bf16_f32 v198, v140, v141
  v_cvt_pk_bf16_f32 v199, v142, v143
  v_mfma_f32_32x32x16_bf16 a[32:47], a[188:191], a[176:179], a[32:47]
  v_exp_f32 v144, v144
  v_exp_f32 v145, v145
  v_exp_f32 v146, v146
  v_exp_f32 v147, v147
  v_cvt_pk_bf16_f32 v200, v144, v145
  v_mfma_f32_32x32x16_bf16 v[80:95], v[44:47], v[216:219], v[80:95]
  v_exp_f32 v148, v148
  v_exp_f32 v149, v149
  v_cvt_pk_bf16_f32 v201, v146, v147
  v_exp_f32 v150, v150
  v_exp_f32 v151, v151
  v_mfma_f32_32x32x16_bf16 v[64:79], v[48:51], v[212:215], v[64:79]
  v_cvt_pk_bf16_f32 v202, v148, v149
  v_exp_f32 v152, v152
  v_exp_f32 v153, v153
  v_cvt_pk_bf16_f32 v203, v150, v151
  v_mfma_f32_32x32x16_bf16 a[48:63], a[188:191], a[180:183], a[48:63]
  buffer_load_dwordx4 a[176:179], v2, s[16:19], s83 offen offset:3072 sc1
  buffer_load_dwordx4 a[184:187], v2, s[16:19], s73 offen offset:3072 sc1
  buffer_load_dwordx4 a[180:183], v54, s[16:19], s83 offen offset:3072 sc1
  v_exp_f32 v154, v154
  v_exp_f32 v155, v155
  v_cvt_pk_bf16_f32 v204, v152, v153
  v_exp_f32 v156, v156
  v_exp_f32 v157, v157
  v_mfma_f32_32x32x16_bf16 v[80:95], v[48:51], v[220:223], v[80:95]
  buffer_load_dwordx4 a[188:191], v54, s[16:19], s73 offen offset:3072 sc1
  s_add_u32 s83, s83, 4096
  s_add_u32 s73, s73, 4096
  v_cvt_pk_bf16_f32 v205, v154, v155
  v_exp_f32 v158, v158
  v_exp_f32 v159, v159
  v_cvt_pk_bf16_f32 v206, v156, v157
  v_cvt_pk_bf16_f32 v207, v158, v159
  v_add_u32 v3, 4096, v3
  v_add_u32 v4, v4, v5
  s_waitcnt lgkmcnt(0)
  v_mfma_f32_32x32x16_bf16 v[128:143], v[28:31], v[20:23], v[224:239]
  ds_read_b128 v[32:35], v3 offset:1024
  ds_read_b128 v[44:47], v4
  ds_read_b128 v[48:51], v4 offset:512
  v_exp_f32 v160, v160
  v_exp_f32 v161, v161
  v_exp_f32 v162, v162
  s_waitcnt vmcnt(28)
  v_mfma_f32_32x32x16_bf16 a[0:15], a[72:75], a[64:67], a[0:15]
  v_exp_f32 v163, v163
  v_cvt_pk_bf16_f32 v208, v160, v161
  v_exp_f32 v164, v164
  v_exp_f32 v165, v165
  v_mfma_f32_32x32x16_bf16 a[16:31], a[72:75], a[68:71], a[16:31]
  v_cvt_pk_bf16_f32 v209, v162, v163
  v_exp_f32 v166, v166
  v_exp_f32 v167, v167
  v_mfma_f32_32x32x16_bf16 v[144:159], v[28:31], v[24:27], v[240:255]
  v_cvt_pk_bf16_f32 v210, v164, v165
  v_exp_f32 v168, v168
  v_exp_f32 v169, v169
  v_cvt_pk_bf16_f32 v211, v166, v167
  v_mfma_f32_32x32x16_bf16 a[32:47], a[76:79], a[64:67], a[32:47]
  v_exp_f32 v170, v170
  v_exp_f32 v171, v171
  v_cvt_pk_bf16_f32 v212, v168, v169
  v_mfma_f32_32x32x16_bf16 v[64:79], v[36:39], v[192:195], v[64:79]
  v_exp_f32 v172, v172
  v_exp_f32 v173, v173
  v_cvt_pk_bf16_f32 v213, v170, v171
  v_exp_f32 v174, v174
  v_mfma_f32_32x32x16_bf16 a[48:63], a[76:79], a[68:71], a[48:63]
  buffer_load_dwordx4 a[64:67], v2, s[16:19], s83 offen sc1
  v_exp_f32 v175, v175
  v_cvt_pk_bf16_f32 v214, v172, v173
  v_cvt_pk_bf16_f32 v215, v174, v175
  s_waitcnt vmcnt(25)
  v_mfma_f32_32x32x16_bf16 a[0:15], a[88:91], a[80:83], a[0:15]
  buffer_load_dwordx4 a[72:75], v2, s[16:19], s73 offen sc1
  v_exp_f32 v176, v176
  v_exp_f32 v177, v177
  v_exp_f32 v178, v178
  v_mfma_f32_32x32x16_bf16 v[80:95], v[36:39], v[200:203], v[80:95]
  buffer_load_dwordx4 a[68:71], v54, s[16:19], s83 offen sc1
  v_exp_f32 v179, v179
  v_cvt_pk_bf16_f32 v216, v176, v177
  v_exp_f32 v180, v180
  v_exp_f32 v181, v181
  v_mfma_f32_32x32x16_bf16 a[16:31], a[88:91], a[84:87], a[16:31]
  buffer_load_dwordx4 a[76:79], v54, s[16:19], s73 offen sc1
  v_cvt_pk_bf16_f32 v217, v178, v179
  v_exp_f32 v182, v182
  v_exp_f32 v183, v183
  v_mfma_f32_32x32x16_bf16 v[64:79], v[40:43], v[196:199], v[64:79]
  v_cvt_pk_bf16_f32 v218, v180, v181
  v_exp_f32 v184, v184
  v_exp_f32 v185, v185
  v_cvt_pk_bf16_f32 v219, v182, v183
  v_mfma_f32_32x32x16_bf16 a[32:47], a[92:95], a[80:83], a[32:47]
  v_exp_f32 v186, v186
  v_exp_f32 v187, v187
  v_cvt_pk_bf16_f32 v220, v184, v185
  v_mfma_f32_32x32x16_bf16 v[80:95], v[40:43], v[204:207], v[80:95]
  v_exp_f32 v188, v188
  v_exp_f32 v189, v189
  v_cvt_pk_bf16_f32 v221, v186, v187
  v_exp_f32 v190, v190
  v_mfma_f32_32x32x16_bf16 a[48:63], a[92:95], a[84:87], a[48:63]
  buffer_load_dwordx4 a[80:83], v2, s[16:19], s83 offen offset:1024 sc1
  buffer_load_dwordx4 a[88:91], v2, s[16:19], s73 offen offset:1024 sc1
  buffer_load_dwordx4 a[84:87], v54, s[16:19], s83 offen offset:1024 sc1
  buffer_load_dwordx4 a[92:95], v54, s[16:19], s73 offen offset:1024 sc1
  v_exp_f32 v191, v191
  v_cvt_pk_bf16_f32 v222, v188, v189
  v_cvt_pk_bf16_f32 v223, v190, v191
  s_waitcnt lgkmcnt(0)
  v_mfma_f32_32x32x16_bf16 v[160:175], v[32:35], v[20:23], v[224:239]
  ds_read_b128 v[28:31], v3 offset:2048
  ds_read_b128 v[36:39], v4 offset:1024
  ds_read_b128 v[40:43], v4 offset:1536
  v_exp_f32 v128, v128
  v_exp_f32 v129, v129
  v_exp_f32 v130, v130
  v_exp_f32 v131, v131
  v_cvt_pk_bf16_f32 v192, v128, v129
  s_waitcnt vmcnt(28)
  v_mfma_f32_32x32x16_bf16 a[0:15], a[104:107], a[96:99], a[0:15]
  v_exp_f32 v132, v132
  v_exp_f32 v133, v133
  v_cvt_pk_bf16_f32 v193, v130, v131
  v_exp_f32 v134, v134
  v_exp_f32 v135, v135
  v_mfma_f32_32x32x16_bf16 v[176:191], v[32:35], v[24:27], v[240:255]
  v_cvt_pk_bf16_f32 v194, v132, v133
  v_exp_f32 v136, v136
  v_exp_f32 v137, v137
  v_cvt_pk_bf16_f32 v195, v134, v135
  v_mfma_f32_32x32x16_bf16 a[16:31], a[104:107], a[100:103], a[16:31]
  v_exp_f32 v138, v138
  v_exp_f32 v139, v139
  v_cvt_pk_bf16_f32 v196, v136, v137
  v_exp_f32 v140, v140
  v_exp_f32 v141, v141
  v_mfma_f32_32x32x16_bf16 v[64:79], v[44:47], v[208:211], v[64:79]
  v_cvt_pk_bf16_f32 v197, v138, v139
  v_exp_f32 v142, v142
  v_exp_f32 v143, v143
  v_cvt_pk_bf16_f32 v198, v140, v141
  v_cvt_pk_bf16_f32 v199, v142, v143
  v_mfma_f32_32x32x16_bf16 a[32:47], a[108:111], a[96:99], a[32:47]
  v_exp_f32 v144, v144
  v_exp_f32 v145, v145
  v_exp_f32 v146, v146
  v_exp_f32 v147, v147
  v_cvt_pk_bf16_f32 v200, v144, v145
  v_mfma_f32_32x32x16_bf16 v[80:95], v[44:47], v[216:219], v[80:95]
  v_exp_f32 v148, v148
  v_exp_f32 v149, v149
  v_cvt_pk_bf16_f32 v201, v146, v147
  v_exp_f32 v150, v150
  v_exp_f32 v151, v151
  v_mfma_f32_32x32x16_bf16 v[64:79], v[48:51], v[212:215], v[64:79]
  v_cvt_pk_bf16_f32 v202, v148, v149
  v_exp_f32 v152, v152
  v_exp_f32 v153, v153
  v_cvt_pk_bf16_f32 v203, v150, v151
  v_mfma_f32_32x32x16_bf16 a[48:63], a[108:111], a[100:103], a[48:63]
  buffer_load_dwordx4 a[96:99], v2, s[16:19], s83 offen offset:2048 sc1
  buffer_load_dwordx4 a[104:107], v2, s[16:19], s73 offen offset:2048 sc1
  v_exp_f32 v154, v154
  v_exp_f32 v155, v155
  v_cvt_pk_bf16_f32 v204, v152, v153
  v_exp_f32 v156, v156
  v_exp_f32 v157, v157
  v_mfma_f32_32x32x16_bf16 v[80:95], v[48:51], v[220:223], v[80:95]
  buffer_load_dwordx4 a[100:103], v54, s[16:19], s83 offen offset:2048 sc1
  buffer_load_dwordx4 a[108:111], v54, s[16:19], s73 offen offset:2048 sc1
  v_cvt_pk_bf16_f32 v205, v154, v155
  v_exp_f32 v158, v158
  v_exp_f32 v159, v159
  v_cvt_pk_bf16_f32 v206, v156, v157
  v_cvt_pk_bf16_f32 v207, v158, v159
  s_waitcnt lgkmcnt(0)
  v_mfma_f32_32x32x16_bf16 v[128:143], v[28:31], v[20:23], v[224:239]
  ds_read_b128 v[32:35], v3 offset:3072
  ds_read_b128 v[44:47], v4 offset:2048
  ds_read_b128 v[48:51], v4 offset:2560
  v_exp_f32 v160, v160
  v_exp_f32 v161, v161
  v_exp_f32 v162, v162
  s_waitcnt vmcnt(28)
  v_mfma_f32_32x32x16_bf16 a[0:15], a[120:123], a[112:115], a[0:15]
  v_exp_f32 v163, v163
  v_cvt_pk_bf16_f32 v208, v160, v161
  v_exp_f32 v164, v164
  v_exp_f32 v165, v165
  v_mfma_f32_32x32x16_bf16 a[16:31], a[120:123], a[116:119], a[16:31]
  v_cvt_pk_bf16_f32 v209, v162, v163
  v_exp_f32 v166, v166
  v_exp_f32 v167, v167
  v_mfma_f32_32x32x16_bf16 v[144:159], v[28:31], v[24:27], v[240:255]
  v_cvt_pk_bf16_f32 v210, v164, v165
  v_exp_f32 v168, v168
  v_exp_f32 v169, v169
  v_cvt_pk_bf16_f32 v211, v166, v167
  v_mfma_f32_32x32x16_bf16 a[32:47], a[124:127], a[112:115], a[32:47]
  v_exp_f32 v170, v170
  v_exp_f32 v171, v171
  v_cvt_pk_bf16_f32 v212, v168, v169
  v_mfma_f32_32x32x16_bf16 v[64:79], v[36:39], v[192:195], v[64:79]
  v_exp_f32 v172, v172
  v_exp_f32 v173, v173
  v_cvt_pk_bf16_f32 v213, v170, v171
  v_exp_f32 v174, v174
  v_mfma_f32_32x32x16_bf16 a[48:63], a[124:127], a[116:119], a[48:63]
  buffer_load_dwordx4 a[112:115], v2, s[16:19], s83 offen offset:3072 sc1
  v_exp_f32 v175, v175
  v_cvt_pk_bf16_f32 v214, v172, v173
  v_cvt_pk_bf16_f32 v215, v174, v175
  s_waitcnt vmcnt(25)
  v_mfma_f32_32x32x16_bf16 a[0:15], a[136:139], a[128:131], a[0:15]
  buffer_load_dwordx4 a[120:123], v2, s[16:19], s73 offen offset:3072 sc1
  v_exp_f32 v176, v176
  v_exp_f32 v177, v177
  v_exp_f32 v178, v178
  v_mfma_f32_32x32x16_bf16 v[80:95], v[36:39], v[200:203], v[80:95]
  buffer_load_dwordx4 a[116:119], v54, s[16:19], s83 offen offset:3072 sc1
  v_exp_f32 v179, v179
  v_cvt_pk_bf16_f32 v216, v176, v177
  v_exp_f32 v180, v180
  v_exp_f32 v181, v181
  v_mfma_f32_32x32x16_bf16 a[16:31], a[136:139], a[132:135], a[16:31]
  buffer_load_dwordx4 a[124:127], v54, s[16:19], s73 offen offset:3072 sc1
  v_cvt_pk_bf16_f32 v217, v178, v179
  v_exp_f32 v182, v182
  v_exp_f32 v183, v183
  v_mfma_f32_32x32x16_bf16 v[64:79], v[40:43], v[196:199], v[64:79]
  s_add_u32 s83, s83, 4096
  v_cvt_pk_bf16_f32 v218, v180, v181
  v_exp_f32 v184, v184
  v_exp_f32 v185, v185
  v_cvt_pk_bf16_f32 v219, v182, v183
  v_mfma_f32_32x32x16_bf16 a[32:47], a[140:143], a[128:131], a[32:47]
  s_add_u32 s73, s73, 4096
  v_exp_f32 v186, v186
  v_exp_f32 v187, v187
  v_cvt_pk_bf16_f32 v220, v184, v185
  v_mfma_f32_32x32x16_bf16 v[80:95], v[40:43], v[204:207], v[80:95]
  v_exp_f32 v188, v188
  v_exp_f32 v189, v189
  v_cvt_pk_bf16_f32 v221, v186, v187
  v_exp_f32 v190, v190
  v_mfma_f32_32x32x16_bf16 a[48:63], a[140:143], a[132:135], a[48:63]
  buffer_load_dwordx4 a[128:131], v2, s[16:19], s83 offen sc1
  buffer_load_dwordx4 a[136:139], v2, s[16:19], s73 offen sc1
  buffer_load_dwordx4 a[132:135], v54, s[16:19], s83 offen sc1
  buffer_load_dwordx4 a[140:143], v54, s[16:19], s73 offen sc1
  v_exp_f32 v191, v191
  v_cvt_pk_bf16_f32 v222, v188, v189
  v_cvt_pk_bf16_f32 v223, v190, v191
  s_waitcnt lgkmcnt(0)
  v_mfma_f32_32x32x16_bf16 v[160:175], v[32:35], v[20:23], v[224:239]
  ds_read_b128 v[28:31], v3 offset:4096
  ds_read_b128 v[36:39], v4 offset:3072
  ds_read_b128 v[40:43], v4 offset:3584
  v_exp_f32 v128, v128
  v_exp_f32 v129, v129
  v_exp_f32 v130, v130
  v_exp_f32 v131, v131
  v_cvt_pk_bf16_f32 v192, v128, v129
  s_waitcnt vmcnt(28)
  v_mfma_f32_32x32x16_bf16 a[0:15], a[152:155], a[144:147], a[0:15]
  v_exp_f32 v132, v132
  v_exp_f32 v133, v133
  v_cvt_pk_bf16_f32 v193, v130, v131
  v_exp_f32 v134, v134
  v_exp_f32 v135, v135
  v_mfma_f32_32x32x16_bf16 v[176:191], v[32:35], v[24:27], v[240:255]
  v_cvt_pk_bf16_f32 v194, v132, v133
  v_exp_f32 v136, v136
  v_exp_f32 v137, v137
  v_cvt_pk_bf16_f32 v195, v134, v135
  v_mfma_f32_32x32x16_bf16 a[16:31], a[152:155], a[148:151], a[16:31]
  v_exp_f32 v138, v138
  v_exp_f32 v139, v139
  v_cvt_pk_bf16_f32 v196, v136, v137
  v_exp_f32 v140, v140
  v_exp_f32 v141, v141
  v_mfma_f32_32x32x16_bf16 v[64:79], v[44:47], v[208:211], v[64:79]
  v_cvt_pk_bf16_f32 v197, v138, v139
  v_exp_f32 v142, v142
  v_exp_f32 v143, v143
  v_cvt_pk_bf16_f32 v198, v140, v141
  v_cvt_pk_bf16_f32 v199, v142, v143
  v_mfma_f32_32x32x16_bf16 a[32:47], a[156:159], a[144:147], a[32:47]
  v_exp_f32 v144, v144
  v_exp_f32 v145, v145
  v_exp_f32 v146, v146
  v_exp_f32 v147, v147
  v_cvt_pk_bf16_f32 v200, v144, v145
  v_mfma_f32_32x32x16_bf16 v[80:95], v[44:47], v[216:219], v[80:95]
  v_exp_f32 v148, v148
  v_exp_f32 v149, v149
  v_cvt_pk_bf16_f32 v201, v146, v147
  v_exp_f32 v150, v150
  v_exp_f32 v151, v151
  v_mfma_f32_32x32x16_bf16 v[64:79], v[48:51], v[212:215], v[64:79]
  v_cvt_pk_bf16_f32 v202, v148, v149
  v_exp_f32 v152, v152
  v_exp_f32 v153, v153
  v_cvt_pk_bf16_f32 v203, v150, v151
  v_mfma_f32_32x32x16_bf16 a[48:63], a[156:159], a[148:151], a[48:63]
  buffer_load_dwordx4 a[144:147], v2, s[16:19], s83 offen offset:1024 sc1
  buffer_load_dwordx4 a[152:155], v2, s[16:19], s73 offen offset:1024 sc1
  v_exp_f32 v154, v154
  v_exp_f32 v155, v155
  v_cvt_pk_bf16_f32 v204, v152, v153
  v_exp_f32 v156, v156
  v_exp_f32 v157, v157
  v_mfma_f32_32x32x16_bf16 v[80:95], v[48:51], v[220:223], v[80:95]
  buffer_load_dwordx4 a[148:151], v54, s[16:19], s83 offen offset:1024 sc1
  buffer_load_dwordx4 a[156:159], v54, s[16:19], s73 offen offset:1024 sc1
  v_cvt_pk_bf16_f32 v205, v154, v155
  v_exp_f32 v158, v158
  v_exp_f32 v159, v159
  v_cvt_pk_bf16_f32 v206, v156, v157
  v_cvt_pk_bf16_f32 v207, v158, v159
  v_add_u32 v3, 4096, v3
  v_add_u32 v4, v4, v5
  s_waitcnt lgkmcnt(0)
  v_mfma_f32_32x32x16_bf16 v[128:143], v[28:31], v[20:23], v[224:239]
  ds_read_b128 v[32:35], v3 offset:1024
  ds_read_b128 v[44:47], v4
  ds_read_b128 v[48:51], v4 offset:512
  v_exp_f32 v160, v160
  v_exp_f32 v161, v161
  v_exp_f32 v162, v162
  s_waitcnt vmcnt(28)
  v_mfma_f32_32x32x16_bf16 a[0:15], a[168:171], a[160:163], a[0:15]
  v_exp_f32 v163, v163
  v_cvt_pk_bf16_f32 v208, v160, v161
  v_exp_f32 v164, v164
  v_exp_f32 v165, v165
  v_mfma_f32_32x32x16_bf16 a[16:31], a[168:171], a[164:167], a[16:31]
  v_cvt_pk_bf16_f32 v209, v162, v163
  v_exp_f32 v166, v166
  v_exp_f32 v167, v167
  v_mfma_f32_32x32x16_bf16 v[144:159], v[28:31], v[24:27], v[240:255]
  v_cvt_pk_bf16_f32 v210, v164, v165
  v_exp_f32 v168, v168
  v_exp_f32 v169, v169
  v_cvt_pk_bf16_f32 v211, v166, v167
  v_mfma_f32_32x32x16_bf16 a[32:47], a[172:175], a[160:163], a[32:47]
  v_exp_f32 v170, v170
  v_exp_f32 v171, v171
  v_cvt_pk_bf16_f32 v212, v168, v169
  v_mfma_f32_32x32x16_bf16 v[64:79], v[36:39], v[192:195], v[64:79]
  v_exp_f32 v172, v172
  v_exp_f32 v173, v173
  v_cvt_pk_bf16_f32 v213, v170, v171
  v_exp_f32 v174, v174
  v_mfma_f32_32x32x16_bf16 a[48:63], a[172:175], a[164:167], a[48:63]
  buffer_load_dwordx4 a[160:163], v2, s[16:19], s83 offen offset:2048 sc1
  v_exp_f32 v175, v175
  v_cvt_pk_bf16_f32 v214, v172, v173
  v_cvt_pk_bf16_f32 v215, v174, v175
  s_waitcnt vmcnt(25)
  v_mfma_f32_32x32x16_bf16 a[0:15], a[184:187], a[176:179], a[0:15]
  buffer_load_dwordx4 a[168:171], v2, s[16:19], s73 offen offset:2048 sc1
  v_exp_f32 v176, v176
  v_exp_f32 v177, v177
  v_exp_f32 v178, v178
  v_mfma_f32_32x32x16_bf16 v[80:95], v[36:39], v[200:203], v[80:95]
  buffer_load_dwordx4 a[164:167], v54, s[16:19], s83 offen offset:2048 sc1
  v_exp_f32 v179, v179
  v_cvt_pk_bf16_f32 v216, v176, v177
  v_exp_f32 v180, v180
  v_exp_f32 v181, v181
  v_mfma_f32_32x32x16_bf16 a[16:31], a[184:187], a[180:183], a[16:31]
  buffer_load_dwordx4 a[172:175], v54, s[16:19], s73 offen offset:2048 sc1
  v_cvt_pk_bf16_f32 v217, v178, v179
  v_exp_f32 v182, v182
  v_exp_f32 v183, v183
  v_mfma_f32_32x32x16_bf16 v[64:79], v[40:43], v[196:199], v[64:79]
  v_cvt_pk_bf16_f32 v218, v180, v181
  v_exp_f32 v184, v184
  v_exp_f32 v185, v185
  v_cvt_pk_bf16_f32 v219, v182, v183
  v_mfma_f32_32x32x16_bf16 a[32:47], a[188:191], a[176:179], a[32:47]
  v_exp_f32 v186, v186
  v_exp_f32 v187, v187
  v_cvt_pk_bf16_f32 v220, v184, v185
  v_mfma_f32_32x32x16_bf16 v[80:95], v[40:43], v[204:207], v[80:95]
  v_exp_f32 v188, v188
  v_exp_f32 v189, v189
  v_cvt_pk_bf16_f32 v221, v186, v187
  v_exp_f32 v190, v190
  v_mfma_f32_32x32x16_bf16 a[48:63], a[188:191], a[180:183], a[48:63]
  buffer_load_dwordx4 a[176:179], v2, s[16:19], s83 offen offset:3072 sc1
  buffer_load_dwordx4 a[184:187], v2, s[16:19], s73 offen offset:3072 sc1
  buffer_load_dwordx4 a[180:183], v54, s[16:19], s83 offen offset:3072 sc1
  buffer_load_dwordx4 a[188:191], v54, s[16:19], s73 offen offset:3072 sc1
  s_add_u32 s83, s83, 4096
  s_add_u32 s73, s73, 4096
  v_exp_f32 v191, v191
  v_cvt_pk_bf16_f32 v222, v188, v189
  v_cvt_pk_bf16_f32 v223, v190, v191
  s_waitcnt lgkmcnt(0)
  v_mfma_f32_32x32x16_bf16 v[160:175], v[32:35], v[20:23], v[224:239]
  ds_read_b128 v[28:31], v3 offset:2048
  ds_read_b128 v[36:39], v4 offset:1024
  ds_read_b128 v[40:43], v4 offset:1536
  v_exp_f32 v128, v128
  v_exp_f32 v129, v129
  v_exp_f32 v130, v130
  v_exp_f32 v131, v131
  v_cvt_pk_bf16_f32 v192, v128, v129
  s_waitcnt vmcnt(28)
  v_mfma_f32_32x32x16_bf16 a[0:15], a[72:75], a[64:67], a[0:15]
  v_exp_f32 v132, v132
  v_exp_f32 v133, v133
  v_cvt_pk_bf16_f32 v193, v130, v131
  v_exp_f32 v134, v134
  v_exp_f32 v135, v135
  v_mfma_f32_32x32x16_bf16 v[176:191], v[32:35], v[24:27], v[240:255]
  v_cvt_pk_bf16_f32 v194, v132, v133
  v_exp_f32 v136, v136
  v_exp_f32 v137, v137
  v_cvt_pk_bf16_f32 v195, v134, v135
  v_mfma_f32_32x32x16_bf16 a[16:31], a[72:75], a[68:71], a[16:31]
  v_exp_f32 v138, v138
  v_exp_f32 v139, v139
  v_cvt_pk_bf16_f32 v196, v136, v137
  v_exp_f32 v140, v140
  v_exp_f32 v141, v141
  v_mfma_f32_32x32x16_bf16 v[64:79], v[44:47], v[208:211], v[64:79]
  v_cvt_pk_bf16_f32 v197, v138, v139
  v_exp_f32 v142, v142
  v_exp_f32 v143, v143
  v_cvt_pk_bf16_f32 v198, v140, v141
  v_cvt_pk_bf16_f32 v199, v142, v143
  v_mfma_f32_32x32x16_bf16 a[32:47], a[76:79], a[64:67], a[32:47]
  v_exp_f32 v144, v144
  v_exp_f32 v145, v145
  v_exp_f32 v146, v146
  v_exp_f32 v147, v147
  v_cvt_pk_bf16_f32 v200, v144, v145
  v_mfma_f32_32x32x16_bf16 v[80:95], v[44:47], v[216:219], v[80:95]
  v_exp_f32 v148, v148
  v_exp_f32 v149, v149
  v_cvt_pk_bf16_f32 v201, v146, v147
  v_exp_f32 v150, v150
  v_exp_f32 v151, v151
  v_mfma_f32_32x32x16_bf16 v[64:79], v[48:51], v[212:215], v[64:79]
  v_cvt_pk_bf16_f32 v202, v148, v149
  v_exp_f32 v152, v152
  v_exp_f32 v153, v153
  v_cvt_pk_bf16_f32 v203, v150, v151
  v_mfma_f32_32x32x16_bf16 a[48:63], a[76:79], a[68:71], a[48:63]
  buffer_load_dwordx4 a[64:67], v2, s[16:19], s83 offen sc1
  buffer_load_dwordx4 a[72:75], v2, s[16:19], s73 offen sc1
  v_exp_f32 v154, v154
  v_exp_f32 v155, v155
  v_cvt_pk_bf16_f32 v204, v152, v153
  v_exp_f32 v156, v156
  v_exp_f32 v157, v157
  v_mfma_f32_32x32x16_bf16 v[80:95], v[48:51], v[220:223], v[80:95]
  buffer_load_dwordx4 a[68:71], v54, s[16:19], s83 offen sc1
  buffer_load_dwordx4 a[76:79], v54, s[16:19], s73 offen sc1
  v_cvt_pk_bf16_f32 v205, v154, v155
  v_exp_f32 v158, v158
  v_exp_f32 v159, v159
  v_cvt_pk_bf16_f32 v206, v156, v157
  v_cvt_pk_bf16_f32 v207, v158, v159
  s_waitcnt lgkmcnt(0)
  v_mfma_f32_32x32x16_bf16 v[128:143], v[28:31], v[20:23], v[224:239]
  ds_read_b128 v[32:35], v3 offset:3072
  ds_read_b128 v[44:47], v4 offset:2048
  ds_read_b128 v[48:51], v4 offset:2560
  v_exp_f32 v160, v160
  v_exp_f32 v161, v161
  v_exp_f32 v162, v162
  v_exp_f32 v163, v163
  v_cvt_pk_bf16_f32 v208, v160, v161
  s_waitcnt vmcnt(28)
  v_mfma_f32_32x32x16_bf16 a[0:15], a[88:91], a[80:83], a[0:15]
  v_exp_f32 v164, v164
  v_exp_f32 v165, v165
  v_cvt_pk_bf16_f32 v209, v162, v163
  v_exp_f32 v166, v166
  v_exp_f32 v167, v167
  v_mfma_f32_32x32x16_bf16 v[144:159], v[28:31], v[24:27], v[240:255]
  v_cvt_pk_bf16_f32 v210, v164, v165
  v_exp_f32 v168, v168
  v_exp_f32 v169, v169
  v_cvt_pk_bf16_f32 v211, v166, v167
  v_mfma_f32_32x32x16_bf16 a[16:31], a[88:91], a[84:87], a[16:31]
  v_exp_f32 v170, v170
  v_exp_f32 v171, v171
  v_cvt_pk_bf16_f32 v212, v168, v169
  v_exp_f32 v172, v172
  v_exp_f32 v173, v173
  v_mfma_f32_32x32x16_bf16 v[64:79], v[36:39], v[192:195], v[64:79]
  v_cvt_pk_bf16_f32 v213, v170, v171
  v_exp_f32 v174, v174
  v_exp_f32 v175, v175
  v_cvt_pk_bf16_f32 v214, v172, v173
  v_cvt_pk_bf16_f32 v215, v174, v175
  v_mfma_f32_32x32x16_bf16 a[32:47], a[92:95], a[80:83], a[32:47]
  v_exp_f32 v176, v176
  v_exp_f32 v177, v177
  v_exp_f32 v178, v178
  v_exp_f32 v179, v179
  v_cvt_pk_bf16_f32 v216, v176, v177
  v_mfma_f32_32x32x16_bf16 v[80:95], v[36:39], v[200:203], v[80:95]
  v_exp_f32 v180, v180
  v_exp_f32 v181, v181
  v_cvt_pk_bf16_f32 v217, v178, v179
  v_exp_f32 v182, v182
  v_exp_f32 v183, v183
  v_mfma_f32_32x32x16_bf16 v[64:79], v[40:43], v[196:199], v[64:79]
  v_cvt_pk_bf16_f32 v218, v180, v181
  v_exp_f32 v184, v184
  v_exp_f32 v185, v185
  v_cvt_pk_bf16_f32 v219, v182, v183
  v_mfma_f32_32x32x16_bf16 a[48:63], a[92:95], a[84:87], a[48:63]
  buffer_load_dwordx4 a[80:83], v2, s[16:19], s83 offen offset:1024 sc1
  buffer_load_dwordx4 a[88:91], v2, s[16:19], s73 offen offset:1024 sc1
  v_exp_f32 v186, v186
  v_exp_f32 v187, v187
  v_cvt_pk_bf16_f32 v220, v184, v185
  v_exp_f32 v188, v188
  v_exp_f32 v189, v189
  v_mfma_f32_32x32x16_bf16 v[80:95], v[40:43], v[204:207], v[80:95]
  buffer_load_dwordx4 a[84:87], v54, s[16:19], s83 offen offset:1024 sc1
  buffer_load_dwordx4 a[92:95], v54, s[16:19], s73 offen offset:1024 sc1
  v_cvt_pk_bf16_f32 v221, v186, v187
  v_exp_f32 v190, v190
  v_exp_f32 v191, v191
  v_cvt_pk_bf16_f32 v222, v188, v189
  v_cvt_pk_bf16_f32 v223, v190, v191
  s_waitcnt lgkmcnt(0)
  v_mfma_f32_32x32x16_bf16 v[160:175], v[32:35], v[20:23], v[224:239]
  ds_read_b128 v[28:31], v3 offset:4096
  ds_read_b128 v[36:39], v4 offset:3072
  ds_read_b128 v[40:43], v4 offset:3584
  v_exp_f32 v128, v128
  v_exp_f32 v129, v129
  v_exp_f32 v130, v130
  s_waitcnt vmcnt(28)
  v_mfma_f32_32x32x16_bf16 a[0:15], a[104:107], a[96:99], a[0:15]
  v_exp_f32 v131, v131
  v_cvt_pk_bf16_f32 v192, v128, v129
  v_exp_f32 v132, v132
  v_exp_f32 v133, v133
  v_mfma_f32_32x32x16_bf16 a[16:31], a[104:107], a[100:103], a[16:31]
  v_cvt_pk_bf16_f32 v193, v130, v131
  v_exp_f32 v134, v134
  v_exp_f32 v135, v135
  v_mfma_f32_32x32x16_bf16 v[176:191], v[32:35], v[24:27], v[240:255]
  v_cvt_pk_bf16_f32 v194, v132, v133
  v_exp_f32 v136, v136
  v_exp_f32 v137, v137
  v_cvt_pk_bf16_f32 v195, v134, v135
  v_mfma_f32_32x32x16_bf16 a[32:47], a[108:111], a[96:99], a[32:47]
  v_exp_f32 v138, v138
  v_exp_f32 v139, v139
  v_cvt_pk_bf16_f32 v196, v136, v137
  v_mfma_f32_32x32x16_bf16 v[64:79], v[44:47], v[208:211], v[64:79]
  v_exp_f32 v140, v140
  v_exp_f32 v141, v141
  v_cvt_pk_bf16_f32 v197, v138, v139
  v_exp_f32 v142, v142
  v_mfma_f32_32x32x16_bf16 a[48:63], a[108:111], a[100:103], a[48:63]
  buffer_load_dwordx4 a[96:99], v2, s[16:19], s83 offen offset:2048 sc1
  v_exp_f32 v143, v143
  v_cvt_pk_bf16_f32 v198, v140, v141
  v_cvt_pk_bf16_f32 v199, v142, v143
  s_waitcnt vmcnt(25)
  v_mfma_f32_32x32x16_bf16 a[0:15], a[120:123], a[112:115], a[0:15]
  buffer_load_dwordx4 a[104:107], v2, s[16:19], s73 offen offset:2048 sc1
  v_exp_f32 v144, v144
  v_exp_f32 v145, v145
  v_exp_f32 v146, v146
  v_mfma_f32_32x32x16_bf16 v[80:95], v[44:47], v[216:219], v[80:95]
  buffer_load_dwordx4 a[100:103], v54, s[16:19], s83 offen offset:2048 sc1
  v_exp_f32 v147, v147
  v_cvt_pk_bf16_f32 v200, v144, v145
  v_exp_f32 v148, v148
  v_exp_f32 v149, v149
  v_mfma_f32_32x32x16_bf16 a[16:31], a[120:123], a[116:119], a[16:31]
  buffer_load_dwordx4 a[108:111], v54, s[16:19], s73 offen offset:2048 sc1
  v_cvt_pk_bf16_f32 v201, v146, v147
  v_exp_f32 v150, v150
  v_exp_f32 v151, v151
  v_mfma_f32_32x32x16_bf16 v[64:79], v[48:51], v[212:215], v[64:79]
  v_cvt_pk_bf16_f32 v202, v148, v149
  v_exp_f32 v152, v152
  v_exp_f32 v153, v153
  v_cvt_pk_bf16_f32 v203, v150, v151
  v_mfma_f32_32x32x16_bf16 a[32:47], a[124:127], a[112:115], a[32:47]
  v_exp_f32 v154, v154
  v_exp_f32 v155, v155
  v_cvt_pk_bf16_f32 v204, v152, v153
  v_mfma_f32_32x32x16_bf16 v[80:95], v[48:51], v[220:223], v[80:95]
  v_exp_f32 v156, v156
  v_exp_f32 v157, v157
  v_cvt_pk_bf16_f32 v205, v154, v155
  v_exp_f32 v158, v158
  v_mfma_f32_32x32x16_bf16 a[48:63], a[124:127], a[116:119], a[48:63]
  buffer_load_dwordx4 a[112:115], v2, s[16:19], s83 offen offset:3072 sc1
  buffer_load_dwordx4 a[120:123], v2, s[16:19], s73 offen offset:3072 sc1
  buffer_load_dwordx4 a[116:119], v54, s[16:19], s83 offen offset:3072 sc1
  buffer_load_dwordx4 a[124:127], v54, s[16:19], s73 offen offset:3072 sc1
  s_add_u32 s83, s83, 4096
  s_add_u32 s73, s73, 4096
  v_exp_f32 v159, v159
  v_cvt_pk_bf16_f32 v206, v156, v157
  v_cvt_pk_bf16_f32 v207, v158, v159
  v_add_u32 v3, 4096, v3
  v_add_u32 v4, v4, v5
  s_waitcnt lgkmcnt(0)
  v_mfma_f32_32x32x16_bf16 v[128:143], v[28:31], v[20:23], v[224:239]
  ds_read_b128 v[32:35], v3 offset:1024
  ds_read_b128 v[44:47], v4
  ds_read_b128 v[48:51], v4 offset:512
  v_exp_f32 v160, v160
  v_exp_f32 v161, v161
  v_exp_f32 v162, v162
  v_exp_f32 v163, v163
  v_cvt_pk_bf16_f32 v208, v160, v161
  s_waitcnt vmcnt(28)
  v_mfma_f32_32x32x16_bf16 a[0:15], a[136:139], a[128:131], a[0:15]
  v_exp_f32 v164, v164
  v_exp_f32 v165, v165
  v_cvt_pk_bf16_f32 v209, v162, v163
  v_exp_f32 v166, v166
  v_exp_f32 v167, v167
  v_mfma_f32_32x32x16_bf16 v[144:159], v[28:31], v[24:27], v[240:255]
  v_cvt_pk_bf16_f32 v210, v164, v165
  v_exp_f32 v168, v168
  v_exp_f32 v169, v169
  v_cvt_pk_bf16_f32 v211, v166, v167
  v_mfma_f32_32x32x16_bf16 a[16:31], a[136:139], a[132:135], a[16:31]
  v_exp_f32 v170, v170
  v_exp_f32 v171, v171
  v_cvt_pk_bf16_f32 v212, v168, v169
  v_exp_f32 v172, v172
  v_exp_f32 v173, v173
  v_mfma_f32_32x32x16_bf16 v[64:79], v[36:39], v[192:195], v[64:79]
  v_cvt_pk_bf16_f32 v213, v170, v171
  v_exp_f32 v174, v174
  v_exp_f32 v175, v175
  v_cvt_pk_bf16_f32 v214, v172, v173
  v_cvt_pk_bf16_f32 v215, v174, v175
  v_mfma_f32_32x32x16_bf16 a[32:47], a[140:143], a[128:131], a[32:47]
  v_exp_f32 v176, v176
  v_exp_f32 v177, v177
  v_exp_f32 v178, v178
  v_exp_f32 v179, v179
  v_cvt_pk_bf16_f32 v216, v176, v177
  v_mfma_f32_32x32x16_bf16 v[80:95], v[36:39], v[200:203], v[80:95]
  v_exp_f32 v180, v180
  v_exp_f32 v181, v181
  v_cvt_pk_bf16_f32 v217, v178, v179
  v_exp_f32 v182, v182
  v_exp_f32 v183, v183
  v_mfma_f32_32x32x16_bf16 v[64:79], v[40:43], v[196:199], v[64:79]
  v_cvt_pk_bf16_f32 v218, v180, v181
  v_exp_f32 v184, v184
  v_exp_f32 v185, v185
  v_cvt_pk_bf16_f32 v219, v182, v183
  v_mfma_f32_32x32x16_bf16 a[48:63], a[140:143], a[132:135], a[48:63]
  buffer_load_dwordx4 a[128:131], v2, s[16:19], s83 offen sc1
  buffer_load_dwordx4 a[136:139], v2, s[16:19], s73 offen sc1
  v_exp_f32 v186, v186
  v_exp_f32 v187, v187
  v_cvt_pk_bf16_f32 v220, v184, v185
  v_exp_f32 v188, v188
  v_exp_f32 v189, v189
  v_mfma_f32_32x32x16_bf16 v[80:95], v[40:43], v[204:207], v[80:95]
  buffer_load_dwordx4 a[132:135], v54, s[16:19], s83 offen sc1
  buffer_load_dwordx4 a[140:143], v54, s[16:19], s73 offen sc1
  v_cvt_pk_bf16_f32 v221, v186, v187
  v_exp_f32 v190, v190
  v_exp_f32 v191, v191
  v_cvt_pk_bf16_f32 v222, v188, v189
  v_cvt_pk_bf16_f32 v223, v190, v191
  s_waitcnt lgkmcnt(0)
  v_mfma_f32_32x32x16_bf16 v[160:175], v[32:35], v[20:23], v[224:239]
  ds_read_b128 v[28:31], v3 offset:2048
  ds_read_b128 v[36:39], v4 offset:1024
  ds_read_b128 v[40:43], v4 offset:1536
  v_exp_f32 v128, v128
  v_exp_f32 v129, v129
  v_exp_f32 v130, v130
  s_waitcnt vmcnt(28)
  v_mfma_f32_32x32x16_bf16 a[0:15], a[152:155], a[144:147], a[0:15]
  v_exp_f32 v131, v131
  v_cvt_pk_bf16_f32 v192, v128, v129
  v_exp_f32 v132, v132
  v_exp_f32 v133, v133
  v_mfma_f32_32x32x16_bf16 a[16:31], a[152:155], a[148:151], a[16:31]
  v_cvt_pk_bf16_f32 v193, v130, v131
  v_exp_f32 v134, v134
  v_exp_f32 v135, v135
  v_mfma_f32_32x32x16_bf16 v[176:191], v[32:35], v[24:27], v[240:255]
  v_cvt_pk_bf16_f32 v194, v132, v133
  v_exp_f32 v136, v136
  v_exp_f32 v137, v137
  v_cvt_pk_bf16_f32 v195, v134, v135
  v_mfma_f32_32x32x16_bf16 a[32:47], a[156:159], a[144:147], a[32:47]
  v_exp_f32 v138, v138
  v_exp_f32 v139, v139
  v_cvt_pk_bf16_f32 v196, v136, v137
  v_mfma_f32_32x32x16_bf16 v[64:79], v[44:47], v[208:211], v[64:79]
  v_exp_f32 v140, v140
  v_exp_f32 v141, v141
  v_cvt_pk_bf16_f32 v197, v138, v139
  v_exp_f32 v142, v142
  v_mfma_f32_32x32x16_bf16 a[48:63], a[156:159], a[148:151], a[48:63]
  buffer_load_dwordx4 a[144:147], v2, s[16:19], s83 offen offset:1024 sc1
  v_exp_f32 v143, v143
  v_cvt_pk_bf16_f32 v198, v140, v141
  v_cvt_pk_bf16_f32 v199, v142, v143
  s_waitcnt vmcnt(25)
  v_mfma_f32_32x32x16_bf16 a[0:15], a[168:171], a[160:163], a[0:15]
  buffer_load_dwordx4 a[152:155], v2, s[16:19], s73 offen offset:1024 sc1
  v_exp_f32 v144, v144
  v_exp_f32 v145, v145
  v_exp_f32 v146, v146
  v_mfma_f32_32x32x16_bf16 v[80:95], v[44:47], v[216:219], v[80:95]
  buffer_load_dwordx4 a[148:151], v54, s[16:19], s83 offen offset:1024 sc1
  v_exp_f32 v147, v147
  v_cvt_pk_bf16_f32 v200, v144, v145
  v_exp_f32 v148, v148
  v_exp_f32 v149, v149
  v_mfma_f32_32x32x16_bf16 a[16:31], a[168:171], a[164:167], a[16:31]
  buffer_load_dwordx4 a[156:159], v54, s[16:19], s73 offen offset:1024 sc1
  v_cvt_pk_bf16_f32 v201, v146, v147
  v_exp_f32 v150, v150
  v_exp_f32 v151, v151
  v_mfma_f32_32x32x16_bf16 v[64:79], v[48:51], v[212:215], v[64:79]
  v_cvt_pk_bf16_f32 v202, v148, v149
  v_exp_f32 v152, v152
  v_exp_f32 v153, v153
  v_cvt_pk_bf16_f32 v203, v150, v151
  v_mfma_f32_32x32x16_bf16 a[32:47], a[172:175], a[160:163], a[32:47]
  v_exp_f32 v154, v154
  v_exp_f32 v155, v155
  v_cvt_pk_bf16_f32 v204, v152, v153
  v_mfma_f32_32x32x16_bf16 v[80:95], v[48:51], v[220:223], v[80:95]
  v_exp_f32 v156, v156
  v_exp_f32 v157, v157
  v_cvt_pk_bf16_f32 v205, v154, v155
  v_exp_f32 v158, v158
  v_mfma_f32_32x32x16_bf16 a[48:63], a[172:175], a[164:167], a[48:63]
  buffer_load_dwordx4 a[160:163], v2, s[16:19], s83 offen offset:2048 sc1
  buffer_load_dwordx4 a[168:171], v2, s[16:19], s73 offen offset:2048 sc1
  buffer_load_dwordx4 a[164:167], v54, s[16:19], s83 offen offset:2048 sc1
  buffer_load_dwordx4 a[172:175], v54, s[16:19], s73 offen offset:2048 sc1
  v_exp_f32 v159, v159
  v_cvt_pk_bf16_f32 v206, v156, v157
  v_cvt_pk_bf16_f32 v207, v158, v159
  s_waitcnt lgkmcnt(0)
  v_mfma_f32_32x32x16_bf16 v[128:143], v[28:31], v[20:23], v[224:239]
  ds_read_b128 v[32:35], v3 offset:3072
  ds_read_b128 v[44:47], v4 offset:2048
  ds_read_b128 v[48:51], v4 offset:2560
  v_exp_f32 v160, v160
  v_exp_f32 v161, v161
  v_exp_f32 v162, v162
  v_exp_f32 v163, v163
  v_cvt_pk_bf16_f32 v208, v160, v161
  s_waitcnt vmcnt(28)
  v_mfma_f32_32x32x16_bf16 a[0:15], a[184:187], a[176:179], a[0:15]
  v_exp_f32 v164, v164
  v_exp_f32 v165, v165
  v_cvt_pk_bf16_f32 v209, v162, v163
  v_exp_f32 v166, v166
  v_exp_f32 v167, v167
  v_mfma_f32_32x32x16_bf16 v[144:159], v[28:31], v[24:27], v[240:255]
  v_cvt_pk_bf16_f32 v210, v164, v165
  v_exp_f32 v168, v168
  v_exp_f32 v169, v169
  v_cvt_pk_bf16_f32 v211, v166, v167
  v_mfma_f32_32x32x16_bf16 a[16:31], a[184:187], a[180:183], a[16:31]
  v_exp_f32 v170, v170
  v_exp_f32 v171, v171
  v_cvt_pk_bf16_f32 v212, v168, v169
  v_exp_f32 v172, v172
  v_exp_f32 v173, v173
  v_mfma_f32_32x32x16_bf16 v[64:79], v[36:39], v[192:195], v[64:79]
  v_cvt_pk_bf16_f32 v213, v170, v171
  v_exp_f32 v174, v174
  v_exp_f32 v175, v175
  v_cvt_pk_bf16_f32 v214, v172, v173
  v_cvt_pk_bf16_f32 v215, v174, v175
  v_mfma_f32_32x32x16_bf16 a[32:47], a[188:191], a[176:179], a[32:47]
  v_exp_f32 v176, v176
  v_exp_f32 v177, v177
  v_exp_f32 v178, v178
  v_exp_f32 v179, v179
  v_cvt_pk_bf16_f32 v216, v176, v177
  v_mfma_f32_32x32x16_bf16 v[80:95], v[36:39], v[200:203], v[80:95]
  v_exp_f32 v180, v180
  v_exp_f32 v181, v181
  v_cvt_pk_bf16_f32 v217, v178, v179
  v_exp_f32 v182, v182
  v_exp_f32 v183, v183
  v_mfma_f32_32x32x16_bf16 v[64:79], v[40:43], v[196:199], v[64:79]
  v_cvt_pk_bf16_f32 v218, v180, v181
  v_exp_f32 v184, v184
  v_exp_f32 v185, v185
  v_cvt_pk_bf16_f32 v219, v182, v183
  v_mfma_f32_32x32x16_bf16 a[48:63], a[188:191], a[180:183], a[48:63]
  buffer_load_dwordx4 a[176:179], v2, s[16:19], s83 offen offset:3072 sc1
  buffer_load_dwordx4 a[184:187], v2, s[16:19], s73 offen offset:3072 sc1
  buffer_load_dwordx4 a[180:183], v54, s[16:19], s83 offen offset:3072 sc1
  v_exp_f32 v186, v186
  v_exp_f32 v187, v187
  v_cvt_pk_bf16_f32 v220, v184, v185
  v_exp_f32 v188, v188
  v_exp_f32 v189, v189
  v_mfma_f32_32x32x16_bf16 v[80:95], v[40:43], v[204:207], v[80:95]
  buffer_load_dwordx4 a[188:191], v54, s[16:19], s73 offen offset:3072 sc1
  s_add_u32 s83, s83, 4096
  s_add_u32 s73, s73, 4096
  v_cvt_pk_bf16_f32 v221, v186, v187
  v_exp_f32 v190, v190
  v_exp_f32 v191, v191
  v_cvt_pk_bf16_f32 v222, v188, v189
  v_cvt_pk_bf16_f32 v223, v190, v191
  s_waitcnt lgkmcnt(0)
  v_mfma_f32_32x32x16_bf16 v[160:175], v[32:35], v[20:23], v[224:239]
  ds_read_b128 v[28:31], v3 offset:4096
  ds_read_b128 v[36:39], v4 offset:3072
  ds_read_b128 v[40:43], v4 offset:3584
  v_exp_f32 v128, v128
  v_exp_f32 v129, v129
  v_exp_f32 v130, v130
  s_waitcnt vmcnt(28)
  v_mfma_f32_32x32x16_bf16 a[0:15], a[72:75], a[64:67], a[0:15]
  v_exp_f32 v131, v131
  v_cvt_pk_bf16_f32 v192, v128, v129
  v_exp_f32 v132, v132
  v_exp_f32 v133, v133
  v_mfma_f32_32x32x16_bf16 a[16:31], a[72:75], a[68:71], a[16:31]
  v_cvt_pk_bf16_f32 v193, v130, v131
  v_exp_f32 v134, v134
  v_exp_f32 v135, v135
  v_mfma_f32_32x32x16_bf16 v[176:191], v[32:35], v[24:27], v[240:255]
  v_cvt_pk_bf16_f32 v194, v132, v133
  v_exp_f32 v136, v136
  v_exp_f32 v137, v137
  v_cvt_pk_bf16_f32 v195, v134, v135
  v_mfma_f32_32x32x16_bf16 a[32:47], a[76:79], a[64:67], a[32:47]
  v_exp_f32 v138, v138
  v_exp_f32 v139, v139
  v_cvt_pk_bf16_f32 v196, v136, v137
  v_mfma_f32_32x32x16_bf16 v[64:79], v[44:47], v[208:211], v[64:79]
  v_exp_f32 v140, v140
  v_exp_f32 v141, v141
  v_cvt_pk_bf16_f32 v197, v138, v139
  v_exp_f32 v142, v142
  v_mfma_f32_32x32x16_bf16 a[48:63], a[76:79], a[68:71], a[48:63]
  v_exp_f32 v143, v143
  v_cvt_pk_bf16_f32 v198, v140, v141
  v_cvt_pk_bf16_f32 v199, v142, v143
  s_waitcnt vmcnt(24)
  v_mfma_f32_32x32x16_bf16 a[0:15], a[88:91], a[80:83], a[0:15]
  v_exp_f32 v144, v144
  v_exp_f32 v145, v145
  v_exp_f32 v146, v146
  v_mfma_f32_32x32x16_bf16 v[80:95], v[44:47], v[216:219], v[80:95]
  v_exp_f32 v147, v147
  v_cvt_pk_bf16_f32 v200, v144, v145
  v_exp_f32 v148, v148
  v_exp_f32 v149, v149
  v_mfma_f32_32x32x16_bf16 a[16:31], a[88:91], a[84:87], a[16:31]
  v_cvt_pk_bf16_f32 v201, v146, v147
  v_exp_f32 v150, v150
  v_exp_f32 v151, v151
  v_mfma_f32_32x32x16_bf16 v[64:79], v[48:51], v[212:215], v[64:79]
  v_cvt_pk_bf16_f32 v202, v148, v149
  v_exp_f32 v152, v152
  v_exp_f32 v153, v153
  v_cvt_pk_bf16_f32 v203, v150, v151
  v_mfma_f32_32x32x16_bf16 a[32:47], a[92:95], a[80:83], a[32:47]
  v_exp_f32 v154, v154
  v_exp_f32 v155, v155
  v_cvt_pk_bf16_f32 v204, v152, v153
  v_mfma_f32_32x32x16_bf16 v[80:95], v[48:51], v[220:223], v[80:95]
  v_exp_f32 v156, v156
  v_exp_f32 v157, v157
  v_cvt_pk_bf16_f32 v205, v154, v155
  v_exp_f32 v158, v158
  v_mfma_f32_32x32x16_bf16 a[48:63], a[92:95], a[84:87], a[48:63]
  v_exp_f32 v159, v159
  v_cvt_pk_bf16_f32 v206, v156, v157
  v_cvt_pk_bf16_f32 v207, v158, v159
  v_add_u32 v3, 4096, v3
  v_add_u32 v4, v4, v5
  s_waitcnt lgkmcnt(0)
  v_mfma_f32_32x32x16_bf16 v[128:143], v[28:31], v[20:23], v[224:239]
  ds_read_b128 v[32:35], v3 offset:1024
  ds_read_b128 v[44:47], v4
  ds_read_b128 v[48:51], v4 offset:512
  v_exp_f32 v160, v160
  v_exp_f32 v161, v161
  v_exp_f32 v162, v162
  v_exp_f32 v163, v163
  v_cvt_pk_bf16_f32 v208, v160, v161
  s_waitcnt vmcnt(20)
  v_mfma_f32_32x32x16_bf16 a[0:15], a[104:107], a[96:99], a[0:15]
  v_exp_f32 v164, v164
  v_exp_f32 v165, v165
  v_cvt_pk_bf16_f32 v209, v162, v163
  v_exp_f32 v166, v166
  v_exp_f32 v167, v167
  v_mfma_f32_32x32x16_bf16 v[144:159], v[28:31], v[24:27], v[240:255]
  v_cvt_pk_bf16_f32 v210, v164, v165
  v_exp_f32 v168, v168
  v_exp_f32 v169, v169
  v_cvt_pk_bf16_f32 v211, v166, v167
  v_mfma_f32_32x32x16_bf16 a[16:31], a[104:107], a[100:103], a[16:31]
  v_exp_f32 v170, v170
  v_exp_f32 v171, v171
  v_cvt_pk_bf16_f32 v212, v168, v169
  v_exp_f32 v172, v172
  v_exp_f32 v173, v173
  v_mfma_f32_32x32x16_bf16 v[64:79], v[36:39], v[192:195], v[64:79]
  v_cvt_pk_bf16_f32 v213, v170, v171
  v_exp_f32 v174, v174
  v_exp_f32 v175, v175
  v_cvt_pk_bf16_f32 v214, v172, v173
  v_cvt_pk_bf16_f32 v215, v174, v175
  v_mfma_f32_32x32x16_bf16 a[32:47], a[108:111], a[96:99], a[32:47]
  v_exp_f32 v176, v176
  v_exp_f32 v177, v177
  v_exp_f32 v178, v178
  v_exp_f32 v179, v179
  v_cvt_pk_bf16_f32 v216, v176, v177
  v_mfma_f32_32x32x16_bf16 v[80:95], v[36:39], v[200:203], v[80:95]
  v_exp_f32 v180, v180
  v_exp_f32 v181, v181
  v_cvt_pk_bf16_f32 v217, v178, v179
  v_exp_f32 v182, v182
  v_exp_f32 v183, v183
  v_mfma_f32_32x32x16_bf16 v[64:79], v[40:43], v[196:199], v[64:79]
  v_cvt_pk_bf16_f32 v218, v180, v181
  v_exp_f32 v184, v184
  v_exp_f32 v185, v185
  v_cvt_pk_bf16_f32 v219, v182, v183
  v_mfma_f32_32x32x16_bf16 a[48:63], a[108:111], a[100:103], a[48:63]
  v_exp_f32 v186, v186
  v_exp_f32 v187, v187
  v_cvt_pk_bf16_f32 v220, v184, v185
  v_exp_f32 v188, v188
  v_exp_f32 v189, v189
  v_mfma_f32_32x32x16_bf16 v[80:95], v[40:43], v[204:207], v[80:95]
  v_cvt_pk_bf16_f32 v221, v186, v187
  v_exp_f32 v190, v190
  v_exp_f32 v191, v191
  v_cvt_pk_bf16_f32 v222, v188, v189
  v_cvt_pk_bf16_f32 v223, v190, v191
  s_waitcnt lgkmcnt(0)
  v_mfma_f32_32x32x16_bf16 v[160:175], v[32:35], v[20:23], v[224:239]
  ds_read_b128 v[28:31], v3 offset:2048
  ds_read_b128 v[36:39], v4 offset:1024
  ds_read_b128 v[40:43], v4 offset:1536
  v_exp_f32 v128, v128
  v_exp_f32 v129, v129
  v_exp_f32 v130, v130
  s_waitcnt vmcnt(16)
  v_mfma_f32_32x32x16_bf16 a[0:15], a[120:123], a[112:115], a[0:15]
  v_exp_f32 v131, v131
  v_cvt_pk_bf16_f32 v192, v128, v129
  v_exp_f32 v132, v132
  v_exp_f32 v133, v133
  v_mfma_f32_32x32x16_bf16 a[16:31], a[120:123], a[116:119], a[16:31]
  v_cvt_pk_bf16_f32 v193, v130, v131
  v_exp_f32 v134, v134
  v_exp_f32 v135, v135
  v_mfma_f32_32x32x16_bf16 v[176:191], v[32:35], v[24:27], v[240:255]
  v_cvt_pk_bf16_f32 v194, v132, v133
  v_exp_f32 v136, v136
  v_exp_f32 v137, v137
  v_cvt_pk_bf16_f32 v195, v134, v135
  v_mfma_f32_32x32x16_bf16 a[32:47], a[124:127], a[112:115], a[32:47]
  v_exp_f32 v138, v138
  v_exp_f32 v139, v139
  v_cvt_pk_bf16_f32 v196, v136, v137
  v_mfma_f32_32x32x16_bf16 v[64:79], v[44:47], v[208:211], v[64:79]
  v_exp_f32 v140, v140
  v_exp_f32 v141, v141
  v_cvt_pk_bf16_f32 v197, v138, v139
  v_exp_f32 v142, v142
  v_mfma_f32_32x32x16_bf16 a[48:63], a[124:127], a[116:119], a[48:63]
  v_exp_f32 v143, v143
  v_cvt_pk_bf16_f32 v198, v140, v141
  v_cvt_pk_bf16_f32 v199, v142, v143
  s_waitcnt vmcnt(12)
  v_mfma_f32_32x32x16_bf16 a[0:15], a[136:139], a[128:131], a[0:15]
  v_exp_f32 v144, v144
  v_exp_f32 v145, v145
  v_exp_f32 v146, v146
  v_mfma_f32_32x32x16_bf16 v[80:95], v[44:47], v[216:219], v[80:95]
  v_exp_f32 v147, v147
  v_cvt_pk_bf16_f32 v200, v144, v145
  v_exp_f32 v148, v148
  v_exp_f32 v149, v149
  v_mfma_f32_32x32x16_bf16 a[16:31], a[136:139], a[132:135], a[16:31]
  v_cvt_pk_bf16_f32 v201, v146, v147
  v_exp_f32 v150, v150
  v_exp_f32 v151, v151
  v_mfma_f32_32x32x16_bf16 v[64:79], v[48:51], v[212:215], v[64:79]
  v_cvt_pk_bf16_f32 v202, v148, v149
  v_exp_f32 v152, v152
  v_exp_f32 v153, v153
  v_cvt_pk_bf16_f32 v203, v150, v151
  v_mfma_f32_32x32x16_bf16 a[32:47], a[140:143], a[128:131], a[32:47]
  v_exp_f32 v154, v154
  v_exp_f32 v155, v155
  v_cvt_pk_bf16_f32 v204, v152, v153
  v_mfma_f32_32x32x16_bf16 v[80:95], v[48:51], v[220:223], v[80:95]
  v_exp_f32 v156, v156
  v_exp_f32 v157, v157
  v_cvt_pk_bf16_f32 v205, v154, v155
  v_exp_f32 v158, v158
  v_mfma_f32_32x32x16_bf16 a[48:63], a[140:143], a[132:135], a[48:63]
  v_exp_f32 v159, v159
  v_cvt_pk_bf16_f32 v206, v156, v157
  v_cvt_pk_bf16_f32 v207, v158, v159
  s_waitcnt lgkmcnt(0)
  v_mfma_f32_32x32x16_bf16 v[128:143], v[28:31], v[20:23], v[224:239]
  ds_read_b128 v[32:35], v3 offset:3072
  ds_read_b128 v[44:47], v4 offset:2048
  ds_read_b128 v[48:51], v4 offset:2560
  v_exp_f32 v160, v160
  v_exp_f32 v161, v161
  v_exp_f32 v162, v162
  v_exp_f32 v163, v163
  v_cvt_pk_bf16_f32 v208, v160, v161
  s_waitcnt vmcnt(8)
  v_mfma_f32_32x32x16_bf16 a[0:15], a[152:155], a[144:147], a[0:15]
  v_exp_f32 v164, v164
  v_exp_f32 v165, v165
  v_cvt_pk_bf16_f32 v209, v162, v163
  v_exp_f32 v166, v166
  v_exp_f32 v167, v167
  v_mfma_f32_32x32x16_bf16 v[144:159], v[28:31], v[24:27], v[240:255]
  v_cvt_pk_bf16_f32 v210, v164, v165
  v_exp_f32 v168, v168
  v_exp_f32 v169, v169
  v_cvt_pk_bf16_f32 v211, v166, v167
  v_mfma_f32_32x32x16_bf16 a[16:31], a[152:155], a[148:151], a[16:31]
  v_exp_f32 v170, v170
  v_exp_f32 v171, v171
  v_cvt_pk_bf16_f32 v212, v168, v169
  v_exp_f32 v172, v172
  v_exp_f32 v173, v173
  v_mfma_f32_32x32x16_bf16 v[64:79], v[36:39], v[192:195], v[64:79]
  v_cvt_pk_bf16_f32 v213, v170, v171
  v_exp_f32 v174, v174
  v_exp_f32 v175, v175
  v_cvt_pk_bf16_f32 v214, v172, v173
  v_cvt_pk_bf16_f32 v215, v174, v175
  v_mfma_f32_32x32x16_bf16 a[32:47], a[156:159], a[144:147], a[32:47]
  v_exp_f32 v176, v176
  v_exp_f32 v177, v177
  v_exp_f32 v178, v178
  v_exp_f32 v179, v179
  v_cvt_pk_bf16_f32 v216, v176, v177
  v_mfma_f32_32x32x16_bf16 v[80:95], v[36:39], v[200:203], v[80:95]
  v_exp_f32 v180, v180
  v_exp_f32 v181, v181
  v_cvt_pk_bf16_f32 v217, v178, v179
  v_exp_f32 v182, v182
  v_exp_f32 v183, v183
  v_mfma_f32_32x32x16_bf16 v[64:79], v[40:43], v[196:199], v[64:79]
  v_cvt_pk_bf16_f32 v218, v180, v181
  v_exp_f32 v184, v184
  v_exp_f32 v185, v185
  v_cvt_pk_bf16_f32 v219, v182, v183
  v_mfma_f32_32x32x16_bf16 a[48:63], a[156:159], a[148:151], a[48:63]
  v_exp_f32 v186, v186
  v_exp_f32 v187, v187
  v_cvt_pk_bf16_f32 v220, v184, v185
  v_exp_f32 v188, v188
  v_exp_f32 v189, v189
  v_mfma_f32_32x32x16_bf16 v[80:95], v[40:43], v[204:207], v[80:95]
  v_cvt_pk_bf16_f32 v221, v186, v187
  v_exp_f32 v190, v190
  v_exp_f32 v191, v191
  v_cvt_pk_bf16_f32 v222, v188, v189
  v_cvt_pk_bf16_f32 v223, v190, v191
  s_waitcnt lgkmcnt(0)
  v_mfma_f32_32x32x16_bf16 v[160:175], v[32:35], v[20:23], v[224:239]
  ds_read_b128 v[28:31], v3 offset:4096
  ds_read_b128 v[36:39], v4 offset:3072
  ds_read_b128 v[40:43], v4 offset:3584
  v_exp_f32 v128, v128
  v_exp_f32 v129, v129
  v_exp_f32 v130, v130
  s_waitcnt vmcnt(4)
  v_mfma_f32_32x32x16_bf16 a[0:15], a[168:171], a[160:163], a[0:15]
  v_exp_f32 v131, v131
  v_cvt_pk_bf16_f32 v192, v128, v129
  v_exp_f32 v132, v132
  v_exp_f32 v133, v133
  v_mfma_f32_32x32x16_bf16 a[16:31], a[168:171], a[164:167], a[16:31]
  v_cvt_pk_bf16_f32 v193, v130, v131
  v_exp_f32 v134, v134
  v_exp_f32 v135, v135
  v_mfma_f32_32x32x16_bf16 v[176:191], v[32:35], v[24:27], v[240:255]
  v_cvt_pk_bf16_f32 v194, v132, v133
  v_exp_f32 v136, v136
  v_exp_f32 v137, v137
  v_cvt_pk_bf16_f32 v195, v134, v135
  v_mfma_f32_32x32x16_bf16 a[32:47], a[172:175], a[160:163], a[32:47]
  v_exp_f32 v138, v138
  v_exp_f32 v139, v139
  v_cvt_pk_bf16_f32 v196, v136, v137
  v_mfma_f32_32x32x16_bf16 v[64:79], v[44:47], v[208:211], v[64:79]
  v_exp_f32 v140, v140
  v_exp_f32 v141, v141
  v_cvt_pk_bf16_f32 v197, v138, v139
  v_exp_f32 v142, v142
  v_mfma_f32_32x32x16_bf16 a[48:63], a[172:175], a[164:167], a[48:63]
  v_exp_f32 v143, v143
  v_cvt_pk_bf16_f32 v198, v140, v141
  v_cvt_pk_bf16_f32 v199, v142, v143
  s_waitcnt vmcnt(0)
  v_mfma_f32_32x32x16_bf16 a[0:15], a[184:187], a[176:179], a[0:15]
  v_exp_f32 v144, v144
  v_exp_f32 v145, v145
  v_exp_f32 v146, v146
  v_mfma_f32_32x32x16_bf16 v[80:95], v[44:47], v[216:219], v[80:95]
  v_exp_f32 v147, v147
  v_cvt_pk_bf16_f32 v200, v144, v145
  v_exp_f32 v148, v148
  v_exp_f32 v149, v149
  v_mfma_f32_32x32x16_bf16 a[16:31], a[184:187], a[180:183], a[16:31]
  v_cvt_pk_bf16_f32 v201, v146, v147
  v_exp_f32 v150, v150
  v_exp_f32 v151, v151
  v_mfma_f32_32x32x16_bf16 v[64:79], v[48:51], v[212:215], v[64:79]
  v_cvt_pk_bf16_f32 v202, v148, v149
  v_exp_f32 v152, v152
  v_exp_f32 v153, v153
  v_cvt_pk_bf16_f32 v203, v150, v151
  v_mfma_f32_32x32x16_bf16 a[32:47], a[188:191], a[176:179], a[32:47]
  v_exp_f32 v154, v154
  v_exp_f32 v155, v155
  v_cvt_pk_bf16_f32 v204, v152, v153
  v_mfma_f32_32x32x16_bf16 v[80:95], v[48:51], v[220:223], v[80:95]
  v_exp_f32 v156, v156
  v_exp_f32 v157, v157
  v_cvt_pk_bf16_f32 v205, v154, v155
  v_exp_f32 v158, v158
  v_mfma_f32_32x32x16_bf16 a[48:63], a[188:191], a[180:183], a[48:63]
  v_exp_f32 v159, v159
  v_cvt_pk_bf16_f32 v206, v156, v157
  v_cvt_pk_bf16_f32 v207, v158, v159
  v_add_u32 v3, 4096, v3
  v_add_u32 v4, v4, v5
  s_waitcnt lgkmcnt(0)
  v_mfma_f32_32x32x16_bf16 v[64:79], v[36:39], v[192:195], v[64:79]
  ds_read_b128 v[44:47], v4
  ds_read_b128 v[48:51], v4 offset:512
  v_exp_f32 v160, v160
  v_exp_f32 v161, v161
  v_exp_f32 v162, v162
  v_exp_f32 v163, v163
  v_cvt_pk_bf16_f32 v208, v160, v161
  v_exp_f32 v164, v164
  v_exp_f32 v165, v165
  v_cvt_pk_bf16_f32 v209, v162, v163
  v_exp_f32 v166, v166
  v_exp_f32 v167, v167
  v_cvt_pk_bf16_f32 v210, v164, v165
  v_exp_f32 v168, v168
  v_mfma_f32_32x32x16_bf16 v[80:95], v[36:39], v[200:203], v[80:95]
  v_exp_f32 v169, v169
  v_cvt_pk_bf16_f32 v211, v166, v167
  v_exp_f32 v170, v170
  v_exp_f32 v171, v171
  v_cvt_pk_bf16_f32 v212, v168, v169
  v_exp_f32 v172, v172
  v_exp_f32 v173, v173
  v_cvt_pk_bf16_f32 v213, v170, v171
  v_exp_f32 v174, v174
  v_exp_f32 v175, v175
  v_cvt_pk_bf16_f32 v214, v172, v173
  v_cvt_pk_bf16_f32 v215, v174, v175
  v_mfma_f32_32x32x16_bf16 v[64:79], v[40:43], v[196:199], v[64:79]
  v_exp_f32 v176, v176
  v_exp_f32 v177, v177
  v_exp_f32 v178, v178
  v_exp_f32 v179, v179
  v_cvt_pk_bf16_f32 v216, v176, v177
  v_exp_f32 v180, v180
  v_exp_f32 v181, v181
  v_cvt_pk_bf16_f32 v217, v178, v179
  v_exp_f32 v182, v182
  v_exp_f32 v183, v183
  v_cvt_pk_bf16_f32 v218, v180, v181
  v_exp_f32 v184, v184
  v_mfma_f32_32x32x16_bf16 v[80:95], v[40:43], v[204:207], v[80:95]
  v_exp_f32 v185, v185
  v_cvt_pk_bf16_f32 v219, v182, v183
  v_exp_f32 v186, v186
  v_exp_f32 v187, v187
  v_cvt_pk_bf16_f32 v220, v184, v185
  v_exp_f32 v188, v188
  v_exp_f32 v189, v189
  v_cvt_pk_bf16_f32 v221, v186, v187
  v_exp_f32 v190, v190
  v_exp_f32 v191, v191
  v_cvt_pk_bf16_f32 v222, v188, v189
  v_cvt_pk_bf16_f32 v223, v190, v191
  s_waitcnt lgkmcnt(0)
  v_mfma_f32_32x32x16_bf16 v[64:79], v[44:47], v[208:211], v[64:79]
  v_mfma_f32_32x32x16_bf16 v[80:95], v[44:47], v[216:219], v[80:95]
  v_mfma_f32_32x32x16_bf16 v[64:79], v[48:51], v[212:215], v[64:79]
  v_mfma_f32_32x32x16_bf16 v[80:95], v[48:51], v[220:223], v[80:95]
  v_mov_b32 v12, 0
  v_mov_b32 v10, 0x71800000
  v_mov_b32 v11, 0x7fc00000
  s_nop 7
  v_cmp_nle_f32 vcc, v72, v10
  v_rcp_f32 v9, v72
  s_nop 0
  v_cndmask_b32 v16, v16, v11, vcc
  v_mul_f32 v64, v64, v9
  v_mul_f32 v65, v65, v9
  v_mul_f32 v66, v66, v9
  v_mul_f32 v67, v67, v9
  v_mul_f32 v68, v68, v9
  v_mul_f32 v69, v69, v9
  v_mul_f32 v70, v70, v9
  v_mul_f32 v71, v71, v9
  v_cvt_pk_bf16_f32 v192, v64, v65
  v_cvt_pk_bf16_f32 v193, v66, v67
  v_cvt_pk_bf16_f32 v194, v68, v69
  v_cvt_pk_bf16_f32 v195, v70, v71
  v_dot2_f32_bf16 v16, v192, v12, v16
  v_dot2_f32_bf16 v16, v193, v12, v16
  v_dot2_f32_bf16 v16, v194, v12, v16
  v_dot2_f32_bf16 v16, v195, v12, v16
  buffer_store_dwordx4 v[192:195], v2, s[16:19], s70 offen sc1
  s_add_u32 s70, s70, 32768
  v_cmp_nle_f32 vcc, v88, v10
  v_rcp_f32 v9, v88
  s_nop 0
  v_cndmask_b32 v16, v16, v11, vcc
  v_mul_f32 v80, v80, v9
  v_mul_f32 v81, v81, v9
  v_mul_f32 v82, v82, v9
  v_mul_f32 v83, v83, v9
  v_mul_f32 v84, v84, v9
  v_mul_f32 v85, v85, v9
  v_mul_f32 v86, v86, v9
  v_mul_f32 v87, v87, v9
  v_cvt_pk_bf16_f32 v200, v80, v81
  v_cvt_pk_bf16_f32 v201, v82, v83
  v_cvt_pk_bf16_f32 v202, v84, v85
  v_cvt_pk_bf16_f32 v203, v86, v87
  v_dot2_f32_bf16 v16, v200, v12, v16
  v_dot2_f32_bf16 v16, v201, v12, v16
  v_dot2_f32_bf16 v16, v202, v12, v16
  v_dot2_f32_bf16 v16, v203, v12, v16
  buffer_store_dwordx4 v[200:203], v2, s[16:19], s70 offen sc1
  s_sub_u32 s70, s70, 32768
  v_cmp_u_f32 vcc, v16, v16
  v_mov_b32 v9, 0x21000
  v_mov_b32 v8, 1
  s_nop 2
  s_cbranch_vccz L_p_f_2
  ds_write_b32 v9, v8
L_p_f_2:
  s_waitcnt lgkmcnt(0)
  s_barrier
  ds_read_b32 v10, v9
  s_waitcnt lgkmcnt(0)
  v_readfirstlane_b32 s76, v10
  s_nop 3
  s_cmp_eq_u32 s76, 0
  s_cbranch_scc1 L_p_red
  v_mov_b32 v6, 0xff800000
  v_mov_b32 v7, 0xff800000
  v_mov_b32 v3, v2
  s_mov_b32 s74, 64
L_p_safe_loop:
  ds_read_b128 v[28:31], v3
  s_waitcnt lgkmcnt(0)
  v_mfma_f32_32x32x16_bf16 v[128:143], v[28:31], v[20:23], 0
  v_mfma_f32_32x32x16_bf16 v[144:159], v[28:31], v[24:27], 0
  s_nop 7
  s_nop 3
  v_max3_f32 v6, v6, v128, v129
  v_max3_f32 v6, v6, v130, v131
  v_max3_f32 v6, v6, v132, v133
  v_max3_f32 v6, v6, v134, v135
  v_max3_f32 v6, v6, v136, v137
  v_max3_f32 v6, v6, v138, v139
  v_max3_f32 v6, v6, v140, v141
  v_max3_f32 v6, v6, v142, v143
  v_max3_f32 v7, v7, v144, v145
  v_max3_f32 v7, v7, v146, v147
  v_max3_f32 v7, v7, v148, v149
  v_max3_f32 v7, v7, v150, v151
  v_max3_f32 v7, v7, v152, v153
  v_max3_f32 v7, v7, v154, v155
  v_max3_f32 v7, v7, v156, v157
  v_max3_f32 v7, v7, v158, v159
  v_add_u32 v3, 1024, v3
  s_sub_u32 s74, s74, 1
  s_cmp_lg_u32 s74, 0
  s_cbranch_scc1 L_p_safe_loop
  v_mov_b32 v8, v6
  s_nop 1
  v_permlane32_swap_b32 v8, v6
  v_max_f32 v6, v6, v8
  v_mov_b32 v9, v7
  s_nop 1
  v_permlane32_swap_b32 v9, v7
  v_max_f32 v7, v7, v9
  s_mov_b32 s82, 1
  s_cmp_lg_u32 s82, 0
  s_cbranch_scc1 L_p_m_3
  ds_read_b128 v[28:31], v2
  ds_read_b128 v[32:35], v2 offset:1024
  s_waitcnt lgkmcnt(1)
  v_mfma_f32_32x32x16_bf16 v[128:143], v[28:31], v[20:23], 0
  v_mfma_f32_32x32x16_bf16 v[144:159], v[28:31], v[24:27], 0
  s_waitcnt lgkmcnt(0)
  v_mfma_f32_32x32x16_bf16 v[160:175], v[32:35], v[20:23], 0
  v_mfma_f32_32x32x16_bf16 v[176:191], v[32:35], v[24:27], 0
  s_nop 7
  s_nop 3
  v_max3_f32 v6, v128, v129, v130
  v_max3_f32 v6, v6, v131, v132
  v_max3_f32 v6, v6, v133, v134
  v_max3_f32 v6, v6, v135, v136
  v_max3_f32 v6, v6, v137, v138
  v_max3_f32 v6, v6, v139, v140
  v_max3_f32 v6, v6, v141, v142
  v_max3_f32 v6, v6, v143, v160
  v_max3_f32 v6, v6, v161, v162
  v_max3_f32 v6, v6, v163, v164
  v_max3_f32 v6, v6, v165, v166
  v_max3_f32 v6, v6, v167, v168
  v_max3_f32 v6, v6, v169, v170
  v_max3_f32 v6, v6, v171, v172
  v_max3_f32 v6, v6, v173, v174
  v_max_f32 v6, v6, v175
  v_mov_b32 v8, v6
  s_nop 1
  v_permlane32_swap_b32 v8, v6
  v_max_f32 v6, v6, v8
  v_add_f32 v6, 0x42800000, v6
  v_max3_f32 v7, v144, v145, v146
  v_max3_f32 v7, v7, v147, v148
  v_max3_f32 v7, v7, v149, v150
  v_max3_f32 v7, v7, v151, v152
  v_max3_f32 v7, v7, v153, v154
  v_max3_f32 v7, v7, v155, v156
  v_max3_f32 v7, v7, v157, v158
  v_max3_f32 v7, v7, v159, v176
  v_max3_f32 v7, v7, v177, v178
  v_max3_f32 v7, v7, v179, v180
  v_max3_f32 v7, v7, v181, v182
  v_max3_f32 v7, v7, v183, v184
  v_max3_f32 v7, v7, v185, v186
  v_max3_f32 v7, v7, v187, v188
  v_max3_f32 v7, v7, v189, v190
  v_max_f32 v7, v7, v191
  v_mov_b32 v9, v7
  s_nop 1
  v_permlane32_swap_b32 v9, v7
  v_max_f32 v7, v7, v9
  v_add_f32 v7, 0x42800000, v7
L_p_m_3:
  v_sub_f32 v224, 0, v6
  v_sub_f32 v225, 0, v6
  v_sub_f32 v226, 0, v6
  v_sub_f32 v227, 0, v6
  v_sub_f32 v228, 0, v6
  v_sub_f32 v229, 0, v6
  v_sub_f32 v230, 0, v6
  v_sub_f32 v231, 0, v6
  v_sub_f32 v232, 0, v6
  v_sub_f32 v233, 0, v6
  v_sub_f32 v234, 0, v6
  v_sub_f32 v235, 0, v6
  v_sub_f32 v236, 0, v6
  v_sub_f32 v237, 0, v6
  v_sub_f32 v238, 0, v6
  v_sub_f32 v239, 0, v6
  v_sub_f32 v240, 0, v7
  v_sub_f32 v241, 0, v7
  v_sub_f32 v242, 0, v7
  v_sub_f32 v243, 0, v7
  v_sub_f32 v244, 0, v7
  v_sub_f32 v245, 0, v7
  v_sub_f32 v246, 0, v7
  v_sub_f32 v247, 0, v7
  v_sub_f32 v248, 0, v7
  v_sub_f32 v249, 0, v7
  v_sub_f32 v250, 0, v7
  v_sub_f32 v251, 0, v7
  v_sub_f32 v252, 0, v7
  v_sub_f32 v253, 0, v7
  v_sub_f32 v254, 0, v7
  v_sub_f32 v255, 0, v7
  v_mov_b32 v3, v2
  v_mov_b32 v4, v17
  v_mov_b32 v16, 0
  ds_read_b128 v[28:31], v3
  s_waitcnt lgkmcnt(0)
  v_mfma_f32_32x32x16_bf16 v[128:143], v[28:31], v[20:23], v[224:239]
  ds_read_b128 v[32:35], v3 offset:1024
  v_mfma_f32_32x32x16_bf16 v[144:159], v[28:31], v[24:27], v[240:255]
  s_waitcnt lgkmcnt(0)
  v_mfma_f32_32x32x16_bf16 v[160:175], v[32:35], v[20:23], v[224:239]
  ds_read_b128 v[28:31], v3 offset:2048
  ds_read_b128 v[36:39], v4 offset:1024
  ds_read_b128 v[40:43], v4 offset:1536
  s_nop 5
  v_exp_f32 v128, v128
  v_exp_f32 v129, v129
  v_exp_f32 v130, v130
  v_exp_f32 v131, v131
  v_cvt_pk_bf16_f32 v192, v128, v129
  v_exp_f32 v132, v132
  v_exp_f32 v133, v133
  v_cvt_pk_bf16_f32 v193, v130, v131
  v_exp_f32 v134, v134
  v_exp_f32 v135, v135
  v_cvt_pk_bf16_f32 v194, v132, v133
  v_exp_f32 v136, v136
  v_exp_f32 v137, v137
  v_cvt_pk_bf16_f32 v195, v134, v135
  v_exp_f32 v138, v138
  v_exp_f32 v139, v139
  v_cvt_pk_bf16_f32 v196, v136, v137
  v_exp_f32 v140, v140
  v_exp_f32 v141, v141
  v_cvt_pk_bf16_f32 v197, v138, v139
  v_exp_f32 v142, v142
  v_exp_f32 v143, v143
  v_cvt_pk_bf16_f32 v198, v140, v141
  v_cvt_pk_bf16_f32 v199, v142, v143
  v_mfma_f32_32x32x16_bf16 v[176:191], v[32:35], v[24:27], v[240:255]
  v_exp_f32 v144, v144
  v_exp_f32 v145, v145
  v_exp_f32 v146, v146
  v_exp_f32 v147, v147
  v_cvt_pk_bf16_f32 v200, v144, v145
  v_exp_f32 v148, v148
  v_exp_f32 v149, v149
  v_cvt_pk_bf16_f32 v201, v146, v147
  v_exp_f32 v150, v150
  v_exp_f32 v151, v151
  v_cvt_pk_bf16_f32 v202, v148, v149
  v_exp_f32 v152, v152
  v_exp_f32 v153, v153
  v_cvt_pk_bf16_f32 v203, v150, v151
  v_exp_f32 v154, v154
  v_exp_f32 v155, v155
  v_cvt_pk_bf16_f32 v204, v152, v153
  v_exp_f32 v156, v156
  v_exp_f32 v157, v157
  v_cvt_pk_bf16_f32 v205, v154, v155
  v_exp_f32 v158, v158
  v_exp_f32 v159, v159
  v_cvt_pk_bf16_f32 v206, v156, v157
  v_cvt_pk_bf16_f32 v207, v158, v159
  s_waitcnt lgkmcnt(0)
  v_mfma_f32_32x32x16_bf16 v[128:143], v[28:31], v[20:23], v[224:239]
  ds_read_b128 v[32:35], v3 offset:3072
  ds_read_b128 v[44:47], v4 offset:2048
  ds_read_b128 v[48:51], v4 offset:2560
  v_exp_f32 v160, v160
  v_exp_f32 v161, v161
  v_exp_f32 v162, v162
  v_exp_f32 v163, v163
  v_cvt_pk_bf16_f32 v208, v160, v161
  v_exp_f32 v164, v164
  v_exp_f32 v165, v165
  v_cvt_pk_bf16_f32 v209, v162, v163
  v_mfma_f32_32x32x16_bf16 v[144:159], v[28:31], v[24:27], v[240:255]
  v_exp_f32 v166, v166
  v_exp_f32 v167, v167
  v_cvt_pk_bf16_f32 v210, v164, v165
  v_exp_f32 v168, v168
  v_exp_f32 v169, v169
  v_cvt_pk_bf16_f32 v211, v166, v167
  v_exp_f32 v170, v170
  v_exp_f32 v171, v171
  v_mfma_f32_32x32x16_bf16 v[64:79], v[36:39], v[192:195], 0
  v_cvt_pk_bf16_f32 v212, v168, v169
  v_exp_f32 v172, v172
  v_exp_f32 v173, v173
  v_cvt_pk_bf16_f32 v213, v170, v171
  v_exp_f32 v174, v174
  v_exp_f32 v175, v175
  v_cvt_pk_bf16_f32 v214, v172, v173
  v_cvt_pk_bf16_f32 v215, v174, v175
  v_mfma_f32_32x32x16_bf16 v[80:95], v[36:39], v[200:203], 0
  v_exp_f32 v176, v176
  v_exp_f32 v177, v177
  v_exp_f32 v178, v178
  v_exp_f32 v179, v179
  v_cvt_pk_bf16_f32 v216, v176, v177
  v_exp_f32 v180, v180
  v_exp_f32 v181, v181
  v_cvt_pk_bf16_f32 v217, v178, v179
  v_mfma_f32_32x32x16_bf16 v[64:79], v[40:43], v[196:199], v[64:79]
  v_exp_f32 v182, v182
  v_exp_f32 v183, v183
  v_cvt_pk_bf16_f32 v218, v180, v181
  v_exp_f32 v184, v184
  v_exp_f32 v185, v185
  v_cvt_pk_bf16_f32 v219, v182, v183
  v_exp_f32 v186, v186
  v_exp_f32 v187, v187
  v_mfma_f32_32x32x16_bf16 v[80:95], v[40:43], v[204:207], v[80:95]
  v_cvt_pk_bf16_f32 v220, v184, v185
  v_exp_f32 v188, v188
  v_exp_f32 v189, v189
  v_cvt_pk_bf16_f32 v221, v186, v187
  v_exp_f32 v190, v190
  v_exp_f32 v191, v191
  v_cvt_pk_bf16_f32 v222, v188, v189
  v_cvt_pk_bf16_f32 v223, v190, v191
  s_waitcnt lgkmcnt(0)
  v_mfma_f32_32x32x16_bf16 v[160:175], v[32:35], v[20:23], v[224:239]
  ds_read_b128 v[28:31], v3 offset:4096
  ds_read_b128 v[36:39], v4 offset:3072
  ds_read_b128 v[40:43], v4 offset:3584
  v_exp_f32 v128, v128
  v_exp_f32 v129, v129
  v_exp_f32 v130, v130
  v_exp_f32 v131, v131
  v_cvt_pk_bf16_f32 v192, v128, v129
  v_exp_f32 v132, v132
  v_exp_f32 v133, v133
  v_cvt_pk_bf16_f32 v193, v130, v131
  v_mfma_f32_32x32x16_bf16 v[176:191], v[32:35], v[24:27], v[240:255]
  v_exp_f32 v134, v134
  v_exp_f32 v135, v135
  v_cvt_pk_bf16_f32 v194, v132, v133
  v_exp_f32 v136, v136
  v_exp_f32 v137, v137
  v_cvt_pk_bf16_f32 v195, v134, v135
  v_exp_f32 v138, v138
  v_exp_f32 v139, v139
  v_mfma_f32_32x32x16_bf16 v[64:79], v[44:47], v[208:211], v[64:79]
  v_cvt_pk_bf16_f32 v196, v136, v137
  v_exp_f32 v140, v140
  v_exp_f32 v141, v141
  v_cvt_pk_bf16_f32 v197, v138, v139
  v_exp_f32 v142, v142
  v_exp_f32 v143, v143
  v_cvt_pk_bf16_f32 v198, v140, v141
  v_cvt_pk_bf16_f32 v199, v142, v143
  v_mfma_f32_32x32x16_bf16 v[80:95], v[44:47], v[216:219], v[80:95]
  v_exp_f32 v144, v144
  v_exp_f32 v145, v145
  v_exp_f32 v146, v146
  v_exp_f32 v147, v147
  v_cvt_pk_bf16_f32 v200, v144, v145
  v_exp_f32 v148, v148
  v_exp_f32 v149, v149
  v_cvt_pk_bf16_f32 v201, v146, v147
  v_mfma_f32_32x32x16_bf16 v[64:79], v[48:51], v[212:215], v[64:79]
  v_exp_f32 v150, v150
  v_exp_f32 v151, v151
  v_cvt_pk_bf16_f32 v202, v148, v149
  v_exp_f32 v152, v152
  v_exp_f32 v153, v153
  v_cvt_pk_bf16_f32 v203, v150, v151
  v_exp_f32 v154, v154
  v_exp_f32 v155, v155
  v_mfma_f32_32x32x16_bf16 v[80:95], v[48:51], v[220:223], v[80:95]
  v_cvt_pk_bf16_f32 v204, v152, v153
  v_exp_f32 v156, v156
  v_exp_f32 v157, v157
  v_cvt_pk_bf16_f32 v205, v154, v155
  v_exp_f32 v158, v158
  v_exp_f32 v159, v159
  v_cvt_pk_bf16_f32 v206, v156, v157
  v_cvt_pk_bf16_f32 v207, v158, v159
  v_add_u32 v3, 4096, v3
  v_add_u32 v4, v4, v5
  s_mov_b32 s74, 15
L_p_SP:
  s_waitcnt lgkmcnt(0)
  v_mfma_f32_32x32x16_bf16 v[128:143], v[28:31], v[20:23], v[224:239]
  ds_read_b128 v[32:35], v3 offset:1024
  ds_read_b128 v[44:47], v4
  ds_read_b128 v[48:51], v4 offset:512
  v_exp_f32 v160, v160
  v_exp_f32 v161, v161
  v_exp_f32 v162, v162
  v_exp_f32 v163, v163
  v_cvt_pk_bf16_f32 v208, v160, v161
  v_exp_f32 v164, v164
  v_exp_f32 v165, v165
  v_cvt_pk_bf16_f32 v209, v162, v163
  v_mfma_f32_32x32x16_bf16 v[144:159], v[28:31], v[24:27], v[240:255]
  v_exp_f32 v166, v166
  v_exp_f32 v167, v167
  v_cvt_pk_bf16_f32 v210, v164, v165
  v_exp_f32 v168, v168
  v_exp_f32 v169, v169
  v_cvt_pk_bf16_f32 v211, v166, v167
  v_exp_f32 v170, v170
  v_exp_f32 v171, v171
  v_mfma_f32_32x32x16_bf16 v[64:79], v[36:39], v[192:195], v[64:79]
  v_cvt_pk_bf16_f32 v212, v168, v169
  v_exp_f32 v172, v172
  v_exp_f32 v173, v173
  v_cvt_pk_bf16_f32 v213, v170, v171
  v_exp_f32 v174, v174
  v_exp_f32 v175, v175
  v_cvt_pk_bf16_f32 v214, v172, v173
  v_cvt_pk_bf16_f32 v215, v174, v175
  v_mfma_f32_32x32x16_bf16 v[80:95], v[36:39], v[200:203], v[80:95]
  v_exp_f32 v176, v176
  v_exp_f32 v177, v177
  v_exp_f32 v178, v178
  v_exp_f32 v179, v179
  v_cvt_pk_bf16_f32 v216, v176, v177
  v_exp_f32 v180, v180
  v_exp_f32 v181, v181
  v_cvt_pk_bf16_f32 v217, v178, v179
  v_mfma_f32_32x32x16_bf16 v[64:79], v[40:43], v[196:199], v[64:79]
  v_exp_f32 v182, v182
  v_exp_f32 v183, v183
  v_cvt_pk_bf16_f32 v218, v180, v181
  v_exp_f32 v184, v184
  v_exp_f32 v185, v185
  v_cvt_pk_bf16_f32 v219, v182, v183
  v_exp_f32 v186, v186
  v_exp_f32 v187, v187
  v_mfma_f32_32x32x16_bf16 v[80:95], v[40:43], v[204:207], v[80:95]
  v_cvt_pk_bf16_f32 v220, v184, v185
  v_exp_f32 v188, v188
  v_exp_f32 v189, v189
  v_cvt_pk_bf16_f32 v221, v186, v187
  v_exp_f32 v190, v190
  v_exp_f32 v191, v191
  v_cvt_pk_bf16_f32 v222, v188, v189
  v_cvt_pk_bf16_f32 v223, v190, v191
  s_waitcnt lgkmcnt(0)
  v_mfma_f32_32x32x16_bf16 v[160:175], v[32:35], v[20:23], v[224:239]
  ds_read_b128 v[28:31], v3 offset:2048
  ds_read_b128 v[36:39], v4 offset:1024
  ds_read_b128 v[40:43], v4 offset:1536
  v_exp_f32 v128, v128
  v_exp_f32 v129, v129
  v_exp_f32 v130, v130
  v_exp_f32 v131, v131
  v_cvt_pk_bf16_f32 v192, v128, v129
  v_exp_f32 v132, v132
  v_exp_f32 v133, v133
  v_cvt_pk_bf16_f32 v193, v130, v131
  v_mfma_f32_32x32x16_bf16 v[176:191], v[32:35], v[24:27], v[240:255]
  v_exp_f32 v134, v134
  v_exp_f32 v135, v135
  v_cvt_pk_bf16_f32 v194, v132, v133
  v_exp_f32 v136, v136
  v_exp_f32 v137, v137
  v_cvt_pk_bf16_f32 v195, v134, v135
  v_exp_f32 v138, v138
  v_exp_f32 v139, v139
  v_mfma_f32_32x32x16_bf16 v[64:79], v[44:47], v[208:211], v[64:79]
  v_cvt_pk_bf16_f32 v196, v136, v137
  v_exp_f32 v140, v140
  v_exp_f32 v141, v141
  v_cvt_pk_bf16_f32 v197, v138, v139
  v_exp_f32 v142, v142
  v_exp_f32 v143, v143
  v_cvt_pk_bf16_f32 v198, v140, v141
  v_cvt_pk_bf16_f32 v199, v142, v143
  v_mfma_f32_32x32x16_bf16 v[80:95], v[44:47], v[216:219], v[80:95]
  v_exp_f32 v144, v144
  v_exp_f32 v145, v145
  v_exp_f32 v146, v146
  v_exp_f32 v147, v147
  v_cvt_pk_bf16_f32 v200, v144, v145
  v_exp_f32 v148, v148
  v_exp_f32 v149, v149
  v_cvt_pk_bf16_f32 v201, v146, v147
  v_mfma_f32_32x32x16_bf16 v[64:79], v[48:51], v[212:215], v[64:79]
  v_exp_f32 v150, v150
  v_exp_f32 v151, v151
  v_cvt_pk_bf16_f32 v202, v148, v149
  v_exp_f32 v152, v152
  v_exp_f32 v153, v153
  v_cvt_pk_bf16_f32 v203, v150, v151
  v_exp_f32 v154, v154
  v_exp_f32 v155, v155
  v_mfma_f32_32x32x16_bf16 v[80:95], v[48:51], v[220:223], v[80:95]
  v_cvt_pk_bf16_f32 v204, v152, v153
  v_exp_f32 v156, v156
  v_exp_f32 v157, v157
  v_cvt_pk_bf16_f32 v205, v154, v155
  v_exp_f32 v158, v158
  v_exp_f32 v159, v159
  v_cvt_pk_bf16_f32 v206, v156, v157
  v_cvt_pk_bf16_f32 v207, v158, v159
  s_waitcnt lgkmcnt(0)
  v_mfma_f32_32x32x16_bf16 v[128:143], v[28:31], v[20:23], v[224:239]
  ds_read_b128 v[32:35], v3 offset:3072
  ds_read_b128 v[44:47], v4 offset:2048
  ds_read_b128 v[48:51], v4 offset:2560
  v_exp_f32 v160, v160
  v_exp_f32 v161, v161
  v_exp_f32 v162, v162
  v_exp_f32 v163, v163
  v_cvt_pk_bf16_f32 v208, v160, v161
  v_exp_f32 v164, v164
  v_exp_f32 v165, v165
  v_cvt_pk_bf16_f32 v209, v162, v163
  v_mfma_f32_32x32x16_bf16 v[144:159], v[28:31], v[24:27], v[240:255]
  v_exp_f32 v166, v166
  v_exp_f32 v167, v167
  v_cvt_pk_bf16_f32 v210, v164, v165
  v_exp_f32 v168, v168
  v_exp_f32 v169, v169
  v_cvt_pk_bf16_f32 v211, v166, v167
  v_exp_f32 v170, v170
  v_exp_f32 v171, v171
  v_mfma_f32_32x32x16_bf16 v[64:79], v[36:39], v[192:195], v[64:79]
  v_cvt_pk_bf16_f32 v212, v168, v169
  v_exp_f32 v172, v172
  v_exp_f32 v173, v173
  v_cvt_pk_bf16_f32 v213, v170, v171
  v_exp_f32 v174, v174
  v_exp_f32 v175, v175
  v_cvt_pk_bf16_f32 v214, v172, v173
  v_cvt_pk_bf16_f32 v215, v174, v175
  v_mfma_f32_32x32x16_bf16 v[80:95], v[36:39], v[200:203], v[80:95]
  v_exp_f32 v176, v176
  v_exp_f32 v177, v177
  v_exp_f32 v178, v178
  v_exp_f32 v179, v179
  v_cvt_pk_bf16_f32 v216, v176, v177
  v_exp_f32 v180, v180
  v_exp_f32 v181, v181
  v_cvt_pk_bf16_f32 v217, v178, v179
  v_mfma_f32_32x32x16_bf16 v[64:79], v[40:43], v[196:199], v[64:79]
  v_exp_f32 v182, v182
  v_exp_f32 v183, v183
  v_cvt_pk_bf16_f32 v218, v180, v181
  v_exp_f32 v184, v184
  v_exp_f32 v185, v185
  v_cvt_pk_bf16_f32 v219, v182, v183
  v_exp_f32 v186, v186
  v_exp_f32 v187, v187
  v_mfma_f32_32x32x16_bf16 v[80:95], v[40:43], v[204:207], v[80:95]
  v_cvt_pk_bf16_f32 v220, v184, v185
  v_exp_f32 v188, v188
  v_exp_f32 v189, v189
  v_cvt_pk_bf16_f32 v221, v186, v187
  v_exp_f32 v190, v190
  v_exp_f32 v191, v191
  v_cvt_pk_bf16_f32 v222, v188, v189
  v_cvt_pk_bf16_f32 v223, v190, v191
  s_waitcnt lgkmcnt(0)
  v_mfma_f32_32x32x16_bf16 v[160:175], v[32:35], v[20:23], v[224:239]
  ds_read_b128 v[28:31], v3 offset:4096
  ds_read_b128 v[36:39], v4 offset:3072
  ds_read_b128 v[40:43], v4 offset:3584
  v_exp_f32 v128, v128
  v_exp_f32 v129, v129
  v_exp_f32 v130, v130
  v_exp_f32 v131, v131
  v_cvt_pk_bf16_f32 v192, v128, v129
  v_exp_f32 v132, v132
  v_exp_f32 v133, v133
  v_cvt_pk_bf16_f32 v193, v130, v131
  v_mfma_f32_32x32x16_bf16 v[176:191], v[32:35], v[24:27], v[240:255]
  v_exp_f32 v134, v134
  v_exp_f32 v135, v135
  v_cvt_pk_bf16_f32 v194, v132, v133
  v_exp_f32 v136, v136
  v_exp_f32 v137, v137
  v_cvt_pk_bf16_f32 v195, v134, v135
  v_exp_f32 v138, v138
  v_exp_f32 v139, v139
  v_mfma_f32_32x32x16_bf16 v[64:79], v[44:47], v[208:211], v[64:79]
  v_cvt_pk_bf16_f32 v196, v136, v137
  v_exp_f32 v140, v140
  v_exp_f32 v141, v141
  v_cvt_pk_bf16_f32 v197, v138, v139
  v_exp_f32 v142, v142
  v_exp_f32 v143, v143
  v_cvt_pk_bf16_f32 v198, v140, v141
  v_cvt_pk_bf16_f32 v199, v142, v143
  v_mfma_f32_32x32x16_bf16 v[80:95], v[44:47], v[216:219], v[80:95]
  v_exp_f32 v144, v144
  v_exp_f32 v145, v145
  v_exp_f32 v146, v146
  v_exp_f32 v147, v147
  v_cvt_pk_bf16_f32 v200, v144, v145
  v_exp_f32 v148, v148
  v_exp_f32 v149, v149
  v_cvt_pk_bf16_f32 v201, v146, v147
  v_mfma_f32_32x32x16_bf16 v[64:79], v[48:51], v[212:215], v[64:79]
  v_exp_f32 v150, v150
  v_exp_f32 v151, v151
  v_cvt_pk_bf16_f32 v202, v148, v149
  v_exp_f32 v152, v152
  v_exp_f32 v153, v153
  v_cvt_pk_bf16_f32 v203, v150, v151
  v_exp_f32 v154, v154
  v_exp_f32 v155, v155
  v_mfma_f32_32x32x16_bf16 v[80:95], v[48:51], v[220:223], v[80:95]
  v_cvt_pk_bf16_f32 v204, v152, v153
  v_exp_f32 v156, v156
  v_exp_f32 v157, v157
  v_cvt_pk_bf16_f32 v205, v154, v155
  v_exp_f32 v158, v158
  v_exp_f32 v159, v159
  v_cvt_pk_bf16_f32 v206, v156, v157
  v_cvt_pk_bf16_f32 v207, v158, v159
  v_add_u32 v3, 4096, v3
  v_add_u32 v4, v4, v5
  s_sub_u32 s74, s74, 1
  s_cmp_lg_u32 s74, 0
  s_cbranch_scc1 L_p_SP
  s_waitcnt lgkmcnt(0)
  v_mfma_f32_32x32x16_bf16 v[64:79], v[36:39], v[192:195], v[64:79]
  ds_read_b128 v[44:47], v4
  ds_read_b128 v[48:51], v4 offset:512
  v_exp_f32 v160, v160
  v_exp_f32 v161, v161
  v_exp_f32 v162, v162
  v_exp_f32 v163, v163
  v_cvt_pk_bf16_f32 v208, v160, v161
  v_exp_f32 v164, v164
  v_exp_f32 v165, v165
  v_cvt_pk_bf16_f32 v209, v162, v163
  v_exp_f32 v166, v166
  v_exp_f32 v167, v167
  v_cvt_pk_bf16_f32 v210, v164, v165
  v_exp_f32 v168, v168
  v_mfma_f32_32x32x16_bf16 v[80:95], v[36:39], v[200:203], v[80:95]
  v_exp_f32 v169, v169
  v_cvt_pk_bf16_f32 v211, v166, v167
  v_exp_f32 v170, v170
  v_exp_f32 v171, v171
  v_cvt_pk_bf16_f32 v212, v168, v169
  v_exp_f32 v172, v172
  v_exp_f32 v173, v173
  v_cvt_pk_bf16_f32 v213, v170, v171
  v_exp_f32 v174, v174
  v_exp_f32 v175, v175
  v_cvt_pk_bf16_f32 v214, v172, v173
  v_cvt_pk_bf16_f32 v215, v174, v175
  v_mfma_f32_32x32x16_bf16 v[64:79], v[40:43], v[196:199], v[64:79]
  v_exp_f32 v176, v176
  v_exp_f32 v177, v177
  v_exp_f32 v178, v178
  v_exp_f32 v179, v179
  v_cvt_pk_bf16_f32 v216, v176, v177
  v_exp_f32 v180, v180
  v_exp_f32 v181, v181
  v_cvt_pk_bf16_f32 v217, v178, v179
  v_exp_f32 v182, v182
  v_exp_f32 v183, v183
  v_cvt_pk_bf16_f32 v218, v180, v181
  v_exp_f32 v184, v184
  v_mfma_f32_32x32x16_bf16 v[80:95], v[40:43], v[204:207], v[80:95]
  v_exp_f32 v185, v185
  v_cvt_pk_bf16_f32 v219, v182, v183
  v_exp_f32 v186, v186
  v_exp_f32 v187, v187
  v_cvt_pk_bf16_f32 v220, v184, v185
  v_exp_f32 v188, v188
  v_exp_f32 v189, v189
  v_cvt_pk_bf16_f32 v221, v186, v187
  v_exp_f32 v190, v190
  v_exp_f32 v191, v191
  v_cvt_pk_bf16_f32 v222, v188, v189
  v_cvt_pk_bf16_f32 v223, v190, v191
  s_waitcnt lgkmcnt(0)
  v_mfma_f32_32x32x16_bf16 v[64:79], v[44:47], v[208:211], v[64:79]
  v_mfma_f32_32x32x16_bf16 v[80:95], v[44:47], v[216:219], v[80:95]
  v_mfma_f32_32x32x16_bf16 v[64:79], v[48:51], v[212:215], v[64:79]
  v_mfma_f32_32x32x16_bf16 v[80:95], v[48:51], v[220:223], v[80:95]
  v_mov_b32 v12, 0
  v_mov_b32 v10, 0x71800000
  v_mov_b32 v11, 0x7fc00000
  s_nop 7
  v_rcp_f32 v9, v72
  s_nop 0
  v_mul_f32 v64, v64, v9
  v_mul_f32 v65, v65, v9
  v_mul_f32 v66, v66, v9
  v_mul_f32 v67, v67, v9
  v_mul_f32 v68, v68, v9
  v_mul_f32 v69, v69, v9
  v_mul_f32 v70, v70, v9
  v_mul_f32 v71, v71, v9
  v_cvt_pk_bf16_f32 v192, v64, v65
  v_cvt_pk_bf16_f32 v193, v66, v67
  v_cvt_pk_bf16_f32 v194, v68, v69
  v_cvt_pk_bf16_f32 v195, v70, v71
  buffer_store_dwordx4 v[192:195], v2, s[16:19], s70 offen sc1
  s_add_u32 s70, s70, 32768
  v_rcp_f32 v9, v88
  s_nop 0
  v_mul_f32 v80, v80, v9
  v_mul_f32 v81, v81, v9
  v_mul_f32 v82, v82, v9
  v_mul_f32 v83, v83, v9
  v_mul_f32 v84, v84, v9
  v_mul_f32 v85, v85, v9
  v_mul_f32 v86, v86, v9
  v_mul_f32 v87, v87, v9
  v_cvt_pk_bf16_f32 v200, v80, v81
  v_cvt_pk_bf16_f32 v201, v82, v83
  v_cvt_pk_bf16_f32 v202, v84, v85
  v_cvt_pk_bf16_f32 v203, v86, v87
  buffer_store_dwordx4 v[200:203], v2, s[16:19], s70 offen sc1
  s_sub_u32 s70, s70, 32768
  s_waitcnt lgkmcnt(0)
  s_barrier
L_p_red:
  s_lshl_b32 s76, s42, 13
  s_lshl_b32 s77, s71, 16
  s_add_u32 s77, s77, s76
  s_add_u32 s83, s77, 0x4600000
  s_add_u32 s84, s83, 32768
  s_lshl_b32 s77, s72, 16
  s_add_u32 s77, s77, s76
  s_add_u32 s73, s77, 0x4c00000
  s_add_u32 s85, s73, 32768
  buffer_load_dwordx4 a[72:75], v2, s[16:19], s73 offen sc1
  buffer_load_dwordx4 a[76:79], v2, s[16:19], s85 offen sc1
  buffer_load_dwordx4 a[88:91], v2, s[16:19], s73 offen offset:1024 sc1
  buffer_load_dwordx4 a[92:95], v2, s[16:19], s85 offen offset:1024 sc1
  buffer_load_dwordx4 a[104:107], v2, s[16:19], s73 offen offset:2048 sc1
  buffer_load_dwordx4 a[108:111], v2, s[16:19], s85 offen offset:2048 sc1
  buffer_load_dwordx4 a[120:123], v2, s[16:19], s73 offen offset:3072 sc1
  buffer_load_dwordx4 a[124:127], v2, s[16:19], s85 offen offset:3072 sc1
  s_add_u32 s73, s73, 4096
  s_add_u32 s85, s85, 4096
  buffer_load_dwordx4 a[136:139], v2, s[16:19], s73 offen sc1
  buffer_load_dwordx4 a[140:143], v2, s[16:19], s85 offen sc1
  buffer_load_dwordx4 a[152:155], v2, s[16:19], s73 offen offset:1024 sc1
  buffer_load_dwordx4 a[156:159], v2, s[16:19], s85 offen offset:1024 sc1
  buffer_load_dwordx4 a[168:171], v2, s[16:19], s73 offen offset:2048 sc1
  buffer_load_dwordx4 a[172:175], v2, s[16:19], s85 offen offset:2048 sc1
  buffer_load_dwordx4 a[184:187], v2, s[16:19], s73 offen offset:3072 sc1
  buffer_load_dwordx4 a[188:191], v2, s[16:19], s85 offen offset:3072 sc1
  s_lshl_b32 s76, s42, 14
  v_add_u32 v8, s76, v2
  ds_write_b128 v8, a[0:3]
  ds_write_b128 v8, a[4:7] offset:1024
  ds_write_b128 v8, a[8:11] offset:2048
  ds_write_b128 v8, a[12:15] offset:3072
  ds_write_b128 v8, a[16:19] offset:4096
  ds_write_b128 v8, a[20:23] offset:5120
  ds_write_b128 v8, a[24:27] offset:6144
  ds_write_b128 v8, a[28:31] offset:7168
  ds_write_b128 v8, a[32:35] offset:8192
  ds_write_b128 v8, a[36:39] offset:9216
  ds_write_b128 v8, a[40:43] offset:10240
  ds_write_b128 v8, a[44:47] offset:11264
  ds_write_b128 v8, a[48:51] offset:12288
  ds_write_b128 v8, a[52:55] offset:13312
  ds_write_b128 v8, a[56:59] offset:14336
  ds_write_b128 v8, a[60:63] offset:15360
  v_and_b32 v10, 31, v1
  v_lshlrev_b32 v10, 11, v10
  v_lshrrev_b32 v11, 5, v1
  v_lshl_add_u32 v3, v11, 4, v10
  s_waitcnt vmcnt(16)
  s_waitcnt lgkmcnt(0)
  s_barrier
  s_cmp_lg_u32 s42, 0
  s_cbranch_scc1 L_p_sigC
  s_lshl_b32 s76, s40, 7
  s_lshl_b32 s77, s41, 2
  s_add_u32 s76, s76, s77
  s_add_u32 s76, s76, 0x4d06000
  v_mov_b32 v12, 0
  v_mov_b32 v13, s59
  s_mov_b64 exec, 1
  s_nop 1
  buffer_store_dword v13, v12, s[16:19], s76 offen sc1
  s_mov_b64 exec, -1
  s_nop 3
L_p_sigC:
  s_lshl_b32 s76, s42, 12
  v_add_u32 v9, s76, v2
  ds_read_b128 v[32:35], v9
  ds_read_b128 v[36:39], v9 offset:1024
  ds_read_b128 v[40:43], v9 offset:2048
  ds_read_b128 v[44:47], v9 offset:3072
  ds_read_b128 v[48:51], v9 offset:16384
  ds_read_b128 v[52:55], v9 offset:17408
  ds_read_b128 v[56:59], v9 offset:18432
  ds_read_b128 v[60:63], v9 offset:19456
  s_waitcnt lgkmcnt(3)
  v_add_f32 v32, v32, v48
  v_add_f32 v33, v33, v49
  v_add_f32 v34, v34, v50
  v_add_f32 v35, v35, v51
  s_waitcnt lgkmcnt(2)
  v_add_f32 v36, v36, v52
  v_add_f32 v37, v37, v53
  v_add_f32 v38, v38, v54
  v_add_f32 v39, v39, v55
  s_waitcnt lgkmcnt(1)
  v_add_f32 v40, v40, v56
  v_add_f32 v41, v41, v57
  v_add_f32 v42, v42, v58
  v_add_f32 v43, v43, v59
  s_waitcnt lgkmcnt(0)
  v_add_f32 v44, v44, v60
  v_add_f32 v45, v45, v61
  v_add_f32 v46, v46, v62
  v_add_f32 v47, v47, v63
  ds_read_b128 v[48:51], v9 offset:32768
  ds_read_b128 v[52:55], v9 offset:33792
  ds_read_b128 v[56:59], v9 offset:34816
  ds_read_b128 v[60:63], v9 offset:35840
  s_waitcnt lgkmcnt(3)
  v_add_f32 v32, v32, v48
  v_add_f32 v33, v33, v49
  v_add_f32 v34, v34, v50
  v_add_f32 v35, v35, v51
  s_waitcnt lgkmcnt(2)
  v_add_f32 v36, v36, v52
  v_add_f32 v37, v37, v53
  v_add_f32 v38, v38, v54
  v_add_f32 v39, v39, v55
  s_waitcnt lgkmcnt(1)
  v_add_f32 v40, v40, v56
  v_add_f32 v41, v41, v57
  v_add_f32 v42, v42, v58
  v_add_f32 v43, v43, v59
  s_waitcnt lgkmcnt(0)
  v_add_f32 v44, v44, v60
  v_add_f32 v45, v45, v61
  v_add_f32 v46, v46, v62
  v_add_f32 v47, v47, v63
  ds_read_b128 v[48:51], v9 offset:49152
  ds_read_b128 v[52:55], v9 offset:50176
  ds_read_b128 v[56:59], v9 offset:51200
  ds_read_b128 v[60:63], v9 offset:52224
  s_waitcnt lgkmcnt(3)
  v_add_f32 v32, v32, v48
  v_add_f32 v33, v33, v49
  v_add_f32 v34, v34, v50
  v_add_f32 v35, v35, v51
  s_waitcnt lgkmcnt(2)
  v_add_f32 v36, v36, v52
  v_add_f32 v37, v37, v53
  v_add_f32 v38, v38, v54
  v_add_f32 v39, v39, v55
  s_waitcnt lgkmcnt(1)
  v_add_f32 v40, v40, v56
  v_add_f32 v41, v41, v57
  v_add_f32 v42, v42, v58
  v_add_f32 v43, v43, v59
  s_waitcnt lgkmcnt(0)
  v_add_f32 v44, v44, v60
  v_add_f32 v45, v45, v61
  v_add_f32 v46, v46, v62
  v_add_f32 v47, v47, v63
  v_cvt_pk_bf16_f32 v64, v32, v33
  v_cvt_pk_bf16_f32 v65, v34, v35
  v_cvt_pk_bf16_f32 v66, v36, v37
  v_cvt_pk_bf16_f32 v67, v38, v39
  v_cvt_pk_bf16_f32 v68, v40, v41
  v_cvt_pk_bf16_f32 v69, v42, v43
  v_cvt_pk_bf16_f32 v70, v44, v45
  v_cvt_pk_bf16_f32 v71, v46, v47
  s_nop 1
  v_permlane32_swap_b32 v64, v66
  v_permlane32_swap_b32 v65, v67
  v_permlane32_swap_b32 v68, v70
  v_permlane32_swap_b32 v69, v71
  s_lshl_b32 s76, s71, 6
  s_and_b32 s77, s42, 1
  s_lshl_b32 s77, s77, 5
  s_add_u32 s76, s76, s77
  s_lshl_b32 s76, s76, 11
  s_lshl_b32 s77, s72, 7
  s_add_u32 s76, s76, s77
  s_lshr_b32 s77, s42, 1
  s_lshl_b32 s77, s77, 6
  s_add_u32 s76, s76, s77
  s_add_u32 s76, s76, 1024
  buffer_store_dwordx4 v[64:67], v3, s[48:51], s76 offen
  buffer_store_dwordx4 v[68:71], v3, s[48:51], s76 offen offset:32
  s_lshr_b32 s52, s71, 2
  s_lshl_b32 s52, s52, 7
  s_add_u32 s52, s52, 0x4d06000
  v_lshlrev_b32 v52, 2, v1
  buffer_load_dword v18, v52, s[16:19], s52 offen sc1
  s_waitcnt vmcnt(0)
  v_cmp_eq_u32 vcc, s59, v18
  s_nop 3
  s_and_b32 s77, vcc_lo, 0xffffffff
  s_cmp_eq_u32 s77, 0xffffffff
  s_cbranch_scc0 L_p_spin_C
L_p_spinr_C:
  buffer_load_dwordx4 a[64:67], v2, s[16:19], s83 offen sc1
  buffer_load_dwordx4 a[68:71], v2, s[16:19], s84 offen sc1
  buffer_load_dwordx4 a[80:83], v2, s[16:19], s83 offen offset:1024 sc1
  buffer_load_dwordx4 a[84:87], v2, s[16:19], s84 offen offset:1024 sc1
  buffer_load_dwordx4 a[96:99], v2, s[16:19], s83 offen offset:2048 sc1
  buffer_load_dwordx4 a[100:103], v2, s[16:19], s84 offen offset:2048 sc1
  buffer_load_dwordx4 a[112:115], v2, s[16:19], s83 offen offset:3072 sc1
  buffer_load_dwordx4 a[116:119], v2, s[16:19], s84 offen offset:3072 sc1
  s_add_u32 s83, s83, 4096
  s_add_u32 s84, s84, 4096
  buffer_load_dwordx4 a[128:131], v2, s[16:19], s83 offen sc1
  buffer_load_dwordx4 a[132:135], v2, s[16:19], s84 offen sc1
  buffer_load_dwordx4 a[144:147], v2, s[16:19], s83 offen offset:1024 sc1
  buffer_load_dwordx4 a[148:151], v2, s[16:19], s84 offen offset:1024 sc1
  buffer_load_dwordx4 a[160:163], v2, s[16:19], s83 offen offset:2048 sc1
  buffer_load_dwordx4 a[164:167], v2, s[16:19], s84 offen offset:2048 sc1
  buffer_load_dwordx4 a[176:179], v2, s[16:19], s83 offen offset:3072 sc1
  buffer_load_dwordx4 a[180:183], v2, s[16:19], s84 offen offset:3072 sc1
  s_waitcnt vmcnt(14)
  v_mfma_f32_32x32x16_bf16 a[0:15], a[72:75], a[64:67], 0
  v_mfma_f32_32x32x16_bf16 a[16:31], a[72:75], a[68:71], 0
  v_mfma_f32_32x32x16_bf16 a[32:47], a[76:79], a[64:67], 0
  v_mfma_f32_32x32x16_bf16 a[48:63], a[76:79], a[68:71], 0
  s_waitcnt vmcnt(12)
  v_mfma_f32_32x32x16_bf16 a[0:15], a[88:91], a[80:83], a[0:15]
  v_mfma_f32_32x32x16_bf16 a[16:31], a[88:91], a[84:87], a[16:31]
  v_mfma_f32_32x32x16_bf16 a[32:47], a[92:95], a[80:83], a[32:47]
  v_mfma_f32_32x32x16_bf16 a[48:63], a[92:95], a[84:87], a[48:63]
  s_waitcnt vmcnt(10)
  v_mfma_f32_32x32x16_bf16 a[0:15], a[104:107], a[96:99], a[0:15]
  v_mfma_f32_32x32x16_bf16 a[16:31], a[104:107], a[100:103], a[16:31]
  v_mfma_f32_32x32x16_bf16 a[32:47], a[108:111], a[96:99], a[32:47]
  v_mfma_f32_32x32x16_bf16 a[48:63], a[108:111], a[100:103], a[48:63]
  s_waitcnt vmcnt(8)
  v_mfma_f32_32x32x16_bf16 a[0:15], a[120:123], a[112:115], a[0:15]
  v_mfma_f32_32x32x16_bf16 a[16:31], a[120:123], a[116:119], a[16:31]
  v_mfma_f32_32x32x16_bf16 a[32:47], a[124:127], a[112:115], a[32:47]
  v_mfma_f32_32x32x16_bf16 a[48:63], a[124:127], a[116:119], a[48:63]
  s_waitcnt vmcnt(6)
  v_mfma_f32_32x32x16_bf16 a[0:15], a[136:139], a[128:131], a[0:15]
  v_mfma_f32_32x32x16_bf16 a[16:31], a[136:139], a[132:135], a[16:31]
  v_mfma_f32_32x32x16_bf16 a[32:47], a[140:143], a[128:131], a[32:47]
  v_mfma_f32_32x32x16_bf16 a[48:63], a[140:143], a[132:135], a[48:63]
  s_waitcnt vmcnt(4)
  v_mfma_f32_32x32x16_bf16 a[0:15], a[152:155], a[144:147], a[0:15]
  v_mfma_f32_32x32x16_bf16 a[16:31], a[152:155], a[148:151], a[16:31]
  v_mfma_f32_32x32x16_bf16 a[32:47], a[156:159], a[144:147], a[32:47]
  v_mfma_f32_32x32x16_bf16 a[48:63], a[156:159], a[148:151], a[48:63]
  s_waitcnt vmcnt(2)
  v_mfma_f32_32x32x16_bf16 a[0:15], a[168:171], a[160:163], a[0:15]
  v_mfma_f32_32x32x16_bf16 a[16:31], a[168:171], a[164:167], a[16:31]
  v_mfma_f32_32x32x16_bf16 a[32:47], a[172:175], a[160:163], a[32:47]
  v_mfma_f32_32x32x16_bf16 a[48:63], a[172:175], a[164:167], a[48:63]
  s_waitcnt vmcnt(0)
  v_mfma_f32_32x32x16_bf16 a[0:15], a[184:187], a[176:179], a[0:15]
  v_mfma_f32_32x32x16_bf16 a[16:31], a[184:187], a[180:183], a[16:31]
  v_mfma_f32_32x32x16_bf16 a[32:47], a[188:191], a[176:179], a[32:47]
  v_mfma_f32_32x32x16_bf16 a[48:63], a[188:191], a[180:183], a[48:63]
  s_barrier
  s_lshl_b32 s76, s42, 14
  v_add_u32 v8, s76, v2
  s_nop 5
  ds_write_b128 v8, a[0:3]
  ds_write_b128 v8, a[4:7] offset:1024
  ds_write_b128 v8, a[8:11] offset:2048
  ds_write_b128 v8, a[12:15] offset:3072
  ds_write_b128 v8, a[16:19] offset:4096
  ds_write_b128 v8, a[20:23] offset:5120
  ds_write_b128 v8, a[24:27] offset:6144
  ds_write_b128 v8, a[28:31] offset:7168
  ds_write_b128 v8, a[32:35] offset:8192
  ds_write_b128 v8, a[36:39] offset:9216
  ds_write_b128 v8, a[40:43] offset:10240
  ds_write_b128 v8, a[44:47] offset:11264
  ds_write_b128 v8, a[48:51] offset:12288
  ds_write_b128 v8, a[52:55] offset:13312
  ds_write_b128 v8, a[56:59] offset:14336
  ds_write_b128 v8, a[60:63] offset:15360
  v_and_b32 v10, 31, v1
  v_lshlrev_b32 v10, 11, v10
  v_lshrrev_b32 v11, 5, v1
  v_lshl_add_u32 v3, v11, 4, v10
  s_waitcnt lgkmcnt(0)
  s_barrier
  s_lshl_b32 s76, s42, 12
  v_add_u32 v9, s76, v2
  ds_read_b128 v[32:35], v9
  ds_read_b128 v[36:39], v9 offset:1024
  ds_read_b128 v[40:43], v9 offset:2048
  ds_read_b128 v[44:47], v9 offset:3072
  ds_read_b128 v[48:51], v9 offset:16384
  ds_read_b128 v[52:55], v9 offset:17408
  ds_read_b128 v[56:59], v9 offset:18432
  ds_read_b128 v[60:63], v9 offset:19456
  s_waitcnt lgkmcnt(3)
  v_add_f32 v32, v32, v48
  v_add_f32 v33, v33, v49
  v_add_f32 v34, v34, v50
  v_add_f32 v35, v35, v51
  s_waitcnt lgkmcnt(2)
  v_add_f32 v36, v36, v52
  v_add_f32 v37, v37, v53
  v_add_f32 v38, v38, v54
  v_add_f32 v39, v39, v55
  s_waitcnt lgkmcnt(1)
  v_add_f32 v40, v40, v56
  v_add_f32 v41, v41, v57
  v_add_f32 v42, v42, v58
  v_add_f32 v43, v43, v59
  s_waitcnt lgkmcnt(0)
  v_add_f32 v44, v44, v60
  v_add_f32 v45, v45, v61
  v_add_f32 v46, v46, v62
  v_add_f32 v47, v47, v63
  ds_read_b128 v[48:51], v9 offset:32768
  ds_read_b128 v[52:55], v9 offset:33792
  ds_read_b128 v[56:59], v9 offset:34816
  ds_read_b128 v[60:63], v9 offset:35840
  s_waitcnt lgkmcnt(3)
  v_add_f32 v32, v32, v48
  v_add_f32 v33, v33, v49
  v_add_f32 v34, v34, v50
  v_add_f32 v35, v35, v51
  s_waitcnt lgkmcnt(2)
  v_add_f32 v36, v36, v52
  v_add_f32 v37, v37, v53
  v_add_f32 v38, v38, v54
  v_add_f32 v39, v39, v55
  s_waitcnt lgkmcnt(1)
  v_add_f32 v40, v40, v56
  v_add_f32 v41, v41, v57
  v_add_f32 v42, v42, v58
  v_add_f32 v43, v43, v59
  s_waitcnt lgkmcnt(0)
  v_add_f32 v44, v44, v60
  v_add_f32 v45, v45, v61
  v_add_f32 v46, v46, v62
  v_add_f32 v47, v47, v63
  ds_read_b128 v[48:51], v9 offset:49152
  ds_read_b128 v[52:55], v9 offset:50176
  ds_read_b128 v[56:59], v9 offset:51200
  ds_read_b128 v[60:63], v9 offset:52224
  s_waitcnt lgkmcnt(3)
  v_add_f32 v32, v32, v48
  v_add_f32 v33, v33, v49
  v_add_f32 v34, v34, v50
  v_add_f32 v35, v35, v51
  s_waitcnt lgkmcnt(2)
  v_add_f32 v36, v36, v52
  v_add_f32 v37, v37, v53
  v_add_f32 v38, v38, v54
  v_add_f32 v39, v39, v55
  s_waitcnt lgkmcnt(1)
  v_add_f32 v40, v40, v56
  v_add_f32 v41, v41, v57
  v_add_f32 v42, v42, v58
  v_add_f32 v43, v43, v59
  s_waitcnt lgkmcnt(0)
  v_add_f32 v44, v44, v60
  v_add_f32 v45, v45, v61
  v_add_f32 v46, v46, v62
  v_add_f32 v47, v47, v63
  v_cvt_pk_bf16_f32 v64, v32, v33
  v_cvt_pk_bf16_f32 v65, v34, v35
  v_cvt_pk_bf16_f32 v66, v36, v37
  v_cvt_pk_bf16_f32 v67, v38, v39
  v_cvt_pk_bf16_f32 v68, v40, v41
  v_cvt_pk_bf16_f32 v69, v42, v43
  v_cvt_pk_bf16_f32 v70, v44, v45
  v_cvt_pk_bf16_f32 v71, v46, v47
  s_nop 1
  v_permlane32_swap_b32 v64, v66
  v_permlane32_swap_b32 v65, v67
  v_permlane32_swap_b32 v68, v70
  v_permlane32_swap_b32 v69, v71
  s_lshl_b32 s76, s71, 6
  s_and_b32 s77, s42, 1
  s_lshl_b32 s77, s77, 5
  s_add_u32 s76, s76, s77
  s_lshl_b32 s76, s76, 11
  s_lshl_b32 s77, s72, 7
  s_add_u32 s76, s76, s77
  s_lshr_b32 s77, s42, 1
  s_lshl_b32 s77, s77, 6
  s_add_u32 s76, s76, s77
  buffer_store_dwordx4 v[64:67], v3, s[48:51], s76 offen
  buffer_store_dwordx4 v[68:71], v3, s[48:51], s76 offen offset:32
L_b_end:
  s_endpgm
.section .rodata,"a"
.p2align 6
.amdhsa_kernel concat_heads__mha_block__compressed_kv_cla__prompt_kernel
  .amdhsa_next_free_vgpr 512
  .amdhsa_next_free_sgpr 102
  .amdhsa_accum_offset 256
  .amdhsa_group_segment_fixed_size 0
  .amdhsa_kernarg_size 96
  .amdhsa_user_sgpr_count 2
  .amdhsa_user_sgpr_kernarg_segment_ptr 1
  .amdhsa_system_sgpr_workgroup_id_x 1
.end_amdhsa_kernel
```
